```python
import torch

def _softmax(x, axis=-1):
    return torch.softmax(x, dim=axis)

def _gelu(x):
    return torch.nn.functional.gelu(x, approximate='tanh')

def _silu(x):
    return torch.nn.functional.silu(x)

def _sigmoid(x):
    return torch.sigmoid(x)

def _layernorm(x, axis=-1, eps=1e-05):
    m = x.mean(dim=axis, keepdim=True)
    v = x.var(dim=axis, keepdim=True, unbiased=False)
    return (x - m) / torch.sqrt(v + eps)

def _scatter_add(tgt, idx, src, axis=0):
    return tgt.clone().index_add_(axis, idx, src)

def _segment_sum(src, seg, n):
    out = torch.zeros((n,) + src.shape[1:], dtype=src.dtype)
    return out.index_add_(0, seg, src)

def _pad(x, pw):
    flat = tuple((v for pair in reversed(pw) for v in pair))
    return torch.nn.functional.pad(x, flat)
kernel_name = 'gated_mix__linear_attn_block__memory_aug_recurrent_mem_tr__prompt'

def setup_inputs():

    _w = lambda a: (lambda t: t.to(torch.bfloat16) if t.is_floating_point() else t)(torch.as_tensor(a))

    def _A_setup():
        B, S, D = (1, 2048, 448)
        return {'x': _w((lambda *s: torch.randn(*s, dtype=torch.bfloat16) * 0.05)(B, S, D)), 'wqkv': _w((lambda *s: torch.randn(*s, dtype=torch.bfloat16) * 1.6)(D, 3 * D)), 'wo': _w((lambda *s: torch.randn(*s, dtype=torch.bfloat16) * 0.1)(D, D))}
    _A_in = _A_setup()

    def _B_setup():
        B, S, Dm = (1, 2048, 448)
        H, Dh = (16, 256)
        M, seg = (8, 32)
        seg = min(seg, S)
        S = S // seg * seg
        return {'x': _w((lambda *s: torch.randn(*s, dtype=torch.bfloat16) * 0.05)(B, S, Dm)), 'mem0': _w((lambda *s: torch.randn(*s, dtype=torch.bfloat16) * 0.8)(B, M, Dm)), 'Wq': _w((lambda *s: torch.randn(*s, dtype=torch.bfloat16) * 3.2)(Dm, H, Dh) * Dm ** (-0.5)), 'Wk': _w((lambda *s: torch.randn(*s, dtype=torch.bfloat16) * 3.2)(Dm, H, Dh) * Dm ** (-0.5)), 'Wv': _w((lambda *s: torch.randn(*s, dtype=torch.bfloat16) * 0.8)(Dm, H, Dh) * Dm ** (-0.5)), 'Wo': _w((lambda *s: torch.randn(*s, dtype=torch.bfloat16) * 0.8)(H, Dh, Dm) * (H * Dh) ** (-0.5)), 'seg_len': seg}
    _B_in = _B_setup()
    return {'A_x': _A_in['x'], 'A_wqkv': _A_in['wqkv'], 'A_wo': _A_in['wo'], 'B_x': _B_in['x'], 'B_mem0': _B_in['mem0'], 'B_Wq': _B_in['Wq'], 'B_Wk': _B_in['Wk'], 'B_Wv': _B_in['Wv'], 'B_Wo': _B_in['Wo'], 'B_seg_len': _B_in['seg_len'], 'gate_w': _w((lambda *s: torch.randn(*s, dtype=torch.bfloat16) * 0.05)(448) * 16.0)}

def reference(A_x, A_wqkv, A_wo, B_x, B_mem0, B_Wq, B_Wk, B_Wv, B_Wo, B_seg_len, gate_w):

    def _A_ref(x, wqkv, wo):
        B, S, D = x.shape
        H = 16
        Dh = D // H
        qkv = (lambda x, *d: x.permute(*d))((x @ wqkv).reshape(B, S, 3, H, Dh), 2, 0, 3, 1, 4)
        q, k, v = (qkv[0], qkv[1], qkv[2])
        phi = lambda t: torch.where(t > 0, t + 1, torch.exp(t)) + 1e-06
        pq, pk = (phi(q), phi(k))
        kv = torch.einsum('bhsd,bhse->bhde', pk, v)
        z = torch.einsum('bhsd->bhd', pk)
        num = torch.einsum('bhqd,bhde->bhqe', pq, kv)
        den = torch.einsum('bhqd,bhd->bhq', pq, z)[..., None] + 1e-06
        o = num / den
        return (lambda x, *d: x.permute(*d))(o, 0, 2, 1, 3).reshape(B, S, D) @ wo

    def _B_ref(x, mem0, Wq, Wk, Wv, Wo, seg_len):
        B, S, Dm = x.shape
        H, Dh = (Wq.shape[1], Wq.shape[2])
        M = mem0.shape[1]
        scale = Dh ** (-0.5)
        n_seg = S // seg_len
        L = M + seg_len
        idx = torch.arange(L)
        mask = (idx[:, None] < M) | (idx[:, None] >= idx[None, :])
        mem = mem0
        outs = []
        for s in range(n_seg):
            xs = x[:, s * seg_len:(s + 1) * seg_len, :].clone()
            h = torch.concatenate([mem, xs], axis=1)
            q = torch.einsum('btd,dhe->bhte', h, Wq)
            k = torch.einsum('btd,dhe->bhte', h, Wk)
            v = torch.einsum('btd,dhe->bhte', h, Wv)
            scores = torch.einsum('bhqe,bhke->bhqk', q, k) * scale
            scores = torch.where(mask[None, None], scores, -1000000000.0)
            p = _softmax(scores, axis=-1)
            o = torch.einsum('bhqk,bhke->bhqe', p, v)
            o = torch.einsum('bhte,hed->btd', o, Wo)
            mem = o[:, :M, :].clone()
            outs.append(o[:, M:, :])
        return torch.concatenate(outs, axis=1)
    x = A_x
    g = _sigmoid((x * gate_w).sum(-1, keepdims=True))
    a = _A_ref(x, A_wqkv, A_wo)
    b = _B_ref(x, B_mem0, B_Wq, B_Wk, B_Wv, B_Wo, B_seg_len)
    return g * a + (1 - g) * b
```

```asm
; @launch grid=(256,1,1) block=(256,1,1) lds=163840
.amdgcn_target "amdgcn-amd-amdhsa--gfx950"
.text
.globl gated_mix__linear_attn_block__memory_aug_recurrent_mem_tr__prompt_kernel
.p2align 8
.type gated_mix__linear_attn_block__memory_aug_recurrent_mem_tr__prompt_kernel,@function
gated_mix__linear_attn_block__memory_aug_recurrent_mem_tr__prompt_kernel:
    s_cmp_ge_u32 s2, 256
    s_cbranch_scc1 gated_mix__linear_attn_block__memory_aug_recurrent_mem_tr__prompt_kernel_M_end
    s_load_dwordx2 s[4:5], s[0:1], 104
    s_load_dwordx2 s[8:9], s[0:1], 0
    s_load_dwordx2 s[84:85], s[0:1], 96
    s_load_dwordx8 s[68:75], s[0:1], 40
    s_and_b32 s24, s2, 7
    s_lshr_b32 s25, s2, 3
    v_lshrrev_b32 v1, 6, v0
    s_nop 0
    v_readfirstlane_b32 s26, v1
    v_and_b32 v1, 63, v0
    v_lshlrev_b32 v2, 4, v1
    v_lshrrev_b32 v3, 4, v1
    v_and_b32 v4, 15, v1
    s_mov_b32 s6, 0x10000000
    s_mov_b32 s7, 0x20000
    s_mov_b32 s10, 0x1c0000
    s_mov_b32 s11, 0x20000
    s_mov_b32 s86, 0x100
    s_mov_b32 s87, 0x20000
    s_waitcnt lgkmcnt(0)
    s_cmp_lg_u32 s2, 0
    s_cbranch_scc1 gated_mix__linear_attn_block__memory_aug_recurrent_mem_tr__prompt_kernel_M_sw_p
    s_cmp_lg_u32 s26, 0
    s_cbranch_scc1 gated_mix__linear_attn_block__memory_aug_recurrent_mem_tr__prompt_kernel_M_sw_p
    s_getreg_b32 s33, hwreg(HW_REG_XCC_ID)
    s_sub_u32 s33, 3, s33
    s_and_b32 s33, s33, 7
    s_add_u32 s33, s33, 1
    v_mov_b32 v5, s33
    s_mov_b64 exec, 1
    buffer_store_dword v5, off, s[84:87], 0 offset:40 sc1
    s_mov_b64 exec, -1
gated_mix__linear_attn_block__memory_aug_recurrent_mem_tr__prompt_kernel_M_sw_p:
    s_cmp_lg_u32 s2, 248
    s_cbranch_scc1 gated_mix__linear_attn_block__memory_aug_recurrent_mem_tr__prompt_kernel_M_nocl
    v_mov_b32 v8, 0
    v_mov_b32 v9, 0
    v_mov_b32 v10, 0
    v_mov_b32 v11, 0
    v_lshlrev_b32 v5, 4, v0
    s_mov_b32 s33, 0x3aa0000
    buffer_store_dwordx4 v[8:11], v5, s[4:7], s33 offen sc1
    s_waitcnt vmcnt(0)
    s_barrier
    v_mov_b32 v8, 1
    s_mov_b64 exec, 1
    s_cmp_lg_u32 s26, 0
    s_cbranch_scc1 gated_mix__linear_attn_block__memory_aug_recurrent_mem_tr__prompt_kernel_M_cl2
    buffer_store_dword v8, off, s[84:87], 0 offset:36 sc1
gated_mix__linear_attn_block__memory_aug_recurrent_mem_tr__prompt_kernel_M_cl2:
    s_mov_b64 exec, -1
gated_mix__linear_attn_block__memory_aug_recurrent_mem_tr__prompt_kernel_M_nocl:
    s_lshr_b32 s34, s25, 3
    s_lshl_b32 s34, s34, 3
    s_add_u32 s34, s34, s24
    s_and_b32 s58, s25, 1
    s_bfe_u32 s35, s25, 0x20001
    v_and_b32 v2, 63, v0
    v_lshlrev_b32 v3, 4, v0
    v_lshlrev_b32 v4, 4, v2
    v_lshrrev_b32 v5, 4, v2
    v_and_b32 v6, 15, v2
    s_and_b32 s36, s34, 15
    s_lshl_b32 s37, s36, 9
    v_lshrrev_b32 v8, 3, v2
    v_and_b32 v9, 7, v2
    v_or_b32 v10, 0, v5
    v_xor_b32 v10, v10, v9
    v_lshlrev_b32 v10, 4, v10
    v_bfe_u32 v11, v8, 1, 1
    v_lshlrev_b32 v11, 3, v11
    v_bfe_u32 v12, v8, 2, 1
    v_lshl_add_u32 v11, v12, 2, v11
    v_and_b32 v13, 1, v8
    v_add_u32 v11, v11, v13
    v_add_u32 v11, 0, v11
    v_lshl_add_u32 v16, v11, 13, v10
    v_lshlrev_b32 v11, 3, v12
    v_and_b32 v13, 3, v8
    v_add_u32 v11, v11, v13
    v_add_u32 v11, 0, v11
    v_lshl_add_u32 v18, v11, 13, v10
    v_or_b32 v10, 4, v5
    v_xor_b32 v10, v10, v9
    v_lshlrev_b32 v10, 4, v10
    v_bfe_u32 v11, v8, 1, 1
    v_lshlrev_b32 v11, 3, v11
    v_bfe_u32 v12, v8, 2, 1
    v_lshl_add_u32 v11, v12, 2, v11
    v_and_b32 v13, 1, v8
    v_add_u32 v11, v11, v13
    v_add_u32 v11, 16, v11
    v_lshl_add_u32 v17, v11, 13, v10
    v_lshlrev_b32 v11, 3, v12
    v_and_b32 v13, 3, v8
    v_add_u32 v11, v11, v13
    v_add_u32 v11, 16, v11
    v_lshl_add_u32 v19, v11, 13, v10
    v_lshrrev_b32 v10, 1, v6
    v_xor_b32 v10, v10, v5
    v_lshlrev_b32 v11, 7, v6
    v_lshl_add_u32 v22, v10, 4, v11
    v_xor_b32 v23, 64, v22
    s_lshl_b32 s48, s26, 13
    v_add_u32 v20, s48, v22
    v_add_u32 v21, s48, v23
    v_add_u32 v22, 32768, v22
    v_add_u32 v23, 32768, v23
    s_lshl_b32 s49, s26, 12
    s_add_u32 s49, s49, 32768
    s_mul_i32 s58, s58, 7
    s_add_u32 s38, s26, 0
    s_min_u32 s38, s38, 6
    s_add_u32 s38, s38, s58
    s_lshl_b32 s40, s38, 18
    s_add_u32 s40, s40, s37
    s_add_u32 s41, s40, 16384
    s_add_u32 s38, s26, 4
    s_min_u32 s38, s38, 6
    s_add_u32 s38, s38, s58
    s_lshl_b32 s42, s38, 18
    s_add_u32 s42, s42, s37
    s_add_u32 s43, s42, 16384
    s_mul_i32 s39, s34, 28
    s_lshl_b32 s38, s35, 3
    s_add_u32 s39, s39, s38
    s_mul_i32 s39, s39, 14336
    s_cmp_ge_u32 s34, 16
    s_cbranch_scc1 gated_mix__linear_attn_block__memory_aug_recurrent_mem_tr__prompt_kernel_K1_bmat
    s_mov_b64 s[12:13], s[68:69]
    s_mov_b64 s[16:17], s[70:71]
    s_mov_b32 s14, 0x380000
    s_mov_b32 s15, 0x20000
    s_mov_b32 s18, 0x380000
    s_mov_b32 s19, 0x20000
    s_lshl_b32 s54, s35, 20
    s_add_u32 s54, s54, s37
    s_lshl_b32 s55, s26, 18
    s_add_u32 s54, s54, s55
    s_mov_b32 s52, 0x3db8aa3b
    s_mov_b32 s53, 0x3db8aa3b
    s_add_u32 s51, s54, 0
    s_add_u32 m0, s49, 0
    s_nop 0
    buffer_load_dwordx4 v18, s[16:19], s51 offen nt lds
    s_add_u32 s51, s54, 0
    s_add_u32 m0, s49, 1024
    s_nop 0
    buffer_load_dwordx4 v19, s[16:19], s51 offen nt lds
    s_add_u32 s51, s54, 32768
    s_add_u32 m0, s49, 2048
    s_nop 0
    buffer_load_dwordx4 v18, s[16:19], s51 offen nt lds
    s_add_u32 s51, s54, 32768
    s_add_u32 m0, s49, 3072
    s_nop 0
    buffer_load_dwordx4 v19, s[16:19], s51 offen nt lds
    s_add_u32 s51, s40, 0
    s_add_u32 m0, s48, 0
    s_nop 0
    buffer_load_dwordx4 v16, s[12:15], s51 offen nt lds
    s_add_u32 s51, s40, 0
    s_add_u32 m0, s48, 1024
    s_nop 0
    buffer_load_dwordx4 v17, s[12:15], s51 offen nt lds
    s_add_u32 s51, s41, 0
    s_add_u32 m0, s48, 2048
    s_nop 0
    buffer_load_dwordx4 v16, s[12:15], s51 offen nt lds
    s_add_u32 s51, s41, 0
    s_add_u32 m0, s48, 3072
    s_nop 0
    buffer_load_dwordx4 v17, s[12:15], s51 offen nt lds
    s_add_u32 s51, s42, 0
    s_add_u32 m0, s48, 4096
    s_nop 0
    buffer_load_dwordx4 v16, s[12:15], s51 offen nt lds
    s_add_u32 s51, s42, 0
    s_add_u32 m0, s48, 5120
    s_nop 0
    buffer_load_dwordx4 v17, s[12:15], s51 offen nt lds
    s_add_u32 s51, s43, 0
    s_add_u32 m0, s48, 6144
    s_nop 0
    buffer_load_dwordx4 v16, s[12:15], s51 offen nt lds
    s_add_u32 s51, s43, 0
    s_add_u32 m0, s48, 7168
    s_nop 0
    buffer_load_dwordx4 v17, s[12:15], s51 offen nt lds
    s_add_u32 s51, s54, 128
    s_add_u32 m0, s49, 49152
    s_nop 0
    buffer_load_dwordx4 v18, s[16:19], s51 offen nt lds
    s_add_u32 s51, s54, 128
    s_add_u32 m0, s49, 50176
    s_nop 0
    buffer_load_dwordx4 v19, s[16:19], s51 offen nt lds
    s_add_u32 s51, s54, 32896
    s_add_u32 m0, s49, 51200
    s_nop 0
    buffer_load_dwordx4 v18, s[16:19], s51 offen nt lds
    s_add_u32 s51, s54, 32896
    s_add_u32 m0, s49, 52224
    s_nop 0
    buffer_load_dwordx4 v19, s[16:19], s51 offen nt lds
    s_add_u32 s51, s40, 128
    s_add_u32 m0, s48, 49152
    s_nop 0
    buffer_load_dwordx4 v16, s[12:15], s51 offen nt lds
    s_add_u32 s51, s40, 128
    s_add_u32 m0, s48, 50176
    s_nop 0
    buffer_load_dwordx4 v17, s[12:15], s51 offen nt lds
    s_add_u32 s51, s41, 128
    s_add_u32 m0, s48, 51200
    s_nop 0
    buffer_load_dwordx4 v16, s[12:15], s51 offen nt lds
    s_add_u32 s51, s41, 128
    s_add_u32 m0, s48, 52224
    s_nop 0
    buffer_load_dwordx4 v17, s[12:15], s51 offen nt lds
    s_add_u32 s51, s42, 128
    s_add_u32 m0, s48, 53248
    s_nop 0
    buffer_load_dwordx4 v16, s[12:15], s51 offen nt lds
    s_add_u32 s51, s42, 128
    s_add_u32 m0, s48, 54272
    s_nop 0
    buffer_load_dwordx4 v17, s[12:15], s51 offen nt lds
    s_add_u32 s51, s43, 128
    s_add_u32 m0, s48, 55296
    s_nop 0
    buffer_load_dwordx4 v16, s[12:15], s51 offen nt lds
    s_add_u32 s51, s43, 128
    s_add_u32 m0, s48, 56320
    s_nop 0
    buffer_load_dwordx4 v17, s[12:15], s51 offen nt lds
    s_add_u32 s51, s54, 256
    s_add_u32 m0, s49, 98304
    s_nop 0
    buffer_load_dwordx4 v18, s[16:19], s51 offen nt lds
    s_add_u32 s51, s54, 256
    s_add_u32 m0, s49, 99328
    s_nop 0
    buffer_load_dwordx4 v19, s[16:19], s51 offen nt lds
    s_add_u32 s51, s54, 33024
    s_add_u32 m0, s49, 100352
    s_nop 0
    buffer_load_dwordx4 v18, s[16:19], s51 offen nt lds
    s_add_u32 s51, s54, 33024
    s_add_u32 m0, s49, 101376
    s_nop 0
    buffer_load_dwordx4 v19, s[16:19], s51 offen nt lds
    s_add_u32 s51, s40, 256
    s_add_u32 m0, s48, 98304
    s_nop 0
    buffer_load_dwordx4 v16, s[12:15], s51 offen nt lds
    s_add_u32 s51, s40, 256
    s_add_u32 m0, s48, 99328
    s_nop 0
    buffer_load_dwordx4 v17, s[12:15], s51 offen nt lds
    s_add_u32 s51, s41, 256
    s_add_u32 m0, s48, 100352
    s_nop 0
    buffer_load_dwordx4 v16, s[12:15], s51 offen nt lds
    s_add_u32 s51, s41, 256
    s_add_u32 m0, s48, 101376
    s_nop 0
    buffer_load_dwordx4 v17, s[12:15], s51 offen nt lds
    s_add_u32 s51, s42, 256
    s_add_u32 m0, s48, 102400
    s_nop 0
    buffer_load_dwordx4 v16, s[12:15], s51 offen nt lds
    s_add_u32 s51, s42, 256
    s_add_u32 m0, s48, 103424
    s_nop 0
    buffer_load_dwordx4 v17, s[12:15], s51 offen nt lds
    s_add_u32 s51, s43, 256
    s_add_u32 m0, s48, 104448
    s_nop 0
    buffer_load_dwordx4 v16, s[12:15], s51 offen nt lds
    s_add_u32 s51, s43, 256
    s_add_u32 m0, s48, 105472
    s_nop 0
    buffer_load_dwordx4 v17, s[12:15], s51 offen nt lds
    s_waitcnt vmcnt(24)
    s_barrier
    ds_read_b128 v[128:131], v22 offset:0
    ds_read_b128 v[136:139], v22 offset:2048
    ds_read_b128 v[144:147], v22 offset:4096
    ds_read_b128 v[152:155], v22 offset:6144
    ds_read_b128 v[160:163], v22 offset:8192
    ds_read_b128 v[168:171], v22 offset:10240
    ds_read_b128 v[176:179], v22 offset:12288
    ds_read_b128 v[184:187], v22 offset:14336
    ds_read_b128 v[64:67], v20 offset:0
    ds_read_b128 v[68:71], v20 offset:2048
    ds_read_b128 v[72:75], v20 offset:4096
    ds_read_b128 v[76:79], v20 offset:6144
    ds_read_b128 v[132:135], v23 offset:0
    ds_read_b128 v[140:143], v23 offset:2048
    ds_read_b128 v[148:151], v23 offset:4096
    ds_read_b128 v[156:159], v23 offset:6144
    ds_read_b128 v[164:167], v23 offset:8192
    ds_read_b128 v[172:175], v23 offset:10240
    ds_read_b128 v[180:183], v23 offset:12288
    ds_read_b128 v[188:191], v23 offset:14336
    ds_read_b128 v[80:83], v21 offset:0
    ds_read_b128 v[84:87], v21 offset:2048
    ds_read_b128 v[88:91], v21 offset:4096
    ds_read_b128 v[92:95], v21 offset:6144
    s_waitcnt lgkmcnt(15)
    v_mfma_f32_16x16x32_bf16 a[0:3], v[64:67], v[128:131], 0
    v_mfma_f32_16x16x32_bf16 a[4:7], v[64:67], v[136:139], 0
    v_mfma_f32_16x16x32_bf16 a[8:11], v[64:67], v[144:147], 0
    v_mfma_f32_16x16x32_bf16 a[12:15], v[64:67], v[152:155], 0
    v_mfma_f32_16x16x32_bf16 a[16:19], v[64:67], v[160:163], 0
    v_mfma_f32_16x16x32_bf16 a[20:23], v[64:67], v[168:171], 0
    v_mfma_f32_16x16x32_bf16 a[24:27], v[64:67], v[176:179], 0
    v_mfma_f32_16x16x32_bf16 a[28:31], v[64:67], v[184:187], 0
    s_waitcnt lgkmcnt(14)
    v_mfma_f32_16x16x32_bf16 a[32:35], v[68:71], v[128:131], 0
    v_mfma_f32_16x16x32_bf16 a[36:39], v[68:71], v[136:139], 0
    v_mfma_f32_16x16x32_bf16 a[40:43], v[68:71], v[144:147], 0
    v_mfma_f32_16x16x32_bf16 a[44:47], v[68:71], v[152:155], 0
    v_mfma_f32_16x16x32_bf16 a[48:51], v[68:71], v[160:163], 0
    v_mfma_f32_16x16x32_bf16 a[52:55], v[68:71], v[168:171], 0
    v_mfma_f32_16x16x32_bf16 a[56:59], v[68:71], v[176:179], 0
    v_mfma_f32_16x16x32_bf16 a[60:63], v[68:71], v[184:187], 0
    s_waitcnt lgkmcnt(13)
    v_mfma_f32_16x16x32_bf16 a[64:67], v[72:75], v[128:131], 0
    v_mfma_f32_16x16x32_bf16 a[68:71], v[72:75], v[136:139], 0
    v_mfma_f32_16x16x32_bf16 a[72:75], v[72:75], v[144:147], 0
    v_mfma_f32_16x16x32_bf16 a[76:79], v[72:75], v[152:155], 0
    v_mfma_f32_16x16x32_bf16 a[80:83], v[72:75], v[160:163], 0
    v_mfma_f32_16x16x32_bf16 a[84:87], v[72:75], v[168:171], 0
    v_mfma_f32_16x16x32_bf16 a[88:91], v[72:75], v[176:179], 0
    v_mfma_f32_16x16x32_bf16 a[92:95], v[72:75], v[184:187], 0
    s_waitcnt lgkmcnt(12)
    v_mfma_f32_16x16x32_bf16 a[96:99], v[76:79], v[128:131], 0
    v_mfma_f32_16x16x32_bf16 a[100:103], v[76:79], v[136:139], 0
    v_mfma_f32_16x16x32_bf16 a[104:107], v[76:79], v[144:147], 0
    v_mfma_f32_16x16x32_bf16 a[108:111], v[76:79], v[152:155], 0
    v_mfma_f32_16x16x32_bf16 a[112:115], v[76:79], v[160:163], 0
    v_mfma_f32_16x16x32_bf16 a[116:119], v[76:79], v[168:171], 0
    v_mfma_f32_16x16x32_bf16 a[120:123], v[76:79], v[176:179], 0
    v_mfma_f32_16x16x32_bf16 a[124:127], v[76:79], v[184:187], 0
    s_waitcnt lgkmcnt(3)
    v_mfma_f32_16x16x32_bf16 a[0:3], v[80:83], v[132:135], a[0:3]
    v_mfma_f32_16x16x32_bf16 a[4:7], v[80:83], v[140:143], a[4:7]
    v_mfma_f32_16x16x32_bf16 a[8:11], v[80:83], v[148:151], a[8:11]
    v_mfma_f32_16x16x32_bf16 a[12:15], v[80:83], v[156:159], a[12:15]
    v_mfma_f32_16x16x32_bf16 a[16:19], v[80:83], v[164:167], a[16:19]
    v_mfma_f32_16x16x32_bf16 a[20:23], v[80:83], v[172:175], a[20:23]
    v_mfma_f32_16x16x32_bf16 a[24:27], v[80:83], v[180:183], a[24:27]
    v_mfma_f32_16x16x32_bf16 a[28:31], v[80:83], v[188:191], a[28:31]
    s_waitcnt lgkmcnt(2)
    v_mfma_f32_16x16x32_bf16 a[32:35], v[84:87], v[132:135], a[32:35]
    v_mfma_f32_16x16x32_bf16 a[36:39], v[84:87], v[140:143], a[36:39]
    v_mfma_f32_16x16x32_bf16 a[40:43], v[84:87], v[148:151], a[40:43]
    v_mfma_f32_16x16x32_bf16 a[44:47], v[84:87], v[156:159], a[44:47]
    v_mfma_f32_16x16x32_bf16 a[48:51], v[84:87], v[164:167], a[48:51]
    v_mfma_f32_16x16x32_bf16 a[52:55], v[84:87], v[172:175], a[52:55]
    v_mfma_f32_16x16x32_bf16 a[56:59], v[84:87], v[180:183], a[56:59]
    v_mfma_f32_16x16x32_bf16 a[60:63], v[84:87], v[188:191], a[60:63]
    s_waitcnt lgkmcnt(1)
    v_mfma_f32_16x16x32_bf16 a[64:67], v[88:91], v[132:135], a[64:67]
    v_mfma_f32_16x16x32_bf16 a[68:71], v[88:91], v[140:143], a[68:71]
    v_mfma_f32_16x16x32_bf16 a[72:75], v[88:91], v[148:151], a[72:75]
    v_mfma_f32_16x16x32_bf16 a[76:79], v[88:91], v[156:159], a[76:79]
    v_mfma_f32_16x16x32_bf16 a[80:83], v[88:91], v[164:167], a[80:83]
    v_mfma_f32_16x16x32_bf16 a[84:87], v[88:91], v[172:175], a[84:87]
    v_mfma_f32_16x16x32_bf16 a[88:91], v[88:91], v[180:183], a[88:91]
    v_mfma_f32_16x16x32_bf16 a[92:95], v[88:91], v[188:191], a[92:95]
    s_waitcnt lgkmcnt(0)
    v_mfma_f32_16x16x32_bf16 a[96:99], v[92:95], v[132:135], a[96:99]
    v_mfma_f32_16x16x32_bf16 a[100:103], v[92:95], v[140:143], a[100:103]
    v_mfma_f32_16x16x32_bf16 a[104:107], v[92:95], v[148:151], a[104:107]
    v_mfma_f32_16x16x32_bf16 a[108:111], v[92:95], v[156:159], a[108:111]
    v_mfma_f32_16x16x32_bf16 a[112:115], v[92:95], v[164:167], a[112:115]
    v_mfma_f32_16x16x32_bf16 a[116:119], v[92:95], v[172:175], a[116:119]
    v_mfma_f32_16x16x32_bf16 a[120:123], v[92:95], v[180:183], a[120:123]
    v_mfma_f32_16x16x32_bf16 a[124:127], v[92:95], v[188:191], a[124:127]
    v_add_u32 v20, 49152, v20
    v_add_u32 v21, 49152, v21
    v_add_u32 v22, 49152, v22
    v_add_u32 v23, 49152, v23
    s_waitcnt vmcnt(12)
    s_barrier
    s_add_u32 s51, s54, 384
    s_add_u32 m0, s49, 0
    s_nop 0
    buffer_load_dwordx4 v18, s[16:19], s51 offen nt lds
    s_add_u32 s51, s54, 384
    s_add_u32 m0, s49, 1024
    s_nop 0
    buffer_load_dwordx4 v19, s[16:19], s51 offen nt lds
    s_add_u32 s51, s54, 33152
    s_add_u32 m0, s49, 2048
    s_nop 0
    buffer_load_dwordx4 v18, s[16:19], s51 offen nt lds
    s_add_u32 s51, s54, 33152
    s_add_u32 m0, s49, 3072
    s_nop 0
    buffer_load_dwordx4 v19, s[16:19], s51 offen nt lds
    s_add_u32 s51, s40, 384
    s_add_u32 m0, s48, 0
    s_nop 0
    buffer_load_dwordx4 v16, s[12:15], s51 offen nt lds
    s_add_u32 s51, s40, 384
    s_add_u32 m0, s48, 1024
    s_nop 0
    buffer_load_dwordx4 v17, s[12:15], s51 offen nt lds
    s_add_u32 s51, s41, 384
    s_add_u32 m0, s48, 2048
    s_nop 0
    buffer_load_dwordx4 v16, s[12:15], s51 offen nt lds
    s_add_u32 s51, s41, 384
    s_add_u32 m0, s48, 3072
    s_nop 0
    buffer_load_dwordx4 v17, s[12:15], s51 offen nt lds
    s_add_u32 s51, s42, 384
    s_add_u32 m0, s48, 4096
    s_nop 0
    buffer_load_dwordx4 v16, s[12:15], s51 offen nt lds
    s_add_u32 s51, s42, 384
    s_add_u32 m0, s48, 5120
    s_nop 0
    buffer_load_dwordx4 v17, s[12:15], s51 offen nt lds
    s_add_u32 s51, s43, 384
    s_add_u32 m0, s48, 6144
    s_nop 0
    buffer_load_dwordx4 v16, s[12:15], s51 offen nt lds
    s_add_u32 s51, s43, 384
    s_add_u32 m0, s48, 7168
    s_nop 0
    buffer_load_dwordx4 v17, s[12:15], s51 offen nt lds
    ds_read_b128 v[128:131], v22 offset:0
    ds_read_b128 v[136:139], v22 offset:2048
    ds_read_b128 v[144:147], v22 offset:4096
    ds_read_b128 v[152:155], v22 offset:6144
    ds_read_b128 v[160:163], v22 offset:8192
    ds_read_b128 v[168:171], v22 offset:10240
    ds_read_b128 v[176:179], v22 offset:12288
    ds_read_b128 v[184:187], v22 offset:14336
    ds_read_b128 v[64:67], v20 offset:0
    ds_read_b128 v[68:71], v20 offset:2048
    ds_read_b128 v[72:75], v20 offset:4096
    ds_read_b128 v[76:79], v20 offset:6144
    ds_read_b128 v[132:135], v23 offset:0
    ds_read_b128 v[140:143], v23 offset:2048
    ds_read_b128 v[148:151], v23 offset:4096
    ds_read_b128 v[156:159], v23 offset:6144
    ds_read_b128 v[164:167], v23 offset:8192
    ds_read_b128 v[172:175], v23 offset:10240
    ds_read_b128 v[180:183], v23 offset:12288
    ds_read_b128 v[188:191], v23 offset:14336
    ds_read_b128 v[80:83], v21 offset:0
    ds_read_b128 v[84:87], v21 offset:2048
    ds_read_b128 v[88:91], v21 offset:4096
    ds_read_b128 v[92:95], v21 offset:6144
    s_waitcnt lgkmcnt(15)
    v_mfma_f32_16x16x32_bf16 a[0:3], v[64:67], v[128:131], a[0:3]
    v_mfma_f32_16x16x32_bf16 a[4:7], v[64:67], v[136:139], a[4:7]
    v_mfma_f32_16x16x32_bf16 a[8:11], v[64:67], v[144:147], a[8:11]
    v_mfma_f32_16x16x32_bf16 a[12:15], v[64:67], v[152:155], a[12:15]
    v_mfma_f32_16x16x32_bf16 a[16:19], v[64:67], v[160:163], a[16:19]
    v_mfma_f32_16x16x32_bf16 a[20:23], v[64:67], v[168:171], a[20:23]
    v_mfma_f32_16x16x32_bf16 a[24:27], v[64:67], v[176:179], a[24:27]
    v_mfma_f32_16x16x32_bf16 a[28:31], v[64:67], v[184:187], a[28:31]
    s_waitcnt lgkmcnt(14)
    v_mfma_f32_16x16x32_bf16 a[32:35], v[68:71], v[128:131], a[32:35]
    v_mfma_f32_16x16x32_bf16 a[36:39], v[68:71], v[136:139], a[36:39]
    v_mfma_f32_16x16x32_bf16 a[40:43], v[68:71], v[144:147], a[40:43]
    v_mfma_f32_16x16x32_bf16 a[44:47], v[68:71], v[152:155], a[44:47]
    v_mfma_f32_16x16x32_bf16 a[48:51], v[68:71], v[160:163], a[48:51]
    v_mfma_f32_16x16x32_bf16 a[52:55], v[68:71], v[168:171], a[52:55]
    v_mfma_f32_16x16x32_bf16 a[56:59], v[68:71], v[176:179], a[56:59]
    v_mfma_f32_16x16x32_bf16 a[60:63], v[68:71], v[184:187], a[60:63]
    s_waitcnt lgkmcnt(13)
    v_mfma_f32_16x16x32_bf16 a[64:67], v[72:75], v[128:131], a[64:67]
    v_mfma_f32_16x16x32_bf16 a[68:71], v[72:75], v[136:139], a[68:71]
    v_mfma_f32_16x16x32_bf16 a[72:75], v[72:75], v[144:147], a[72:75]
    v_mfma_f32_16x16x32_bf16 a[76:79], v[72:75], v[152:155], a[76:79]
    v_mfma_f32_16x16x32_bf16 a[80:83], v[72:75], v[160:163], a[80:83]
    v_mfma_f32_16x16x32_bf16 a[84:87], v[72:75], v[168:171], a[84:87]
    v_mfma_f32_16x16x32_bf16 a[88:91], v[72:75], v[176:179], a[88:91]
    v_mfma_f32_16x16x32_bf16 a[92:95], v[72:75], v[184:187], a[92:95]
    s_waitcnt lgkmcnt(12)
    v_mfma_f32_16x16x32_bf16 a[96:99], v[76:79], v[128:131], a[96:99]
    v_mfma_f32_16x16x32_bf16 a[100:103], v[76:79], v[136:139], a[100:103]
    v_mfma_f32_16x16x32_bf16 a[104:107], v[76:79], v[144:147], a[104:107]
    v_mfma_f32_16x16x32_bf16 a[108:111], v[76:79], v[152:155], a[108:111]
    v_mfma_f32_16x16x32_bf16 a[112:115], v[76:79], v[160:163], a[112:115]
    v_mfma_f32_16x16x32_bf16 a[116:119], v[76:79], v[168:171], a[116:119]
    v_mfma_f32_16x16x32_bf16 a[120:123], v[76:79], v[176:179], a[120:123]
    v_mfma_f32_16x16x32_bf16 a[124:127], v[76:79], v[184:187], a[124:127]
    s_waitcnt lgkmcnt(3)
    v_mfma_f32_16x16x32_bf16 a[0:3], v[80:83], v[132:135], a[0:3]
    v_mfma_f32_16x16x32_bf16 a[4:7], v[80:83], v[140:143], a[4:7]
    v_mfma_f32_16x16x32_bf16 a[8:11], v[80:83], v[148:151], a[8:11]
    v_mfma_f32_16x16x32_bf16 a[12:15], v[80:83], v[156:159], a[12:15]
    v_mfma_f32_16x16x32_bf16 a[16:19], v[80:83], v[164:167], a[16:19]
    v_mfma_f32_16x16x32_bf16 a[20:23], v[80:83], v[172:175], a[20:23]
    v_mfma_f32_16x16x32_bf16 a[24:27], v[80:83], v[180:183], a[24:27]
    v_mfma_f32_16x16x32_bf16 a[28:31], v[80:83], v[188:191], a[28:31]
    s_waitcnt lgkmcnt(2)
    v_mfma_f32_16x16x32_bf16 a[32:35], v[84:87], v[132:135], a[32:35]
    v_mfma_f32_16x16x32_bf16 a[36:39], v[84:87], v[140:143], a[36:39]
    v_mfma_f32_16x16x32_bf16 a[40:43], v[84:87], v[148:151], a[40:43]
    v_mfma_f32_16x16x32_bf16 a[44:47], v[84:87], v[156:159], a[44:47]
    v_mfma_f32_16x16x32_bf16 a[48:51], v[84:87], v[164:167], a[48:51]
    v_mfma_f32_16x16x32_bf16 a[52:55], v[84:87], v[172:175], a[52:55]
    v_mfma_f32_16x16x32_bf16 a[56:59], v[84:87], v[180:183], a[56:59]
    v_mfma_f32_16x16x32_bf16 a[60:63], v[84:87], v[188:191], a[60:63]
    s_waitcnt lgkmcnt(1)
    v_mfma_f32_16x16x32_bf16 a[64:67], v[88:91], v[132:135], a[64:67]
    v_mfma_f32_16x16x32_bf16 a[68:71], v[88:91], v[140:143], a[68:71]
    v_mfma_f32_16x16x32_bf16 a[72:75], v[88:91], v[148:151], a[72:75]
    v_mfma_f32_16x16x32_bf16 a[76:79], v[88:91], v[156:159], a[76:79]
    v_mfma_f32_16x16x32_bf16 a[80:83], v[88:91], v[164:167], a[80:83]
    v_mfma_f32_16x16x32_bf16 a[84:87], v[88:91], v[172:175], a[84:87]
    v_mfma_f32_16x16x32_bf16 a[88:91], v[88:91], v[180:183], a[88:91]
    v_mfma_f32_16x16x32_bf16 a[92:95], v[88:91], v[188:191], a[92:95]
    s_waitcnt lgkmcnt(0)
    v_mfma_f32_16x16x32_bf16 a[96:99], v[92:95], v[132:135], a[96:99]
    v_mfma_f32_16x16x32_bf16 a[100:103], v[92:95], v[140:143], a[100:103]
    v_mfma_f32_16x16x32_bf16 a[104:107], v[92:95], v[148:151], a[104:107]
    v_mfma_f32_16x16x32_bf16 a[108:111], v[92:95], v[156:159], a[108:111]
    v_mfma_f32_16x16x32_bf16 a[112:115], v[92:95], v[164:167], a[112:115]
    v_mfma_f32_16x16x32_bf16 a[116:119], v[92:95], v[172:175], a[116:119]
    v_mfma_f32_16x16x32_bf16 a[120:123], v[92:95], v[180:183], a[120:123]
    v_mfma_f32_16x16x32_bf16 a[124:127], v[92:95], v[188:191], a[124:127]
    v_add_u32 v20, 49152, v20
    v_add_u32 v21, 49152, v21
    v_add_u32 v22, 49152, v22
    v_add_u32 v23, 49152, v23
    s_waitcnt vmcnt(12)
    s_barrier
    ds_read_b128 v[128:131], v22 offset:0
    ds_read_b128 v[136:139], v22 offset:2048
    ds_read_b128 v[144:147], v22 offset:4096
    ds_read_b128 v[152:155], v22 offset:6144
    ds_read_b128 v[160:163], v22 offset:8192
    ds_read_b128 v[168:171], v22 offset:10240
    ds_read_b128 v[176:179], v22 offset:12288
    ds_read_b128 v[184:187], v22 offset:14336
    ds_read_b128 v[64:67], v20 offset:0
    ds_read_b128 v[68:71], v20 offset:2048
    ds_read_b128 v[72:75], v20 offset:4096
    ds_read_b128 v[76:79], v20 offset:6144
    ds_read_b128 v[132:135], v23 offset:0
    ds_read_b128 v[140:143], v23 offset:2048
    ds_read_b128 v[148:151], v23 offset:4096
    ds_read_b128 v[156:159], v23 offset:6144
    ds_read_b128 v[164:167], v23 offset:8192
    ds_read_b128 v[172:175], v23 offset:10240
    ds_read_b128 v[180:183], v23 offset:12288
    ds_read_b128 v[188:191], v23 offset:14336
    ds_read_b128 v[80:83], v21 offset:0
    ds_read_b128 v[84:87], v21 offset:2048
    ds_read_b128 v[88:91], v21 offset:4096
    ds_read_b128 v[92:95], v21 offset:6144
    s_waitcnt lgkmcnt(15)
    v_mfma_f32_16x16x32_bf16 a[0:3], v[64:67], v[128:131], a[0:3]
    v_mfma_f32_16x16x32_bf16 a[4:7], v[64:67], v[136:139], a[4:7]
    v_mfma_f32_16x16x32_bf16 a[8:11], v[64:67], v[144:147], a[8:11]
    v_mfma_f32_16x16x32_bf16 a[12:15], v[64:67], v[152:155], a[12:15]
    v_mfma_f32_16x16x32_bf16 a[16:19], v[64:67], v[160:163], a[16:19]
    v_mfma_f32_16x16x32_bf16 a[20:23], v[64:67], v[168:171], a[20:23]
    v_mfma_f32_16x16x32_bf16 a[24:27], v[64:67], v[176:179], a[24:27]
    v_mfma_f32_16x16x32_bf16 a[28:31], v[64:67], v[184:187], a[28:31]
    s_waitcnt lgkmcnt(14)
    v_mfma_f32_16x16x32_bf16 a[32:35], v[68:71], v[128:131], a[32:35]
    v_mfma_f32_16x16x32_bf16 a[36:39], v[68:71], v[136:139], a[36:39]
    v_mfma_f32_16x16x32_bf16 a[40:43], v[68:71], v[144:147], a[40:43]
    v_mfma_f32_16x16x32_bf16 a[44:47], v[68:71], v[152:155], a[44:47]
    v_mfma_f32_16x16x32_bf16 a[48:51], v[68:71], v[160:163], a[48:51]
    v_mfma_f32_16x16x32_bf16 a[52:55], v[68:71], v[168:171], a[52:55]
    v_mfma_f32_16x16x32_bf16 a[56:59], v[68:71], v[176:179], a[56:59]
    v_mfma_f32_16x16x32_bf16 a[60:63], v[68:71], v[184:187], a[60:63]
    s_waitcnt lgkmcnt(13)
    v_mfma_f32_16x16x32_bf16 a[64:67], v[72:75], v[128:131], a[64:67]
    v_mfma_f32_16x16x32_bf16 a[68:71], v[72:75], v[136:139], a[68:71]
    v_mfma_f32_16x16x32_bf16 a[72:75], v[72:75], v[144:147], a[72:75]
    v_mfma_f32_16x16x32_bf16 a[76:79], v[72:75], v[152:155], a[76:79]
    v_mfma_f32_16x16x32_bf16 a[80:83], v[72:75], v[160:163], a[80:83]
    v_mfma_f32_16x16x32_bf16 a[84:87], v[72:75], v[168:171], a[84:87]
    v_mfma_f32_16x16x32_bf16 a[88:91], v[72:75], v[176:179], a[88:91]
    v_mfma_f32_16x16x32_bf16 a[92:95], v[72:75], v[184:187], a[92:95]
    s_waitcnt lgkmcnt(12)
    v_mfma_f32_16x16x32_bf16 a[96:99], v[76:79], v[128:131], a[96:99]
    v_mfma_f32_16x16x32_bf16 a[100:103], v[76:79], v[136:139], a[100:103]
    v_mfma_f32_16x16x32_bf16 a[104:107], v[76:79], v[144:147], a[104:107]
    v_mfma_f32_16x16x32_bf16 a[108:111], v[76:79], v[152:155], a[108:111]
    v_mfma_f32_16x16x32_bf16 a[112:115], v[76:79], v[160:163], a[112:115]
    v_mfma_f32_16x16x32_bf16 a[116:119], v[76:79], v[168:171], a[116:119]
    v_mfma_f32_16x16x32_bf16 a[120:123], v[76:79], v[176:179], a[120:123]
    v_mfma_f32_16x16x32_bf16 a[124:127], v[76:79], v[184:187], a[124:127]
    s_waitcnt lgkmcnt(3)
    v_mfma_f32_16x16x32_bf16 a[0:3], v[80:83], v[132:135], a[0:3]
    v_mfma_f32_16x16x32_bf16 a[4:7], v[80:83], v[140:143], a[4:7]
    v_mfma_f32_16x16x32_bf16 a[8:11], v[80:83], v[148:151], a[8:11]
    v_mfma_f32_16x16x32_bf16 a[12:15], v[80:83], v[156:159], a[12:15]
    v_mfma_f32_16x16x32_bf16 a[16:19], v[80:83], v[164:167], a[16:19]
    v_mfma_f32_16x16x32_bf16 a[20:23], v[80:83], v[172:175], a[20:23]
    v_mfma_f32_16x16x32_bf16 a[24:27], v[80:83], v[180:183], a[24:27]
    v_mfma_f32_16x16x32_bf16 a[28:31], v[80:83], v[188:191], a[28:31]
    s_waitcnt lgkmcnt(2)
    v_mfma_f32_16x16x32_bf16 a[32:35], v[84:87], v[132:135], a[32:35]
    v_mfma_f32_16x16x32_bf16 a[36:39], v[84:87], v[140:143], a[36:39]
    v_mfma_f32_16x16x32_bf16 a[40:43], v[84:87], v[148:151], a[40:43]
    v_mfma_f32_16x16x32_bf16 a[44:47], v[84:87], v[156:159], a[44:47]
    v_mfma_f32_16x16x32_bf16 a[48:51], v[84:87], v[164:167], a[48:51]
    v_mfma_f32_16x16x32_bf16 a[52:55], v[84:87], v[172:175], a[52:55]
    v_mfma_f32_16x16x32_bf16 a[56:59], v[84:87], v[180:183], a[56:59]
    v_mfma_f32_16x16x32_bf16 a[60:63], v[84:87], v[188:191], a[60:63]
    s_waitcnt lgkmcnt(1)
    v_mfma_f32_16x16x32_bf16 a[64:67], v[88:91], v[132:135], a[64:67]
    v_mfma_f32_16x16x32_bf16 a[68:71], v[88:91], v[140:143], a[68:71]
    v_mfma_f32_16x16x32_bf16 a[72:75], v[88:91], v[148:151], a[72:75]
    v_mfma_f32_16x16x32_bf16 a[76:79], v[88:91], v[156:159], a[76:79]
    v_mfma_f32_16x16x32_bf16 a[80:83], v[88:91], v[164:167], a[80:83]
    v_mfma_f32_16x16x32_bf16 a[84:87], v[88:91], v[172:175], a[84:87]
    v_mfma_f32_16x16x32_bf16 a[88:91], v[88:91], v[180:183], a[88:91]
    v_mfma_f32_16x16x32_bf16 a[92:95], v[88:91], v[188:191], a[92:95]
    s_waitcnt lgkmcnt(0)
    v_mfma_f32_16x16x32_bf16 a[96:99], v[92:95], v[132:135], a[96:99]
    v_mfma_f32_16x16x32_bf16 a[100:103], v[92:95], v[140:143], a[100:103]
    v_mfma_f32_16x16x32_bf16 a[104:107], v[92:95], v[148:151], a[104:107]
    v_mfma_f32_16x16x32_bf16 a[108:111], v[92:95], v[156:159], a[108:111]
    v_mfma_f32_16x16x32_bf16 a[112:115], v[92:95], v[164:167], a[112:115]
    v_mfma_f32_16x16x32_bf16 a[116:119], v[92:95], v[172:175], a[116:119]
    v_mfma_f32_16x16x32_bf16 a[120:123], v[92:95], v[180:183], a[120:123]
    v_mfma_f32_16x16x32_bf16 a[124:127], v[92:95], v[188:191], a[124:127]
    v_add_u32 v20, -98304, v20
    v_add_u32 v21, -98304, v21
    v_add_u32 v22, -98304, v22
    v_add_u32 v23, -98304, v23
    s_waitcnt vmcnt(0)
    s_barrier
    ds_read_b128 v[128:131], v22 offset:0
    ds_read_b128 v[136:139], v22 offset:2048
    ds_read_b128 v[144:147], v22 offset:4096
    ds_read_b128 v[152:155], v22 offset:6144
    ds_read_b128 v[160:163], v22 offset:8192
    ds_read_b128 v[168:171], v22 offset:10240
    ds_read_b128 v[176:179], v22 offset:12288
    ds_read_b128 v[184:187], v22 offset:14336
    ds_read_b128 v[64:67], v20 offset:0
    ds_read_b128 v[68:71], v20 offset:2048
    ds_read_b128 v[72:75], v20 offset:4096
    ds_read_b128 v[76:79], v20 offset:6144
    ds_read_b128 v[132:135], v23 offset:0
    ds_read_b128 v[140:143], v23 offset:2048
    ds_read_b128 v[148:151], v23 offset:4096
    ds_read_b128 v[156:159], v23 offset:6144
    ds_read_b128 v[164:167], v23 offset:8192
    ds_read_b128 v[172:175], v23 offset:10240
    ds_read_b128 v[180:183], v23 offset:12288
    ds_read_b128 v[188:191], v23 offset:14336
    ds_read_b128 v[80:83], v21 offset:0
    ds_read_b128 v[84:87], v21 offset:2048
    ds_read_b128 v[88:91], v21 offset:4096
    ds_read_b128 v[92:95], v21 offset:6144
    s_waitcnt lgkmcnt(15)
    v_mfma_f32_16x16x32_bf16 a[0:3], v[64:67], v[128:131], a[0:3]
    v_mfma_f32_16x16x32_bf16 a[4:7], v[64:67], v[136:139], a[4:7]
    v_mfma_f32_16x16x32_bf16 a[8:11], v[64:67], v[144:147], a[8:11]
    v_mfma_f32_16x16x32_bf16 a[12:15], v[64:67], v[152:155], a[12:15]
    v_mfma_f32_16x16x32_bf16 a[16:19], v[64:67], v[160:163], a[16:19]
    v_mfma_f32_16x16x32_bf16 a[20:23], v[64:67], v[168:171], a[20:23]
    v_mfma_f32_16x16x32_bf16 a[24:27], v[64:67], v[176:179], a[24:27]
    v_mfma_f32_16x16x32_bf16 a[28:31], v[64:67], v[184:187], a[28:31]
    s_waitcnt lgkmcnt(14)
    v_mfma_f32_16x16x32_bf16 a[32:35], v[68:71], v[128:131], a[32:35]
    v_mfma_f32_16x16x32_bf16 a[36:39], v[68:71], v[136:139], a[36:39]
    v_mfma_f32_16x16x32_bf16 a[40:43], v[68:71], v[144:147], a[40:43]
    v_mfma_f32_16x16x32_bf16 a[44:47], v[68:71], v[152:155], a[44:47]
    v_mfma_f32_16x16x32_bf16 a[48:51], v[68:71], v[160:163], a[48:51]
    v_mfma_f32_16x16x32_bf16 a[52:55], v[68:71], v[168:171], a[52:55]
    v_mfma_f32_16x16x32_bf16 a[56:59], v[68:71], v[176:179], a[56:59]
    v_mfma_f32_16x16x32_bf16 a[60:63], v[68:71], v[184:187], a[60:63]
    s_waitcnt lgkmcnt(13)
    v_mfma_f32_16x16x32_bf16 a[64:67], v[72:75], v[128:131], a[64:67]
    v_mfma_f32_16x16x32_bf16 a[68:71], v[72:75], v[136:139], a[68:71]
    v_mfma_f32_16x16x32_bf16 a[72:75], v[72:75], v[144:147], a[72:75]
    v_mfma_f32_16x16x32_bf16 a[76:79], v[72:75], v[152:155], a[76:79]
    v_mfma_f32_16x16x32_bf16 a[80:83], v[72:75], v[160:163], a[80:83]
    v_mfma_f32_16x16x32_bf16 a[84:87], v[72:75], v[168:171], a[84:87]
    v_mfma_f32_16x16x32_bf16 a[88:91], v[72:75], v[176:179], a[88:91]
    v_mfma_f32_16x16x32_bf16 a[92:95], v[72:75], v[184:187], a[92:95]
    s_waitcnt lgkmcnt(12)
    v_mfma_f32_16x16x32_bf16 a[96:99], v[76:79], v[128:131], a[96:99]
    v_mfma_f32_16x16x32_bf16 a[100:103], v[76:79], v[136:139], a[100:103]
    v_mfma_f32_16x16x32_bf16 a[104:107], v[76:79], v[144:147], a[104:107]
    v_mfma_f32_16x16x32_bf16 a[108:111], v[76:79], v[152:155], a[108:111]
    v_mfma_f32_16x16x32_bf16 a[112:115], v[76:79], v[160:163], a[112:115]
    v_mfma_f32_16x16x32_bf16 a[116:119], v[76:79], v[168:171], a[116:119]
    v_mfma_f32_16x16x32_bf16 a[120:123], v[76:79], v[176:179], a[120:123]
    v_mfma_f32_16x16x32_bf16 a[124:127], v[76:79], v[184:187], a[124:127]
    s_waitcnt lgkmcnt(3)
    v_mfma_f32_16x16x32_bf16 a[0:3], v[80:83], v[132:135], a[0:3]
    v_mfma_f32_16x16x32_bf16 a[4:7], v[80:83], v[140:143], a[4:7]
    v_mfma_f32_16x16x32_bf16 a[8:11], v[80:83], v[148:151], a[8:11]
    v_mfma_f32_16x16x32_bf16 a[12:15], v[80:83], v[156:159], a[12:15]
    v_mfma_f32_16x16x32_bf16 a[16:19], v[80:83], v[164:167], a[16:19]
    v_mfma_f32_16x16x32_bf16 a[20:23], v[80:83], v[172:175], a[20:23]
    v_mfma_f32_16x16x32_bf16 a[24:27], v[80:83], v[180:183], a[24:27]
    v_mfma_f32_16x16x32_bf16 a[28:31], v[80:83], v[188:191], a[28:31]
    s_waitcnt lgkmcnt(2)
    v_mfma_f32_16x16x32_bf16 a[32:35], v[84:87], v[132:135], a[32:35]
    v_mfma_f32_16x16x32_bf16 a[36:39], v[84:87], v[140:143], a[36:39]
    v_mfma_f32_16x16x32_bf16 a[40:43], v[84:87], v[148:151], a[40:43]
    v_mfma_f32_16x16x32_bf16 a[44:47], v[84:87], v[156:159], a[44:47]
    v_mfma_f32_16x16x32_bf16 a[48:51], v[84:87], v[164:167], a[48:51]
    v_mfma_f32_16x16x32_bf16 a[52:55], v[84:87], v[172:175], a[52:55]
    v_mfma_f32_16x16x32_bf16 a[56:59], v[84:87], v[180:183], a[56:59]
    v_mfma_f32_16x16x32_bf16 a[60:63], v[84:87], v[188:191], a[60:63]
    s_waitcnt lgkmcnt(1)
    v_mfma_f32_16x16x32_bf16 a[64:67], v[88:91], v[132:135], a[64:67]
    v_mfma_f32_16x16x32_bf16 a[68:71], v[88:91], v[140:143], a[68:71]
    v_mfma_f32_16x16x32_bf16 a[72:75], v[88:91], v[148:151], a[72:75]
    v_mfma_f32_16x16x32_bf16 a[76:79], v[88:91], v[156:159], a[76:79]
    v_mfma_f32_16x16x32_bf16 a[80:83], v[88:91], v[164:167], a[80:83]
    v_mfma_f32_16x16x32_bf16 a[84:87], v[88:91], v[172:175], a[84:87]
    v_mfma_f32_16x16x32_bf16 a[88:91], v[88:91], v[180:183], a[88:91]
    v_mfma_f32_16x16x32_bf16 a[92:95], v[88:91], v[188:191], a[92:95]
    s_waitcnt lgkmcnt(0)
    v_mfma_f32_16x16x32_bf16 a[96:99], v[92:95], v[132:135], a[96:99]
    v_mfma_f32_16x16x32_bf16 a[100:103], v[92:95], v[140:143], a[100:103]
    v_mfma_f32_16x16x32_bf16 a[104:107], v[92:95], v[148:151], a[104:107]
    v_mfma_f32_16x16x32_bf16 a[108:111], v[92:95], v[156:159], a[108:111]
    v_mfma_f32_16x16x32_bf16 a[112:115], v[92:95], v[164:167], a[112:115]
    v_mfma_f32_16x16x32_bf16 a[116:119], v[92:95], v[172:175], a[116:119]
    v_mfma_f32_16x16x32_bf16 a[120:123], v[92:95], v[180:183], a[120:123]
    v_mfma_f32_16x16x32_bf16 a[124:127], v[92:95], v[188:191], a[124:127]
    s_add_u32 s50, s26, 0
    s_add_u32 s50, s50, s58
    s_lshl_b32 s50, s50, 10
    s_add_u32 s50, s50, s39
    v_accvgpr_read_b32 v96, a0
    v_accvgpr_read_b32 v97, a1
    v_accvgpr_read_b32 v98, a2
    v_accvgpr_read_b32 v99, a3
    v_accvgpr_read_b32 v100, a32
    v_accvgpr_read_b32 v101, a33
    v_accvgpr_read_b32 v102, a34
    v_accvgpr_read_b32 v103, a35
    v_pk_mul_f32 v[96:97], v[96:97], s[52:53]
    v_pk_mul_f32 v[98:99], v[98:99], s[52:53]
    v_cvt_pk_bf16_f32 v32, v96, v97
    v_cvt_pk_bf16_f32 v33, v98, v99
    v_pk_mul_f32 v[100:101], v[100:101], s[52:53]
    v_pk_mul_f32 v[102:103], v[102:103], s[52:53]
    v_cvt_pk_bf16_f32 v34, v100, v101
    v_cvt_pk_bf16_f32 v35, v102, v103
    buffer_store_dwordx4 v[32:35], v4, s[4:7], s50 offen sc1
    s_add_u32 s50, s50, 14336
    v_accvgpr_read_b32 v96, a4
    v_accvgpr_read_b32 v97, a5
    v_accvgpr_read_b32 v98, a6
    v_accvgpr_read_b32 v99, a7
    v_accvgpr_read_b32 v100, a36
    v_accvgpr_read_b32 v101, a37
    v_accvgpr_read_b32 v102, a38
    v_accvgpr_read_b32 v103, a39
    v_pk_mul_f32 v[96:97], v[96:97], s[52:53]
    v_pk_mul_f32 v[98:99], v[98:99], s[52:53]
    v_cvt_pk_bf16_f32 v36, v96, v97
    v_cvt_pk_bf16_f32 v37, v98, v99
    v_pk_mul_f32 v[100:101], v[100:101], s[52:53]
    v_pk_mul_f32 v[102:103], v[102:103], s[52:53]
    v_cvt_pk_bf16_f32 v38, v100, v101
    v_cvt_pk_bf16_f32 v39, v102, v103
    buffer_store_dwordx4 v[36:39], v4, s[4:7], s50 offen sc1
    s_add_u32 s50, s50, 14336
    v_accvgpr_read_b32 v96, a8
    v_accvgpr_read_b32 v97, a9
    v_accvgpr_read_b32 v98, a10
    v_accvgpr_read_b32 v99, a11
    v_accvgpr_read_b32 v100, a40
    v_accvgpr_read_b32 v101, a41
    v_accvgpr_read_b32 v102, a42
    v_accvgpr_read_b32 v103, a43
    v_pk_mul_f32 v[96:97], v[96:97], s[52:53]
    v_pk_mul_f32 v[98:99], v[98:99], s[52:53]
    v_cvt_pk_bf16_f32 v40, v96, v97
    v_cvt_pk_bf16_f32 v41, v98, v99
    v_pk_mul_f32 v[100:101], v[100:101], s[52:53]
    v_pk_mul_f32 v[102:103], v[102:103], s[52:53]
    v_cvt_pk_bf16_f32 v42, v100, v101
    v_cvt_pk_bf16_f32 v43, v102, v103
    buffer_store_dwordx4 v[40:43], v4, s[4:7], s50 offen sc1
    s_add_u32 s50, s50, 14336
    v_accvgpr_read_b32 v96, a12
    v_accvgpr_read_b32 v97, a13
    v_accvgpr_read_b32 v98, a14
    v_accvgpr_read_b32 v99, a15
    v_accvgpr_read_b32 v100, a44
    v_accvgpr_read_b32 v101, a45
    v_accvgpr_read_b32 v102, a46
    v_accvgpr_read_b32 v103, a47
    v_pk_mul_f32 v[96:97], v[96:97], s[52:53]
    v_pk_mul_f32 v[98:99], v[98:99], s[52:53]
    v_cvt_pk_bf16_f32 v44, v96, v97
    v_cvt_pk_bf16_f32 v45, v98, v99
    v_pk_mul_f32 v[100:101], v[100:101], s[52:53]
    v_pk_mul_f32 v[102:103], v[102:103], s[52:53]
    v_cvt_pk_bf16_f32 v46, v100, v101
    v_cvt_pk_bf16_f32 v47, v102, v103
    buffer_store_dwordx4 v[44:47], v4, s[4:7], s50 offen sc1
    s_add_u32 s50, s50, 14336
    s_cmp_eq_u32 s35, 3
    s_cselect_b32 s50, 0x40000000, s50
    v_accvgpr_read_b32 v96, a16
    v_accvgpr_read_b32 v97, a17
    v_accvgpr_read_b32 v98, a18
    v_accvgpr_read_b32 v99, a19
    v_accvgpr_read_b32 v100, a48
    v_accvgpr_read_b32 v101, a49
    v_accvgpr_read_b32 v102, a50
    v_accvgpr_read_b32 v103, a51
    v_pk_mul_f32 v[96:97], v[96:97], s[52:53]
    v_pk_mul_f32 v[98:99], v[98:99], s[52:53]
    v_cvt_pk_bf16_f32 v48, v96, v97
    v_cvt_pk_bf16_f32 v49, v98, v99
    v_pk_mul_f32 v[100:101], v[100:101], s[52:53]
    v_pk_mul_f32 v[102:103], v[102:103], s[52:53]
    v_cvt_pk_bf16_f32 v50, v100, v101
    v_cvt_pk_bf16_f32 v51, v102, v103
    buffer_store_dwordx4 v[48:51], v4, s[4:7], s50 offen sc1
    s_add_u32 s50, s50, 14336
    v_accvgpr_read_b32 v96, a20
    v_accvgpr_read_b32 v97, a21
    v_accvgpr_read_b32 v98, a22
    v_accvgpr_read_b32 v99, a23
    v_accvgpr_read_b32 v100, a52
    v_accvgpr_read_b32 v101, a53
    v_accvgpr_read_b32 v102, a54
    v_accvgpr_read_b32 v103, a55
    v_pk_mul_f32 v[96:97], v[96:97], s[52:53]
    v_pk_mul_f32 v[98:99], v[98:99], s[52:53]
    v_cvt_pk_bf16_f32 v52, v96, v97
    v_cvt_pk_bf16_f32 v53, v98, v99
    v_pk_mul_f32 v[100:101], v[100:101], s[52:53]
    v_pk_mul_f32 v[102:103], v[102:103], s[52:53]
    v_cvt_pk_bf16_f32 v54, v100, v101
    v_cvt_pk_bf16_f32 v55, v102, v103
    buffer_store_dwordx4 v[52:55], v4, s[4:7], s50 offen sc1
    s_add_u32 s50, s50, 14336
    v_accvgpr_read_b32 v96, a24
    v_accvgpr_read_b32 v97, a25
    v_accvgpr_read_b32 v98, a26
    v_accvgpr_read_b32 v99, a27
    v_accvgpr_read_b32 v100, a56
    v_accvgpr_read_b32 v101, a57
    v_accvgpr_read_b32 v102, a58
    v_accvgpr_read_b32 v103, a59
    v_pk_mul_f32 v[96:97], v[96:97], s[52:53]
    v_pk_mul_f32 v[98:99], v[98:99], s[52:53]
    v_cvt_pk_bf16_f32 v56, v96, v97
    v_cvt_pk_bf16_f32 v57, v98, v99
    v_pk_mul_f32 v[100:101], v[100:101], s[52:53]
    v_pk_mul_f32 v[102:103], v[102:103], s[52:53]
    v_cvt_pk_bf16_f32 v58, v100, v101
    v_cvt_pk_bf16_f32 v59, v102, v103
    buffer_store_dwordx4 v[56:59], v4, s[4:7], s50 offen sc1
    s_add_u32 s50, s50, 14336
    v_accvgpr_read_b32 v96, a28
    v_accvgpr_read_b32 v97, a29
    v_accvgpr_read_b32 v98, a30
    v_accvgpr_read_b32 v99, a31
    v_accvgpr_read_b32 v100, a60
    v_accvgpr_read_b32 v101, a61
    v_accvgpr_read_b32 v102, a62
    v_accvgpr_read_b32 v103, a63
    v_pk_mul_f32 v[96:97], v[96:97], s[52:53]
    v_pk_mul_f32 v[98:99], v[98:99], s[52:53]
    v_cvt_pk_bf16_f32 v60, v96, v97
    v_cvt_pk_bf16_f32 v61, v98, v99
    v_pk_mul_f32 v[100:101], v[100:101], s[52:53]
    v_pk_mul_f32 v[102:103], v[102:103], s[52:53]
    v_cvt_pk_bf16_f32 v62, v100, v101
    v_cvt_pk_bf16_f32 v63, v102, v103
    buffer_store_dwordx4 v[60:63], v4, s[4:7], s50 offen sc1
    s_add_u32 s50, s26, 4
    s_add_u32 s50, s50, s58
    s_lshl_b32 s50, s50, 10
    s_add_u32 s50, s50, s39
    s_cmp_eq_u32 s26, 3
    s_cbranch_scc1 gated_mix__linear_attn_block__memory_aug_recurrent_mem_tr__prompt_kernel_M_join
    v_accvgpr_read_b32 v96, a64
    v_accvgpr_read_b32 v97, a65
    v_accvgpr_read_b32 v98, a66
    v_accvgpr_read_b32 v99, a67
    v_accvgpr_read_b32 v100, a96
    v_accvgpr_read_b32 v101, a97
    v_accvgpr_read_b32 v102, a98
    v_accvgpr_read_b32 v103, a99
    v_pk_mul_f32 v[96:97], v[96:97], s[52:53]
    v_pk_mul_f32 v[98:99], v[98:99], s[52:53]
    v_cvt_pk_bf16_f32 v32, v96, v97
    v_cvt_pk_bf16_f32 v33, v98, v99
    v_pk_mul_f32 v[100:101], v[100:101], s[52:53]
    v_pk_mul_f32 v[102:103], v[102:103], s[52:53]
    v_cvt_pk_bf16_f32 v34, v100, v101
    v_cvt_pk_bf16_f32 v35, v102, v103
    buffer_store_dwordx4 v[32:35], v4, s[4:7], s50 offen sc1
    s_add_u32 s50, s50, 14336
    v_accvgpr_read_b32 v96, a68
    v_accvgpr_read_b32 v97, a69
    v_accvgpr_read_b32 v98, a70
    v_accvgpr_read_b32 v99, a71
    v_accvgpr_read_b32 v100, a100
    v_accvgpr_read_b32 v101, a101
    v_accvgpr_read_b32 v102, a102
    v_accvgpr_read_b32 v103, a103
    v_pk_mul_f32 v[96:97], v[96:97], s[52:53]
    v_pk_mul_f32 v[98:99], v[98:99], s[52:53]
    v_cvt_pk_bf16_f32 v36, v96, v97
    v_cvt_pk_bf16_f32 v37, v98, v99
    v_pk_mul_f32 v[100:101], v[100:101], s[52:53]
    v_pk_mul_f32 v[102:103], v[102:103], s[52:53]
    v_cvt_pk_bf16_f32 v38, v100, v101
    v_cvt_pk_bf16_f32 v39, v102, v103
    buffer_store_dwordx4 v[36:39], v4, s[4:7], s50 offen sc1
    s_add_u32 s50, s50, 14336
    v_accvgpr_read_b32 v96, a72
    v_accvgpr_read_b32 v97, a73
    v_accvgpr_read_b32 v98, a74
    v_accvgpr_read_b32 v99, a75
    v_accvgpr_read_b32 v100, a104
    v_accvgpr_read_b32 v101, a105
    v_accvgpr_read_b32 v102, a106
    v_accvgpr_read_b32 v103, a107
    v_pk_mul_f32 v[96:97], v[96:97], s[52:53]
    v_pk_mul_f32 v[98:99], v[98:99], s[52:53]
    v_cvt_pk_bf16_f32 v40, v96, v97
    v_cvt_pk_bf16_f32 v41, v98, v99
    v_pk_mul_f32 v[100:101], v[100:101], s[52:53]
    v_pk_mul_f32 v[102:103], v[102:103], s[52:53]
    v_cvt_pk_bf16_f32 v42, v100, v101
    v_cvt_pk_bf16_f32 v43, v102, v103
    buffer_store_dwordx4 v[40:43], v4, s[4:7], s50 offen sc1
    s_add_u32 s50, s50, 14336
    v_accvgpr_read_b32 v96, a76
    v_accvgpr_read_b32 v97, a77
    v_accvgpr_read_b32 v98, a78
    v_accvgpr_read_b32 v99, a79
    v_accvgpr_read_b32 v100, a108
    v_accvgpr_read_b32 v101, a109
    v_accvgpr_read_b32 v102, a110
    v_accvgpr_read_b32 v103, a111
    v_pk_mul_f32 v[96:97], v[96:97], s[52:53]
    v_pk_mul_f32 v[98:99], v[98:99], s[52:53]
    v_cvt_pk_bf16_f32 v44, v96, v97
    v_cvt_pk_bf16_f32 v45, v98, v99
    v_pk_mul_f32 v[100:101], v[100:101], s[52:53]
    v_pk_mul_f32 v[102:103], v[102:103], s[52:53]
    v_cvt_pk_bf16_f32 v46, v100, v101
    v_cvt_pk_bf16_f32 v47, v102, v103
    buffer_store_dwordx4 v[44:47], v4, s[4:7], s50 offen sc1
    s_add_u32 s50, s50, 14336
    s_cmp_eq_u32 s35, 3
    s_cselect_b32 s50, 0x40000000, s50
    v_accvgpr_read_b32 v96, a80
    v_accvgpr_read_b32 v97, a81
    v_accvgpr_read_b32 v98, a82
    v_accvgpr_read_b32 v99, a83
    v_accvgpr_read_b32 v100, a112
    v_accvgpr_read_b32 v101, a113
    v_accvgpr_read_b32 v102, a114
    v_accvgpr_read_b32 v103, a115
    v_pk_mul_f32 v[96:97], v[96:97], s[52:53]
    v_pk_mul_f32 v[98:99], v[98:99], s[52:53]
    v_cvt_pk_bf16_f32 v48, v96, v97
    v_cvt_pk_bf16_f32 v49, v98, v99
    v_pk_mul_f32 v[100:101], v[100:101], s[52:53]
    v_pk_mul_f32 v[102:103], v[102:103], s[52:53]
    v_cvt_pk_bf16_f32 v50, v100, v101
    v_cvt_pk_bf16_f32 v51, v102, v103
    buffer_store_dwordx4 v[48:51], v4, s[4:7], s50 offen sc1
    s_add_u32 s50, s50, 14336
    v_accvgpr_read_b32 v96, a84
    v_accvgpr_read_b32 v97, a85
    v_accvgpr_read_b32 v98, a86
    v_accvgpr_read_b32 v99, a87
    v_accvgpr_read_b32 v100, a116
    v_accvgpr_read_b32 v101, a117
    v_accvgpr_read_b32 v102, a118
    v_accvgpr_read_b32 v103, a119
    v_pk_mul_f32 v[96:97], v[96:97], s[52:53]
    v_pk_mul_f32 v[98:99], v[98:99], s[52:53]
    v_cvt_pk_bf16_f32 v52, v96, v97
    v_cvt_pk_bf16_f32 v53, v98, v99
    v_pk_mul_f32 v[100:101], v[100:101], s[52:53]
    v_pk_mul_f32 v[102:103], v[102:103], s[52:53]
    v_cvt_pk_bf16_f32 v54, v100, v101
    v_cvt_pk_bf16_f32 v55, v102, v103
    buffer_store_dwordx4 v[52:55], v4, s[4:7], s50 offen sc1
    s_add_u32 s50, s50, 14336
    v_accvgpr_read_b32 v96, a88
    v_accvgpr_read_b32 v97, a89
    v_accvgpr_read_b32 v98, a90
    v_accvgpr_read_b32 v99, a91
    v_accvgpr_read_b32 v100, a120
    v_accvgpr_read_b32 v101, a121
    v_accvgpr_read_b32 v102, a122
    v_accvgpr_read_b32 v103, a123
    v_pk_mul_f32 v[96:97], v[96:97], s[52:53]
    v_pk_mul_f32 v[98:99], v[98:99], s[52:53]
    v_cvt_pk_bf16_f32 v56, v96, v97
    v_cvt_pk_bf16_f32 v57, v98, v99
    v_pk_mul_f32 v[100:101], v[100:101], s[52:53]
    v_pk_mul_f32 v[102:103], v[102:103], s[52:53]
    v_cvt_pk_bf16_f32 v58, v100, v101
    v_cvt_pk_bf16_f32 v59, v102, v103
    buffer_store_dwordx4 v[56:59], v4, s[4:7], s50 offen sc1
    s_add_u32 s50, s50, 14336
    v_accvgpr_read_b32 v96, a92
    v_accvgpr_read_b32 v97, a93
    v_accvgpr_read_b32 v98, a94
    v_accvgpr_read_b32 v99, a95
    v_accvgpr_read_b32 v100, a124
    v_accvgpr_read_b32 v101, a125
    v_accvgpr_read_b32 v102, a126
    v_accvgpr_read_b32 v103, a127
    v_pk_mul_f32 v[96:97], v[96:97], s[52:53]
    v_pk_mul_f32 v[98:99], v[98:99], s[52:53]
    v_cvt_pk_bf16_f32 v60, v96, v97
    v_cvt_pk_bf16_f32 v61, v98, v99
    v_pk_mul_f32 v[100:101], v[100:101], s[52:53]
    v_pk_mul_f32 v[102:103], v[102:103], s[52:53]
    v_cvt_pk_bf16_f32 v62, v100, v101
    v_cvt_pk_bf16_f32 v63, v102, v103
    buffer_store_dwordx4 v[60:63], v4, s[4:7], s50 offen sc1
    s_branch gated_mix__linear_attn_block__memory_aug_recurrent_mem_tr__prompt_kernel_M_join
gated_mix__linear_attn_block__memory_aug_recurrent_mem_tr__prompt_kernel_K1_bmat:
    s_mov_b64 s[12:13], s[72:73]
    s_mov_b64 s[16:17], s[74:75]
    s_mov_b32 s14, 0x380000
    s_mov_b32 s15, 0x20000
    s_mov_b32 s18, 0x380000
    s_mov_b32 s19, 0x20000
    v_and_b32 v10, 1, v5
    v_lshlrev_b32 v10, 2, v10
    v_xor_b32 v10, v10, v9
    v_mul_u32_u24 v18, 896, v8
    v_lshl_add_u32 v18, v10, 4, v18
    s_lshl_b32 s54, s36, 8
    s_lshl_b32 s55, s26, 4
    s_add_u32 s54, s54, s55
    s_mul_i32 s54, s54, 896
    s_lshl_b32 s55, s35, 8
    s_add_u32 s54, s54, s55
    s_lshl_b32 s55, s26, 11
    s_add_u32 s55, s55, 32768
    v_lshrrev_b32 v8, 2, v6
    v_lshlrev_b32 v10, 1, v8
    v_and_b32 v10, 4, v10
    v_lshl_add_u32 v8, v5, 3, v8
    v_lshlrev_b32 v8, 7, v8
    v_and_b32 v9, 3, v6
    v_or_b32 v9, v9, v10
    v_lshl_add_u32 v26, v9, 4, v8
    v_add_u32 v26, 32768, v26
    v_xor_b32 v27, 64, v26
    s_add_u32 s51, s54, 0
    s_add_u32 m0, s55, 0
    s_nop 0
    buffer_load_dwordx4 v18, s[16:19], s51 offen nt lds
    s_add_u32 s51, s54, 7168
    s_add_u32 m0, s55, 1024
    s_nop 0
    buffer_load_dwordx4 v18, s[16:19], s51 offen nt lds
    s_add_u32 s51, s54, 128
    s_add_u32 m0, s55, 8192
    s_nop 0
    buffer_load_dwordx4 v18, s[16:19], s51 offen nt lds
    s_add_u32 s51, s54, 7296
    s_add_u32 m0, s55, 9216
    s_nop 0
    buffer_load_dwordx4 v18, s[16:19], s51 offen nt lds
    s_add_u32 s51, s40, 0
    s_add_u32 m0, s48, 0
    s_nop 0
    buffer_load_dwordx4 v16, s[12:15], s51 offen nt lds
    s_add_u32 s51, s40, 0
    s_add_u32 m0, s48, 1024
    s_nop 0
    buffer_load_dwordx4 v17, s[12:15], s51 offen nt lds
    s_add_u32 s51, s41, 0
    s_add_u32 m0, s48, 2048
    s_nop 0
    buffer_load_dwordx4 v16, s[12:15], s51 offen nt lds
    s_add_u32 s51, s41, 0
    s_add_u32 m0, s48, 3072
    s_nop 0
    buffer_load_dwordx4 v17, s[12:15], s51 offen nt lds
    s_add_u32 s51, s42, 0
    s_add_u32 m0, s48, 4096
    s_nop 0
    buffer_load_dwordx4 v16, s[12:15], s51 offen nt lds
    s_add_u32 s51, s42, 0
    s_add_u32 m0, s48, 5120
    s_nop 0
    buffer_load_dwordx4 v17, s[12:15], s51 offen nt lds
    s_add_u32 s51, s43, 0
    s_add_u32 m0, s48, 6144
    s_nop 0
    buffer_load_dwordx4 v16, s[12:15], s51 offen nt lds
    s_add_u32 s51, s43, 0
    s_add_u32 m0, s48, 7168
    s_nop 0
    buffer_load_dwordx4 v17, s[12:15], s51 offen nt lds
    s_add_u32 s51, s54, 57344
    s_add_u32 m0, s55, 49152
    s_nop 0
    buffer_load_dwordx4 v18, s[16:19], s51 offen nt lds
    s_add_u32 s51, s54, 64512
    s_add_u32 m0, s55, 50176
    s_nop 0
    buffer_load_dwordx4 v18, s[16:19], s51 offen nt lds
    s_add_u32 s51, s54, 57472
    s_add_u32 m0, s55, 57344
    s_nop 0
    buffer_load_dwordx4 v18, s[16:19], s51 offen nt lds
    s_add_u32 s51, s54, 64640
    s_add_u32 m0, s55, 58368
    s_nop 0
    buffer_load_dwordx4 v18, s[16:19], s51 offen nt lds
    s_add_u32 s51, s40, 128
    s_add_u32 m0, s48, 49152
    s_nop 0
    buffer_load_dwordx4 v16, s[12:15], s51 offen nt lds
    s_add_u32 s51, s40, 128
    s_add_u32 m0, s48, 50176
    s_nop 0
    buffer_load_dwordx4 v17, s[12:15], s51 offen nt lds
    s_add_u32 s51, s41, 128
    s_add_u32 m0, s48, 51200
    s_nop 0
    buffer_load_dwordx4 v16, s[12:15], s51 offen nt lds
    s_add_u32 s51, s41, 128
    s_add_u32 m0, s48, 52224
    s_nop 0
    buffer_load_dwordx4 v17, s[12:15], s51 offen nt lds
    s_add_u32 s51, s42, 128
    s_add_u32 m0, s48, 53248
    s_nop 0
    buffer_load_dwordx4 v16, s[12:15], s51 offen nt lds
    s_add_u32 s51, s42, 128
    s_add_u32 m0, s48, 54272
    s_nop 0
    buffer_load_dwordx4 v17, s[12:15], s51 offen nt lds
    s_add_u32 s51, s43, 128
    s_add_u32 m0, s48, 55296
    s_nop 0
    buffer_load_dwordx4 v16, s[12:15], s51 offen nt lds
    s_add_u32 s51, s43, 128
    s_add_u32 m0, s48, 56320
    s_nop 0
    buffer_load_dwordx4 v17, s[12:15], s51 offen nt lds
    s_add_u32 s51, s54, 114688
    s_add_u32 m0, s55, 98304
    s_nop 0
    buffer_load_dwordx4 v18, s[16:19], s51 offen nt lds
    s_add_u32 s51, s54, 121856
    s_add_u32 m0, s55, 99328
    s_nop 0
    buffer_load_dwordx4 v18, s[16:19], s51 offen nt lds
    s_add_u32 s51, s54, 114816
    s_add_u32 m0, s55, 106496
    s_nop 0
    buffer_load_dwordx4 v18, s[16:19], s51 offen nt lds
    s_add_u32 s51, s54, 121984
    s_add_u32 m0, s55, 107520
    s_nop 0
    buffer_load_dwordx4 v18, s[16:19], s51 offen nt lds
    s_add_u32 s51, s40, 256
    s_add_u32 m0, s48, 98304
    s_nop 0
    buffer_load_dwordx4 v16, s[12:15], s51 offen nt lds
    s_add_u32 s51, s40, 256
    s_add_u32 m0, s48, 99328
    s_nop 0
    buffer_load_dwordx4 v17, s[12:15], s51 offen nt lds
    s_add_u32 s51, s41, 256
    s_add_u32 m0, s48, 100352
    s_nop 0
    buffer_load_dwordx4 v16, s[12:15], s51 offen nt lds
    s_add_u32 s51, s41, 256
    s_add_u32 m0, s48, 101376
    s_nop 0
    buffer_load_dwordx4 v17, s[12:15], s51 offen nt lds
    s_add_u32 s51, s42, 256
    s_add_u32 m0, s48, 102400
    s_nop 0
    buffer_load_dwordx4 v16, s[12:15], s51 offen nt lds
    s_add_u32 s51, s42, 256
    s_add_u32 m0, s48, 103424
    s_nop 0
    buffer_load_dwordx4 v17, s[12:15], s51 offen nt lds
    s_add_u32 s51, s43, 256
    s_add_u32 m0, s48, 104448
    s_nop 0
    buffer_load_dwordx4 v16, s[12:15], s51 offen nt lds
    s_add_u32 s51, s43, 256
    s_add_u32 m0, s48, 105472
    s_nop 0
    buffer_load_dwordx4 v17, s[12:15], s51 offen nt lds
    s_waitcnt vmcnt(24)
    s_barrier
    ds_read_b64_tr_b16 v[128:129], v26 offset:0
    ds_read_b64_tr_b16 v[130:131], v26 offset:512
    ds_read_b64_tr_b16 v[136:137], v26 offset:8
    ds_read_b64_tr_b16 v[138:139], v26 offset:520
    ds_read_b64_tr_b16 v[144:145], v27 offset:0
    ds_read_b64_tr_b16 v[146:147], v27 offset:512
    ds_read_b64_tr_b16 v[152:153], v27 offset:8
    ds_read_b64_tr_b16 v[154:155], v27 offset:520
    ds_read_b64_tr_b16 v[160:161], v26 offset:8192
    ds_read_b64_tr_b16 v[162:163], v26 offset:8704
    ds_read_b64_tr_b16 v[168:169], v26 offset:8200
    ds_read_b64_tr_b16 v[170:171], v26 offset:8712
    ds_read_b64_tr_b16 v[176:177], v27 offset:8192
    ds_read_b64_tr_b16 v[178:179], v27 offset:8704
    ds_read_b64_tr_b16 v[184:185], v27 offset:8200
    ds_read_b64_tr_b16 v[186:187], v27 offset:8712
    ds_read_b128 v[64:67], v20 offset:0
    ds_read_b128 v[68:71], v20 offset:2048
    ds_read_b128 v[72:75], v20 offset:4096
    ds_read_b128 v[76:79], v20 offset:6144
    ds_read_b64_tr_b16 v[132:133], v26 offset:4096
    ds_read_b64_tr_b16 v[134:135], v26 offset:4608
    ds_read_b64_tr_b16 v[140:141], v26 offset:4104
    ds_read_b64_tr_b16 v[142:143], v26 offset:4616
    ds_read_b64_tr_b16 v[148:149], v27 offset:4096
    ds_read_b64_tr_b16 v[150:151], v27 offset:4608
    ds_read_b64_tr_b16 v[156:157], v27 offset:4104
    ds_read_b64_tr_b16 v[158:159], v27 offset:4616
    ds_read_b64_tr_b16 v[164:165], v26 offset:12288
    ds_read_b64_tr_b16 v[166:167], v26 offset:12800
    ds_read_b64_tr_b16 v[172:173], v26 offset:12296
    ds_read_b64_tr_b16 v[174:175], v26 offset:12808
    ds_read_b64_tr_b16 v[180:181], v27 offset:12288
    ds_read_b64_tr_b16 v[182:183], v27 offset:12800
    ds_read_b64_tr_b16 v[188:189], v27 offset:12296
    ds_read_b64_tr_b16 v[190:191], v27 offset:12808
    ds_read_b128 v[80:83], v21 offset:0
    ds_read_b128 v[84:87], v21 offset:2048
    ds_read_b128 v[88:91], v21 offset:4096
    ds_read_b128 v[92:95], v21 offset:6144
    s_waitcnt lgkmcnt(15)
    v_mfma_f32_16x16x32_bf16 a[0:3], v[64:67], v[128:131], 0
    v_mfma_f32_16x16x32_bf16 a[4:7], v[64:67], v[136:139], 0
    v_mfma_f32_16x16x32_bf16 a[8:11], v[64:67], v[144:147], 0
    v_mfma_f32_16x16x32_bf16 a[12:15], v[64:67], v[152:155], 0
    v_mfma_f32_16x16x32_bf16 a[16:19], v[64:67], v[160:163], 0
    v_mfma_f32_16x16x32_bf16 a[20:23], v[64:67], v[168:171], 0
    v_mfma_f32_16x16x32_bf16 a[24:27], v[64:67], v[176:179], 0
    v_mfma_f32_16x16x32_bf16 a[28:31], v[64:67], v[184:187], 0
    s_waitcnt lgkmcnt(15)
    v_mfma_f32_16x16x32_bf16 a[32:35], v[68:71], v[128:131], 0
    v_mfma_f32_16x16x32_bf16 a[36:39], v[68:71], v[136:139], 0
    v_mfma_f32_16x16x32_bf16 a[40:43], v[68:71], v[144:147], 0
    v_mfma_f32_16x16x32_bf16 a[44:47], v[68:71], v[152:155], 0
    v_mfma_f32_16x16x32_bf16 a[48:51], v[68:71], v[160:163], 0
    v_mfma_f32_16x16x32_bf16 a[52:55], v[68:71], v[168:171], 0
    v_mfma_f32_16x16x32_bf16 a[56:59], v[68:71], v[176:179], 0
    v_mfma_f32_16x16x32_bf16 a[60:63], v[68:71], v[184:187], 0
    s_waitcnt lgkmcnt(15)
    v_mfma_f32_16x16x32_bf16 a[64:67], v[72:75], v[128:131], 0
    v_mfma_f32_16x16x32_bf16 a[68:71], v[72:75], v[136:139], 0
    v_mfma_f32_16x16x32_bf16 a[72:75], v[72:75], v[144:147], 0
    v_mfma_f32_16x16x32_bf16 a[76:79], v[72:75], v[152:155], 0
    v_mfma_f32_16x16x32_bf16 a[80:83], v[72:75], v[160:163], 0
    v_mfma_f32_16x16x32_bf16 a[84:87], v[72:75], v[168:171], 0
    v_mfma_f32_16x16x32_bf16 a[88:91], v[72:75], v[176:179], 0
    v_mfma_f32_16x16x32_bf16 a[92:95], v[72:75], v[184:187], 0
    s_waitcnt lgkmcnt(15)
    v_mfma_f32_16x16x32_bf16 a[96:99], v[76:79], v[128:131], 0
    v_mfma_f32_16x16x32_bf16 a[100:103], v[76:79], v[136:139], 0
    v_mfma_f32_16x16x32_bf16 a[104:107], v[76:79], v[144:147], 0
    v_mfma_f32_16x16x32_bf16 a[108:111], v[76:79], v[152:155], 0
    v_mfma_f32_16x16x32_bf16 a[112:115], v[76:79], v[160:163], 0
    v_mfma_f32_16x16x32_bf16 a[116:119], v[76:79], v[168:171], 0
    v_mfma_f32_16x16x32_bf16 a[120:123], v[76:79], v[176:179], 0
    v_mfma_f32_16x16x32_bf16 a[124:127], v[76:79], v[184:187], 0
    s_waitcnt lgkmcnt(3)
    v_mfma_f32_16x16x32_bf16 a[0:3], v[80:83], v[132:135], a[0:3]
    v_mfma_f32_16x16x32_bf16 a[4:7], v[80:83], v[140:143], a[4:7]
    v_mfma_f32_16x16x32_bf16 a[8:11], v[80:83], v[148:151], a[8:11]
    v_mfma_f32_16x16x32_bf16 a[12:15], v[80:83], v[156:159], a[12:15]
    v_mfma_f32_16x16x32_bf16 a[16:19], v[80:83], v[164:167], a[16:19]
    v_mfma_f32_16x16x32_bf16 a[20:23], v[80:83], v[172:175], a[20:23]
    v_mfma_f32_16x16x32_bf16 a[24:27], v[80:83], v[180:183], a[24:27]
    v_mfma_f32_16x16x32_bf16 a[28:31], v[80:83], v[188:191], a[28:31]
    s_waitcnt lgkmcnt(2)
    v_mfma_f32_16x16x32_bf16 a[32:35], v[84:87], v[132:135], a[32:35]
    v_mfma_f32_16x16x32_bf16 a[36:39], v[84:87], v[140:143], a[36:39]
    v_mfma_f32_16x16x32_bf16 a[40:43], v[84:87], v[148:151], a[40:43]
    v_mfma_f32_16x16x32_bf16 a[44:47], v[84:87], v[156:159], a[44:47]
    v_mfma_f32_16x16x32_bf16 a[48:51], v[84:87], v[164:167], a[48:51]
    v_mfma_f32_16x16x32_bf16 a[52:55], v[84:87], v[172:175], a[52:55]
    v_mfma_f32_16x16x32_bf16 a[56:59], v[84:87], v[180:183], a[56:59]
    v_mfma_f32_16x16x32_bf16 a[60:63], v[84:87], v[188:191], a[60:63]
    s_waitcnt lgkmcnt(1)
    v_mfma_f32_16x16x32_bf16 a[64:67], v[88:91], v[132:135], a[64:67]
    v_mfma_f32_16x16x32_bf16 a[68:71], v[88:91], v[140:143], a[68:71]
    v_mfma_f32_16x16x32_bf16 a[72:75], v[88:91], v[148:151], a[72:75]
    v_mfma_f32_16x16x32_bf16 a[76:79], v[88:91], v[156:159], a[76:79]
    v_mfma_f32_16x16x32_bf16 a[80:83], v[88:91], v[164:167], a[80:83]
    v_mfma_f32_16x16x32_bf16 a[84:87], v[88:91], v[172:175], a[84:87]
    v_mfma_f32_16x16x32_bf16 a[88:91], v[88:91], v[180:183], a[88:91]
    v_mfma_f32_16x16x32_bf16 a[92:95], v[88:91], v[188:191], a[92:95]
    s_waitcnt lgkmcnt(0)
    v_mfma_f32_16x16x32_bf16 a[96:99], v[92:95], v[132:135], a[96:99]
    v_mfma_f32_16x16x32_bf16 a[100:103], v[92:95], v[140:143], a[100:103]
    v_mfma_f32_16x16x32_bf16 a[104:107], v[92:95], v[148:151], a[104:107]
    v_mfma_f32_16x16x32_bf16 a[108:111], v[92:95], v[156:159], a[108:111]
    v_mfma_f32_16x16x32_bf16 a[112:115], v[92:95], v[164:167], a[112:115]
    v_mfma_f32_16x16x32_bf16 a[116:119], v[92:95], v[172:175], a[116:119]
    v_mfma_f32_16x16x32_bf16 a[120:123], v[92:95], v[180:183], a[120:123]
    v_mfma_f32_16x16x32_bf16 a[124:127], v[92:95], v[188:191], a[124:127]
    v_add_u32 v20, 49152, v20
    v_add_u32 v21, 49152, v21
    v_add_u32 v22, 49152, v22
    v_add_u32 v23, 49152, v23
    v_add_u32 v26, 49152, v26
    v_add_u32 v27, 49152, v27
    s_waitcnt vmcnt(12)
    s_barrier
    s_add_u32 s51, s54, 172032
    s_add_u32 m0, s55, 0
    s_nop 0
    buffer_load_dwordx4 v18, s[16:19], s51 offen nt lds
    s_add_u32 s51, s54, 179200
    s_add_u32 m0, s55, 1024
    s_nop 0
    buffer_load_dwordx4 v18, s[16:19], s51 offen nt lds
    s_add_u32 s51, s54, 172160
    s_add_u32 m0, s55, 8192
    s_nop 0
    buffer_load_dwordx4 v18, s[16:19], s51 offen nt lds
    s_add_u32 s51, s54, 179328
    s_add_u32 m0, s55, 9216
    s_nop 0
    buffer_load_dwordx4 v18, s[16:19], s51 offen nt lds
    s_add_u32 s51, s40, 384
    s_add_u32 m0, s48, 0
    s_nop 0
    buffer_load_dwordx4 v16, s[12:15], s51 offen nt lds
    s_add_u32 s51, s40, 384
    s_add_u32 m0, s48, 1024
    s_nop 0
    buffer_load_dwordx4 v17, s[12:15], s51 offen nt lds
    s_add_u32 s51, s41, 384
    s_add_u32 m0, s48, 2048
    s_nop 0
    buffer_load_dwordx4 v16, s[12:15], s51 offen nt lds
    s_add_u32 s51, s41, 384
    s_add_u32 m0, s48, 3072
    s_nop 0
    buffer_load_dwordx4 v17, s[12:15], s51 offen nt lds
    s_add_u32 s51, s42, 384
    s_add_u32 m0, s48, 4096
    s_nop 0
    buffer_load_dwordx4 v16, s[12:15], s51 offen nt lds
    s_add_u32 s51, s42, 384
    s_add_u32 m0, s48, 5120
    s_nop 0
    buffer_load_dwordx4 v17, s[12:15], s51 offen nt lds
    s_add_u32 s51, s43, 384
    s_add_u32 m0, s48, 6144
    s_nop 0
    buffer_load_dwordx4 v16, s[12:15], s51 offen nt lds
    s_add_u32 s51, s43, 384
    s_add_u32 m0, s48, 7168
    s_nop 0
    buffer_load_dwordx4 v17, s[12:15], s51 offen nt lds
    ds_read_b64_tr_b16 v[128:129], v26 offset:0
    ds_read_b64_tr_b16 v[130:131], v26 offset:512
    ds_read_b64_tr_b16 v[136:137], v26 offset:8
    ds_read_b64_tr_b16 v[138:139], v26 offset:520
    ds_read_b64_tr_b16 v[144:145], v27 offset:0
    ds_read_b64_tr_b16 v[146:147], v27 offset:512
    ds_read_b64_tr_b16 v[152:153], v27 offset:8
    ds_read_b64_tr_b16 v[154:155], v27 offset:520
    ds_read_b64_tr_b16 v[160:161], v26 offset:8192
    ds_read_b64_tr_b16 v[162:163], v26 offset:8704
    ds_read_b64_tr_b16 v[168:169], v26 offset:8200
    ds_read_b64_tr_b16 v[170:171], v26 offset:8712
    ds_read_b64_tr_b16 v[176:177], v27 offset:8192
    ds_read_b64_tr_b16 v[178:179], v27 offset:8704
    ds_read_b64_tr_b16 v[184:185], v27 offset:8200
    ds_read_b64_tr_b16 v[186:187], v27 offset:8712
    ds_read_b128 v[64:67], v20 offset:0
    ds_read_b128 v[68:71], v20 offset:2048
    ds_read_b128 v[72:75], v20 offset:4096
    ds_read_b128 v[76:79], v20 offset:6144
    ds_read_b64_tr_b16 v[132:133], v26 offset:4096
    ds_read_b64_tr_b16 v[134:135], v26 offset:4608
    ds_read_b64_tr_b16 v[140:141], v26 offset:4104
    ds_read_b64_tr_b16 v[142:143], v26 offset:4616
    ds_read_b64_tr_b16 v[148:149], v27 offset:4096
    ds_read_b64_tr_b16 v[150:151], v27 offset:4608
    ds_read_b64_tr_b16 v[156:157], v27 offset:4104
    ds_read_b64_tr_b16 v[158:159], v27 offset:4616
    ds_read_b64_tr_b16 v[164:165], v26 offset:12288
    ds_read_b64_tr_b16 v[166:167], v26 offset:12800
    ds_read_b64_tr_b16 v[172:173], v26 offset:12296
    ds_read_b64_tr_b16 v[174:175], v26 offset:12808
    ds_read_b64_tr_b16 v[180:181], v27 offset:12288
    ds_read_b64_tr_b16 v[182:183], v27 offset:12800
    ds_read_b64_tr_b16 v[188:189], v27 offset:12296
    ds_read_b64_tr_b16 v[190:191], v27 offset:12808
    ds_read_b128 v[80:83], v21 offset:0
    ds_read_b128 v[84:87], v21 offset:2048
    ds_read_b128 v[88:91], v21 offset:4096
    ds_read_b128 v[92:95], v21 offset:6144
    s_waitcnt lgkmcnt(15)
    v_mfma_f32_16x16x32_bf16 a[0:3], v[64:67], v[128:131], a[0:3]
    v_mfma_f32_16x16x32_bf16 a[4:7], v[64:67], v[136:139], a[4:7]
    v_mfma_f32_16x16x32_bf16 a[8:11], v[64:67], v[144:147], a[8:11]
    v_mfma_f32_16x16x32_bf16 a[12:15], v[64:67], v[152:155], a[12:15]
    v_mfma_f32_16x16x32_bf16 a[16:19], v[64:67], v[160:163], a[16:19]
    v_mfma_f32_16x16x32_bf16 a[20:23], v[64:67], v[168:171], a[20:23]
    v_mfma_f32_16x16x32_bf16 a[24:27], v[64:67], v[176:179], a[24:27]
    v_mfma_f32_16x16x32_bf16 a[28:31], v[64:67], v[184:187], a[28:31]
    s_waitcnt lgkmcnt(15)
    v_mfma_f32_16x16x32_bf16 a[32:35], v[68:71], v[128:131], a[32:35]
    v_mfma_f32_16x16x32_bf16 a[36:39], v[68:71], v[136:139], a[36:39]
    v_mfma_f32_16x16x32_bf16 a[40:43], v[68:71], v[144:147], a[40:43]
    v_mfma_f32_16x16x32_bf16 a[44:47], v[68:71], v[152:155], a[44:47]
    v_mfma_f32_16x16x32_bf16 a[48:51], v[68:71], v[160:163], a[48:51]
    v_mfma_f32_16x16x32_bf16 a[52:55], v[68:71], v[168:171], a[52:55]
    v_mfma_f32_16x16x32_bf16 a[56:59], v[68:71], v[176:179], a[56:59]
    v_mfma_f32_16x16x32_bf16 a[60:63], v[68:71], v[184:187], a[60:63]
    s_waitcnt lgkmcnt(15)
    v_mfma_f32_16x16x32_bf16 a[64:67], v[72:75], v[128:131], a[64:67]
    v_mfma_f32_16x16x32_bf16 a[68:71], v[72:75], v[136:139], a[68:71]
    v_mfma_f32_16x16x32_bf16 a[72:75], v[72:75], v[144:147], a[72:75]
    v_mfma_f32_16x16x32_bf16 a[76:79], v[72:75], v[152:155], a[76:79]
    v_mfma_f32_16x16x32_bf16 a[80:83], v[72:75], v[160:163], a[80:83]
    v_mfma_f32_16x16x32_bf16 a[84:87], v[72:75], v[168:171], a[84:87]
    v_mfma_f32_16x16x32_bf16 a[88:91], v[72:75], v[176:179], a[88:91]
    v_mfma_f32_16x16x32_bf16 a[92:95], v[72:75], v[184:187], a[92:95]
    s_waitcnt lgkmcnt(15)
    v_mfma_f32_16x16x32_bf16 a[96:99], v[76:79], v[128:131], a[96:99]
    v_mfma_f32_16x16x32_bf16 a[100:103], v[76:79], v[136:139], a[100:103]
    v_mfma_f32_16x16x32_bf16 a[104:107], v[76:79], v[144:147], a[104:107]
    v_mfma_f32_16x16x32_bf16 a[108:111], v[76:79], v[152:155], a[108:111]
    v_mfma_f32_16x16x32_bf16 a[112:115], v[76:79], v[160:163], a[112:115]
    v_mfma_f32_16x16x32_bf16 a[116:119], v[76:79], v[168:171], a[116:119]
    v_mfma_f32_16x16x32_bf16 a[120:123], v[76:79], v[176:179], a[120:123]
    v_mfma_f32_16x16x32_bf16 a[124:127], v[76:79], v[184:187], a[124:127]
    s_waitcnt lgkmcnt(3)
    v_mfma_f32_16x16x32_bf16 a[0:3], v[80:83], v[132:135], a[0:3]
    v_mfma_f32_16x16x32_bf16 a[4:7], v[80:83], v[140:143], a[4:7]
    v_mfma_f32_16x16x32_bf16 a[8:11], v[80:83], v[148:151], a[8:11]
    v_mfma_f32_16x16x32_bf16 a[12:15], v[80:83], v[156:159], a[12:15]
    v_mfma_f32_16x16x32_bf16 a[16:19], v[80:83], v[164:167], a[16:19]
    v_mfma_f32_16x16x32_bf16 a[20:23], v[80:83], v[172:175], a[20:23]
    v_mfma_f32_16x16x32_bf16 a[24:27], v[80:83], v[180:183], a[24:27]
    v_mfma_f32_16x16x32_bf16 a[28:31], v[80:83], v[188:191], a[28:31]
    s_waitcnt lgkmcnt(2)
    v_mfma_f32_16x16x32_bf16 a[32:35], v[84:87], v[132:135], a[32:35]
    v_mfma_f32_16x16x32_bf16 a[36:39], v[84:87], v[140:143], a[36:39]
    v_mfma_f32_16x16x32_bf16 a[40:43], v[84:87], v[148:151], a[40:43]
    v_mfma_f32_16x16x32_bf16 a[44:47], v[84:87], v[156:159], a[44:47]
    v_mfma_f32_16x16x32_bf16 a[48:51], v[84:87], v[164:167], a[48:51]
    v_mfma_f32_16x16x32_bf16 a[52:55], v[84:87], v[172:175], a[52:55]
    v_mfma_f32_16x16x32_bf16 a[56:59], v[84:87], v[180:183], a[56:59]
    v_mfma_f32_16x16x32_bf16 a[60:63], v[84:87], v[188:191], a[60:63]
    s_waitcnt lgkmcnt(1)
    v_mfma_f32_16x16x32_bf16 a[64:67], v[88:91], v[132:135], a[64:67]
    v_mfma_f32_16x16x32_bf16 a[68:71], v[88:91], v[140:143], a[68:71]
    v_mfma_f32_16x16x32_bf16 a[72:75], v[88:91], v[148:151], a[72:75]
    v_mfma_f32_16x16x32_bf16 a[76:79], v[88:91], v[156:159], a[76:79]
    v_mfma_f32_16x16x32_bf16 a[80:83], v[88:91], v[164:167], a[80:83]
    v_mfma_f32_16x16x32_bf16 a[84:87], v[88:91], v[172:175], a[84:87]
    v_mfma_f32_16x16x32_bf16 a[88:91], v[88:91], v[180:183], a[88:91]
    v_mfma_f32_16x16x32_bf16 a[92:95], v[88:91], v[188:191], a[92:95]
    s_waitcnt lgkmcnt(0)
    v_mfma_f32_16x16x32_bf16 a[96:99], v[92:95], v[132:135], a[96:99]
    v_mfma_f32_16x16x32_bf16 a[100:103], v[92:95], v[140:143], a[100:103]
    v_mfma_f32_16x16x32_bf16 a[104:107], v[92:95], v[148:151], a[104:107]
    v_mfma_f32_16x16x32_bf16 a[108:111], v[92:95], v[156:159], a[108:111]
    v_mfma_f32_16x16x32_bf16 a[112:115], v[92:95], v[164:167], a[112:115]
    v_mfma_f32_16x16x32_bf16 a[116:119], v[92:95], v[172:175], a[116:119]
    v_mfma_f32_16x16x32_bf16 a[120:123], v[92:95], v[180:183], a[120:123]
    v_mfma_f32_16x16x32_bf16 a[124:127], v[92:95], v[188:191], a[124:127]
    v_add_u32 v20, 49152, v20
    v_add_u32 v21, 49152, v21
    v_add_u32 v22, 49152, v22
    v_add_u32 v23, 49152, v23
    v_add_u32 v26, 49152, v26
    v_add_u32 v27, 49152, v27
    s_waitcnt vmcnt(12)
    s_barrier
    ds_read_b64_tr_b16 v[128:129], v26 offset:0
    ds_read_b64_tr_b16 v[130:131], v26 offset:512
    ds_read_b64_tr_b16 v[136:137], v26 offset:8
    ds_read_b64_tr_b16 v[138:139], v26 offset:520
    ds_read_b64_tr_b16 v[144:145], v27 offset:0
    ds_read_b64_tr_b16 v[146:147], v27 offset:512
    ds_read_b64_tr_b16 v[152:153], v27 offset:8
    ds_read_b64_tr_b16 v[154:155], v27 offset:520
    ds_read_b64_tr_b16 v[160:161], v26 offset:8192
    ds_read_b64_tr_b16 v[162:163], v26 offset:8704
    ds_read_b64_tr_b16 v[168:169], v26 offset:8200
    ds_read_b64_tr_b16 v[170:171], v26 offset:8712
    ds_read_b64_tr_b16 v[176:177], v27 offset:8192
    ds_read_b64_tr_b16 v[178:179], v27 offset:8704
    ds_read_b64_tr_b16 v[184:185], v27 offset:8200
    ds_read_b64_tr_b16 v[186:187], v27 offset:8712
    ds_read_b128 v[64:67], v20 offset:0
    ds_read_b128 v[68:71], v20 offset:2048
    ds_read_b128 v[72:75], v20 offset:4096
    ds_read_b128 v[76:79], v20 offset:6144
    ds_read_b64_tr_b16 v[132:133], v26 offset:4096
    ds_read_b64_tr_b16 v[134:135], v26 offset:4608
    ds_read_b64_tr_b16 v[140:141], v26 offset:4104
    ds_read_b64_tr_b16 v[142:143], v26 offset:4616
    ds_read_b64_tr_b16 v[148:149], v27 offset:4096
    ds_read_b64_tr_b16 v[150:151], v27 offset:4608
    ds_read_b64_tr_b16 v[156:157], v27 offset:4104
    ds_read_b64_tr_b16 v[158:159], v27 offset:4616
    ds_read_b64_tr_b16 v[164:165], v26 offset:12288
    ds_read_b64_tr_b16 v[166:167], v26 offset:12800
    ds_read_b64_tr_b16 v[172:173], v26 offset:12296
    ds_read_b64_tr_b16 v[174:175], v26 offset:12808
    ds_read_b64_tr_b16 v[180:181], v27 offset:12288
    ds_read_b64_tr_b16 v[182:183], v27 offset:12800
    ds_read_b64_tr_b16 v[188:189], v27 offset:12296
    ds_read_b64_tr_b16 v[190:191], v27 offset:12808
    ds_read_b128 v[80:83], v21 offset:0
    ds_read_b128 v[84:87], v21 offset:2048
    ds_read_b128 v[88:91], v21 offset:4096
    ds_read_b128 v[92:95], v21 offset:6144
    s_waitcnt lgkmcnt(15)
    v_mfma_f32_16x16x32_bf16 a[0:3], v[64:67], v[128:131], a[0:3]
    v_mfma_f32_16x16x32_bf16 a[4:7], v[64:67], v[136:139], a[4:7]
    v_mfma_f32_16x16x32_bf16 a[8:11], v[64:67], v[144:147], a[8:11]
    v_mfma_f32_16x16x32_bf16 a[12:15], v[64:67], v[152:155], a[12:15]
    v_mfma_f32_16x16x32_bf16 a[16:19], v[64:67], v[160:163], a[16:19]
    v_mfma_f32_16x16x32_bf16 a[20:23], v[64:67], v[168:171], a[20:23]
    v_mfma_f32_16x16x32_bf16 a[24:27], v[64:67], v[176:179], a[24:27]
    v_mfma_f32_16x16x32_bf16 a[28:31], v[64:67], v[184:187], a[28:31]
    s_waitcnt lgkmcnt(15)
    v_mfma_f32_16x16x32_bf16 a[32:35], v[68:71], v[128:131], a[32:35]
    v_mfma_f32_16x16x32_bf16 a[36:39], v[68:71], v[136:139], a[36:39]
    v_mfma_f32_16x16x32_bf16 a[40:43], v[68:71], v[144:147], a[40:43]
    v_mfma_f32_16x16x32_bf16 a[44:47], v[68:71], v[152:155], a[44:47]
    v_mfma_f32_16x16x32_bf16 a[48:51], v[68:71], v[160:163], a[48:51]
    v_mfma_f32_16x16x32_bf16 a[52:55], v[68:71], v[168:171], a[52:55]
    v_mfma_f32_16x16x32_bf16 a[56:59], v[68:71], v[176:179], a[56:59]
    v_mfma_f32_16x16x32_bf16 a[60:63], v[68:71], v[184:187], a[60:63]
    s_waitcnt lgkmcnt(15)
    v_mfma_f32_16x16x32_bf16 a[64:67], v[72:75], v[128:131], a[64:67]
    v_mfma_f32_16x16x32_bf16 a[68:71], v[72:75], v[136:139], a[68:71]
    v_mfma_f32_16x16x32_bf16 a[72:75], v[72:75], v[144:147], a[72:75]
    v_mfma_f32_16x16x32_bf16 a[76:79], v[72:75], v[152:155], a[76:79]
    v_mfma_f32_16x16x32_bf16 a[80:83], v[72:75], v[160:163], a[80:83]
    v_mfma_f32_16x16x32_bf16 a[84:87], v[72:75], v[168:171], a[84:87]
    v_mfma_f32_16x16x32_bf16 a[88:91], v[72:75], v[176:179], a[88:91]
    v_mfma_f32_16x16x32_bf16 a[92:95], v[72:75], v[184:187], a[92:95]
    s_waitcnt lgkmcnt(15)
    v_mfma_f32_16x16x32_bf16 a[96:99], v[76:79], v[128:131], a[96:99]
    v_mfma_f32_16x16x32_bf16 a[100:103], v[76:79], v[136:139], a[100:103]
    v_mfma_f32_16x16x32_bf16 a[104:107], v[76:79], v[144:147], a[104:107]
    v_mfma_f32_16x16x32_bf16 a[108:111], v[76:79], v[152:155], a[108:111]
    v_mfma_f32_16x16x32_bf16 a[112:115], v[76:79], v[160:163], a[112:115]
    v_mfma_f32_16x16x32_bf16 a[116:119], v[76:79], v[168:171], a[116:119]
    v_mfma_f32_16x16x32_bf16 a[120:123], v[76:79], v[176:179], a[120:123]
    v_mfma_f32_16x16x32_bf16 a[124:127], v[76:79], v[184:187], a[124:127]
    s_waitcnt lgkmcnt(3)
    v_mfma_f32_16x16x32_bf16 a[0:3], v[80:83], v[132:135], a[0:3]
    v_mfma_f32_16x16x32_bf16 a[4:7], v[80:83], v[140:143], a[4:7]
    v_mfma_f32_16x16x32_bf16 a[8:11], v[80:83], v[148:151], a[8:11]
    v_mfma_f32_16x16x32_bf16 a[12:15], v[80:83], v[156:159], a[12:15]
    v_mfma_f32_16x16x32_bf16 a[16:19], v[80:83], v[164:167], a[16:19]
    v_mfma_f32_16x16x32_bf16 a[20:23], v[80:83], v[172:175], a[20:23]
    v_mfma_f32_16x16x32_bf16 a[24:27], v[80:83], v[180:183], a[24:27]
    v_mfma_f32_16x16x32_bf16 a[28:31], v[80:83], v[188:191], a[28:31]
    s_waitcnt lgkmcnt(2)
    v_mfma_f32_16x16x32_bf16 a[32:35], v[84:87], v[132:135], a[32:35]
    v_mfma_f32_16x16x32_bf16 a[36:39], v[84:87], v[140:143], a[36:39]
    v_mfma_f32_16x16x32_bf16 a[40:43], v[84:87], v[148:151], a[40:43]
    v_mfma_f32_16x16x32_bf16 a[44:47], v[84:87], v[156:159], a[44:47]
    v_mfma_f32_16x16x32_bf16 a[48:51], v[84:87], v[164:167], a[48:51]
    v_mfma_f32_16x16x32_bf16 a[52:55], v[84:87], v[172:175], a[52:55]
    v_mfma_f32_16x16x32_bf16 a[56:59], v[84:87], v[180:183], a[56:59]
    v_mfma_f32_16x16x32_bf16 a[60:63], v[84:87], v[188:191], a[60:63]
    s_waitcnt lgkmcnt(1)
    v_mfma_f32_16x16x32_bf16 a[64:67], v[88:91], v[132:135], a[64:67]
    v_mfma_f32_16x16x32_bf16 a[68:71], v[88:91], v[140:143], a[68:71]
    v_mfma_f32_16x16x32_bf16 a[72:75], v[88:91], v[148:151], a[72:75]
    v_mfma_f32_16x16x32_bf16 a[76:79], v[88:91], v[156:159], a[76:79]
    v_mfma_f32_16x16x32_bf16 a[80:83], v[88:91], v[164:167], a[80:83]
    v_mfma_f32_16x16x32_bf16 a[84:87], v[88:91], v[172:175], a[84:87]
    v_mfma_f32_16x16x32_bf16 a[88:91], v[88:91], v[180:183], a[88:91]
    v_mfma_f32_16x16x32_bf16 a[92:95], v[88:91], v[188:191], a[92:95]
    s_waitcnt lgkmcnt(0)
    v_mfma_f32_16x16x32_bf16 a[96:99], v[92:95], v[132:135], a[96:99]
    v_mfma_f32_16x16x32_bf16 a[100:103], v[92:95], v[140:143], a[100:103]
    v_mfma_f32_16x16x32_bf16 a[104:107], v[92:95], v[148:151], a[104:107]
    v_mfma_f32_16x16x32_bf16 a[108:111], v[92:95], v[156:159], a[108:111]
    v_mfma_f32_16x16x32_bf16 a[112:115], v[92:95], v[164:167], a[112:115]
    v_mfma_f32_16x16x32_bf16 a[116:119], v[92:95], v[172:175], a[116:119]
    v_mfma_f32_16x16x32_bf16 a[120:123], v[92:95], v[180:183], a[120:123]
    v_mfma_f32_16x16x32_bf16 a[124:127], v[92:95], v[188:191], a[124:127]
    v_add_u32 v20, -98304, v20
    v_add_u32 v21, -98304, v21
    v_add_u32 v22, -98304, v22
    v_add_u32 v23, -98304, v23
    v_add_u32 v26, -98304, v26
    v_add_u32 v27, -98304, v27
    s_waitcnt vmcnt(0)
    s_barrier
    ds_read_b64_tr_b16 v[128:129], v26 offset:0
    ds_read_b64_tr_b16 v[130:131], v26 offset:512
    ds_read_b64_tr_b16 v[136:137], v26 offset:8
    ds_read_b64_tr_b16 v[138:139], v26 offset:520
    ds_read_b64_tr_b16 v[144:145], v27 offset:0
    ds_read_b64_tr_b16 v[146:147], v27 offset:512
    ds_read_b64_tr_b16 v[152:153], v27 offset:8
    ds_read_b64_tr_b16 v[154:155], v27 offset:520
    ds_read_b64_tr_b16 v[160:161], v26 offset:8192
    ds_read_b64_tr_b16 v[162:163], v26 offset:8704
    ds_read_b64_tr_b16 v[168:169], v26 offset:8200
    ds_read_b64_tr_b16 v[170:171], v26 offset:8712
    ds_read_b64_tr_b16 v[176:177], v27 offset:8192
    ds_read_b64_tr_b16 v[178:179], v27 offset:8704
    ds_read_b64_tr_b16 v[184:185], v27 offset:8200
    ds_read_b64_tr_b16 v[186:187], v27 offset:8712
    ds_read_b128 v[64:67], v20 offset:0
    ds_read_b128 v[68:71], v20 offset:2048
    ds_read_b128 v[72:75], v20 offset:4096
    ds_read_b128 v[76:79], v20 offset:6144
    ds_read_b64_tr_b16 v[132:133], v26 offset:4096
    ds_read_b64_tr_b16 v[134:135], v26 offset:4608
    ds_read_b64_tr_b16 v[140:141], v26 offset:4104
    ds_read_b64_tr_b16 v[142:143], v26 offset:4616
    ds_read_b64_tr_b16 v[148:149], v27 offset:4096
    ds_read_b64_tr_b16 v[150:151], v27 offset:4608
    ds_read_b64_tr_b16 v[156:157], v27 offset:4104
    ds_read_b64_tr_b16 v[158:159], v27 offset:4616
    ds_read_b64_tr_b16 v[164:165], v26 offset:12288
    ds_read_b64_tr_b16 v[166:167], v26 offset:12800
    ds_read_b64_tr_b16 v[172:173], v26 offset:12296
    ds_read_b64_tr_b16 v[174:175], v26 offset:12808
    ds_read_b64_tr_b16 v[180:181], v27 offset:12288
    ds_read_b64_tr_b16 v[182:183], v27 offset:12800
    ds_read_b64_tr_b16 v[188:189], v27 offset:12296
    ds_read_b64_tr_b16 v[190:191], v27 offset:12808
    ds_read_b128 v[80:83], v21 offset:0
    ds_read_b128 v[84:87], v21 offset:2048
    ds_read_b128 v[88:91], v21 offset:4096
    ds_read_b128 v[92:95], v21 offset:6144
    s_waitcnt lgkmcnt(15)
    v_mfma_f32_16x16x32_bf16 a[0:3], v[64:67], v[128:131], a[0:3]
    v_mfma_f32_16x16x32_bf16 a[4:7], v[64:67], v[136:139], a[4:7]
    v_mfma_f32_16x16x32_bf16 a[8:11], v[64:67], v[144:147], a[8:11]
    v_mfma_f32_16x16x32_bf16 a[12:15], v[64:67], v[152:155], a[12:15]
    v_mfma_f32_16x16x32_bf16 a[16:19], v[64:67], v[160:163], a[16:19]
    v_mfma_f32_16x16x32_bf16 a[20:23], v[64:67], v[168:171], a[20:23]
    v_mfma_f32_16x16x32_bf16 a[24:27], v[64:67], v[176:179], a[24:27]
    v_mfma_f32_16x16x32_bf16 a[28:31], v[64:67], v[184:187], a[28:31]
    s_waitcnt lgkmcnt(15)
    v_mfma_f32_16x16x32_bf16 a[32:35], v[68:71], v[128:131], a[32:35]
    v_mfma_f32_16x16x32_bf16 a[36:39], v[68:71], v[136:139], a[36:39]
    v_mfma_f32_16x16x32_bf16 a[40:43], v[68:71], v[144:147], a[40:43]
    v_mfma_f32_16x16x32_bf16 a[44:47], v[68:71], v[152:155], a[44:47]
    v_mfma_f32_16x16x32_bf16 a[48:51], v[68:71], v[160:163], a[48:51]
    v_mfma_f32_16x16x32_bf16 a[52:55], v[68:71], v[168:171], a[52:55]
    v_mfma_f32_16x16x32_bf16 a[56:59], v[68:71], v[176:179], a[56:59]
    v_mfma_f32_16x16x32_bf16 a[60:63], v[68:71], v[184:187], a[60:63]
    s_waitcnt lgkmcnt(15)
    v_mfma_f32_16x16x32_bf16 a[64:67], v[72:75], v[128:131], a[64:67]
    v_mfma_f32_16x16x32_bf16 a[68:71], v[72:75], v[136:139], a[68:71]
    v_mfma_f32_16x16x32_bf16 a[72:75], v[72:75], v[144:147], a[72:75]
    v_mfma_f32_16x16x32_bf16 a[76:79], v[72:75], v[152:155], a[76:79]
    v_mfma_f32_16x16x32_bf16 a[80:83], v[72:75], v[160:163], a[80:83]
    v_mfma_f32_16x16x32_bf16 a[84:87], v[72:75], v[168:171], a[84:87]
    v_mfma_f32_16x16x32_bf16 a[88:91], v[72:75], v[176:179], a[88:91]
    v_mfma_f32_16x16x32_bf16 a[92:95], v[72:75], v[184:187], a[92:95]
    s_waitcnt lgkmcnt(15)
    v_mfma_f32_16x16x32_bf16 a[96:99], v[76:79], v[128:131], a[96:99]
    v_mfma_f32_16x16x32_bf16 a[100:103], v[76:79], v[136:139], a[100:103]
    v_mfma_f32_16x16x32_bf16 a[104:107], v[76:79], v[144:147], a[104:107]
    v_mfma_f32_16x16x32_bf16 a[108:111], v[76:79], v[152:155], a[108:111]
    v_mfma_f32_16x16x32_bf16 a[112:115], v[76:79], v[160:163], a[112:115]
    v_mfma_f32_16x16x32_bf16 a[116:119], v[76:79], v[168:171], a[116:119]
    v_mfma_f32_16x16x32_bf16 a[120:123], v[76:79], v[176:179], a[120:123]
    v_mfma_f32_16x16x32_bf16 a[124:127], v[76:79], v[184:187], a[124:127]
    s_waitcnt lgkmcnt(3)
    v_mfma_f32_16x16x32_bf16 a[0:3], v[80:83], v[132:135], a[0:3]
    v_mfma_f32_16x16x32_bf16 a[4:7], v[80:83], v[140:143], a[4:7]
    v_mfma_f32_16x16x32_bf16 a[8:11], v[80:83], v[148:151], a[8:11]
    v_mfma_f32_16x16x32_bf16 a[12:15], v[80:83], v[156:159], a[12:15]
    v_mfma_f32_16x16x32_bf16 a[16:19], v[80:83], v[164:167], a[16:19]
    v_mfma_f32_16x16x32_bf16 a[20:23], v[80:83], v[172:175], a[20:23]
    v_mfma_f32_16x16x32_bf16 a[24:27], v[80:83], v[180:183], a[24:27]
    v_mfma_f32_16x16x32_bf16 a[28:31], v[80:83], v[188:191], a[28:31]
    s_waitcnt lgkmcnt(2)
    v_mfma_f32_16x16x32_bf16 a[32:35], v[84:87], v[132:135], a[32:35]
    v_mfma_f32_16x16x32_bf16 a[36:39], v[84:87], v[140:143], a[36:39]
    v_mfma_f32_16x16x32_bf16 a[40:43], v[84:87], v[148:151], a[40:43]
    v_mfma_f32_16x16x32_bf16 a[44:47], v[84:87], v[156:159], a[44:47]
    v_mfma_f32_16x16x32_bf16 a[48:51], v[84:87], v[164:167], a[48:51]
    v_mfma_f32_16x16x32_bf16 a[52:55], v[84:87], v[172:175], a[52:55]
    v_mfma_f32_16x16x32_bf16 a[56:59], v[84:87], v[180:183], a[56:59]
    v_mfma_f32_16x16x32_bf16 a[60:63], v[84:87], v[188:191], a[60:63]
    s_waitcnt lgkmcnt(1)
    v_mfma_f32_16x16x32_bf16 a[64:67], v[88:91], v[132:135], a[64:67]
    v_mfma_f32_16x16x32_bf16 a[68:71], v[88:91], v[140:143], a[68:71]
    v_mfma_f32_16x16x32_bf16 a[72:75], v[88:91], v[148:151], a[72:75]
    v_mfma_f32_16x16x32_bf16 a[76:79], v[88:91], v[156:159], a[76:79]
    v_mfma_f32_16x16x32_bf16 a[80:83], v[88:91], v[164:167], a[80:83]
    v_mfma_f32_16x16x32_bf16 a[84:87], v[88:91], v[172:175], a[84:87]
    v_mfma_f32_16x16x32_bf16 a[88:91], v[88:91], v[180:183], a[88:91]
    v_mfma_f32_16x16x32_bf16 a[92:95], v[88:91], v[188:191], a[92:95]
    s_waitcnt lgkmcnt(0)
    v_mfma_f32_16x16x32_bf16 a[96:99], v[92:95], v[132:135], a[96:99]
    v_mfma_f32_16x16x32_bf16 a[100:103], v[92:95], v[140:143], a[100:103]
    v_mfma_f32_16x16x32_bf16 a[104:107], v[92:95], v[148:151], a[104:107]
    v_mfma_f32_16x16x32_bf16 a[108:111], v[92:95], v[156:159], a[108:111]
    v_mfma_f32_16x16x32_bf16 a[112:115], v[92:95], v[164:167], a[112:115]
    v_mfma_f32_16x16x32_bf16 a[116:119], v[92:95], v[172:175], a[116:119]
    v_mfma_f32_16x16x32_bf16 a[120:123], v[92:95], v[180:183], a[120:123]
    v_mfma_f32_16x16x32_bf16 a[124:127], v[92:95], v[188:191], a[124:127]
    s_add_u32 s50, s26, 0
    s_add_u32 s50, s50, s58
    s_lshl_b32 s50, s50, 10
    s_add_u32 s50, s50, s39
    v_accvgpr_read_b32 v96, a0
    v_accvgpr_read_b32 v97, a1
    v_accvgpr_read_b32 v98, a2
    v_accvgpr_read_b32 v99, a3
    v_accvgpr_read_b32 v100, a32
    v_accvgpr_read_b32 v101, a33
    v_accvgpr_read_b32 v102, a34
    v_accvgpr_read_b32 v103, a35
    v_cvt_pk_bf16_f32 v32, v96, v97
    v_cvt_pk_bf16_f32 v33, v98, v99
    v_cvt_pk_bf16_f32 v34, v100, v101
    v_cvt_pk_bf16_f32 v35, v102, v103
    buffer_store_dwordx4 v[32:35], v4, s[4:7], s50 offen sc1
    s_add_u32 s50, s50, 14336
    v_accvgpr_read_b32 v96, a4
    v_accvgpr_read_b32 v97, a5
    v_accvgpr_read_b32 v98, a6
    v_accvgpr_read_b32 v99, a7
    v_accvgpr_read_b32 v100, a36
    v_accvgpr_read_b32 v101, a37
    v_accvgpr_read_b32 v102, a38
    v_accvgpr_read_b32 v103, a39
    v_cvt_pk_bf16_f32 v36, v96, v97
    v_cvt_pk_bf16_f32 v37, v98, v99
    v_cvt_pk_bf16_f32 v38, v100, v101
    v_cvt_pk_bf16_f32 v39, v102, v103
    buffer_store_dwordx4 v[36:39], v4, s[4:7], s50 offen sc1
    s_add_u32 s50, s50, 14336
    v_accvgpr_read_b32 v96, a8
    v_accvgpr_read_b32 v97, a9
    v_accvgpr_read_b32 v98, a10
    v_accvgpr_read_b32 v99, a11
    v_accvgpr_read_b32 v100, a40
    v_accvgpr_read_b32 v101, a41
    v_accvgpr_read_b32 v102, a42
    v_accvgpr_read_b32 v103, a43
    v_cvt_pk_bf16_f32 v40, v96, v97
    v_cvt_pk_bf16_f32 v41, v98, v99
    v_cvt_pk_bf16_f32 v42, v100, v101
    v_cvt_pk_bf16_f32 v43, v102, v103
    buffer_store_dwordx4 v[40:43], v4, s[4:7], s50 offen sc1
    s_add_u32 s50, s50, 14336
    v_accvgpr_read_b32 v96, a12
    v_accvgpr_read_b32 v97, a13
    v_accvgpr_read_b32 v98, a14
    v_accvgpr_read_b32 v99, a15
    v_accvgpr_read_b32 v100, a44
    v_accvgpr_read_b32 v101, a45
    v_accvgpr_read_b32 v102, a46
    v_accvgpr_read_b32 v103, a47
    v_cvt_pk_bf16_f32 v44, v96, v97
    v_cvt_pk_bf16_f32 v45, v98, v99
    v_cvt_pk_bf16_f32 v46, v100, v101
    v_cvt_pk_bf16_f32 v47, v102, v103
    buffer_store_dwordx4 v[44:47], v4, s[4:7], s50 offen sc1
    s_add_u32 s50, s50, 14336
    s_cmp_eq_u32 s35, 3
    s_cselect_b32 s50, 0x40000000, s50
    v_accvgpr_read_b32 v96, a16
    v_accvgpr_read_b32 v97, a17
    v_accvgpr_read_b32 v98, a18
    v_accvgpr_read_b32 v99, a19
    v_accvgpr_read_b32 v100, a48
    v_accvgpr_read_b32 v101, a49
    v_accvgpr_read_b32 v102, a50
    v_accvgpr_read_b32 v103, a51
    v_cvt_pk_bf16_f32 v48, v96, v97
    v_cvt_pk_bf16_f32 v49, v98, v99
    v_cvt_pk_bf16_f32 v50, v100, v101
    v_cvt_pk_bf16_f32 v51, v102, v103
    buffer_store_dwordx4 v[48:51], v4, s[4:7], s50 offen sc1
    s_add_u32 s50, s50, 14336
    v_accvgpr_read_b32 v96, a20
    v_accvgpr_read_b32 v97, a21
    v_accvgpr_read_b32 v98, a22
    v_accvgpr_read_b32 v99, a23
    v_accvgpr_read_b32 v100, a52
    v_accvgpr_read_b32 v101, a53
    v_accvgpr_read_b32 v102, a54
    v_accvgpr_read_b32 v103, a55
    v_cvt_pk_bf16_f32 v52, v96, v97
    v_cvt_pk_bf16_f32 v53, v98, v99
    v_cvt_pk_bf16_f32 v54, v100, v101
    v_cvt_pk_bf16_f32 v55, v102, v103
    buffer_store_dwordx4 v[52:55], v4, s[4:7], s50 offen sc1
    s_add_u32 s50, s50, 14336
    v_accvgpr_read_b32 v96, a24
    v_accvgpr_read_b32 v97, a25
    v_accvgpr_read_b32 v98, a26
    v_accvgpr_read_b32 v99, a27
    v_accvgpr_read_b32 v100, a56
    v_accvgpr_read_b32 v101, a57
    v_accvgpr_read_b32 v102, a58
    v_accvgpr_read_b32 v103, a59
    v_cvt_pk_bf16_f32 v56, v96, v97
    v_cvt_pk_bf16_f32 v57, v98, v99
    v_cvt_pk_bf16_f32 v58, v100, v101
    v_cvt_pk_bf16_f32 v59, v102, v103
    buffer_store_dwordx4 v[56:59], v4, s[4:7], s50 offen sc1
    s_add_u32 s50, s50, 14336
    v_accvgpr_read_b32 v96, a28
    v_accvgpr_read_b32 v97, a29
    v_accvgpr_read_b32 v98, a30
    v_accvgpr_read_b32 v99, a31
    v_accvgpr_read_b32 v100, a60
    v_accvgpr_read_b32 v101, a61
    v_accvgpr_read_b32 v102, a62
    v_accvgpr_read_b32 v103, a63
    v_cvt_pk_bf16_f32 v60, v96, v97
    v_cvt_pk_bf16_f32 v61, v98, v99
    v_cvt_pk_bf16_f32 v62, v100, v101
    v_cvt_pk_bf16_f32 v63, v102, v103
    buffer_store_dwordx4 v[60:63], v4, s[4:7], s50 offen sc1
    s_add_u32 s50, s26, 4
    s_add_u32 s50, s50, s58
    s_lshl_b32 s50, s50, 10
    s_add_u32 s50, s50, s39
    s_cmp_eq_u32 s26, 3
    s_cbranch_scc1 gated_mix__linear_attn_block__memory_aug_recurrent_mem_tr__prompt_kernel_M_join
    v_accvgpr_read_b32 v96, a64
    v_accvgpr_read_b32 v97, a65
    v_accvgpr_read_b32 v98, a66
    v_accvgpr_read_b32 v99, a67
    v_accvgpr_read_b32 v100, a96
    v_accvgpr_read_b32 v101, a97
    v_accvgpr_read_b32 v102, a98
    v_accvgpr_read_b32 v103, a99
    v_cvt_pk_bf16_f32 v32, v96, v97
    v_cvt_pk_bf16_f32 v33, v98, v99
    v_cvt_pk_bf16_f32 v34, v100, v101
    v_cvt_pk_bf16_f32 v35, v102, v103
    buffer_store_dwordx4 v[32:35], v4, s[4:7], s50 offen sc1
    s_add_u32 s50, s50, 14336
    v_accvgpr_read_b32 v96, a68
    v_accvgpr_read_b32 v97, a69
    v_accvgpr_read_b32 v98, a70
    v_accvgpr_read_b32 v99, a71
    v_accvgpr_read_b32 v100, a100
    v_accvgpr_read_b32 v101, a101
    v_accvgpr_read_b32 v102, a102
    v_accvgpr_read_b32 v103, a103
    v_cvt_pk_bf16_f32 v36, v96, v97
    v_cvt_pk_bf16_f32 v37, v98, v99
    v_cvt_pk_bf16_f32 v38, v100, v101
    v_cvt_pk_bf16_f32 v39, v102, v103
    buffer_store_dwordx4 v[36:39], v4, s[4:7], s50 offen sc1
    s_add_u32 s50, s50, 14336
    v_accvgpr_read_b32 v96, a72
    v_accvgpr_read_b32 v97, a73
    v_accvgpr_read_b32 v98, a74
    v_accvgpr_read_b32 v99, a75
    v_accvgpr_read_b32 v100, a104
    v_accvgpr_read_b32 v101, a105
    v_accvgpr_read_b32 v102, a106
    v_accvgpr_read_b32 v103, a107
    v_cvt_pk_bf16_f32 v40, v96, v97
    v_cvt_pk_bf16_f32 v41, v98, v99
    v_cvt_pk_bf16_f32 v42, v100, v101
    v_cvt_pk_bf16_f32 v43, v102, v103
    buffer_store_dwordx4 v[40:43], v4, s[4:7], s50 offen sc1
    s_add_u32 s50, s50, 14336
    v_accvgpr_read_b32 v96, a76
    v_accvgpr_read_b32 v97, a77
    v_accvgpr_read_b32 v98, a78
    v_accvgpr_read_b32 v99, a79
    v_accvgpr_read_b32 v100, a108
    v_accvgpr_read_b32 v101, a109
    v_accvgpr_read_b32 v102, a110
    v_accvgpr_read_b32 v103, a111
    v_cvt_pk_bf16_f32 v44, v96, v97
    v_cvt_pk_bf16_f32 v45, v98, v99
    v_cvt_pk_bf16_f32 v46, v100, v101
    v_cvt_pk_bf16_f32 v47, v102, v103
    buffer_store_dwordx4 v[44:47], v4, s[4:7], s50 offen sc1
    s_add_u32 s50, s50, 14336
    s_cmp_eq_u32 s35, 3
    s_cselect_b32 s50, 0x40000000, s50
    v_accvgpr_read_b32 v96, a80
    v_accvgpr_read_b32 v97, a81
    v_accvgpr_read_b32 v98, a82
    v_accvgpr_read_b32 v99, a83
    v_accvgpr_read_b32 v100, a112
    v_accvgpr_read_b32 v101, a113
    v_accvgpr_read_b32 v102, a114
    v_accvgpr_read_b32 v103, a115
    v_cvt_pk_bf16_f32 v48, v96, v97
    v_cvt_pk_bf16_f32 v49, v98, v99
    v_cvt_pk_bf16_f32 v50, v100, v101
    v_cvt_pk_bf16_f32 v51, v102, v103
    buffer_store_dwordx4 v[48:51], v4, s[4:7], s50 offen sc1
    s_add_u32 s50, s50, 14336
    v_accvgpr_read_b32 v96, a84
    v_accvgpr_read_b32 v97, a85
    v_accvgpr_read_b32 v98, a86
    v_accvgpr_read_b32 v99, a87
    v_accvgpr_read_b32 v100, a116
    v_accvgpr_read_b32 v101, a117
    v_accvgpr_read_b32 v102, a118
    v_accvgpr_read_b32 v103, a119
    v_cvt_pk_bf16_f32 v52, v96, v97
    v_cvt_pk_bf16_f32 v53, v98, v99
    v_cvt_pk_bf16_f32 v54, v100, v101
    v_cvt_pk_bf16_f32 v55, v102, v103
    buffer_store_dwordx4 v[52:55], v4, s[4:7], s50 offen sc1
    s_add_u32 s50, s50, 14336
    v_accvgpr_read_b32 v96, a88
    v_accvgpr_read_b32 v97, a89
    v_accvgpr_read_b32 v98, a90
    v_accvgpr_read_b32 v99, a91
    v_accvgpr_read_b32 v100, a120
    v_accvgpr_read_b32 v101, a121
    v_accvgpr_read_b32 v102, a122
    v_accvgpr_read_b32 v103, a123
    v_cvt_pk_bf16_f32 v56, v96, v97
    v_cvt_pk_bf16_f32 v57, v98, v99
    v_cvt_pk_bf16_f32 v58, v100, v101
    v_cvt_pk_bf16_f32 v59, v102, v103
    buffer_store_dwordx4 v[56:59], v4, s[4:7], s50 offen sc1
    s_add_u32 s50, s50, 14336
    v_accvgpr_read_b32 v96, a92
    v_accvgpr_read_b32 v97, a93
    v_accvgpr_read_b32 v98, a94
    v_accvgpr_read_b32 v99, a95
    v_accvgpr_read_b32 v100, a124
    v_accvgpr_read_b32 v101, a125
    v_accvgpr_read_b32 v102, a126
    v_accvgpr_read_b32 v103, a127
    v_cvt_pk_bf16_f32 v60, v96, v97
    v_cvt_pk_bf16_f32 v61, v98, v99
    v_cvt_pk_bf16_f32 v62, v100, v101
    v_cvt_pk_bf16_f32 v63, v102, v103
    buffer_store_dwordx4 v[60:63], v4, s[4:7], s50 offen sc1
    s_branch gated_mix__linear_attn_block__memory_aug_recurrent_mem_tr__prompt_kernel_M_join
gated_mix__linear_attn_block__memory_aug_recurrent_mem_tr__prompt_kernel_M_join:
    buffer_load_dwordx2 v[8:9], off, s[84:87], 0 offset:36 sc1
    s_waitcnt vmcnt(0)
    v_readfirstlane_b32 s33, v8
    v_readfirstlane_b32 s38, v9
    s_cmp_eq_u32 s33, 0
    s_cbranch_scc1 gated_mix__linear_attn_block__memory_aug_recurrent_mem_tr__prompt_kernel_M_join
    s_cmp_eq_u32 s38, 0
    s_cbranch_scc1 gated_mix__linear_attn_block__memory_aug_recurrent_mem_tr__prompt_kernel_M_join
    s_barrier
    s_cmp_lg_u32 s26, 0
    s_cbranch_scc1 gated_mix__linear_attn_block__memory_aug_recurrent_mem_tr__prompt_kernel_M_a2
    s_and_b32 s35, s34, 3
    s_lshl_b32 s35, s35, 3
    s_lshl_b32 s36, 1, s35
    s_and_b32 s37, s34, 28
    s_mov_b64 exec, 1
    v_mov_b32 v5, s36
    buffer_atomic_add v5, off, s[84:87], s37 offset:192 sc0 sc1
    s_waitcnt vmcnt(0)
    v_readfirstlane_b32 s33, v5
    s_nop 0
    s_lshr_b32 s33, s33, s35
    s_and_b32 s33, s33, 255
    s_cmp_lg_u32 s33, 7
    s_cbranch_scc1 gated_mix__linear_attn_block__memory_aug_recurrent_mem_tr__prompt_kernel_M_a2x
    s_lshl_b32 s36, s34, 7
    s_add_u32 s36, s36, 0x3aa0000
    v_mov_b32 v5, 1
    buffer_store_dword v5, off, s[4:7], s36 sc1
gated_mix__linear_attn_block__memory_aug_recurrent_mem_tr__prompt_kernel_M_a2x:
    s_mov_b64 exec, -1
gated_mix__linear_attn_block__memory_aug_recurrent_mem_tr__prompt_kernel_M_a2:
    s_sub_u32 s24, s24, s38
    s_add_u32 s24, s24, 1
    s_and_b32 s24, s24, 7
    s_lshl_b32 s2, s25, 3
    s_or_b32 s2, s2, s24
    s_cmp_lg_u32 s24, 0
    s_cbranch_scc1 gated_mix__linear_attn_block__memory_aug_recurrent_mem_tr__prompt_kernel_M_rg
    s_cmp_gt_u32 s25, 30
    s_cbranch_scc1 gated_mix__linear_attn_block__memory_aug_recurrent_mem_tr__prompt_kernel_M_rg
    s_cmp_lg_u32 s26, 0
    s_cbranch_scc1 gated_mix__linear_attn_block__memory_aug_recurrent_mem_tr__prompt_kernel_M_rg
    s_getreg_b32 s33, hwreg(HW_REG_XCC_ID)
    s_and_b32 s33, s33, 7
    s_lshl_b32 s33, s33, 3
    s_lshl_b64 s[34:35], 1, s33
    v_mov_b32 v6, s34
    v_mov_b32 v7, s35
    s_mov_b64 exec, 1
    buffer_atomic_add_x2 v[6:7], off, s[84:87], 0 offset:224 sc1
    s_mov_b64 exec, -1
gated_mix__linear_attn_block__memory_aug_recurrent_mem_tr__prompt_kernel_M_rg:
    s_mov_b32 s27, s25
    s_cmp_eq_u32 s24, 1
    s_cbranch_scc1 gated_mix__linear_attn_block__memory_aug_recurrent_mem_tr__prompt_kernel_M_misc
    s_add_u32 s27, s25, 32
    s_cmp_lg_u32 s24, 7
    s_cbranch_scc1 gated_mix__linear_attn_block__memory_aug_recurrent_mem_tr__prompt_kernel_M_go
gated_mix__linear_attn_block__memory_aug_recurrent_mem_tr__prompt_kernel_M_misc:
    v_and_b32 v2, 63, v0
    v_lshlrev_b32 v3, 4, v0
    v_lshlrev_b32 v4, 4, v2
    v_lshrrev_b32 v5, 4, v2
    v_and_b32 v6, 15, v2
    s_load_dwordx2 s[20:21], s[0:1], 32
    s_mov_b32 s22, 0x1c00
    s_mov_b32 s23, 0x20000
    v_lshrrev_b32 v8, 2, v6
    v_lshlrev_b32 v8, 3, v8
    v_and_b32 v9, 3, v6
    v_add_u32 v8, v8, v9
    v_mul_u32_u24 v8, 896, v8
    v_lshl_add_u32 v19, v5, 4, v8
    s_lshl_b32 s28, s27, 5
    s_lshr_b32 s29, s26, 1
    s_lshl_b32 s29, s29, 2
    s_add_u32 s28, s28, s29
    s_mul_i32 s28, s28, 896
    s_and_b32 s29, s26, 1
    s_mul_i32 s29, s29, 448
    s_add_u32 s28, s28, s29
    s_lshl_b32 s29, s27, 2
    s_add_u32 s29, s29, s26
    s_mul_i32 s29, s29, 7168
    s_add_u32 s30, s29, 0x38e0000
    s_add_u32 s29, s29, 0xe00000
    s_add_u32 s31, s30, 4096
    s_add_u32 s32, s29, 4096
    buffer_load_dwordx4 v[200:203], v19, s[8:11], s28 offen offset:0
    buffer_load_dwordx4 v[204:207], v19, s[8:11], s28 offen offset:64
    buffer_load_dwordx4 v[208:211], v19, s[8:11], s28 offen offset:128
    buffer_load_dwordx4 v[212:215], v19, s[8:11], s28 offen offset:192
    buffer_load_dwordx4 v[216:219], v19, s[8:11], s28 offen offset:256
    buffer_load_dwordx4 v[220:223], v19, s[8:11], s28 offen offset:320
    buffer_load_dwordx4 v[224:227], v19, s[8:11], s28 offen offset:384
    v_mov_b32 v8, -1
    v_mov_b32 v9, -1
    v_mov_b32 v10, -1
    v_mov_b32 v11, -1
    s_lshl_b32 s33, s27, 14
    s_add_u32 s33, s33, 0xfc0000
    s_and_b32 s36, s27, 31
    s_cmp_eq_u32 s36, 0
    s_cselect_b32 s34, 0x40000000, s33
    s_add_u32 s35, s34, 4096
    buffer_store_dwordx4 v[8:11], v3, s[4:7], s34 offen sc1
    buffer_store_dwordx4 v[8:11], v3, s[4:7], s35 offen sc1
    s_add_u32 s34, s33, 8192
    s_add_u32 s35, s33, 12288
    buffer_store_dwordx4 v[8:11], v3, s[4:7], s34 offen sc1
    buffer_store_dwordx4 v[8:11], v3, s[4:7], s35 offen sc1
    s_cmp_ge_u32 s27, 32
    s_cbranch_scc1 gated_mix__linear_attn_block__memory_aug_recurrent_mem_tr__prompt_kernel_K1_zero
    s_mul_i32 s34, s27, 20480
    s_add_u32 s34, s34, 0x10c0000
    buffer_store_dwordx4 v[8:11], v3, s[4:7], s34 offen sc1
    s_add_u32 s34, s34, 4096
    buffer_store_dwordx4 v[8:11], v3, s[4:7], s34 offen sc1
    s_add_u32 s34, s34, 4096
    buffer_store_dwordx4 v[8:11], v3, s[4:7], s34 offen sc1
    s_add_u32 s34, s34, 4096
    buffer_store_dwordx4 v[8:11], v3, s[4:7], s34 offen sc1
    s_add_u32 s34, s34, 4096
    buffer_store_dwordx4 v[8:11], v3, s[4:7], s34 offen sc1
    s_branch gated_mix__linear_attn_block__memory_aug_recurrent_mem_tr__prompt_kernel_K1_z2
gated_mix__linear_attn_block__memory_aug_recurrent_mem_tr__prompt_kernel_K1_zero:
    v_mov_b32 v12, 0
    v_mov_b32 v13, 0
    v_mov_b32 v14, 0
    v_mov_b32 v15, 0
    s_mul_i32 s34, s36, 3072
    s_add_u32 s34, s34, 0x1160000
    v_mov_b32 v16, 0x40000000
    v_cmp_gt_u32 vcc, 192, v0
    s_nop 1
    v_cndmask_b32 v16, v16, v3, vcc
    buffer_store_dwordx4 v[12:15], v16, s[4:7], s34 offen sc1
gated_mix__linear_attn_block__memory_aug_recurrent_mem_tr__prompt_kernel_K1_z2:
    s_cmp_lg_u32 s36, 0
    s_cbranch_scc1 gated_mix__linear_attn_block__memory_aug_recurrent_mem_tr__prompt_kernel_K1_filled
    v_and_b32 v8, 7, v0
    v_mul_u32_u24 v8, 896, v8
    v_lshrrev_b32 v9, 3, v0
    v_lshl_add_u32 v8, v9, 4, v8
    s_waitcnt lgkmcnt(0)
    buffer_load_dwordx4 v[12:15], v8, s[20:23], 0 offen
    buffer_load_dwordx4 v[16:19], v8, s[20:23], 0 offen offset:512
    s_add_u32 s34, s33, 4096
    s_waitcnt vmcnt(0)
    v_min_u32 v12, -2, v12
    v_min_u32 v13, -2, v13
    v_min_u32 v14, -2, v14
    v_min_u32 v15, -2, v15
    v_min_u32 v16, -2, v16
    v_min_u32 v17, -2, v17
    v_min_u32 v18, -2, v18
    v_min_u32 v19, -2, v19
    buffer_store_dwordx4 v[12:15], v3, s[4:7], s33 offen sc1
    buffer_store_dwordx4 v[16:19], v3, s[4:7], s34 offen sc1
gated_mix__linear_attn_block__memory_aug_recurrent_mem_tr__prompt_kernel_K1_filled:
    s_waitcnt vmcnt(2) lgkmcnt(0)
    buffer_store_dwordx4 v[200:203], v4, s[4:7], s30 offen offset:0 sc1
    buffer_store_dwordx4 v[204:207], v4, s[4:7], s30 offen offset:1024 sc1
    buffer_store_dwordx4 v[208:211], v4, s[4:7], s30 offen offset:2048 sc1
    buffer_store_dwordx4 v[212:215], v4, s[4:7], s30 offen offset:3072 sc1
    buffer_store_dwordx4 v[216:219], v4, s[4:7], s31 offen offset:0 sc1
    buffer_store_dwordx4 v[220:223], v4, s[4:7], s31 offen offset:1024 sc1
    buffer_store_dwordx4 v[224:227], v4, s[4:7], s31 offen offset:2048 sc1
    v_permlane16_swap_b32 v200, v202
    v_permlane16_swap_b32 v201, v203
    v_swap_b32 v201, v202
    buffer_store_dwordx4 v[200:203], v4, s[4:7], s29 offen offset:0 sc1
    v_permlane16_swap_b32 v204, v206
    v_permlane16_swap_b32 v205, v207
    v_swap_b32 v205, v206
    buffer_store_dwordx4 v[204:207], v4, s[4:7], s29 offen offset:1024 sc1
    v_permlane16_swap_b32 v208, v210
    v_permlane16_swap_b32 v209, v211
    v_swap_b32 v209, v210
    buffer_store_dwordx4 v[208:211], v4, s[4:7], s29 offen offset:2048 sc1
    v_permlane16_swap_b32 v212, v214
    v_permlane16_swap_b32 v213, v215
    v_swap_b32 v213, v214
    buffer_store_dwordx4 v[212:215], v4, s[4:7], s29 offen offset:3072 sc1
    v_permlane16_swap_b32 v216, v218
    v_permlane16_swap_b32 v217, v219
    v_swap_b32 v217, v218
    buffer_store_dwordx4 v[216:219], v4, s[4:7], s32 offen offset:0 sc1
    v_permlane16_swap_b32 v220, v222
    v_permlane16_swap_b32 v221, v223
    v_swap_b32 v221, v222
    buffer_store_dwordx4 v[220:223], v4, s[4:7], s32 offen offset:1024 sc1
    v_permlane16_swap_b32 v224, v226
    v_permlane16_swap_b32 v225, v227
    v_swap_b32 v225, v226
    buffer_store_dwordx4 v[224:227], v4, s[4:7], s32 offen offset:2048 sc1
    s_waitcnt vmcnt(0) lgkmcnt(0)
    s_barrier
    s_cmp_lg_u32 s26, 0
    s_cbranch_scc1 gated_mix__linear_attn_block__memory_aug_recurrent_mem_tr__prompt_kernel_M_am
    s_mov_b64 exec, 1
    v_mov_b32 v5, 1
    buffer_atomic_add v5, off, s[84:87], 0 offset:128 sc0 sc1
    s_waitcnt vmcnt(0)
    v_readfirstlane_b32 s33, v5
    s_nop 0
    s_cmp_lg_u32 s33, 63
    s_cbranch_scc1 gated_mix__linear_attn_block__memory_aug_recurrent_mem_tr__prompt_kernel_M_am_x
    buffer_store_dword v5, off, s[84:87], 0 offset:24 sc1
gated_mix__linear_attn_block__memory_aug_recurrent_mem_tr__prompt_kernel_M_am_x:
    s_mov_b64 exec, -1
gated_mix__linear_attn_block__memory_aug_recurrent_mem_tr__prompt_kernel_M_am:
    s_cmp_lg_u32 s24, 1
    s_cbranch_scc1 gated_mix__linear_attn_block__memory_aug_recurrent_mem_tr__prompt_kernel_M_go
    s_mov_b32 s34, s25
    v_and_b32 v2, 63, v0
    v_lshlrev_b32 v3, 4, v0
    v_lshlrev_b32 v4, 4, v2
    v_lshrrev_b32 v5, 4, v2
    v_and_b32 v6, 15, v2
    v_lshrrev_b32 v8, 2, v6
    v_lshl_add_u32 v40, v5, 3, v8
    v_and_b32 v41, 3, v6
    s_cmp_ge_u32 s34, 28
    s_cbranch_scc1 gated_mix__linear_attn_block__memory_aug_recurrent_mem_tr__prompt_kernel_K1_wo
    s_load_dwordx2 s[16:17], s[0:1], 8
    s_mov_b32 s18, 0x126000
    s_mov_b32 s19, 0x20000
    s_lshr_b32 s35, s34, 1
    s_and_b32 s36, s34, 1
    s_lshl_b32 s37, s35, 5
    s_lshl_b32 s38, s26, 3
    s_add_u32 s37, s37, s38
    s_mul_i32 s37, s37, 2688
    s_mul_i32 s39, s36, 1344
    s_add_u32 s37, s37, s39
    s_mul_i32 s38, s38, 1360
    v_add_u32 v42, s38, v4
    s_waitcnt lgkmcnt(0)
    buffer_load_dwordx4 v[64:67], v4, s[16:19], s37 offen
    buffer_load_dwordx4 v[68:71], v4, s[16:19], s37 offen offset:1024
    s_add_u32 s37, s37, 2688
    buffer_load_dwordx4 v[72:75], v4, s[16:19], s37 offen
    buffer_load_dwordx4 v[76:79], v4, s[16:19], s37 offen offset:1024
    s_add_u32 s37, s37, 2688
    buffer_load_dwordx4 v[80:83], v4, s[16:19], s37 offen
    buffer_load_dwordx4 v[84:87], v4, s[16:19], s37 offen offset:1024
    s_add_u32 s37, s37, 2688
    buffer_load_dwordx4 v[88:91], v4, s[16:19], s37 offen
    buffer_load_dwordx4 v[92:95], v4, s[16:19], s37 offen offset:1024
    s_add_u32 s37, s37, 2688
    buffer_load_dwordx4 v[96:99], v4, s[16:19], s37 offen
    buffer_load_dwordx4 v[100:103], v4, s[16:19], s37 offen offset:1024
    s_add_u32 s37, s37, 2688
    buffer_load_dwordx4 v[104:107], v4, s[16:19], s37 offen
    buffer_load_dwordx4 v[108:111], v4, s[16:19], s37 offen offset:1024
    s_add_u32 s37, s37, 2688
    buffer_load_dwordx4 v[112:115], v4, s[16:19], s37 offen
    buffer_load_dwordx4 v[116:119], v4, s[16:19], s37 offen offset:1024
    s_add_u32 s37, s37, 2688
    buffer_load_dwordx4 v[120:123], v4, s[16:19], s37 offen
    buffer_load_dwordx4 v[124:127], v4, s[16:19], s37 offen offset:1024
    v_cmp_gt_u32 vcc, 20, v2
    s_nop 0
    s_mov_b64 s[60:61], vcc
    s_waitcnt vmcnt(14)
    ds_write_b128 v42, v[64:67] offset:0
    s_mov_b64 exec, s[60:61]
    ds_write_b128 v42, v[68:71] offset:1024
    s_mov_b64 exec, -1
    s_waitcnt vmcnt(12)
    ds_write_b128 v42, v[72:75] offset:1360
    s_mov_b64 exec, s[60:61]
    ds_write_b128 v42, v[76:79] offset:2384
    s_mov_b64 exec, -1
    s_waitcnt vmcnt(10)
    ds_write_b128 v42, v[80:83] offset:2720
    s_mov_b64 exec, s[60:61]
    ds_write_b128 v42, v[84:87] offset:3744
    s_mov_b64 exec, -1
    s_waitcnt vmcnt(8)
    ds_write_b128 v42, v[88:91] offset:4080
    s_mov_b64 exec, s[60:61]
    ds_write_b128 v42, v[92:95] offset:5104
    s_mov_b64 exec, -1
    s_waitcnt vmcnt(6)
    ds_write_b128 v42, v[96:99] offset:5440
    s_mov_b64 exec, s[60:61]
    ds_write_b128 v42, v[100:103] offset:6464
    s_mov_b64 exec, -1
    s_waitcnt vmcnt(4)
    ds_write_b128 v42, v[104:107] offset:6800
    s_mov_b64 exec, s[60:61]
    ds_write_b128 v42, v[108:111] offset:7824
    s_mov_b64 exec, -1
    s_waitcnt vmcnt(2)
    ds_write_b128 v42, v[112:115] offset:8160
    s_mov_b64 exec, s[60:61]
    ds_write_b128 v42, v[116:119] offset:9184
    s_mov_b64 exec, -1
    s_waitcnt vmcnt(0)
    ds_write_b128 v42, v[120:123] offset:9520
    s_mov_b64 exec, s[60:61]
    ds_write_b128 v42, v[124:127] offset:10544
    s_mov_b64 exec, -1
    v_mul_u32_u24 v43, 1360, v40
    v_lshl_add_u32 v43, v41, 4, v43
    s_mul_i32 s38, s26, 336
    v_add_u32 v43, s38, v43
    v_cmp_gt_u32 vcc, 12, v6
    s_nop 1
    v_cndmask_b32 v44, 0, -1, vcc
    s_mul_i32 s40, s36, 24
    s_mul_i32 s41, s26, 6
    s_add_u32 s40, s40, s41
    s_waitcnt lgkmcnt(0)
    s_barrier
    ds_read_b64_tr_b16 v[64:65], v43 offset:0
    ds_read_b64_tr_b16 v[66:67], v43 offset:5440
    ds_read_b64_tr_b16 v[68:69], v43 offset:8
    ds_read_b64_tr_b16 v[70:71], v43 offset:5448
    ds_read_b64_tr_b16 v[72:73], v43 offset:56
    ds_read_b64_tr_b16 v[74:75], v43 offset:5496
    ds_read_b64_tr_b16 v[76:77], v43 offset:64
    ds_read_b64_tr_b16 v[78:79], v43 offset:5504
    ds_read_b64_tr_b16 v[80:81], v43 offset:112
    ds_read_b64_tr_b16 v[82:83], v43 offset:5552
    ds_read_b64_tr_b16 v[84:85], v43 offset:120
    ds_read_b64_tr_b16 v[86:87], v43 offset:5560
    ds_read_b64_tr_b16 v[88:89], v43 offset:168
    ds_read_b64_tr_b16 v[90:91], v43 offset:5608
    ds_read_b64_tr_b16 v[92:93], v43 offset:176
    ds_read_b64_tr_b16 v[94:95], v43 offset:5616
    ds_read_b64_tr_b16 v[96:97], v43 offset:224
    ds_read_b64_tr_b16 v[98:99], v43 offset:5664
    ds_read_b64_tr_b16 v[100:101], v43 offset:232
    ds_read_b64_tr_b16 v[102:103], v43 offset:5672
    ds_read_b64_tr_b16 v[104:105], v43 offset:280
    ds_read_b64_tr_b16 v[106:107], v43 offset:5720
    ds_read_b64_tr_b16 v[108:109], v43 offset:288
    ds_read_b64_tr_b16 v[110:111], v43 offset:5728
    s_waitcnt lgkmcnt(0)
    s_add_u32 s41, s40, 0
    s_and_b32 s42, s41, 15
    s_lshr_b32 s41, s41, 4
    s_mul_i32 s42, s42, 3
    s_add_u32 s41, s41, s42
    s_mul_i32 s41, s41, 28
    s_add_u32 s41, s41, s35
    s_lshl_b32 s41, s41, 10
    s_add_u32 s41, s41, 0xc40000
    s_add_u32 s42, s41, 14336
    v_and_b32 v68, v68, v44
    v_and_b32 v69, v69, v44
    v_and_b32 v70, v70, v44
    v_and_b32 v71, v71, v44
    buffer_store_dwordx4 v[64:67], v4, s[4:7], s41 offen sc1
    buffer_store_dwordx4 v[68:71], v4, s[4:7], s42 offen sc1
    s_add_u32 s41, s40, 1
    s_and_b32 s42, s41, 15
    s_lshr_b32 s41, s41, 4
    s_mul_i32 s42, s42, 3
    s_add_u32 s41, s41, s42
    s_mul_i32 s41, s41, 28
    s_add_u32 s41, s41, s35
    s_lshl_b32 s41, s41, 10
    s_add_u32 s41, s41, 0xc40000
    s_add_u32 s42, s41, 14336
    v_and_b32 v76, v76, v44
    v_and_b32 v77, v77, v44
    v_and_b32 v78, v78, v44
    v_and_b32 v79, v79, v44
    buffer_store_dwordx4 v[72:75], v4, s[4:7], s41 offen sc1
    buffer_store_dwordx4 v[76:79], v4, s[4:7], s42 offen sc1
    s_add_u32 s41, s40, 2
    s_and_b32 s42, s41, 15
    s_lshr_b32 s41, s41, 4
    s_mul_i32 s42, s42, 3
    s_add_u32 s41, s41, s42
    s_mul_i32 s41, s41, 28
    s_add_u32 s41, s41, s35
    s_lshl_b32 s41, s41, 10
    s_add_u32 s41, s41, 0xc40000
    s_add_u32 s42, s41, 14336
    v_and_b32 v84, v84, v44
    v_and_b32 v85, v85, v44
    v_and_b32 v86, v86, v44
    v_and_b32 v87, v87, v44
    buffer_store_dwordx4 v[80:83], v4, s[4:7], s41 offen sc1
    buffer_store_dwordx4 v[84:87], v4, s[4:7], s42 offen sc1
    s_add_u32 s41, s40, 3
    s_and_b32 s42, s41, 15
    s_lshr_b32 s41, s41, 4
    s_mul_i32 s42, s42, 3
    s_add_u32 s41, s41, s42
    s_mul_i32 s41, s41, 28
    s_add_u32 s41, s41, s35
    s_lshl_b32 s41, s41, 10
    s_add_u32 s41, s41, 0xc40000
    s_add_u32 s42, s41, 14336
    v_and_b32 v92, v92, v44
    v_and_b32 v93, v93, v44
    v_and_b32 v94, v94, v44
    v_and_b32 v95, v95, v44
    buffer_store_dwordx4 v[88:91], v4, s[4:7], s41 offen sc1
    buffer_store_dwordx4 v[92:95], v4, s[4:7], s42 offen sc1
    s_add_u32 s41, s40, 4
    s_and_b32 s42, s41, 15
    s_lshr_b32 s41, s41, 4
    s_mul_i32 s42, s42, 3
    s_add_u32 s41, s41, s42
    s_mul_i32 s41, s41, 28
    s_add_u32 s41, s41, s35
    s_lshl_b32 s41, s41, 10
    s_add_u32 s41, s41, 0xc40000
    s_add_u32 s42, s41, 14336
    v_and_b32 v100, v100, v44
    v_and_b32 v101, v101, v44
    v_and_b32 v102, v102, v44
    v_and_b32 v103, v103, v44
    buffer_store_dwordx4 v[96:99], v4, s[4:7], s41 offen sc1
    buffer_store_dwordx4 v[100:103], v4, s[4:7], s42 offen sc1
    s_add_u32 s41, s40, 5
    s_and_b32 s42, s41, 15
    s_lshr_b32 s41, s41, 4
    s_mul_i32 s42, s42, 3
    s_add_u32 s41, s41, s42
    s_mul_i32 s41, s41, 28
    s_add_u32 s41, s41, s35
    s_lshl_b32 s41, s41, 10
    s_add_u32 s41, s41, 0xc40000
    s_add_u32 s42, s41, 14336
    v_and_b32 v108, v108, v44
    v_and_b32 v109, v109, v44
    v_and_b32 v110, v110, v44
    v_and_b32 v111, v111, v44
    buffer_store_dwordx4 v[104:107], v4, s[4:7], s41 offen sc1
    buffer_store_dwordx4 v[108:111], v4, s[4:7], s42 offen sc1
    s_branch gated_mix__linear_attn_block__memory_aug_recurrent_mem_tr__prompt_kernel_K1_mdone
gated_mix__linear_attn_block__memory_aug_recurrent_mem_tr__prompt_kernel_K1_wo:
    s_load_dwordx2 s[16:17], s[0:1], 16
    s_mov_b32 s18, 0x62000
    s_mov_b32 s19, 0x20000
    s_sub_u32 s35, s34, 28
    s_lshl_b32 s35, s35, 2
    s_add_u32 s35, s35, s26
    s_mul_i32 s37, s35, 25088
    s_mul_i32 s38, s26, 29184
    v_add_u32 v42, s38, v4
    s_waitcnt lgkmcnt(0)
    buffer_load_dwordx4 v[64:67], v4, s[16:19], s37 offen offset:0
    buffer_load_dwordx4 v[68:71], v4, s[16:19], s37 offen offset:896
    buffer_load_dwordx4 v[72:75], v4, s[16:19], s37 offen offset:1792
    buffer_load_dwordx4 v[76:79], v4, s[16:19], s37 offen offset:2688
    s_add_u32 s37, s37, 3584
    buffer_load_dwordx4 v[80:83], v4, s[16:19], s37 offen offset:0
    buffer_load_dwordx4 v[84:87], v4, s[16:19], s37 offen offset:896
    buffer_load_dwordx4 v[88:91], v4, s[16:19], s37 offen offset:1792
    buffer_load_dwordx4 v[92:95], v4, s[16:19], s37 offen offset:2688
    s_add_u32 s37, s37, 3584
    buffer_load_dwordx4 v[96:99], v4, s[16:19], s37 offen offset:0
    buffer_load_dwordx4 v[100:103], v4, s[16:19], s37 offen offset:896
    buffer_load_dwordx4 v[104:107], v4, s[16:19], s37 offen offset:1792
    buffer_load_dwordx4 v[108:111], v4, s[16:19], s37 offen offset:2688
    s_add_u32 s37, s37, 3584
    buffer_load_dwordx4 v[112:115], v4, s[16:19], s37 offen offset:0
    buffer_load_dwordx4 v[116:119], v4, s[16:19], s37 offen offset:896
    buffer_load_dwordx4 v[120:123], v4, s[16:19], s37 offen offset:1792
    buffer_load_dwordx4 v[124:127], v4, s[16:19], s37 offen offset:2688
    s_add_u32 s37, s37, 3584
    buffer_load_dwordx4 v[128:131], v4, s[16:19], s37 offen offset:0
    buffer_load_dwordx4 v[132:135], v4, s[16:19], s37 offen offset:896
    buffer_load_dwordx4 v[136:139], v4, s[16:19], s37 offen offset:1792
    buffer_load_dwordx4 v[140:143], v4, s[16:19], s37 offen offset:2688
    s_add_u32 s37, s37, 3584
    buffer_load_dwordx4 v[144:147], v4, s[16:19], s37 offen offset:0
    buffer_load_dwordx4 v[148:151], v4, s[16:19], s37 offen offset:896
    buffer_load_dwordx4 v[152:155], v4, s[16:19], s37 offen offset:1792
    buffer_load_dwordx4 v[156:159], v4, s[16:19], s37 offen offset:2688
    s_add_u32 s37, s37, 3584
    buffer_load_dwordx4 v[160:163], v4, s[16:19], s37 offen offset:0
    buffer_load_dwordx4 v[164:167], v4, s[16:19], s37 offen offset:896
    buffer_load_dwordx4 v[168:171], v4, s[16:19], s37 offen offset:1792
    buffer_load_dwordx4 v[172:175], v4, s[16:19], s37 offen offset:2688
    s_add_u32 s37, s37, 3584
    v_cmp_gt_u32 vcc, 56, v2
    s_nop 0
    s_and_saveexec_b64 s[60:61], vcc
    s_waitcnt vmcnt(27)
    ds_write_b128 v42, v[64:67] offset:0
    s_waitcnt vmcnt(26)
    ds_write_b128 v42, v[68:71] offset:912
    s_waitcnt vmcnt(25)
    ds_write_b128 v42, v[72:75] offset:1824
    s_waitcnt vmcnt(24)
    ds_write_b128 v42, v[76:79] offset:2736
    s_waitcnt vmcnt(23)
    ds_write_b128 v42, v[80:83] offset:3648
    s_waitcnt vmcnt(22)
    ds_write_b128 v42, v[84:87] offset:4560
    s_waitcnt vmcnt(21)
    ds_write_b128 v42, v[88:91] offset:5472
    s_waitcnt vmcnt(20)
    ds_write_b128 v42, v[92:95] offset:6384
    s_waitcnt vmcnt(19)
    ds_write_b128 v42, v[96:99] offset:7296
    s_waitcnt vmcnt(18)
    ds_write_b128 v42, v[100:103] offset:8208
    s_waitcnt vmcnt(17)
    ds_write_b128 v42, v[104:107] offset:9120
    s_waitcnt vmcnt(16)
    ds_write_b128 v42, v[108:111] offset:10032
    s_waitcnt vmcnt(15)
    ds_write_b128 v42, v[112:115] offset:10944
    s_waitcnt vmcnt(14)
    ds_write_b128 v42, v[116:119] offset:11856
    s_waitcnt vmcnt(13)
    ds_write_b128 v42, v[120:123] offset:12768
    s_waitcnt vmcnt(12)
    ds_write_b128 v42, v[124:127] offset:13680
    s_waitcnt vmcnt(11)
    ds_write_b128 v42, v[128:131] offset:14592
    s_waitcnt vmcnt(10)
    ds_write_b128 v42, v[132:135] offset:15504
    s_waitcnt vmcnt(9)
    ds_write_b128 v42, v[136:139] offset:16416
    s_waitcnt vmcnt(8)
    ds_write_b128 v42, v[140:143] offset:17328
    s_waitcnt vmcnt(7)
    ds_write_b128 v42, v[144:147] offset:18240
    s_waitcnt vmcnt(6)
    ds_write_b128 v42, v[148:151] offset:19152
    s_waitcnt vmcnt(5)
    ds_write_b128 v42, v[152:155] offset:20064
    s_waitcnt vmcnt(4)
    ds_write_b128 v42, v[156:159] offset:20976
    s_waitcnt vmcnt(3)
    ds_write_b128 v42, v[160:163] offset:21888
    s_waitcnt vmcnt(2)
    ds_write_b128 v42, v[164:167] offset:22800
    s_waitcnt vmcnt(1)
    ds_write_b128 v42, v[168:171] offset:23712
    s_waitcnt vmcnt(0)
    ds_write_b128 v42, v[172:175] offset:24624
    s_mov_b64 exec, s[60:61]
    v_mul_u32_u24 v43, 912, v40
    v_lshl_add_u32 v43, v41, 4, v43
    v_add_u32 v43, s38, v43
    v_cmp_gt_u32 vcc, 3, v5
    s_nop 1
    v_cndmask_b32 v44, 0, -1, vcc
    s_lshl_b32 s41, s35, 10
    s_add_u32 s41, s41, 0xd90000
    s_waitcnt lgkmcnt(0)
    ds_read_b64_tr_b16 v[64:65], v43 offset:0
    ds_read_b64_tr_b16 v[66:67], v43 offset:3648
    ds_read_b64_tr_b16 v[68:69], v43 offset:8
    ds_read_b64_tr_b16 v[70:71], v43 offset:3656
    ds_read_b64_tr_b16 v[72:73], v43 offset:64
    ds_read_b64_tr_b16 v[74:75], v43 offset:3712
    ds_read_b64_tr_b16 v[76:77], v43 offset:72
    ds_read_b64_tr_b16 v[78:79], v43 offset:3720
    ds_read_b64_tr_b16 v[80:81], v43 offset:128
    ds_read_b64_tr_b16 v[82:83], v43 offset:3776
    ds_read_b64_tr_b16 v[84:85], v43 offset:136
    ds_read_b64_tr_b16 v[86:87], v43 offset:3784
    ds_read_b64_tr_b16 v[88:89], v43 offset:192
    ds_read_b64_tr_b16 v[90:91], v43 offset:3840
    s_waitcnt lgkmcnt(0)
    ds_read_b64_tr_b16 v[92:93], v43 offset:200
    ds_read_b64_tr_b16 v[94:95], v43 offset:3848
    ds_read_b64_tr_b16 v[96:97], v43 offset:256
    ds_read_b64_tr_b16 v[98:99], v43 offset:3904
    ds_read_b64_tr_b16 v[100:101], v43 offset:264
    ds_read_b64_tr_b16 v[102:103], v43 offset:3912
    ds_read_b64_tr_b16 v[104:105], v43 offset:320
    ds_read_b64_tr_b16 v[106:107], v43 offset:3968
    ds_read_b64_tr_b16 v[108:109], v43 offset:328
    ds_read_b64_tr_b16 v[110:111], v43 offset:3976
    ds_read_b64_tr_b16 v[112:113], v43 offset:384
    ds_read_b64_tr_b16 v[114:115], v43 offset:4032
    ds_read_b64_tr_b16 v[116:117], v43 offset:392
    ds_read_b64_tr_b16 v[118:119], v43 offset:4040
    s_waitcnt lgkmcnt(0)
    ds_read_b64_tr_b16 v[120:121], v43 offset:448
    ds_read_b64_tr_b16 v[122:123], v43 offset:4096
    ds_read_b64_tr_b16 v[124:125], v43 offset:456
    ds_read_b64_tr_b16 v[126:127], v43 offset:4104
    ds_read_b64_tr_b16 v[128:129], v43 offset:512
    ds_read_b64_tr_b16 v[130:131], v43 offset:4160
    ds_read_b64_tr_b16 v[132:133], v43 offset:520
    ds_read_b64_tr_b16 v[134:135], v43 offset:4168
    ds_read_b64_tr_b16 v[136:137], v43 offset:576
    ds_read_b64_tr_b16 v[138:139], v43 offset:4224
    ds_read_b64_tr_b16 v[140:141], v43 offset:584
    ds_read_b64_tr_b16 v[142:143], v43 offset:4232
    ds_read_b64_tr_b16 v[144:145], v43 offset:640
    ds_read_b64_tr_b16 v[146:147], v43 offset:4288
    s_waitcnt lgkmcnt(0)
    ds_read_b64_tr_b16 v[148:149], v43 offset:648
    ds_read_b64_tr_b16 v[150:151], v43 offset:4296
    ds_read_b64_tr_b16 v[152:153], v43 offset:704
    ds_read_b64_tr_b16 v[154:155], v43 offset:4352
    ds_read_b64_tr_b16 v[156:157], v43 offset:712
    ds_read_b64_tr_b16 v[158:159], v43 offset:4360
    ds_read_b64_tr_b16 v[160:161], v43 offset:768
    ds_read_b64_tr_b16 v[162:163], v43 offset:4416
    ds_read_b64_tr_b16 v[164:165], v43 offset:776
    ds_read_b64_tr_b16 v[166:167], v43 offset:4424
    ds_read_b64_tr_b16 v[168:169], v43 offset:832
    ds_read_b64_tr_b16 v[170:171], v43 offset:4480
    ds_read_b64_tr_b16 v[172:173], v43 offset:840
    ds_read_b64_tr_b16 v[174:175], v43 offset:4488
    s_waitcnt lgkmcnt(0)
    v_and_b32 v66, v66, v44
    v_and_b32 v67, v67, v44
    buffer_store_dwordx4 v[64:67], v4, s[4:7], s41 offen sc1
    s_add_u32 s41, s41, 16384
    v_and_b32 v70, v70, v44
    v_and_b32 v71, v71, v44
    buffer_store_dwordx4 v[68:71], v4, s[4:7], s41 offen sc1
    s_add_u32 s41, s41, 16384
    v_and_b32 v74, v74, v44
    v_and_b32 v75, v75, v44
    buffer_store_dwordx4 v[72:75], v4, s[4:7], s41 offen sc1
    s_add_u32 s41, s41, 16384
    v_and_b32 v78, v78, v44
    v_and_b32 v79, v79, v44
    buffer_store_dwordx4 v[76:79], v4, s[4:7], s41 offen sc1
    s_add_u32 s41, s41, 16384
    v_and_b32 v82, v82, v44
    v_and_b32 v83, v83, v44
    buffer_store_dwordx4 v[80:83], v4, s[4:7], s41 offen sc1
    s_add_u32 s41, s41, 16384
    v_and_b32 v86, v86, v44
    v_and_b32 v87, v87, v44
    buffer_store_dwordx4 v[84:87], v4, s[4:7], s41 offen sc1
    s_add_u32 s41, s41, 16384
    v_and_b32 v90, v90, v44
    v_and_b32 v91, v91, v44
    buffer_store_dwordx4 v[88:91], v4, s[4:7], s41 offen sc1
    s_add_u32 s41, s41, 16384
    v_and_b32 v94, v94, v44
    v_and_b32 v95, v95, v44
    buffer_store_dwordx4 v[92:95], v4, s[4:7], s41 offen sc1
    s_add_u32 s41, s41, 16384
    v_and_b32 v98, v98, v44
    v_and_b32 v99, v99, v44
    buffer_store_dwordx4 v[96:99], v4, s[4:7], s41 offen sc1
    s_add_u32 s41, s41, 16384
    v_and_b32 v102, v102, v44
    v_and_b32 v103, v103, v44
    buffer_store_dwordx4 v[100:103], v4, s[4:7], s41 offen sc1
    s_add_u32 s41, s41, 16384
    v_and_b32 v106, v106, v44
    v_and_b32 v107, v107, v44
    buffer_store_dwordx4 v[104:107], v4, s[4:7], s41 offen sc1
    s_add_u32 s41, s41, 16384
    v_and_b32 v110, v110, v44
    v_and_b32 v111, v111, v44
    buffer_store_dwordx4 v[108:111], v4, s[4:7], s41 offen sc1
    s_add_u32 s41, s41, 16384
    v_and_b32 v114, v114, v44
    v_and_b32 v115, v115, v44
    buffer_store_dwordx4 v[112:115], v4, s[4:7], s41 offen sc1
    s_add_u32 s41, s41, 16384
    v_and_b32 v118, v118, v44
    v_and_b32 v119, v119, v44
    buffer_store_dwordx4 v[116:119], v4, s[4:7], s41 offen sc1
    s_add_u32 s41, s41, 16384
    v_and_b32 v122, v122, v44
    v_and_b32 v123, v123, v44
    buffer_store_dwordx4 v[120:123], v4, s[4:7], s41 offen sc1
    s_add_u32 s41, s41, 16384
    v_and_b32 v126, v126, v44
    v_and_b32 v127, v127, v44
    buffer_store_dwordx4 v[124:127], v4, s[4:7], s41 offen sc1
    s_add_u32 s41, s41, 16384
    v_and_b32 v130, v130, v44
    v_and_b32 v131, v131, v44
    buffer_store_dwordx4 v[128:131], v4, s[4:7], s41 offen sc1
    s_add_u32 s41, s41, 16384
    v_and_b32 v134, v134, v44
    v_and_b32 v135, v135, v44
    buffer_store_dwordx4 v[132:135], v4, s[4:7], s41 offen sc1
    s_add_u32 s41, s41, 16384
    v_and_b32 v138, v138, v44
    v_and_b32 v139, v139, v44
    buffer_store_dwordx4 v[136:139], v4, s[4:7], s41 offen sc1
    s_add_u32 s41, s41, 16384
    v_and_b32 v142, v142, v44
    v_and_b32 v143, v143, v44
    buffer_store_dwordx4 v[140:143], v4, s[4:7], s41 offen sc1
    s_add_u32 s41, s41, 16384
    v_and_b32 v146, v146, v44
    v_and_b32 v147, v147, v44
    buffer_store_dwordx4 v[144:147], v4, s[4:7], s41 offen sc1
    s_add_u32 s41, s41, 16384
    v_and_b32 v150, v150, v44
    v_and_b32 v151, v151, v44
    buffer_store_dwordx4 v[148:151], v4, s[4:7], s41 offen sc1
    s_add_u32 s41, s41, 16384
    v_and_b32 v154, v154, v44
    v_and_b32 v155, v155, v44
    buffer_store_dwordx4 v[152:155], v4, s[4:7], s41 offen sc1
    s_add_u32 s41, s41, 16384
    v_and_b32 v158, v158, v44
    v_and_b32 v159, v159, v44
    buffer_store_dwordx4 v[156:159], v4, s[4:7], s41 offen sc1
    s_add_u32 s41, s41, 16384
    v_and_b32 v162, v162, v44
    v_and_b32 v163, v163, v44
    buffer_store_dwordx4 v[160:163], v4, s[4:7], s41 offen sc1
    s_add_u32 s41, s41, 16384
    v_and_b32 v166, v166, v44
    v_and_b32 v167, v167, v44
    buffer_store_dwordx4 v[164:167], v4, s[4:7], s41 offen sc1
    s_add_u32 s41, s41, 16384
    v_and_b32 v170, v170, v44
    v_and_b32 v171, v171, v44
    buffer_store_dwordx4 v[168:171], v4, s[4:7], s41 offen sc1
    s_add_u32 s41, s41, 16384
    v_and_b32 v174, v174, v44
    v_and_b32 v175, v175, v44
    buffer_store_dwordx4 v[172:175], v4, s[4:7], s41 offen sc1
    s_add_u32 s41, s41, 16384
gated_mix__linear_attn_block__memory_aug_recurrent_mem_tr__prompt_kernel_K1_mdone:
    s_waitcnt vmcnt(0) lgkmcnt(0)
    s_barrier
    s_cmp_lg_u32 s26, 0
    s_cbranch_scc1 gated_mix__linear_attn_block__memory_aug_recurrent_mem_tr__prompt_kernel_M_ai
    s_mov_b64 exec, 1
    v_mov_b32 v5, 1
    buffer_atomic_add v5, off, s[84:87], 0 offset:144 sc0 sc1
    s_waitcnt vmcnt(0)
    v_readfirstlane_b32 s33, v5
    s_nop 0
    s_cmp_lg_u32 s33, 31
    s_cbranch_scc1 gated_mix__linear_attn_block__memory_aug_recurrent_mem_tr__prompt_kernel_M_ai_x
    buffer_store_dword v5, off, s[84:87], 0 offset:16 sc1
gated_mix__linear_attn_block__memory_aug_recurrent_mem_tr__prompt_kernel_M_ai_x:
    s_mov_b64 exec, -1
gated_mix__linear_attn_block__memory_aug_recurrent_mem_tr__prompt_kernel_M_ai:
gated_mix__linear_attn_block__memory_aug_recurrent_mem_tr__prompt_kernel_M_go:
    v_lshrrev_b32 v1, 6, v0
    s_nop 0
    v_readfirstlane_b32 s26, v1
    v_and_b32 v1, 63, v0
    v_lshlrev_b32 v2, 4, v1
    v_lshrrev_b32 v3, 4, v1
    v_and_b32 v4, 15, v1
    s_waitcnt lgkmcnt(0)
    s_cmp_lg_u32 s24, 0
    s_cbranch_scc1 gated_mix__linear_attn_block__memory_aug_recurrent_mem_tr__prompt_kernel_M_worker
    s_mov_b32 s27, s25
    s_cmp_lt_u32 s25, 16
    s_cbranch_scc1 gated_mix__linear_attn_block__memory_aug_recurrent_mem_tr__prompt_kernel_R_A
    s_sub_u32 s27, s25, 16
    s_cmp_lt_u32 s25, 30
    s_cbranch_scc1 gated_mix__linear_attn_block__memory_aug_recurrent_mem_tr__prompt_kernel_R_B
    s_branch gated_mix__linear_attn_block__memory_aug_recurrent_mem_tr__prompt_kernel_R_H
gated_mix__linear_attn_block__memory_aug_recurrent_mem_tr__prompt_kernel_M_worker:
    s_add_u32 s27, s25, 32
    s_cmp_eq_u32 s24, 7
    s_cbranch_scc1 gated_mix__linear_attn_block__memory_aug_recurrent_mem_tr__prompt_kernel_R_F
    s_mov_b32 s27, s25
    s_cmp_eq_u32 s24, 1
    s_cbranch_scc1 gated_mix__linear_attn_block__memory_aug_recurrent_mem_tr__prompt_kernel_R_F
    s_cmp_eq_u32 s24, 6
    s_cbranch_scc1 gated_mix__linear_attn_block__memory_aug_recurrent_mem_tr__prompt_kernel_R_L
    s_sub_u32 s29, s24, 2
    s_cmp_lt_u32 s25, 24
    s_cbranch_scc1 gated_mix__linear_attn_block__memory_aug_recurrent_mem_tr__prompt_kernel_M_w3
    s_lshl_b32 s27, s29, 3
    s_add_u32 s27, s27, s25
    s_add_u32 s27, s27, 8
    s_branch gated_mix__linear_attn_block__memory_aug_recurrent_mem_tr__prompt_kernel_R_L
gated_mix__linear_attn_block__memory_aug_recurrent_mem_tr__prompt_kernel_M_w3:
    s_sub_u32 s30, s25, 12
    s_cmp_lt_u32 s25, 12
    s_cselect_b32 s30, s25, s30
    s_mul_i32 s31, s30, 43
    s_lshr_b32 s31, s31, 7
    s_mul_i32 s28, s31, 3
    s_sub_u32 s28, s30, s28
    s_lshl_b32 s27, s29, 2
    s_add_u32 s27, s27, s31
    s_cmp_lt_u32 s25, 12
    s_cbranch_scc1 gated_mix__linear_attn_block__memory_aug_recurrent_mem_tr__prompt_kernel_R_Z
    s_branch gated_mix__linear_attn_block__memory_aug_recurrent_mem_tr__prompt_kernel_R_T
gated_mix__linear_attn_block__memory_aug_recurrent_mem_tr__prompt_kernel_M_end:
    s_endpgm
gated_mix__linear_attn_block__memory_aug_recurrent_mem_tr__prompt_kernel_R_A:
    s_add_u32 s33, s26, 0
    s_and_b32 s33, s33, 3
    s_lshl_b32 s50, s33, 11
    s_add_u32 s33, s26, 1
    s_and_b32 s33, s33, 3
    s_lshl_b32 s51, s33, 11
    s_add_u32 s33, s26, 2
    s_and_b32 s33, s33, 3
    s_lshl_b32 s52, s33, 11
    s_add_u32 s33, s26, 3
    s_and_b32 s33, s33, 3
    s_lshl_b32 s53, s33, 11
    s_add_u32 s33, s26, 0
    s_sub_u32 s34, s33, 3
    s_cmp_ge_u32 s33, 3
    s_cselect_b32 s33, s34, s33
    s_lshl_b32 s33, s33, 11
    s_add_u32 s54, s33, 1024
    s_add_u32 s33, s26, 1
    s_sub_u32 s34, s33, 3
    s_cmp_ge_u32 s33, 3
    s_cselect_b32 s33, s34, s33
    s_lshl_b32 s33, s33, 11
    s_add_u32 s55, s33, 1024
    s_add_u32 s33, s26, 2
    s_sub_u32 s34, s33, 3
    s_cmp_ge_u32 s33, 3
    s_cselect_b32 s33, s34, s33
    s_lshl_b32 s33, s33, 11
    s_add_u32 s56, s33, 1024
    s_and_b32 s32, s26, 1
    s_mul_i32 s31, s26, 7
    s_add_u32 s30, s31, s32
    s_xor_b32 s33, s32, 1
    s_mul_i32 s33, s33, 6
    s_add_u32 s31, s31, s33
    s_lshr_b32 s37, s30, 1
    s_lshr_b32 s38, s31, 1
    v_and_b32 v12, 7, v4
    v_lshrrev_b32 v13, 3, v4
    v_lshrrev_b32 v14, 2, v4
    v_and_b32 v15, 3, v4
    v_and_b32 v16, 1, v4
    v_lshl_add_u32 v16, v14, 1, v16
    v_lshlrev_b32 v16, 4, v16
    v_lshl_add_u32 v16, v3, 7, v16
    s_lshl_b32 s33, s37, 9
    v_add_u32 v20, s33, v16
    s_lshl_b32 s33, s38, 9
    s_lshl_b32 s34, s32, 3
    s_add_u32 s33, s33, s34
    v_add_u32 v21, s33, v16
    s_mul_i32 s33, s26, 6400
    s_add_u32 s33, s33, 7168
    v_mul_u32_u24 v5, 392, v14
    v_lshl_add_u32 v5, v15, 5, v5
    v_lshl_add_u32 v5, v3, 3, v5
    v_add_u32 v5, s33, v5
    v_mul_u32_u24 v6, 392, v3
    v_lshl_add_u32 v6, v14, 5, v6
    v_lshl_add_u32 v6, v15, 3, v6
    v_add_u32 v6, s33, v6
    v_lshl_add_u32 v7, v3, 1, v13
    v_add_u32 v7, v7, v12
    v_and_b32 v7, 7, v7
    v_lshl_add_u32 v7, v12, 3, v7
    v_lshlrev_b32 v7, 4, v7
    s_lshl_b32 s33, s26, 10
    s_add_u32 s33, s33, 32768
    v_add_u32 v7, s33, v7
    v_lshrrev_b32 v17, 3, v1
    v_and_b32 v18, 7, v1
    v_add_u32 v8, v17, v18
    v_and_b32 v8, 7, v8
    v_lshl_add_u32 v8, v17, 3, v8
    v_lshlrev_b32 v8, 4, v8
    v_add_u32 v8, 32768, v8
    s_lshl_b32 s33, s38, 10
    s_lshl_b32 s34, s32, 3
    s_add_u32 s33, s33, s34
    v_add_u32 v11, s33, v2
    s_lshl_b32 s33, s37, 10
    v_add_u32 v10, s33, v2
    v_lshrrev_b32 v19, 1, v18
    v_and_b32 v22, 1, v18
    s_and_b32 s33, s27, 3
    s_lshr_b32 s34, s27, 2
    s_mul_i32 s34, s34, 2560
    v_lshlrev_b32 v25, 4, v17
    v_add_u32 v25, s34, v25
    s_lshl_b32 s35, s33, 9
    v_lshl_add_u32 v9, v19, 7, v25
    v_lshl_add_u32 v9, v22, 3, v9
    v_add_u32 v9, s35, v9
    s_lshl_b32 s35, s33, 7
    s_add_u32 s35, s35, 2048
    v_lshl_add_u32 v27, v19, 2, v25
    v_add_u32 v27, s35, v27
    v_mov_b32 v28, 0x40000000
    v_cmp_eq_u32 vcc, 0, v22
    s_nop 1
    v_cndmask_b32 v0, v28, v27, vcc
    v_mov_b32 v28, 0x44444444
    v_mov_b32 v29, 0xeeeeeeee
    v_cmp_eq_u32 vcc, 0, v13
    s_nop 1
    v_cndmask_b32 v1, v29, v28, vcc
    v_mov_b32 v3, v20
    v_mov_b32 v4, v21
    s_mov_b32 s40, 0
    s_mov_b32 s41, 0xfc0000
    s_mov_b32 s42, 0x10c0000
    s_mov_b32 s43, 0x38e0000
    s_mul_i32 s34, s27, 28
    s_add_u32 s35, s34, s31
    s_add_u32 s34, s34, s30
    s_mul_i32 s34, s34, 14336
    s_mul_i32 s35, s35, 14336
    s_cmp_lg_u32 s26, 0
    s_cbranch_scc1 gated_mix__linear_attn_block__memory_aug_recurrent_mem_tr__prompt_kernel_RA_wi_b
    s_lshl_b32 s36, s27, 7
    s_add_u32 s36, s36, 0x3aa0000
gated_mix__linear_attn_block__memory_aug_recurrent_mem_tr__prompt_kernel_RA_wi:
    buffer_load_dword v12, off, s[4:7], s36 sc1
    s_waitcnt vmcnt(0)
    v_readfirstlane_b32 s33, v12
    s_nop 0
    s_cmp_lg_u32 s33, 0
    s_cbranch_scc1 gated_mix__linear_attn_block__memory_aug_recurrent_mem_tr__prompt_kernel_RA_wi_b
    s_sleep 2
    s_branch gated_mix__linear_attn_block__memory_aug_recurrent_mem_tr__prompt_kernel_RA_wi
gated_mix__linear_attn_block__memory_aug_recurrent_mem_tr__prompt_kernel_RA_wi_b:
    s_barrier
    s_lshl_b32 s36, s50, 1
    s_add_u32 s36, s36, s34
    buffer_load_dwordx4 a[0:3], v2, s[4:7], s36 offen offset:0 sc1
    buffer_load_dwordx4 a[4:7], v2, s[4:7], s36 offen offset:1024 sc1
    s_lshl_b32 s36, s51, 1
    s_add_u32 s36, s36, s34
    buffer_load_dwordx4 a[8:11], v2, s[4:7], s36 offen offset:0 sc1
    buffer_load_dwordx4 a[12:15], v2, s[4:7], s36 offen offset:1024 sc1
    s_lshl_b32 s36, s52, 1
    s_add_u32 s36, s36, s34
    buffer_load_dwordx4 a[16:19], v2, s[4:7], s36 offen offset:0 sc1
    buffer_load_dwordx4 a[20:23], v2, s[4:7], s36 offen offset:1024 sc1
    s_lshl_b32 s36, s53, 1
    s_add_u32 s36, s36, s34
    buffer_load_dwordx4 a[24:27], v2, s[4:7], s36 offen offset:0 sc1
    buffer_load_dwordx4 a[28:31], v2, s[4:7], s36 offen offset:1024 sc1
    s_lshl_b32 s36, s54, 1
    s_add_u32 s36, s36, s34
    buffer_load_dwordx4 a[32:35], v2, s[4:7], s36 offen offset:0 sc1
    buffer_load_dwordx4 a[36:39], v2, s[4:7], s36 offen offset:1024 sc1
    s_lshl_b32 s36, s55, 1
    s_add_u32 s36, s36, s34
    buffer_load_dwordx4 a[40:43], v2, s[4:7], s36 offen offset:0 sc1
    buffer_load_dwordx4 a[44:47], v2, s[4:7], s36 offen offset:1024 sc1
    s_lshl_b32 s36, s56, 1
    s_add_u32 s36, s36, s34
    buffer_load_dwordx4 a[48:51], v2, s[4:7], s36 offen offset:0 sc1
    buffer_load_dwordx4 a[52:55], v2, s[4:7], s36 offen offset:1024 sc1
    s_lshl_b32 s36, s50, 1
    s_add_u32 s36, s36, s34
    s_add_u32 s36, s36, 14336
    buffer_load_dwordx4 a[56:59], v2, s[4:7], s36 offen offset:0 sc1
    buffer_load_dwordx4 a[60:63], v2, s[4:7], s36 offen offset:1024 sc1
    s_lshl_b32 s36, s51, 1
    s_add_u32 s36, s36, s34
    s_add_u32 s36, s36, 14336
    buffer_load_dwordx4 a[64:67], v2, s[4:7], s36 offen offset:0 sc1
    buffer_load_dwordx4 a[68:71], v2, s[4:7], s36 offen offset:1024 sc1
    s_lshl_b32 s36, s52, 1
    s_add_u32 s36, s36, s34
    s_add_u32 s36, s36, 14336
    buffer_load_dwordx4 a[72:75], v2, s[4:7], s36 offen offset:0 sc1
    buffer_load_dwordx4 a[76:79], v2, s[4:7], s36 offen offset:1024 sc1
    s_lshl_b32 s36, s53, 1
    s_add_u32 s36, s36, s34
    s_add_u32 s36, s36, 14336
    buffer_load_dwordx4 a[80:83], v2, s[4:7], s36 offen offset:0 sc1
    buffer_load_dwordx4 a[84:87], v2, s[4:7], s36 offen offset:1024 sc1
    s_lshl_b32 s36, s54, 1
    s_add_u32 s36, s36, s34
    s_add_u32 s36, s36, 14336
    buffer_load_dwordx4 a[88:91], v2, s[4:7], s36 offen offset:0 sc1
    buffer_load_dwordx4 a[92:95], v2, s[4:7], s36 offen offset:1024 sc1
    s_lshl_b32 s36, s55, 1
    s_add_u32 s36, s36, s34
    s_add_u32 s36, s36, 14336
    buffer_load_dwordx4 a[96:99], v2, s[4:7], s36 offen offset:0 sc1
    buffer_load_dwordx4 a[100:103], v2, s[4:7], s36 offen offset:1024 sc1
    s_lshl_b32 s36, s56, 1
    s_add_u32 s36, s36, s34
    s_add_u32 s36, s36, 14336
    buffer_load_dwordx4 a[104:107], v2, s[4:7], s36 offen offset:0 sc1
    buffer_load_dwordx4 a[108:111], v2, s[4:7], s36 offen offset:1024 sc1
    s_lshl_b32 s36, s50, 1
    s_add_u32 s36, s36, s34
    s_add_u32 s36, s36, 28672
    buffer_load_dwordx4 a[112:115], v2, s[4:7], s36 offen offset:0 sc1
    buffer_load_dwordx4 a[116:119], v2, s[4:7], s36 offen offset:1024 sc1
    s_lshl_b32 s36, s51, 1
    s_add_u32 s36, s36, s34
    s_add_u32 s36, s36, 28672
    buffer_load_dwordx4 a[120:123], v2, s[4:7], s36 offen offset:0 sc1
    buffer_load_dwordx4 a[124:127], v2, s[4:7], s36 offen offset:1024 sc1
    s_lshl_b32 s36, s52, 1
    s_add_u32 s36, s36, s34
    s_add_u32 s36, s36, 28672
    buffer_load_dwordx4 a[128:131], v2, s[4:7], s36 offen offset:0 sc1
    buffer_load_dwordx4 a[132:135], v2, s[4:7], s36 offen offset:1024 sc1
    s_lshl_b32 s36, s53, 1
    s_add_u32 s36, s36, s34
    s_add_u32 s36, s36, 28672
    buffer_load_dwordx4 a[136:139], v2, s[4:7], s36 offen offset:0 sc1
    buffer_load_dwordx4 a[140:143], v2, s[4:7], s36 offen offset:1024 sc1
    s_lshl_b32 s36, s54, 1
    s_add_u32 s36, s36, s34
    s_add_u32 s36, s36, 28672
    buffer_load_dwordx4 a[144:147], v2, s[4:7], s36 offen offset:0 sc1
    buffer_load_dwordx4 a[148:151], v2, s[4:7], s36 offen offset:1024 sc1
    s_lshl_b32 s36, s55, 1
    s_add_u32 s36, s36, s34
    s_add_u32 s36, s36, 28672
    buffer_load_dwordx4 a[152:155], v2, s[4:7], s36 offen offset:0 sc1
    buffer_load_dwordx4 a[156:159], v2, s[4:7], s36 offen offset:1024 sc1
    s_lshl_b32 s36, s56, 1
    s_add_u32 s36, s36, s34
    s_add_u32 s36, s36, 28672
    buffer_load_dwordx4 a[160:163], v2, s[4:7], s36 offen offset:0 sc1
    buffer_load_dwordx4 a[164:167], v2, s[4:7], s36 offen offset:1024 sc1
    s_lshl_b32 s36, s50, 1
    s_add_u32 s36, s36, s34
    s_add_u32 s36, s36, 43008
    buffer_load_dwordx4 a[168:171], v2, s[4:7], s36 offen offset:0 sc1
    buffer_load_dwordx4 a[172:175], v2, s[4:7], s36 offen offset:1024 sc1
    s_lshl_b32 s36, s51, 1
    s_add_u32 s36, s36, s34
    s_add_u32 s36, s36, 43008
    buffer_load_dwordx4 a[176:179], v2, s[4:7], s36 offen offset:0 sc1
    buffer_load_dwordx4 a[180:183], v2, s[4:7], s36 offen offset:1024 sc1
    s_lshl_b32 s36, s52, 1
    s_add_u32 s36, s36, s34
    s_add_u32 s36, s36, 43008
    buffer_load_dwordx4 a[184:187], v2, s[4:7], s36 offen offset:0 sc1
    buffer_load_dwordx4 a[188:191], v2, s[4:7], s36 offen offset:1024 sc1
    s_lshl_b32 s36, s53, 1
    s_add_u32 s36, s36, s34
    s_add_u32 s36, s36, 43008
    buffer_load_dwordx4 a[192:195], v2, s[4:7], s36 offen offset:0 sc1
    buffer_load_dwordx4 a[196:199], v2, s[4:7], s36 offen offset:1024 sc1
    s_lshl_b32 s36, s54, 1
    s_add_u32 s36, s36, s34
    s_add_u32 s36, s36, 43008
    buffer_load_dwordx4 a[200:203], v2, s[4:7], s36 offen offset:0 sc1
    buffer_load_dwordx4 a[204:207], v2, s[4:7], s36 offen offset:1024 sc1
    s_lshl_b32 s36, s55, 1
    s_add_u32 s36, s36, s34
    s_add_u32 s36, s36, 43008
    buffer_load_dwordx4 a[208:211], v2, s[4:7], s36 offen offset:0 sc1
    buffer_load_dwordx4 a[212:215], v2, s[4:7], s36 offen offset:1024 sc1
    s_lshl_b32 s36, s56, 1
    s_add_u32 s36, s36, s34
    s_add_u32 s36, s36, 43008
    buffer_load_dwordx4 a[216:219], v2, s[4:7], s36 offen offset:0 sc1
    buffer_load_dwordx4 a[220:223], v2, s[4:7], s36 offen offset:1024 sc1
    s_lshl_b32 s36, s50, 1
    s_add_u32 s36, s36, s34
    s_add_u32 s36, s36, 57344
    buffer_load_dwordx4 a[224:227], v2, s[4:7], s36 offen offset:0 sc1
    buffer_load_dwordx4 a[228:231], v2, s[4:7], s36 offen offset:1024 sc1
    s_lshl_b32 s36, s51, 1
    s_add_u32 s36, s36, s34
    s_add_u32 s36, s36, 57344
    buffer_load_dwordx4 a[232:235], v2, s[4:7], s36 offen offset:0 sc1
    buffer_load_dwordx4 a[236:239], v2, s[4:7], s36 offen offset:1024 sc1
    s_lshl_b32 s36, s52, 1
    s_add_u32 s36, s36, s34
    s_add_u32 s36, s36, 57344
    buffer_load_dwordx4 a[240:243], v2, s[4:7], s36 offen offset:0 sc1
    buffer_load_dwordx4 a[244:247], v2, s[4:7], s36 offen offset:1024 sc1
    s_lshl_b32 s36, s53, 1
    s_add_u32 s36, s36, s34
    s_add_u32 s36, s36, 57344
    buffer_load_dwordx4 a[248:251], v2, s[4:7], s36 offen offset:0 sc1
    buffer_load_dwordx4 a[252:255], v2, s[4:7], s36 offen offset:1024 sc1
    s_lshl_b32 s36, s54, 1
    s_add_u32 s36, s36, s34
    s_add_u32 s36, s36, 57344
    buffer_load_dwordx4 v[120:123], v2, s[4:7], s36 offen offset:0 sc1
    buffer_load_dwordx4 v[124:127], v2, s[4:7], s36 offen offset:1024 sc1
    s_lshl_b32 s36, s55, 1
    s_add_u32 s36, s36, s34
    s_add_u32 s36, s36, 57344
    buffer_load_dwordx4 v[128:131], v2, s[4:7], s36 offen offset:0 sc1
    buffer_load_dwordx4 v[132:135], v2, s[4:7], s36 offen offset:1024 sc1
    s_lshl_b32 s36, s56, 1
    s_add_u32 s36, s36, s34
    s_add_u32 s36, s36, 57344
    buffer_load_dwordx4 v[136:139], v2, s[4:7], s36 offen offset:0 sc1
    buffer_load_dwordx4 v[140:143], v2, s[4:7], s36 offen offset:1024 sc1
    buffer_load_dwordx2 v[12:13], off, s[84:87], 0 offset:224 sc1
    buffer_load_dword v15, off, s[84:87], 0 offset:24 sc1
    s_lshl_b32 s36, s50, 1
    s_add_u32 s36, s36, s34
    s_add_u32 s36, s36, 71680
    buffer_load_dwordx4 v[144:147], v2, s[4:7], s36 offen offset:0 sc1
    buffer_load_dwordx4 v[148:151], v2, s[4:7], s36 offen offset:1024 sc1
    s_lshl_b32 s36, s51, 1
    s_add_u32 s36, s36, s34
    s_add_u32 s36, s36, 71680
    buffer_load_dwordx4 v[152:155], v2, s[4:7], s36 offen offset:0 sc1
    buffer_load_dwordx4 v[156:159], v2, s[4:7], s36 offen offset:1024 sc1
    s_lshl_b32 s36, s52, 1
    s_add_u32 s36, s36, s34
    s_add_u32 s36, s36, 71680
    buffer_load_dwordx4 v[160:163], v2, s[4:7], s36 offen offset:0 sc1
    buffer_load_dwordx4 v[164:167], v2, s[4:7], s36 offen offset:1024 sc1
    s_lshl_b32 s36, s53, 1
    s_add_u32 s36, s36, s34
    s_add_u32 s36, s36, 71680
    buffer_load_dwordx4 v[168:171], v2, s[4:7], s36 offen offset:0 sc1
    buffer_load_dwordx4 v[172:175], v2, s[4:7], s36 offen offset:1024 sc1
    s_lshl_b32 s36, s54, 1
    s_add_u32 s36, s36, s34
    s_add_u32 s36, s36, 71680
    buffer_load_dwordx4 v[176:179], v2, s[4:7], s36 offen offset:0 sc1
    buffer_load_dwordx4 v[180:183], v2, s[4:7], s36 offen offset:1024 sc1
    s_lshl_b32 s36, s55, 1
    s_add_u32 s36, s36, s34
    s_add_u32 s36, s36, 71680
    buffer_load_dwordx4 v[184:187], v2, s[4:7], s36 offen offset:0 sc1
    buffer_load_dwordx4 v[188:191], v2, s[4:7], s36 offen offset:1024 sc1
    s_lshl_b32 s36, s56, 1
    s_add_u32 s36, s36, s34
    s_add_u32 s36, s36, 71680
    buffer_load_dwordx4 v[192:195], v2, s[4:7], s36 offen offset:0 sc1
    buffer_load_dwordx4 v[196:199], v2, s[4:7], s36 offen offset:1024 sc1
    s_lshl_b32 s36, s50, 1
    s_add_u32 s36, s36, s35
    buffer_load_dwordx4 v[200:203], v2, s[4:7], s36 offen offset:0 sc1
    buffer_load_dwordx4 v[204:207], v2, s[4:7], s36 offen offset:1024 sc1
    s_lshl_b32 s36, s51, 1
    s_add_u32 s36, s36, s35
    buffer_load_dwordx4 v[208:211], v2, s[4:7], s36 offen offset:0 sc1
    buffer_load_dwordx4 v[212:215], v2, s[4:7], s36 offen offset:1024 sc1
    s_lshl_b32 s36, s52, 1
    s_add_u32 s36, s36, s35
    buffer_load_dwordx4 v[216:219], v2, s[4:7], s36 offen offset:0 sc1
    buffer_load_dwordx4 v[220:223], v2, s[4:7], s36 offen offset:1024 sc1
    s_lshl_b32 s36, s53, 1
    s_add_u32 s36, s36, s35
    buffer_load_dwordx4 v[224:227], v2, s[4:7], s36 offen offset:0 sc1
    buffer_load_dwordx4 v[228:231], v2, s[4:7], s36 offen offset:1024 sc1
    s_lshl_b32 s36, s54, 1
    s_add_u32 s36, s36, s35
    buffer_load_dwordx4 v[232:235], v2, s[4:7], s36 offen offset:0 sc1
    buffer_load_dwordx4 v[236:239], v2, s[4:7], s36 offen offset:1024 sc1
    s_lshl_b32 s36, s55, 1
    s_add_u32 s36, s36, s35
    buffer_load_dwordx4 v[240:243], v2, s[4:7], s36 offen offset:0 sc1
    buffer_load_dwordx4 v[244:247], v2, s[4:7], s36 offen offset:1024 sc1
    s_lshl_b32 s36, s56, 1
    s_add_u32 s36, s36, s35
    buffer_load_dwordx4 v[248:251], v2, s[4:7], s36 offen offset:0 sc1
    buffer_load_dwordx4 v[252:255], v2, s[4:7], s36 offen offset:1024 sc1
    s_waitcnt vmcnt(28)
    s_branch gated_mix__linear_attn_block__memory_aug_recurrent_mem_tr__prompt_kernel_RA_m2
gated_mix__linear_attn_block__memory_aug_recurrent_mem_tr__prompt_kernel_RA_mode:
    buffer_load_dwordx2 v[12:13], off, s[84:87], 0 offset:224 sc1
    buffer_load_dword v15, off, s[84:87], 0 offset:24 sc1
    s_waitcnt vmcnt(0)
gated_mix__linear_attn_block__memory_aug_recurrent_mem_tr__prompt_kernel_RA_m2:
    v_sad_u8 v14, v12, 0, 0
    v_sad_u8 v14, v13, 0, v14
    v_readfirstlane_b32 s34, v12
    v_readfirstlane_b32 s35, v13
    v_readfirstlane_b32 s36, v15
    v_readfirstlane_b32 s33, v14
    s_nop 0
    s_cmp_lt_u32 s33, 31
    s_cbranch_scc1 gated_mix__linear_attn_block__memory_aug_recurrent_mem_tr__prompt_kernel_RA_mode
    s_cmp_eq_u32 s36, 0
    s_cbranch_scc1 gated_mix__linear_attn_block__memory_aug_recurrent_mem_tr__prompt_kernel_RA_mode
    s_cmp_eq_u32 s34, 0
    s_cselect_b32 s34, s35, s34
    s_ff1_i32_b32 s33, s34
    s_and_b32 s33, s33, 24
    s_lshr_b32 s34, s34, s33
    s_cmp_eq_u32 s34, 31
    s_cselect_b32 s49, 1, 0
    s_add_u32 s33, s43, 14336
    buffer_load_dwordx4 v[72:75], v10, s[4:7], s43 offen offset:0 sc1
    buffer_load_dwordx4 v[76:79], v10, s[4:7], s43 offen offset:1024 sc1
    buffer_load_dwordx4 v[80:83], v10, s[4:7], s43 offen offset:2048 sc1
    buffer_load_dwordx2 v[84:85], v11, s[4:7], s43 offen sc1
    buffer_load_dwordx4 v[86:89], v10, s[4:7], s33 offen offset:0 sc1
    buffer_load_dwordx4 v[90:93], v10, s[4:7], s33 offen offset:1024 sc1
    buffer_load_dwordx4 v[94:97], v10, s[4:7], s33 offen offset:2048 sc1
    buffer_load_dwordx2 v[98:99], v11, s[4:7], s33 offen sc1
    v_mov_b32 v44, 0
    v_mov_b32 v45, 0
    v_mov_b32 v46, 0
    v_mov_b32 v47, 0
    v_mov_b32 v48, 0
    v_mov_b32 v49, 0
    v_mov_b32 v50, 0
    v_mov_b32 v51, 0
    v_mov_b32 v52, 0
    v_mov_b32 v53, 0
    v_mov_b32 v54, 0
    v_mov_b32 v55, 0
    v_mov_b32 v56, 0
    v_mov_b32 v57, 0
    v_mov_b32 v58, 0
    v_mov_b32 v59, 0
    v_mov_b32 v60, 0
    v_mov_b32 v61, 0
    v_mov_b32 v62, 0
    v_mov_b32 v63, 0
    v_mov_b32 v64, 0
    v_mov_b32 v65, 0
    v_mov_b32 v66, 0
    v_mov_b32 v67, 0
    v_mov_b32 v68, 0
    v_mov_b32 v69, 0
    v_mov_b32 v70, 0
    v_mov_b32 v71, 0
.p2align 6
gated_mix__linear_attn_block__memory_aug_recurrent_mem_tr__prompt_kernel_RA_loop:
    s_add_u32 s44, s41, s50
    s_add_u32 s45, s41, s54
    v_add_u32 v12, s50, v2
    v_add_u32 v13, s54, v2
    s_sleep 6
    buffer_load_dwordx4 v[16:19], v2, s[4:7], s44 offen sc1
    s_nop 3
    s_nop 3
    s_nop 3
    s_nop 3
    s_nop 3
    buffer_load_dwordx4 v[16:19], v2, s[4:7], s44 offen sc1
    s_nop 3
    s_nop 3
    s_nop 3
    s_nop 3
    s_nop 3
    buffer_load_dwordx4 v[16:19], v2, s[4:7], s44 offen sc1
    s_branch gated_mix__linear_attn_block__memory_aug_recurrent_mem_tr__prompt_kernel_RA_poll
gated_mix__linear_attn_block__memory_aug_recurrent_mem_tr__prompt_kernel_RA_poll0:
    buffer_load_dwordx4 v[16:19], v2, s[4:7], s44 offen sc1
gated_mix__linear_attn_block__memory_aug_recurrent_mem_tr__prompt_kernel_RA_poll:
    s_waitcnt vmcnt(2)
    v_max3_u32 v14, v16, v17, v18
    v_max_u32 v14, v14, v19
    v_cmp_eq_u32 vcc, -1, v14
    ds_write_b128 v12, v[16:19] offset:0
    s_cbranch_vccnz gated_mix__linear_attn_block__memory_aug_recurrent_mem_tr__prompt_kernel_RA_poll0
    buffer_load_dwordx4 v[32:35], v2, s[4:7], s45 offen sc1
    v_smfmac_f32_16x16x64_bf16 v[44:47], v[16:19], a[0:7], v1
    v_add_u32 v119, s51, v2
    v_smfmac_f32_16x16x64_bf16 v[48:51], v[16:19], a[56:63], v1
    v_add_u32 v118, s52, v2
    v_smfmac_f32_16x16x64_bf16 v[52:55], v[16:19], a[112:119], v1
    v_add_u32 v117, s53, v2
    v_smfmac_f32_16x16x64_bf16 v[56:59], v[16:19], a[168:175], v1
    v_add_u32 v100, s55, v2
    s_waitcnt lgkmcnt(0)
    s_barrier
    ds_read_b128 v[20:23], v119 offset:0
    v_smfmac_f32_16x16x64_bf16 v[60:63], v[16:19], a[224:231], v1
    ds_read_b128 v[24:27], v118 offset:0
    v_smfmac_f32_16x16x64_bf16 v[64:67], v[16:19], v[144:151], v1
    ds_read_b128 v[28:31], v117 offset:0
    v_smfmac_f32_16x16x64_bf16 v[68:71], v[16:19], v[200:207], v1
    v_add_u32 v101, s56, v2
    s_waitcnt lgkmcnt(2)
    v_smfmac_f32_16x16x64_bf16 v[44:47], v[20:23], a[8:15], v1
    v_smfmac_f32_16x16x64_bf16 v[48:51], v[20:23], a[64:71], v1
    v_smfmac_f32_16x16x64_bf16 v[52:55], v[20:23], a[120:127], v1
    v_smfmac_f32_16x16x64_bf16 v[56:59], v[20:23], a[176:183], v1
    v_smfmac_f32_16x16x64_bf16 v[60:63], v[20:23], a[232:239], v1
    v_smfmac_f32_16x16x64_bf16 v[64:67], v[20:23], v[152:159], v1
    v_smfmac_f32_16x16x64_bf16 v[68:71], v[20:23], v[208:215], v1
    s_waitcnt lgkmcnt(1)
    v_smfmac_f32_16x16x64_bf16 v[44:47], v[24:27], a[16:23], v1
    s_waitcnt vmcnt(0)
    v_max3_u32 v14, v32, v33, v34
    v_smfmac_f32_16x16x64_bf16 v[48:51], v[24:27], a[72:79], v1
    v_max_u32 v14, v14, v35
    v_smfmac_f32_16x16x64_bf16 v[52:55], v[24:27], a[128:135], v1
    v_cmp_eq_u32 vcc, -1, v14
    v_smfmac_f32_16x16x64_bf16 v[56:59], v[24:27], a[184:191], v1
    ds_write_b128 v13, v[32:35] offset:0
    v_smfmac_f32_16x16x64_bf16 v[60:63], v[24:27], a[240:247], v1
    s_cbranch_vccnz gated_mix__linear_attn_block__memory_aug_recurrent_mem_tr__prompt_kernel_RA_p1r
gated_mix__linear_attn_block__memory_aug_recurrent_mem_tr__prompt_kernel_RA_p1b:
    v_smfmac_f32_16x16x64_bf16 v[64:67], v[24:27], v[160:167], v1
    v_smfmac_f32_16x16x64_bf16 v[68:71], v[24:27], v[216:223], v1
    s_waitcnt lgkmcnt(1)
    v_smfmac_f32_16x16x64_bf16 v[44:47], v[28:31], a[24:31], v1
    v_smfmac_f32_16x16x64_bf16 v[48:51], v[28:31], a[80:87], v1
    s_waitcnt lgkmcnt(0)
    s_barrier
    ds_read_b128 v[36:39], v100 offset:0
    v_smfmac_f32_16x16x64_bf16 v[52:55], v[28:31], a[136:143], v1
    ds_read_b128 v[40:43], v101 offset:0
    v_smfmac_f32_16x16x64_bf16 v[56:59], v[28:31], a[192:199], v1
    ds_read_b128 v[112:115], v3 offset:0
    v_smfmac_f32_16x16x64_bf16 v[60:63], v[28:31], a[248:255], v1
    ds_read_b128 v[116:119], v3 offset:512
    v_smfmac_f32_16x16x64_bf16 v[64:67], v[28:31], v[168:175], v1
    v_smfmac_f32_16x16x64_bf16 v[68:71], v[28:31], v[224:231], v1
    v_smfmac_f32_16x16x64_bf16 v[44:47], v[32:35], a[32:39], v1
    s_waitcnt lgkmcnt(2)
    v_smfmac_f32_16x16x64_bf16 v[44:47], v[36:39], a[40:47], v1
    v_smfmac_f32_16x16x64_bf16 v[44:47], v[40:43], a[48:55], v1
    v_smfmac_f32_16x16x64_bf16 v[48:51], v[32:35], a[88:95], v1
    v_smfmac_f32_16x16x64_bf16 v[48:51], v[36:39], a[96:103], v1
    v_smfmac_f32_16x16x64_bf16 v[48:51], v[40:43], a[104:111], v1
    v_cvt_pk_bf16_f32 v14, v44, v45
    v_smfmac_f32_16x16x64_bf16 v[52:55], v[32:35], a[144:151], v1
    v_cvt_pk_bf16_f32 v15, v46, v47
    v_smfmac_f32_16x16x64_bf16 v[52:55], v[36:39], a[152:159], v1
    ds_write_b64 v5, v[14:15] offset:0
    v_smfmac_f32_16x16x64_bf16 v[52:55], v[40:43], a[160:167], v1
    v_cvt_pk_bf16_f32 v14, v48, v49
    v_smfmac_f32_16x16x64_bf16 v[56:59], v[32:35], a[200:207], v1
    v_cvt_pk_bf16_f32 v15, v50, v51
    v_smfmac_f32_16x16x64_bf16 v[56:59], v[36:39], a[208:215], v1
    ds_write_b64 v5, v[14:15] offset:128
    v_smfmac_f32_16x16x64_bf16 v[56:59], v[40:43], a[216:223], v1
    ds_read_b64_tr_b16 v[44:45], v6 offset:0
    ds_read_b64_tr_b16 v[46:47], v6 offset:128
    v_cvt_pk_bf16_f32 v14, v52, v53
    v_smfmac_f32_16x16x64_bf16 v[60:63], v[32:35], v[120:127], v1
    v_cvt_pk_bf16_f32 v15, v54, v55
    v_smfmac_f32_16x16x64_bf16 v[60:63], v[36:39], v[128:135], v1
    ds_write_b64 v5, v[14:15] offset:1568
    v_smfmac_f32_16x16x64_bf16 v[60:63], v[40:43], v[136:143], v1
    v_cvt_pk_bf16_f32 v14, v56, v57
    v_smfmac_f32_16x16x64_bf16 v[64:67], v[32:35], v[176:183], v1
    v_cvt_pk_bf16_f32 v15, v58, v59
    v_smfmac_f32_16x16x64_bf16 v[64:67], v[36:39], v[184:191], v1
    ds_write_b64 v5, v[14:15] offset:1696
    s_waitcnt lgkmcnt(2)
    v_mfma_f32_16x16x32_bf16 v[100:103], v[72:75], v[44:47], 0
    v_mfma_f32_16x16x32_bf16 v[104:107], v[86:89], v[44:47], 0
    v_mfma_f32_16x16x32_bf16 v[108:111], v[112:115], v[44:47], 0
    ds_read_b128 v[112:115], v3 offset:1024
    v_smfmac_f32_16x16x64_bf16 v[64:67], v[40:43], v[192:199], v1
    ds_read_b64_tr_b16 v[52:53], v6 offset:1568
    ds_read_b64_tr_b16 v[54:55], v6 offset:1696
    v_cvt_pk_bf16_f32 v14, v60, v61
    v_smfmac_f32_16x16x64_bf16 v[68:71], v[32:35], v[232:239], v1
    v_cvt_pk_bf16_f32 v15, v62, v63
    v_smfmac_f32_16x16x64_bf16 v[68:71], v[36:39], v[240:247], v1
    ds_write_b64 v5, v[14:15] offset:3136
    v_smfmac_f32_16x16x64_bf16 v[68:71], v[40:43], v[248:255], v1
    v_cvt_pk_bf16_f32 v14, v64, v65
    v_cvt_pk_bf16_f32 v15, v66, v67
    ds_write_b64 v5, v[14:15] offset:3264
    ds_read_b64_tr_b16 v[60:61], v6 offset:3136
    ds_read_b64_tr_b16 v[62:63], v6 offset:3264
    s_waitcnt lgkmcnt(4)
    v_mfma_f32_16x16x32_bf16 v[100:103], v[76:79], v[52:55], v[100:103]
    v_mfma_f32_16x16x32_bf16 v[104:107], v[90:93], v[52:55], v[104:107]
    v_cvt_pk_bf16_f32 v14, v68, v69
    v_cvt_pk_bf16_f32 v15, v70, v71
    ds_write_b64 v5, v[14:15] offset:4704
    ds_read_b64_tr_b16 v[68:69], v6 offset:4704
    v_mfma_f32_16x16x32_bf16 v[108:111], v[116:119], v[52:55], v[108:111]
    ds_read_b64 v[116:117], v4 offset:0
    s_waitcnt lgkmcnt(3)
    v_mfma_f32_16x16x32_bf16 v[100:103], v[80:83], v[60:63], v[100:103]
    v_mfma_f32_16x16x32_bf16 v[104:107], v[94:97], v[60:63], v[104:107]
    v_mfma_f32_16x16x32_bf16 v[108:111], v[112:115], v[60:63], v[108:111]
    s_waitcnt lgkmcnt(0)
    v_mfma_f32_16x16x16_bf16 v[100:103], v[84:85], v[68:69], v[100:103]
    v_mfma_f32_16x16x16_bf16 v[104:107], v[98:99], v[68:69], v[104:107]
    v_mfma_f32_16x16x16_bf16 v[108:111], v[116:117], v[68:69], v[108:111]
    s_nop 3
    v_add_f32_dpp v100, v100, v100 row_ror:8 row_mask:0xf bank_mask:0x3
    v_add_f32_dpp v101, v101, v101 row_ror:8 row_mask:0xf bank_mask:0x3
    v_add_f32_dpp v102, v102, v102 row_ror:8 row_mask:0xf bank_mask:0x3
    v_add_f32_dpp v103, v103, v103 row_ror:8 row_mask:0xf bank_mask:0x3
    v_add_f32_dpp v100, v104, v104 row_ror:8 row_mask:0xf bank_mask:0xc
    v_add_f32_dpp v101, v105, v105 row_ror:8 row_mask:0xf bank_mask:0xc
    v_add_f32_dpp v102, v106, v106 row_ror:8 row_mask:0xf bank_mask:0xc
    v_add_f32_dpp v103, v107, v107 row_ror:8 row_mask:0xf bank_mask:0xc
    v_add_f32_dpp v108, v108, v108 row_ror:8 row_mask:0xf bank_mask:0x3
    ds_write_b128 v7, v[100:103]
    s_nop 0
    v_add_f32_dpp v108, v109, v109 row_ror:8 row_mask:0xf bank_mask:0xc
    ds_write_b32 v7, v108 offset:4096
    s_add_u32 s40, s40, 1
    s_add_u32 s41, s41, 8192
    s_add_u32 s43, s43, 28672
    s_cmp_lg_u32 s26, 0
    s_waitcnt vmcnt(0) lgkmcnt(0)
    s_barrier
    s_cbranch_scc1 gated_mix__linear_attn_block__memory_aug_recurrent_mem_tr__prompt_kernel_RA_other
    ds_read_b128 v[16:19], v8 offset:0
    ds_read_b128 v[20:23], v8 offset:1024
    ds_read_b128 v[24:27], v8 offset:2048
    ds_read_b128 v[28:31], v8 offset:3072
    ds_read_b32 v32, v8 offset:4096
    ds_read_b32 v33, v8 offset:5120
    ds_read_b32 v34, v8 offset:6144
    ds_read_b32 v35, v8 offset:7168
    s_cmp_eq_u32 s49, 0
    s_waitcnt lgkmcnt(6)
    v_pk_add_f32 v[16:17], v[16:17], v[20:21]
    v_pk_add_f32 v[18:19], v[18:19], v[22:23]
    s_waitcnt lgkmcnt(4)
    v_pk_add_f32 v[24:25], v[24:25], v[28:29]
    v_pk_add_f32 v[26:27], v[26:27], v[30:31]
    v_pk_add_f32 v[16:17], v[16:17], v[24:25]
    v_pk_add_f32 v[18:19], v[18:19], v[26:27]
    s_waitcnt lgkmcnt(0)
    v_pk_add_f32 v[32:33], v[32:33], v[34:35]
    v_max3_f32 v38, v16, v17, v18
    v_add_f32 v32, v32, v33
    v_max3_f32 v38, v19, v32, v38
    v_sub_f32 v32, v32, v38
    v_sub_f32 v16, v16, v38
    v_max_f32_dpp v39, v38, v38 quad_perm:[1,0,3,2] row_mask:0xf bank_mask:0xf
    v_exp_f32 v32, v32
    v_sub_f32 v17, v17, v38
    v_max_f32_dpp v39, v39, v39 quad_perm:[2,3,0,1] row_mask:0xf bank_mask:0xf
    v_exp_f32 v16, v16
    v_sub_f32 v18, v18, v38
    v_max_f32_dpp v39, v39, v39 row_half_mirror row_mask:0xf bank_mask:0xf
    v_exp_f32 v17, v17
    v_sub_f32 v19, v19, v38
    v_sub_f32 v39, v38, v39
    v_exp_f32 v18, v18
    v_add_f32 v38, v32, v16
    v_exp_f32 v19, v19
    v_add_f32 v38, v38, v17
    v_exp_f32 v39, v39
    v_add_f32 v38, v38, v18
    v_add_f32 v38, v38, v19
    v_mul_f32 v32, v32, v39
    v_mul_f32 v38, v38, v39
    v_pk_mul_f32 v[16:17], v[16:17], v[38:39] op_sel:[0,1] op_sel_hi:[1,1]
    v_pk_mul_f32 v[18:19], v[18:19], v[38:39] op_sel:[0,1] op_sel_hi:[1,1]
    v_add_f32_dpp v36, v38, v38 quad_perm:[1,0,3,2] row_mask:0xf bank_mask:0xf
    v_mov_b32_dpp v33, v32 quad_perm:[1,0,3,2] row_mask:0xf bank_mask:0xf
    s_nop 0
    v_add_f32_dpp v36, v36, v36 quad_perm:[2,3,0,1] row_mask:0xf bank_mask:0xf
    s_nop 1
    v_add_f32_dpp v36, v36, v36 row_half_mirror row_mask:0xf bank_mask:0xf
    v_rcp_f32 v36, v36
    s_nop 0
    v_pk_mul_f32 v[16:17], v[16:17], v[36:37] op_sel_hi:[1,0]
    v_pk_mul_f32 v[18:19], v[18:19], v[36:37] op_sel_hi:[1,0]
    v_pk_mul_f32 v[32:33], v[32:33], v[36:37] op_sel_hi:[1,0]
    v_cvt_pk_bf16_f32 v16, v16, v17
    v_cvt_pk_bf16_f32 v17, v18, v19
    v_cvt_pk_bf16_f32 v32, v32, v33
    v_min_u32 v16, -2, v16
    v_min_u32 v17, -2, v17
    v_min_u32 v32, -2, v32
    s_cbranch_scc1 gated_mix__linear_attn_block__memory_aug_recurrent_mem_tr__prompt_kernel_RA_slow
    buffer_store_dwordx2 v[16:17], v9, s[4:7], s42 offen
    buffer_store_dword v32, v0, s[4:7], s42 offen
gated_mix__linear_attn_block__memory_aug_recurrent_mem_tr__prompt_kernel_RA_st:
    s_barrier
    s_add_u32 s42, s42, 10240
    v_mov_b32 v44, 0
    v_mov_b32 v45, 0
    v_mov_b32 v46, 0
    v_mov_b32 v47, 0
    v_mov_b32 v48, 0
    v_mov_b32 v49, 0
    v_mov_b32 v50, 0
    v_mov_b32 v51, 0
    v_mov_b32 v52, 0
    v_mov_b32 v53, 0
    v_mov_b32 v54, 0
    v_mov_b32 v55, 0
    v_mov_b32 v56, 0
    v_mov_b32 v57, 0
    v_mov_b32 v58, 0
    v_mov_b32 v59, 0
    v_mov_b32 v60, 0
    v_mov_b32 v61, 0
    v_mov_b32 v62, 0
    v_mov_b32 v63, 0
    v_mov_b32 v64, 0
    v_mov_b32 v65, 0
    v_mov_b32 v66, 0
    v_mov_b32 v67, 0
    v_mov_b32 v68, 0
    v_mov_b32 v69, 0
    v_mov_b32 v70, 0
    v_mov_b32 v71, 0
    s_add_u32 s33, s43, 14336
    buffer_load_dwordx4 v[72:75], v10, s[4:7], s43 offen offset:0 sc1
    buffer_load_dwordx4 v[76:79], v10, s[4:7], s43 offen offset:1024 sc1
    buffer_load_dwordx4 v[80:83], v10, s[4:7], s43 offen offset:2048 sc1
    buffer_load_dwordx2 v[84:85], v11, s[4:7], s43 offen sc1
    buffer_load_dwordx4 v[86:89], v10, s[4:7], s33 offen offset:0 sc1
    buffer_load_dwordx4 v[90:93], v10, s[4:7], s33 offen offset:1024 sc1
    buffer_load_dwordx4 v[94:97], v10, s[4:7], s33 offen offset:2048 sc1
    buffer_load_dwordx2 v[98:99], v11, s[4:7], s33 offen sc1
    s_cmp_lt_u32 s40, 63
    s_cbranch_scc1 gated_mix__linear_attn_block__memory_aug_recurrent_mem_tr__prompt_kernel_RA_loop
    s_endpgm
gated_mix__linear_attn_block__memory_aug_recurrent_mem_tr__prompt_kernel_RA_other:
    s_cmp_lg_u32 s26, 1
    s_cbranch_scc1 gated_mix__linear_attn_block__memory_aug_recurrent_mem_tr__prompt_kernel_RA_st
    s_branch gated_mix__linear_attn_block__memory_aug_recurrent_mem_tr__prompt_kernel_RA_st
gated_mix__linear_attn_block__memory_aug_recurrent_mem_tr__prompt_kernel_RA_p1r:
    buffer_load_dwordx4 v[32:35], v2, s[4:7], s45 offen sc1
    s_waitcnt vmcnt(0)
    v_max3_u32 v14, v32, v33, v34
    v_max_u32 v14, v14, v35
    v_cmp_eq_u32 vcc, -1, v14
    ds_write_b128 v13, v[32:35] offset:0
    s_cbranch_vccnz gated_mix__linear_attn_block__memory_aug_recurrent_mem_tr__prompt_kernel_RA_p1r
    s_branch gated_mix__linear_attn_block__memory_aug_recurrent_mem_tr__prompt_kernel_RA_p1b
gated_mix__linear_attn_block__memory_aug_recurrent_mem_tr__prompt_kernel_RA_slow:
    buffer_store_dwordx2 v[16:17], v9, s[4:7], s42 offen sc1
    buffer_store_dword v32, v0, s[4:7], s42 offen sc1
    s_branch gated_mix__linear_attn_block__memory_aug_recurrent_mem_tr__prompt_kernel_RA_st
gated_mix__linear_attn_block__memory_aug_recurrent_mem_tr__prompt_kernel_R_B:
    s_lshl_b32 s33, s26, 1
    s_add_u32 s33, s33, 0
    s_sub_u32 s34, s33, 7
    s_cmp_ge_u32 s33, 7
    s_cselect_b32 s33, s34, s33
    s_lshl_b32 s50, s33, 10
    s_lshl_b32 s33, s26, 1
    s_add_u32 s33, s33, 1
    s_sub_u32 s34, s33, 7
    s_cmp_ge_u32 s33, 7
    s_cselect_b32 s33, s34, s33
    s_lshl_b32 s51, s33, 10
    s_lshl_b32 s33, s26, 1
    s_add_u32 s33, s33, 2
    s_sub_u32 s34, s33, 7
    s_cmp_ge_u32 s33, 7
    s_cselect_b32 s33, s34, s33
    s_lshl_b32 s52, s33, 10
    s_lshl_b32 s33, s26, 1
    s_add_u32 s33, s33, 3
    s_sub_u32 s34, s33, 7
    s_cmp_ge_u32 s33, 7
    s_cselect_b32 s33, s34, s33
    s_lshl_b32 s53, s33, 10
    s_lshl_b32 s33, s26, 1
    s_add_u32 s33, s33, 4
    s_sub_u32 s34, s33, 7
    s_cmp_ge_u32 s33, 7
    s_cselect_b32 s33, s34, s33
    s_lshl_b32 s54, s33, 10
    s_lshl_b32 s33, s26, 1
    s_add_u32 s33, s33, 5
    s_sub_u32 s34, s33, 7
    s_cmp_ge_u32 s33, 7
    s_cselect_b32 s33, s34, s33
    s_lshl_b32 s55, s33, 10
    s_lshl_b32 s33, s26, 1
    s_add_u32 s33, s33, 6
    s_sub_u32 s34, s33, 7
    s_cmp_ge_u32 s33, 7
    s_cselect_b32 s33, s34, s33
    s_lshl_b32 s56, s33, 10
    s_lshl_b32 s34, s26, 2
    s_mul_i32 s34, s34, 28
    s_lshl_b32 s35, s27, 1
    s_add_u32 s34, s34, s35
    s_mul_i32 s34, s34, 14336
    s_add_u32 s34, s34, 0x620000
    s_mul_i32 s37, s26, 20480
    s_add_u32 s37, s37, 11264
    s_lshl_b32 s38, s26, 9
    s_add_u32 s38, s38, 0x3aa0800
    s_mov_b32 s39, 15
    v_and_b32 v6, 3, v1
    v_lshlrev_b32 v6, 7, v6
gated_mix__linear_attn_block__memory_aug_recurrent_mem_tr__prompt_kernel_RB_wl:
    buffer_load_dword v5, v6, s[4:7], s38 offen sc1
    s_waitcnt vmcnt(0)
    v_cmp_ne_u32 vcc, 0, v5
    s_nop 0
    s_mov_b32 s33, vcc_lo
gated_mix__linear_attn_block__memory_aug_recurrent_mem_tr__prompt_kernel_RB_wn:
    s_and_b32 s33, s33, s39
    s_bitcmp1_b32 s33, 0
    s_cbranch_scc1 gated_mix__linear_attn_block__memory_aug_recurrent_mem_tr__prompt_kernel_RB_wl0
    s_bitcmp1_b32 s33, 1
    s_cbranch_scc1 gated_mix__linear_attn_block__memory_aug_recurrent_mem_tr__prompt_kernel_RB_wl1
    s_bitcmp1_b32 s33, 2
    s_cbranch_scc1 gated_mix__linear_attn_block__memory_aug_recurrent_mem_tr__prompt_kernel_RB_wl2
    s_bitcmp1_b32 s33, 3
    s_cbranch_scc1 gated_mix__linear_attn_block__memory_aug_recurrent_mem_tr__prompt_kernel_RB_wl3
    s_sleep 8
    s_branch gated_mix__linear_attn_block__memory_aug_recurrent_mem_tr__prompt_kernel_RB_wl
gated_mix__linear_attn_block__memory_aug_recurrent_mem_tr__prompt_kernel_RB_wl0:
    s_bitset0_b32 s39, 0
    buffer_load_dword v5, v6, s[4:7], s38 offen sc1
    s_lshl_b32 s36, s50, 1
    s_add_u32 s36, s36, s34
    buffer_load_dwordx4 a[0:3], v2, s[4:7], s36 offen offset:0 sc1
    buffer_load_dwordx4 a[4:7], v2, s[4:7], s36 offen offset:1024 sc1
    s_lshl_b32 s36, s51, 1
    s_add_u32 s36, s36, s34
    buffer_load_dwordx4 a[8:11], v2, s[4:7], s36 offen offset:0 sc1
    buffer_load_dwordx4 a[12:15], v2, s[4:7], s36 offen offset:1024 sc1
    s_lshl_b32 s36, s52, 1
    s_add_u32 s36, s36, s34
    buffer_load_dwordx4 a[16:19], v2, s[4:7], s36 offen offset:0 sc1
    buffer_load_dwordx4 a[20:23], v2, s[4:7], s36 offen offset:1024 sc1
    s_lshl_b32 s36, s53, 1
    s_add_u32 s36, s36, s34
    buffer_load_dwordx4 a[24:27], v2, s[4:7], s36 offen offset:0 sc1
    buffer_load_dwordx4 a[28:31], v2, s[4:7], s36 offen offset:1024 sc1
    s_lshl_b32 s36, s54, 1
    s_add_u32 s36, s36, s34
    buffer_load_dwordx4 a[32:35], v2, s[4:7], s36 offen offset:0 sc1
    buffer_load_dwordx4 a[36:39], v2, s[4:7], s36 offen offset:1024 sc1
    s_lshl_b32 s36, s55, 1
    s_add_u32 s36, s36, s34
    buffer_load_dwordx4 a[40:43], v2, s[4:7], s36 offen offset:0 sc1
    buffer_load_dwordx4 a[44:47], v2, s[4:7], s36 offen offset:1024 sc1
    s_lshl_b32 s36, s56, 1
    s_add_u32 s36, s36, s34
    buffer_load_dwordx4 a[48:51], v2, s[4:7], s36 offen offset:0 sc1
    buffer_load_dwordx4 a[52:55], v2, s[4:7], s36 offen offset:1024 sc1
    s_lshl_b32 s36, s50, 1
    s_add_u32 s36, s36, s34
    s_add_u32 s36, s36, 14336
    buffer_load_dwordx4 a[56:59], v2, s[4:7], s36 offen offset:0 sc1
    buffer_load_dwordx4 a[60:63], v2, s[4:7], s36 offen offset:1024 sc1
    s_lshl_b32 s36, s51, 1
    s_add_u32 s36, s36, s34
    s_add_u32 s36, s36, 14336
    buffer_load_dwordx4 a[64:67], v2, s[4:7], s36 offen offset:0 sc1
    buffer_load_dwordx4 a[68:71], v2, s[4:7], s36 offen offset:1024 sc1
    s_lshl_b32 s36, s52, 1
    s_add_u32 s36, s36, s34
    s_add_u32 s36, s36, 14336
    buffer_load_dwordx4 a[72:75], v2, s[4:7], s36 offen offset:0 sc1
    buffer_load_dwordx4 a[76:79], v2, s[4:7], s36 offen offset:1024 sc1
    s_lshl_b32 s36, s53, 1
    s_add_u32 s36, s36, s34
    s_add_u32 s36, s36, 14336
    buffer_load_dwordx4 a[80:83], v2, s[4:7], s36 offen offset:0 sc1
    buffer_load_dwordx4 a[84:87], v2, s[4:7], s36 offen offset:1024 sc1
    s_lshl_b32 s36, s54, 1
    s_add_u32 s36, s36, s34
    s_add_u32 s36, s36, 14336
    buffer_load_dwordx4 a[88:91], v2, s[4:7], s36 offen offset:0 sc1
    buffer_load_dwordx4 a[92:95], v2, s[4:7], s36 offen offset:1024 sc1
    s_lshl_b32 s36, s55, 1
    s_add_u32 s36, s36, s34
    s_add_u32 s36, s36, 14336
    buffer_load_dwordx4 a[96:99], v2, s[4:7], s36 offen offset:0 sc1
    buffer_load_dwordx4 a[100:103], v2, s[4:7], s36 offen offset:1024 sc1
    s_lshl_b32 s36, s56, 1
    s_add_u32 s36, s36, s34
    s_add_u32 s36, s36, 14336
    buffer_load_dwordx4 a[104:107], v2, s[4:7], s36 offen offset:0 sc1
    buffer_load_dwordx4 a[108:111], v2, s[4:7], s36 offen offset:1024 sc1
    s_waitcnt vmcnt(28)
    v_cmp_ne_u32 vcc, 0, v5
    s_nop 0
    s_mov_b32 s33, vcc_lo
    s_cmp_lg_u32 s39, 0
    s_cbranch_scc1 gated_mix__linear_attn_block__memory_aug_recurrent_mem_tr__prompt_kernel_RB_wn
    s_branch gated_mix__linear_attn_block__memory_aug_recurrent_mem_tr__prompt_kernel_RB_wdone
gated_mix__linear_attn_block__memory_aug_recurrent_mem_tr__prompt_kernel_RB_wl1:
    s_bitset0_b32 s39, 1
    buffer_load_dword v5, v6, s[4:7], s38 offen sc1
    s_lshl_b32 s36, s50, 1
    s_add_u32 s36, s36, s34
    s_add_u32 s36, s36, 401408
    buffer_load_dwordx4 a[112:115], v2, s[4:7], s36 offen offset:0 sc1
    buffer_load_dwordx4 a[116:119], v2, s[4:7], s36 offen offset:1024 sc1
    s_lshl_b32 s36, s51, 1
    s_add_u32 s36, s36, s34
    s_add_u32 s36, s36, 401408
    buffer_load_dwordx4 a[120:123], v2, s[4:7], s36 offen offset:0 sc1
    buffer_load_dwordx4 a[124:127], v2, s[4:7], s36 offen offset:1024 sc1
    s_lshl_b32 s36, s52, 1
    s_add_u32 s36, s36, s34
    s_add_u32 s36, s36, 401408
    buffer_load_dwordx4 a[128:131], v2, s[4:7], s36 offen offset:0 sc1
    buffer_load_dwordx4 a[132:135], v2, s[4:7], s36 offen offset:1024 sc1
    s_lshl_b32 s36, s53, 1
    s_add_u32 s36, s36, s34
    s_add_u32 s36, s36, 401408
    buffer_load_dwordx4 a[136:139], v2, s[4:7], s36 offen offset:0 sc1
    buffer_load_dwordx4 a[140:143], v2, s[4:7], s36 offen offset:1024 sc1
    s_lshl_b32 s36, s54, 1
    s_add_u32 s36, s36, s34
    s_add_u32 s36, s36, 401408
    buffer_load_dwordx4 a[144:147], v2, s[4:7], s36 offen offset:0 sc1
    buffer_load_dwordx4 a[148:151], v2, s[4:7], s36 offen offset:1024 sc1
    s_lshl_b32 s36, s55, 1
    s_add_u32 s36, s36, s34
    s_add_u32 s36, s36, 401408
    buffer_load_dwordx4 a[152:155], v2, s[4:7], s36 offen offset:0 sc1
    buffer_load_dwordx4 a[156:159], v2, s[4:7], s36 offen offset:1024 sc1
    s_lshl_b32 s36, s56, 1
    s_add_u32 s36, s36, s34
    s_add_u32 s36, s36, 401408
    buffer_load_dwordx4 a[160:163], v2, s[4:7], s36 offen offset:0 sc1
    buffer_load_dwordx4 a[164:167], v2, s[4:7], s36 offen offset:1024 sc1
    s_lshl_b32 s36, s50, 1
    s_add_u32 s36, s36, s34
    s_add_u32 s36, s36, 415744
    buffer_load_dwordx4 a[168:171], v2, s[4:7], s36 offen offset:0 sc1
    buffer_load_dwordx4 a[172:175], v2, s[4:7], s36 offen offset:1024 sc1
    s_lshl_b32 s36, s51, 1
    s_add_u32 s36, s36, s34
    s_add_u32 s36, s36, 415744
    buffer_load_dwordx4 a[176:179], v2, s[4:7], s36 offen offset:0 sc1
    buffer_load_dwordx4 a[180:183], v2, s[4:7], s36 offen offset:1024 sc1
    s_lshl_b32 s36, s52, 1
    s_add_u32 s36, s36, s34
    s_add_u32 s36, s36, 415744
    buffer_load_dwordx4 a[184:187], v2, s[4:7], s36 offen offset:0 sc1
    buffer_load_dwordx4 a[188:191], v2, s[4:7], s36 offen offset:1024 sc1
    s_lshl_b32 s36, s53, 1
    s_add_u32 s36, s36, s34
    s_add_u32 s36, s36, 415744
    buffer_load_dwordx4 a[192:195], v2, s[4:7], s36 offen offset:0 sc1
    buffer_load_dwordx4 a[196:199], v2, s[4:7], s36 offen offset:1024 sc1
    s_lshl_b32 s36, s54, 1
    s_add_u32 s36, s36, s34
    s_add_u32 s36, s36, 415744
    buffer_load_dwordx4 a[200:203], v2, s[4:7], s36 offen offset:0 sc1
    buffer_load_dwordx4 a[204:207], v2, s[4:7], s36 offen offset:1024 sc1
    s_lshl_b32 s36, s55, 1
    s_add_u32 s36, s36, s34
    s_add_u32 s36, s36, 415744
    buffer_load_dwordx4 a[208:211], v2, s[4:7], s36 offen offset:0 sc1
    buffer_load_dwordx4 a[212:215], v2, s[4:7], s36 offen offset:1024 sc1
    s_lshl_b32 s36, s56, 1
    s_add_u32 s36, s36, s34
    s_add_u32 s36, s36, 415744
    buffer_load_dwordx4 a[216:219], v2, s[4:7], s36 offen offset:0 sc1
    buffer_load_dwordx4 a[220:223], v2, s[4:7], s36 offen offset:1024 sc1
    s_waitcnt vmcnt(28)
    v_cmp_ne_u32 vcc, 0, v5
    s_nop 0
    s_mov_b32 s33, vcc_lo
    s_cmp_lg_u32 s39, 0
    s_cbranch_scc1 gated_mix__linear_attn_block__memory_aug_recurrent_mem_tr__prompt_kernel_RB_wn
    s_branch gated_mix__linear_attn_block__memory_aug_recurrent_mem_tr__prompt_kernel_RB_wdone
gated_mix__linear_attn_block__memory_aug_recurrent_mem_tr__prompt_kernel_RB_wl2:
    s_bitset0_b32 s39, 2
    buffer_load_dword v5, v6, s[4:7], s38 offen sc1
    s_lshl_b32 s36, s50, 1
    s_add_u32 s36, s36, s34
    s_add_u32 s36, s36, 802816
    buffer_load_dwordx4 a[224:227], v2, s[4:7], s36 offen offset:0 sc1
    buffer_load_dwordx4 a[228:231], v2, s[4:7], s36 offen offset:1024 sc1
    s_lshl_b32 s36, s51, 1
    s_add_u32 s36, s36, s34
    s_add_u32 s36, s36, 802816
    buffer_load_dwordx4 a[232:235], v2, s[4:7], s36 offen offset:0 sc1
    buffer_load_dwordx4 a[236:239], v2, s[4:7], s36 offen offset:1024 sc1
    s_lshl_b32 s36, s52, 1
    s_add_u32 s36, s36, s34
    s_add_u32 s36, s36, 802816
    buffer_load_dwordx4 a[240:243], v2, s[4:7], s36 offen offset:0 sc1
    buffer_load_dwordx4 a[244:247], v2, s[4:7], s36 offen offset:1024 sc1
    s_lshl_b32 s36, s53, 1
    s_add_u32 s36, s36, s34
    s_add_u32 s36, s36, 802816
    buffer_load_dwordx4 a[248:251], v2, s[4:7], s36 offen offset:0 sc1
    buffer_load_dwordx4 a[252:255], v2, s[4:7], s36 offen offset:1024 sc1
    s_lshl_b32 s36, s54, 1
    s_add_u32 s36, s36, s34
    s_add_u32 s36, s36, 802816
    buffer_load_dwordx4 v[144:147], v2, s[4:7], s36 offen offset:0 sc1
    buffer_load_dwordx4 v[148:151], v2, s[4:7], s36 offen offset:1024 sc1
    s_lshl_b32 s36, s55, 1
    s_add_u32 s36, s36, s34
    s_add_u32 s36, s36, 802816
    buffer_load_dwordx4 v[152:155], v2, s[4:7], s36 offen offset:0 sc1
    buffer_load_dwordx4 v[156:159], v2, s[4:7], s36 offen offset:1024 sc1
    s_lshl_b32 s36, s56, 1
    s_add_u32 s36, s36, s34
    s_add_u32 s36, s36, 802816
    buffer_load_dwordx4 v[160:163], v2, s[4:7], s36 offen offset:0 sc1
    buffer_load_dwordx4 v[164:167], v2, s[4:7], s36 offen offset:1024 sc1
    s_lshl_b32 s36, s50, 1
    s_add_u32 s36, s36, s34
    s_add_u32 s36, s36, 817152
    buffer_load_dwordx4 v[168:171], v2, s[4:7], s36 offen offset:0 sc1
    buffer_load_dwordx4 v[172:175], v2, s[4:7], s36 offen offset:1024 sc1
    s_lshl_b32 s36, s51, 1
    s_add_u32 s36, s36, s34
    s_add_u32 s36, s36, 817152
    buffer_load_dwordx4 v[176:179], v2, s[4:7], s36 offen offset:0 sc1
    buffer_load_dwordx4 v[180:183], v2, s[4:7], s36 offen offset:1024 sc1
    s_lshl_b32 s36, s52, 1
    s_add_u32 s36, s36, s34
    s_add_u32 s36, s36, 817152
    buffer_load_dwordx4 v[184:187], v2, s[4:7], s36 offen offset:0 sc1
    buffer_load_dwordx4 v[188:191], v2, s[4:7], s36 offen offset:1024 sc1
    s_lshl_b32 s36, s53, 1
    s_add_u32 s36, s36, s34
    s_add_u32 s36, s36, 817152
    buffer_load_dwordx4 v[192:195], v2, s[4:7], s36 offen offset:0 sc1
    buffer_load_dwordx4 v[196:199], v2, s[4:7], s36 offen offset:1024 sc1
    s_lshl_b32 s36, s54, 1
    s_add_u32 s36, s36, s34
    s_add_u32 s36, s36, 817152
    buffer_load_dwordx4 v[200:203], v2, s[4:7], s36 offen offset:0 sc1
    buffer_load_dwordx4 v[204:207], v2, s[4:7], s36 offen offset:1024 sc1
    s_lshl_b32 s36, s55, 1
    s_add_u32 s36, s36, s34
    s_add_u32 s36, s36, 817152
    buffer_load_dwordx4 v[208:211], v2, s[4:7], s36 offen offset:0 sc1
    buffer_load_dwordx4 v[212:215], v2, s[4:7], s36 offen offset:1024 sc1
    s_lshl_b32 s36, s56, 1
    s_add_u32 s36, s36, s34
    s_add_u32 s36, s36, 817152
    buffer_load_dwordx4 v[216:219], v2, s[4:7], s36 offen offset:0 sc1
    buffer_load_dwordx4 v[220:223], v2, s[4:7], s36 offen offset:1024 sc1
    s_waitcnt vmcnt(28)
    v_cmp_ne_u32 vcc, 0, v5
    s_nop 0
    s_mov_b32 s33, vcc_lo
    s_cmp_lg_u32 s39, 0
    s_cbranch_scc1 gated_mix__linear_attn_block__memory_aug_recurrent_mem_tr__prompt_kernel_RB_wn
    s_branch gated_mix__linear_attn_block__memory_aug_recurrent_mem_tr__prompt_kernel_RB_wdone
gated_mix__linear_attn_block__memory_aug_recurrent_mem_tr__prompt_kernel_RB_wl3:
    s_bitset0_b32 s39, 3
    buffer_load_dword v5, v6, s[4:7], s38 offen sc1
    s_lshl_b32 s36, s50, 1
    s_add_u32 s36, s36, s34
    s_add_u32 s36, s36, 1204224
    buffer_load_dwordx4 v[224:227], v2, s[4:7], s36 offen offset:0 sc1
    buffer_load_dwordx4 v[228:231], v2, s[4:7], s36 offen offset:1024 sc1
    s_lshl_b32 s36, s51, 1
    s_add_u32 s36, s36, s34
    s_add_u32 s36, s36, 1204224
    buffer_load_dwordx4 v[232:235], v2, s[4:7], s36 offen offset:0 sc1
    buffer_load_dwordx4 v[236:239], v2, s[4:7], s36 offen offset:1024 sc1
    s_lshl_b32 s36, s52, 1
    s_add_u32 s36, s36, s34
    s_add_u32 s36, s36, 1204224
    s_add_u32 m0, s37, 0
    s_nop 0
    buffer_load_dwordx4 v2, s[4:7], s36 offen offset:0 sc1 lds
    buffer_load_dwordx4 v2, s[4:7], s36 offen offset:1024 sc1 lds
    s_lshl_b32 s36, s53, 1
    s_add_u32 s36, s36, s34
    s_add_u32 s36, s36, 1204224
    s_add_u32 m0, s37, 2048
    s_nop 0
    buffer_load_dwordx4 v2, s[4:7], s36 offen offset:0 sc1 lds
    buffer_load_dwordx4 v2, s[4:7], s36 offen offset:1024 sc1 lds
    s_lshl_b32 s36, s54, 1
    s_add_u32 s36, s36, s34
    s_add_u32 s36, s36, 1204224
    s_add_u32 m0, s37, 4096
    s_nop 0
    buffer_load_dwordx4 v2, s[4:7], s36 offen offset:0 sc1 lds
    buffer_load_dwordx4 v2, s[4:7], s36 offen offset:1024 sc1 lds
    s_lshl_b32 s36, s55, 1
    s_add_u32 s36, s36, s34
    s_add_u32 s36, s36, 1204224
    s_add_u32 m0, s37, 6144
    s_nop 0
    buffer_load_dwordx4 v2, s[4:7], s36 offen offset:0 sc1 lds
    buffer_load_dwordx4 v2, s[4:7], s36 offen offset:1024 sc1 lds
    s_lshl_b32 s36, s56, 1
    s_add_u32 s36, s36, s34
    s_add_u32 s36, s36, 1204224
    s_add_u32 m0, s37, 8192
    s_nop 0
    buffer_load_dwordx4 v2, s[4:7], s36 offen offset:0 sc1 lds
    buffer_load_dwordx4 v2, s[4:7], s36 offen offset:1024 sc1 lds
    s_lshl_b32 s36, s50, 1
    s_add_u32 s36, s36, s34
    s_add_u32 s36, s36, 1218560
    buffer_load_dwordx4 v[240:243], v2, s[4:7], s36 offen offset:0 sc1
    buffer_load_dwordx4 v[244:247], v2, s[4:7], s36 offen offset:1024 sc1
    s_lshl_b32 s36, s51, 1
    s_add_u32 s36, s36, s34
    s_add_u32 s36, s36, 1218560
    buffer_load_dwordx4 v[248:251], v2, s[4:7], s36 offen offset:0 sc1
    buffer_load_dwordx4 v[252:255], v2, s[4:7], s36 offen offset:1024 sc1
    s_lshl_b32 s36, s52, 1
    s_add_u32 s36, s36, s34
    s_add_u32 s36, s36, 1218560
    s_add_u32 m0, s37, 10240
    s_nop 0
    buffer_load_dwordx4 v2, s[4:7], s36 offen offset:0 sc1 lds
    buffer_load_dwordx4 v2, s[4:7], s36 offen offset:1024 sc1 lds
    s_lshl_b32 s36, s53, 1
    s_add_u32 s36, s36, s34
    s_add_u32 s36, s36, 1218560
    s_add_u32 m0, s37, 12288
    s_nop 0
    buffer_load_dwordx4 v2, s[4:7], s36 offen offset:0 sc1 lds
    buffer_load_dwordx4 v2, s[4:7], s36 offen offset:1024 sc1 lds
    s_lshl_b32 s36, s54, 1
    s_add_u32 s36, s36, s34
    s_add_u32 s36, s36, 1218560
    s_add_u32 m0, s37, 14336
    s_nop 0
    buffer_load_dwordx4 v2, s[4:7], s36 offen offset:0 sc1 lds
    buffer_load_dwordx4 v2, s[4:7], s36 offen offset:1024 sc1 lds
    s_lshl_b32 s36, s55, 1
    s_add_u32 s36, s36, s34
    s_add_u32 s36, s36, 1218560
    s_add_u32 m0, s37, 16384
    s_nop 0
    buffer_load_dwordx4 v2, s[4:7], s36 offen offset:0 sc1 lds
    buffer_load_dwordx4 v2, s[4:7], s36 offen offset:1024 sc1 lds
    s_lshl_b32 s36, s56, 1
    s_add_u32 s36, s36, s34
    s_add_u32 s36, s36, 1218560
    s_add_u32 m0, s37, 18432
    s_nop 0
    buffer_load_dwordx4 v2, s[4:7], s36 offen offset:0 sc1 lds
    buffer_load_dwordx4 v2, s[4:7], s36 offen offset:1024 sc1 lds
    s_waitcnt vmcnt(28)
    v_cmp_ne_u32 vcc, 0, v5
    s_nop 0
    s_mov_b32 s33, vcc_lo
    s_cmp_lg_u32 s39, 0
    s_cbranch_scc1 gated_mix__linear_attn_block__memory_aug_recurrent_mem_tr__prompt_kernel_RB_wn
gated_mix__linear_attn_block__memory_aug_recurrent_mem_tr__prompt_kernel_RB_wdone:
    v_and_b32 v12, 7, v4
    v_lshrrev_b32 v13, 3, v4
    v_lshlrev_b32 v3, 7, v3
    v_lshl_add_u32 v3, v12, 4, v3
    v_lshl_add_u32 v5, v13, 9, v3
    s_lshl_b32 s33, s26, 10
    s_add_u32 s33, s33, 7168
    v_add_u32 v6, s33, v2
    v_add_u32 v7, s37, v2
    v_lshl_add_u32 v8, v13, 3, v3
    s_lshl_b32 s33, s27, 9
    v_add_u32 v8, s33, v8
    v_mov_b32 v14, 0x40000000
    v_cmp_gt_u32 vcc, 64, v0
    s_nop 1
    v_cndmask_b32 v4, v14, v8, vcc
    v_cmp_eq_u32 vcc, 64, v0
    s_nop 1
    v_cndmask_b32 v10, v14, 0, vcc
    v_and_b32 v9, 3, v1
    s_lshl_b32 s33, s26, 2
    v_add_u32 v9, s33, v9
    v_lshlrev_b32 v9, 2, v9
    v_mov_b32 v11, 1
    v_mov_b32 v28, 0x44444444
    v_mov_b32 v29, 0xeeeeeeee
    v_cmp_eq_u32 vcc, 0, v13
    s_nop 1
    v_cndmask_b32 v1, v29, v28, vcc
    s_mov_b32 s40, 0
    s_mov_b32 s41, 0xfc0000
    s_mul_i32 s42, s26, 2560
    s_add_u32 s42, s42, 0x10c0000
    s_lshl_b32 s43, s26, 2
    s_mul_i32 s43, s43, 28
    s_lshl_b32 s33, s27, 1
    s_add_u32 s43, s43, s33
    s_lshl_b32 s43, s43, 10
    s_add_u32 s43, s43, 0x1ce0000
    s_mul_i32 s46, s26, 28
    s_add_u32 s46, s46, s33
    s_lshl_b32 s46, s46, 10
    s_add_u32 s46, s46, 0x15c4000
    s_lshl_b32 s47, s26, 10
    s_add_u32 s47, s47, 0x1164000
    s_mov_b32 s72, 0
    s_mov_b32 s81, 0
    s_lshl_b32 s48, s27, 2
    s_add_u32 s48, s48, 0x1166400
gated_mix__linear_attn_block__memory_aug_recurrent_mem_tr__prompt_kernel_RB_mode:
    buffer_load_dwordx2 v[12:13], off, s[84:87], 0 offset:224 sc1
    buffer_load_dword v15, off, s[84:87], 0 offset:24 sc1
    s_waitcnt vmcnt(0)
gated_mix__linear_attn_block__memory_aug_recurrent_mem_tr__prompt_kernel_RB_m2:
    v_sad_u8 v14, v12, 0, 0
    v_sad_u8 v14, v13, 0, v14
    v_readfirstlane_b32 s34, v12
    v_readfirstlane_b32 s35, v13
    v_readfirstlane_b32 s36, v15
    v_readfirstlane_b32 s33, v14
    s_nop 0
    s_cmp_lt_u32 s33, 31
    s_cbranch_scc1 gated_mix__linear_attn_block__memory_aug_recurrent_mem_tr__prompt_kernel_RB_mode
    s_cmp_eq_u32 s36, 0
    s_cbranch_scc1 gated_mix__linear_attn_block__memory_aug_recurrent_mem_tr__prompt_kernel_RB_mode
    s_cmp_eq_u32 s34, 0
    s_cselect_b32 s34, s35, s34
    s_ff1_i32_b32 s33, s34
    s_and_b32 s33, s33, 24
    s_lshr_b32 s34, s34, s33
    s_cmp_eq_u32 s34, 31
    s_cselect_b32 s49, 1, 0
    v_mov_b32 v44, 0
    v_mov_b32 v45, 0
    v_mov_b32 v46, 0
    v_mov_b32 v47, 0
    v_mov_b32 v48, 0
    v_mov_b32 v49, 0
    v_mov_b32 v50, 0
    v_mov_b32 v51, 0
    v_mov_b32 v52, 0
    v_mov_b32 v53, 0
    v_mov_b32 v54, 0
    v_mov_b32 v55, 0
    v_mov_b32 v56, 0
    v_mov_b32 v57, 0
    v_mov_b32 v58, 0
    v_mov_b32 v59, 0
    v_mov_b32 v60, 0
    v_mov_b32 v61, 0
    v_mov_b32 v62, 0
    v_mov_b32 v63, 0
    v_mov_b32 v64, 0
    v_mov_b32 v65, 0
    v_mov_b32 v66, 0
    v_mov_b32 v67, 0
    v_mov_b32 v68, 0
    v_mov_b32 v69, 0
    v_mov_b32 v70, 0
    v_mov_b32 v71, 0
    v_mov_b32 v72, 0
    v_mov_b32 v73, 0
    v_mov_b32 v74, 0
    v_mov_b32 v75, 0
.p2align 6
gated_mix__linear_attn_block__memory_aug_recurrent_mem_tr__prompt_kernel_RB_loop:
    s_add_u32 s44, s41, s50
    s_add_u32 s45, s41, s51
    v_add_u32 v12, s50, v2
    v_add_u32 v13, s51, v2
    s_add_u32 s58, s41, 0x80000
    s_cmp_eq_u32 s40, 0
    s_cselect_b32 s58, 0x40000000, s58
    s_cmp_lt_u32 s40, 61
    s_cselect_b32 s57, 0x40000000, s46
    s_add_u32 s46, s46, 114688
    s_cmp_eq_u32 s40, 63
    s_cselect_b32 s68, 0x40000000, s43
    s_cbranch_scc1 gated_mix__linear_attn_block__memory_aug_recurrent_mem_tr__prompt_kernel_RB_zok
    s_cmp_eq_u32 s81, 0
    s_cbranch_scc1 gated_mix__linear_attn_block__memory_aug_recurrent_mem_tr__prompt_kernel_RB_znp
    v_and_b32 v140, v140, v141
    v_and_b32 v142, v142, v143
    v_and_b32 v140, v140, v142
    v_cmp_eq_u32 vcc, 0, v140
    s_nop 0
    s_ff1_i32_b64 s72, vcc
    s_min_u32 s72, s72, 64
gated_mix__linear_attn_block__memory_aug_recurrent_mem_tr__prompt_kernel_RB_znp:
    s_cmp_lt_u32 s40, s72
    s_cbranch_scc1 gated_mix__linear_attn_block__memory_aug_recurrent_mem_tr__prompt_kernel_RB_zok
gated_mix__linear_attn_block__memory_aug_recurrent_mem_tr__prompt_kernel_RB_zspin:
    buffer_load_dwordx4 v[116:119], v2, s[4:7], s47 offen sc1
    s_waitcnt vmcnt(0)
    v_and_b32 v116, v116, v117
    v_and_b32 v118, v118, v119
    v_and_b32 v116, v116, v118
    v_cmp_eq_u32 vcc, 0, v116
    s_nop 0
    s_ff1_i32_b64 s72, vcc
    s_min_u32 s72, s72, 64
    s_cmp_lt_u32 s40, s72
    s_cbranch_scc1 gated_mix__linear_attn_block__memory_aug_recurrent_mem_tr__prompt_kernel_RB_zok
    s_sleep 2
    s_branch gated_mix__linear_attn_block__memory_aug_recurrent_mem_tr__prompt_kernel_RB_zspin
gated_mix__linear_attn_block__memory_aug_recurrent_mem_tr__prompt_kernel_RB_zok:
    s_add_u32 s81, s40, 3
    s_cmp_ge_u32 s81, s72
    s_cselect_b32 s81, 1, 0
    s_cmp_ge_u32 s72, 63
    s_cselect_b32 s81, 0, s81
    s_add_u32 s69, s68, 28672
    s_add_u32 s70, s68, 57344
    s_add_u32 s71, s68, 86016
    buffer_load_dwordx4 v[16:19], v2, s[4:7], s44 offen sc1
    buffer_load_dwordx4 v[20:23], v2, s[4:7], s45 offen sc1
gated_mix__linear_attn_block__memory_aug_recurrent_mem_tr__prompt_kernel_RB_poll:
    s_waitcnt vmcnt(1)
    v_max3_u32 v14, v16, v17, v18
    s_waitcnt vmcnt(0)
    v_max3_u32 v15, v20, v21, v22
    v_max3_u32 v14, v19, v23, v14
    v_max_u32 v14, v14, v15
    v_cmp_eq_u32 vcc, -1, v14
    buffer_load_dwordx4 v[16:19], v2, s[4:7], s44 offen sc1
    buffer_load_dwordx4 v[20:23], v2, s[4:7], s45 offen sc1
    s_cbranch_vccnz gated_mix__linear_attn_block__memory_aug_recurrent_mem_tr__prompt_kernel_RB_poll
    ds_write_b128 v12, v[16:19] offset:0
    ds_write_b128 v13, v[20:23] offset:0
    v_smfmac_f32_16x16x64_bf16 v[44:47], v[16:19], a[0:7], v1
    v_add_u32 v0, s52, v2
    buffer_store_dwordx2 v[132:133], v4, s[4:7], s58 offen sc1
    v_smfmac_f32_16x16x64_bf16 v[48:51], v[16:19], a[56:63], v1
    v_add_u32 v12, s53, v2
    s_cmp_lt_u32 s40, 61
    s_cbranch_scc1 gated_mix__linear_attn_block__memory_aug_recurrent_mem_tr__prompt_kernel_RB_nou
    buffer_store_dwordx4 v[108:111], v2, s[4:7], s57 offen sc1
    buffer_store_dwordx4 v[112:115], v2, s[4:7], s57 offen offset:1024 sc1
gated_mix__linear_attn_block__memory_aug_recurrent_mem_tr__prompt_kernel_RB_nou:
    v_smfmac_f32_16x16x64_bf16 v[52:55], v[16:19], a[112:119], v1
    v_add_u32 v13, s54, v2
    s_cmp_eq_u32 s81, 0
    s_cbranch_scc1 gated_mix__linear_attn_block__memory_aug_recurrent_mem_tr__prompt_kernel_RB_nozf
    buffer_load_dwordx4 v[140:143], v2, s[4:7], s47 offen sc1
gated_mix__linear_attn_block__memory_aug_recurrent_mem_tr__prompt_kernel_RB_nozf:
    v_smfmac_f32_16x16x64_bf16 v[56:59], v[16:19], a[168:175], v1
    v_add_u32 v14, s55, v2
    buffer_load_dwordx4 v[76:79], v2, s[4:7], s68 offen offset:0 sc1
    v_smfmac_f32_16x16x64_bf16 v[60:63], v[16:19], a[224:231], v1
    v_add_u32 v15, s56, v2
    buffer_load_dwordx4 v[80:83], v2, s[4:7], s68 offen offset:1024 sc1
    v_smfmac_f32_16x16x64_bf16 v[64:67], v[16:19], v[168:175], v1
    buffer_load_dwordx4 v[84:87], v2, s[4:7], s69 offen offset:0 sc1
    v_smfmac_f32_16x16x64_bf16 v[68:71], v[16:19], v[224:231], v1
    buffer_load_dwordx4 v[88:91], v2, s[4:7], s69 offen offset:1024 sc1
    v_smfmac_f32_16x16x64_bf16 v[72:75], v[16:19], v[240:247], v1
    buffer_load_dwordx4 v[92:95], v2, s[4:7], s70 offen offset:0 sc1
    s_waitcnt lgkmcnt(0)
    s_barrier
    v_smfmac_f32_16x16x64_bf16 v[44:47], v[20:23], a[8:15], v1
    ds_read_b128 v[24:27], v0 offset:0
    v_smfmac_f32_16x16x64_bf16 v[48:51], v[20:23], a[64:71], v1
    ds_read_b128 v[28:31], v12 offset:0
    v_smfmac_f32_16x16x64_bf16 v[52:55], v[20:23], a[120:127], v1
    ds_read_b128 v[32:35], v13 offset:0
    v_smfmac_f32_16x16x64_bf16 v[56:59], v[20:23], a[176:183], v1
    ds_read_b128 v[36:39], v14 offset:0
    v_smfmac_f32_16x16x64_bf16 v[60:63], v[20:23], a[232:239], v1
    ds_read_b128 v[40:43], v15 offset:0
    v_smfmac_f32_16x16x64_bf16 v[64:67], v[20:23], v[176:183], v1
    ds_read_b128 v[116:119], v7 offset:0
    v_smfmac_f32_16x16x64_bf16 v[68:71], v[20:23], v[232:239], v1
    ds_read_b128 v[120:123], v7 offset:1024
    v_smfmac_f32_16x16x64_bf16 v[72:75], v[20:23], v[248:255], v1
    s_waitcnt lgkmcnt(2)
    v_smfmac_f32_16x16x64_bf16 v[44:47], v[24:27], a[16:23], v1
    ds_read_b128 v[124:127], v7 offset:2048
    v_smfmac_f32_16x16x64_bf16 v[44:47], v[28:31], a[24:31], v1
    ds_read_b128 v[128:131], v7 offset:3072
    v_smfmac_f32_16x16x64_bf16 v[44:47], v[32:35], a[32:39], v1
    buffer_load_dwordx4 v[96:99], v2, s[4:7], s70 offen offset:1024 sc1
    s_waitcnt lgkmcnt(2)
    v_smfmac_f32_16x16x64_bf16 v[68:71], v[24:27], v[116:123], v1
    v_smfmac_f32_16x16x64_bf16 v[44:47], v[36:39], a[40:47], v1
    ds_read_b128 v[116:119], v7 offset:4096
    v_smfmac_f32_16x16x64_bf16 v[44:47], v[40:43], a[48:55], v1
    ds_read_b128 v[120:123], v7 offset:5120
    v_smfmac_f32_16x16x64_bf16 v[52:55], v[24:27], a[128:135], v1
    buffer_load_dwordx4 v[100:103], v2, s[4:7], s71 offen offset:0 sc1
    s_waitcnt lgkmcnt(2)
    v_smfmac_f32_16x16x64_bf16 v[68:71], v[28:31], v[124:131], v1
    v_smfmac_f32_16x16x64_bf16 v[52:55], v[28:31], a[136:143], v1
    ds_read_b128 v[124:127], v7 offset:6144
    v_smfmac_f32_16x16x64_bf16 v[52:55], v[32:35], a[144:151], v1
    ds_read_b128 v[128:131], v7 offset:7168
    v_smfmac_f32_16x16x64_bf16 v[52:55], v[36:39], a[152:159], v1
    buffer_load_dwordx4 v[104:107], v2, s[4:7], s71 offen offset:1024 sc1
    s_waitcnt lgkmcnt(2)
    v_smfmac_f32_16x16x64_bf16 v[68:71], v[32:35], v[116:123], v1
    v_smfmac_f32_16x16x64_bf16 v[52:55], v[40:43], a[160:167], v1
    ds_read_b128 v[116:119], v7 offset:8192
    v_smfmac_f32_16x16x64_bf16 v[60:63], v[24:27], a[240:247], v1
    ds_read_b128 v[120:123], v7 offset:9216
    v_smfmac_f32_16x16x64_bf16 v[60:63], v[28:31], a[248:255], v1
    s_waitcnt lgkmcnt(2)
    v_smfmac_f32_16x16x64_bf16 v[68:71], v[36:39], v[124:131], v1
    v_smfmac_f32_16x16x64_bf16 v[60:63], v[32:35], v[144:151], v1
    ds_read_b128 v[124:127], v7 offset:10240
    v_smfmac_f32_16x16x64_bf16 v[60:63], v[36:39], v[152:159], v1
    ds_read_b128 v[128:131], v7 offset:11264
    v_smfmac_f32_16x16x64_bf16 v[60:63], v[40:43], v[160:167], v1
    s_waitcnt lgkmcnt(2)
    v_smfmac_f32_16x16x64_bf16 v[68:71], v[40:43], v[116:123], v1
    v_smfmac_f32_16x16x64_bf16 v[48:51], v[24:27], a[72:79], v1
    ds_read_b128 v[116:119], v7 offset:12288
    v_smfmac_f32_16x16x64_bf16 v[48:51], v[28:31], a[80:87], v1
    ds_read_b128 v[120:123], v7 offset:13312
    v_smfmac_f32_16x16x64_bf16 v[48:51], v[32:35], a[88:95], v1
    s_waitcnt lgkmcnt(2)
    v_smfmac_f32_16x16x64_bf16 v[72:75], v[24:27], v[124:131], v1
    v_permlane32_swap_b32 v44, v60
    v_smfmac_f32_16x16x64_bf16 v[48:51], v[36:39], a[96:103], v1
    ds_read_b128 v[124:127], v7 offset:14336
    v_permlane32_swap_b32 v52, v68
    v_smfmac_f32_16x16x64_bf16 v[48:51], v[40:43], a[104:111], v1
    ds_read_b128 v[128:131], v7 offset:15360
    v_permlane32_swap_b32 v45, v61
    v_smfmac_f32_16x16x64_bf16 v[56:59], v[24:27], a[184:191], v1
    v_permlane32_swap_b32 v53, v69
    s_waitcnt lgkmcnt(2)
    v_smfmac_f32_16x16x64_bf16 v[72:75], v[28:31], v[116:123], v1
    v_permlane32_swap_b32 v46, v62
    v_smfmac_f32_16x16x64_bf16 v[56:59], v[28:31], a[192:199], v1
    ds_read_b128 v[116:119], v7 offset:16384
    v_permlane32_swap_b32 v54, v70
    v_smfmac_f32_16x16x64_bf16 v[56:59], v[32:35], a[200:207], v1
    ds_read_b128 v[120:123], v7 offset:17408
    v_permlane32_swap_b32 v47, v63
    v_smfmac_f32_16x16x64_bf16 v[56:59], v[36:39], a[208:215], v1
    v_permlane32_swap_b32 v55, v71
    s_waitcnt lgkmcnt(2)
    v_smfmac_f32_16x16x64_bf16 v[72:75], v[32:35], v[124:131], v1
    v_add_f32 v44, v44, v60
    v_smfmac_f32_16x16x64_bf16 v[56:59], v[40:43], a[216:223], v1
    ds_read_b128 v[124:127], v7 offset:18432
    v_add_f32 v52, v52, v68
    v_smfmac_f32_16x16x64_bf16 v[64:67], v[24:27], v[184:191], v1
    ds_read_b128 v[128:131], v7 offset:19456
    v_add_f32 v45, v45, v61
    v_smfmac_f32_16x16x64_bf16 v[64:67], v[28:31], v[192:199], v1
    v_add_f32 v53, v53, v69
    s_waitcnt lgkmcnt(2)
    v_smfmac_f32_16x16x64_bf16 v[72:75], v[36:39], v[116:123], v1
    v_add_f32 v46, v46, v62
    v_smfmac_f32_16x16x64_bf16 v[64:67], v[32:35], v[200:207], v1
    v_add_f32 v54, v54, v70
    v_smfmac_f32_16x16x64_bf16 v[64:67], v[36:39], v[208:215], v1
    v_add_f32 v47, v47, v63
    v_smfmac_f32_16x16x64_bf16 v[64:67], v[40:43], v[216:223], v1
    v_add_f32 v55, v55, v71
    s_waitcnt lgkmcnt(0)
    v_smfmac_f32_16x16x64_bf16 v[72:75], v[40:43], v[124:131], v1
    v_cvt_pk_bf16_f32 v108, v44, v45
    v_cvt_pk_bf16_f32 v109, v46, v47
    v_cvt_pk_bf16_f32 v110, v52, v53
    v_cvt_pk_bf16_f32 v111, v54, v55
    s_nop 0
    v_permlane16_swap_b32 v108, v110
    v_permlane16_swap_b32 v109, v111
    v_permlane32_swap_b32 v48, v64
    v_permlane32_swap_b32 v56, v72
    v_permlane32_swap_b32 v49, v65
    v_permlane32_swap_b32 v57, v73
    v_permlane32_swap_b32 v50, v66
    v_permlane32_swap_b32 v58, v74
    v_permlane32_swap_b32 v51, v67
    v_permlane32_swap_b32 v59, v75
    v_add_f32 v48, v48, v64
    v_add_f32 v56, v56, v72
    v_add_f32 v49, v49, v65
    v_add_f32 v57, v57, v73
    v_add_f32 v50, v50, v66
    v_add_f32 v58, v58, v74
    v_add_f32 v51, v51, v67
    v_add_f32 v59, v59, v75
    v_cvt_pk_bf16_f32 v112, v48, v49
    v_cvt_pk_bf16_f32 v113, v50, v51
    v_cvt_pk_bf16_f32 v114, v56, v57
    v_cvt_pk_bf16_f32 v115, v58, v59
    s_nop 0
    v_permlane16_swap_b32 v112, v114
    v_permlane16_swap_b32 v113, v115
    s_cmp_eq_u32 s40, 63
    s_cbranch_scc1 gated_mix__linear_attn_block__memory_aug_recurrent_mem_tr__prompt_kernel_RB_last
    s_lshl_b32 s73, s27, 2
    s_add_u32 s73, s73, s26
    s_lshl_b32 s73, s73, 2
    s_add_u32 s73, s73, s41
    s_add_u32 s73, s73, 12288
    s_add_u32 s41, s41, 8192
    s_add_u32 s43, s43, 458752
    s_add_u32 s40, s40, 1
    buffer_load_dwordx4 v[16:19], v5, s[4:7], s42 offen sc1
    buffer_load_dwordx4 v[20:23], v5, s[4:7], s42 offen offset:1024 sc1
    buffer_load_dwordx4 v[24:27], v3, s[4:7], s42 offen offset:2048 sc1
    v_mov_b32 v44, 0
    v_mov_b32 v45, 0
    v_mov_b32 v46, 0
    v_mov_b32 v47, 0
    v_mov_b32 v48, 0
    v_mov_b32 v49, 0
    v_mov_b32 v50, 0
    v_mov_b32 v51, 0
    v_mov_b32 v52, 0
    v_mov_b32 v53, 0
    v_mov_b32 v54, 0
    v_mov_b32 v55, 0
    v_mov_b32 v56, 0
    v_mov_b32 v57, 0
    v_mov_b32 v58, 0
    v_mov_b32 v59, 0
    v_mov_b32 v60, 0
    v_mov_b32 v61, 0
    v_mov_b32 v62, 0
    v_mov_b32 v63, 0
    v_mov_b32 v64, 0
    v_mov_b32 v65, 0
    v_mov_b32 v66, 0
    v_mov_b32 v67, 0
    v_mov_b32 v68, 0
    v_mov_b32 v69, 0
    v_mov_b32 v70, 0
    v_mov_b32 v71, 0
    v_mov_b32 v72, 0
    v_mov_b32 v73, 0
    v_mov_b32 v74, 0
    v_mov_b32 v75, 0
gated_mix__linear_attn_block__memory_aug_recurrent_mem_tr__prompt_kernel_RB_pollp:
    s_waitcnt vmcnt(2)
    v_max3_u32 v14, v16, v17, v18
    v_max_u32 v14, v14, v19
    v_cmp_eq_u32 vcc, -1, v14
    buffer_load_dwordx4 v[16:19], v5, s[4:7], s42 offen sc1
    buffer_load_dwordx4 v[20:23], v5, s[4:7], s42 offen offset:1024 sc1
    buffer_load_dwordx4 v[24:27], v3, s[4:7], s42 offen offset:2048 sc1
    s_cbranch_vccnz gated_mix__linear_attn_block__memory_aug_recurrent_mem_tr__prompt_kernel_RB_pollp
    v_mfma_f32_16x16x32_bf16 v[116:119], v[76:79], v[16:19], 0
    v_mfma_f32_16x16x32_bf16 v[124:127], v[84:87], v[16:19], 0
    s_cmp_eq_u32 s26, 0
    s_waitcnt vmcnt(4)
    v_mfma_f32_16x16x32_bf16 v[120:123], v[80:83], v[16:19], 0
    v_max3_u32 v14, v20, v21, v22
    v_mfma_f32_16x16x32_bf16 v[128:131], v[88:91], v[16:19], 0
    v_max_u32 v14, v14, v23
    s_waitcnt vmcnt(3)
    v_mfma_f32_16x16x32_bf16 v[124:127], v[100:103], v[20:23], v[124:127]
    v_max3_u32 v15, v24, v25, v26
    v_mfma_f32_16x16x32_bf16 v[116:119], v[92:95], v[20:23], v[116:119]
    v_max3_u32 v14, v14, v15, v27
    v_mfma_f32_16x16x32_bf16 v[116:119], v[108:111], v[24:27], v[116:119]
    v_cmp_eq_u32 vcc, -1, v14
    v_mfma_f32_16x16x32_bf16 v[128:131], v[104:107], v[20:23], v[128:131]
    v_mfma_f32_16x16x32_bf16 v[120:123], v[96:99], v[20:23], v[120:123]
    v_mfma_f32_16x16x32_bf16 v[120:123], v[112:115], v[24:27], v[120:123]
    s_cbranch_vccnz gated_mix__linear_attn_block__memory_aug_recurrent_mem_tr__prompt_kernel_RB_pollp
    v_add_f32_dpp v136, v124, v116 row_ror:8 row_mask:0xf bank_mask:0x3
    v_add_f32_dpp v137, v125, v117 row_ror:8 row_mask:0xf bank_mask:0x3
    v_add_f32_dpp v138, v126, v118 row_ror:8 row_mask:0xf bank_mask:0x3
    v_add_f32_dpp v139, v127, v119 row_ror:8 row_mask:0xf bank_mask:0x3
    s_nop 2
    v_add_f32_dpp v136, v120, v128 row_ror:8 row_mask:0xf bank_mask:0xc
    v_add_f32_dpp v137, v121, v129 row_ror:8 row_mask:0xf bank_mask:0xc
    v_add_f32_dpp v138, v122, v130 row_ror:8 row_mask:0xf bank_mask:0xc
    v_add_f32_dpp v139, v123, v131 row_ror:8 row_mask:0xf bank_mask:0xc
    s_cbranch_scc1 gated_mix__linear_attn_block__memory_aug_recurrent_mem_tr__prompt_kernel_RB_w0
    ds_write_b128 v6, v[136:139]
    s_add_u32 s42, s42, 10240
    s_waitcnt lgkmcnt(0)
    s_barrier
    s_branch gated_mix__linear_attn_block__memory_aug_recurrent_mem_tr__prompt_kernel_RB_next
gated_mix__linear_attn_block__memory_aug_recurrent_mem_tr__prompt_kernel_RB_w0:
    s_add_u32 s42, s42, 10240
    s_cmp_eq_u32 s49, 0
    s_barrier
    ds_read_b128 v[120:123], v2 offset:8192
    ds_read_b128 v[124:127], v2 offset:9216
    ds_read_b128 v[128:131], v2 offset:10240
    s_waitcnt lgkmcnt(2)
    v_pk_add_f32 v[116:117], v[136:137], v[120:121]
    v_pk_add_f32 v[118:119], v[138:139], v[122:123]
    s_waitcnt lgkmcnt(0)
    v_pk_add_f32 v[124:125], v[124:125], v[128:129]
    v_pk_add_f32 v[126:127], v[126:127], v[130:131]
    v_pk_add_f32 v[116:117], v[116:117], v[124:125]
    v_pk_add_f32 v[118:119], v[118:119], v[126:127]
    v_cvt_pk_bf16_f32 v132, v116, v117
    v_cvt_pk_bf16_f32 v133, v118, v119
    v_min_u32 v132, -2, v132
    v_min_u32 v133, -2, v133
    s_cbranch_scc1 gated_mix__linear_attn_block__memory_aug_recurrent_mem_tr__prompt_kernel_RB_slow
    buffer_store_dwordx2 v[132:133], v8, s[4:7], s41 offen
gated_mix__linear_attn_block__memory_aug_recurrent_mem_tr__prompt_kernel_RB_pub:
    s_cmp_lg_u32 s40, 63
    s_cbranch_scc1 gated_mix__linear_attn_block__memory_aug_recurrent_mem_tr__prompt_kernel_RB_next
    s_add_u32 s33, s41, 0x80000
    buffer_store_dwordx2 v[132:133], v8, s[4:7], s33 offen sc1
gated_mix__linear_attn_block__memory_aug_recurrent_mem_tr__prompt_kernel_RB_next:
    s_branch gated_mix__linear_attn_block__memory_aug_recurrent_mem_tr__prompt_kernel_RB_loop
gated_mix__linear_attn_block__memory_aug_recurrent_mem_tr__prompt_kernel_RB_slow:
    buffer_store_dwordx2 v[132:133], v8, s[4:7], s41 offen sc1
    s_branch gated_mix__linear_attn_block__memory_aug_recurrent_mem_tr__prompt_kernel_RB_pub
gated_mix__linear_attn_block__memory_aug_recurrent_mem_tr__prompt_kernel_RB_last:
    buffer_store_dwordx4 v[108:111], v2, s[4:7], s46 offen sc1
    buffer_store_dwordx4 v[112:115], v2, s[4:7], s46 offen offset:1024 sc1
    s_waitcnt vmcnt(0)
    s_barrier
    buffer_store_dword v11, v10, s[4:7], s48 offen sc1
    s_endpgm
gated_mix__linear_attn_block__memory_aug_recurrent_mem_tr__prompt_kernel_R_H:
    s_and_b32 s27, s27, 1
    s_cmp_lg_u32 s27, 0
    s_cbranch_scc1 gated_mix__linear_attn_block__memory_aug_recurrent_mem_tr__prompt_kernel_M_end
    s_cmp_lg_u32 s26, 0
    s_cbranch_scc1 gated_mix__linear_attn_block__memory_aug_recurrent_mem_tr__prompt_kernel_RH_iw_b
gated_mix__linear_attn_block__memory_aug_recurrent_mem_tr__prompt_kernel_RH_iw:
    buffer_load_dword v5, off, s[84:87], 0 offset:24 sc1
    s_waitcnt vmcnt(0)
    v_readfirstlane_b32 s33, v5
    s_nop 0
    s_cmp_lg_u32 s33, 0
    s_cbranch_scc1 gated_mix__linear_attn_block__memory_aug_recurrent_mem_tr__prompt_kernel_RH_iw_b
    s_sleep 6
    s_branch gated_mix__linear_attn_block__memory_aug_recurrent_mem_tr__prompt_kernel_RH_iw
gated_mix__linear_attn_block__memory_aug_recurrent_mem_tr__prompt_kernel_RH_iw_b:
    s_barrier
    v_lshlrev_b32 v9, 7, v0
    v_mov_b32 v6, 0
    v_mov_b32 v10, 0x40000000
    s_cmp_eq_u32 s27, 0
    s_cselect_b32 s33, 224, 0
    s_cselect_b32 s34, 64, 0
    s_cselect_b32 s35, 80, 0
    v_cmp_gt_u32 vcc, s33, v0
    s_nop 1
    v_cndmask_b32 v5, v10, v9, vcc
    v_cmp_gt_u32 vcc, s34, v0
    s_nop 1
    v_cndmask_b32 v11, v10, v9, vcc
    v_cmp_gt_u32 vcc, s35, v0
    s_nop 1
    v_cndmask_b32 v12, v10, v9, vcc
    v_and_b32 v13, 3, v0
    v_lshlrev_b32 v13, 2, v13
    v_and_b32 v14, 4, v0
    v_lshl_add_u32 v13, v14, 8, v13
    v_cmp_eq_u32 vcc, 0, v0
    s_nop 1
    v_cndmask_b32 v14, v10, 0, vcc
    s_lshl_b32 s46, s27, 11
    s_add_u32 s46, s46, 0x1164000
    s_mul_i32 s47, s27, 229376
    s_add_u32 s47, s47, 0x1ce0000
    s_mov_b32 s40, 0
    s_mov_b32 s41, 0xfc0000
    s_mov_b32 s43, 0x38e7000
    s_mov_b32 s44, 0xfc2000
    s_mov_b32 s45, 0x10c0000
    buffer_load_dword v8, v5, s[4:7], s43 offen sc1
    buffer_load_dword v8, v11, s[4:7], s44 offen sc1
    buffer_load_dword v8, v12, s[4:7], s45 offen sc1
gated_mix__linear_attn_block__memory_aug_recurrent_mem_tr__prompt_kernel_RH_loop:
    buffer_load_dword v7, v6, s[4:7], s41 offen sc1
    s_waitcnt vmcnt(0)
    v_readfirstlane_b32 s33, v7
    s_nop 0
    s_cmp_lg_u32 s33, -1
    s_cbranch_scc1 gated_mix__linear_attn_block__memory_aug_recurrent_mem_tr__prompt_kernel_RH_go
    s_sleep 4
    s_branch gated_mix__linear_attn_block__memory_aug_recurrent_mem_tr__prompt_kernel_RH_loop
gated_mix__linear_attn_block__memory_aug_recurrent_mem_tr__prompt_kernel_RH_go:
    v_mov_b32 v7, s40
    s_mov_b32 s33, 0x1165000
    buffer_store_dword v7, v14, s[4:7], s33 offen sc1
    s_add_u32 s43, s43, 28672
    s_add_u32 s44, s44, 8192
    s_add_u32 s45, s45, 10240
    buffer_load_dword v8, v11, s[4:7], s44 offen sc1
    buffer_load_dword v8, v12, s[4:7], s45 offen sc1
    buffer_load_dword v8, v5, s[4:7], s43 offen sc1
    s_cmp_ge_u32 s40, 61
    s_cbranch_scc1 gated_mix__linear_attn_block__memory_aug_recurrent_mem_tr__prompt_kernel_RH_noz
gated_mix__linear_attn_block__memory_aug_recurrent_mem_tr__prompt_kernel_RH_noz:
    s_add_u32 s41, s41, 8192
    s_add_u32 s40, s40, 1
    s_cmp_lt_u32 s40, 62
    s_cbranch_scc1 gated_mix__linear_attn_block__memory_aug_recurrent_mem_tr__prompt_kernel_RH_loop
    s_endpgm
gated_mix__linear_attn_block__memory_aug_recurrent_mem_tr__prompt_kernel_R_Z:
    s_and_b32 s32, s26, 1
    s_mul_i32 s31, s26, 7
    s_add_u32 s30, s31, s32
    s_xor_b32 s33, s32, 1
    s_mul_i32 s33, s33, 6
    s_add_u32 s31, s31, s33
    s_mov_b32 s40, s28
    s_mul_i32 s43, s26, 7168
    s_mul_i32 s41, s40, 28672
    s_add_u32 s41, s41, s43
    s_add_u32 s41, s41, 0xe00000
    s_mov_b32 s42, s43
    s_mov_b32 s44, 0
    s_add_u32 s35, s27, 16
    s_cmp_lg_u32 s26, 0
    s_cbranch_scc1 gated_mix__linear_attn_block__memory_aug_recurrent_mem_tr__prompt_kernel_RZ_wi_b
    s_lshl_b32 s36, s35, 7
    s_add_u32 s36, s36, 0x3aa0000
gated_mix__linear_attn_block__memory_aug_recurrent_mem_tr__prompt_kernel_RZ_wi:
    buffer_load_dword v5, off, s[4:7], s36 sc1
    s_waitcnt vmcnt(0)
    v_readfirstlane_b32 s33, v5
    s_nop 0
    s_cmp_lg_u32 s33, 0
    s_cbranch_scc1 gated_mix__linear_attn_block__memory_aug_recurrent_mem_tr__prompt_kernel_RZ_wi_b
    s_sleep 2
    s_branch gated_mix__linear_attn_block__memory_aug_recurrent_mem_tr__prompt_kernel_RZ_wi
gated_mix__linear_attn_block__memory_aug_recurrent_mem_tr__prompt_kernel_RZ_wi_b:
    s_barrier
    s_mul_i32 s34, s27, 28
    s_add_u32 s35, s34, s31
    s_add_u32 s34, s34, s30
    s_mul_i32 s34, s34, 14336
    s_mul_i32 s35, s35, 14336
    s_add_u32 s34, s34, 0x620000
    s_add_u32 s35, s35, 0x620000
    buffer_load_dwordx4 a[0:3], v2, s[4:7], s34 offen offset:0 sc1
    buffer_load_dwordx4 a[4:7], v2, s[4:7], s34 offen offset:1024 sc1
    buffer_load_dwordx4 a[8:11], v2, s[4:7], s34 offen offset:2048 sc1
    buffer_load_dwordx4 a[12:15], v2, s[4:7], s34 offen offset:3072 sc1
    s_add_u32 s34, s34, 4096
    buffer_load_dwordx4 a[16:19], v2, s[4:7], s34 offen offset:0 sc1
    buffer_load_dwordx4 a[20:23], v2, s[4:7], s34 offen offset:1024 sc1
    buffer_load_dwordx4 a[24:27], v2, s[4:7], s34 offen offset:2048 sc1
    buffer_load_dwordx4 a[28:31], v2, s[4:7], s34 offen offset:3072 sc1
    s_add_u32 s34, s34, 4096
    buffer_load_dwordx4 a[32:35], v2, s[4:7], s34 offen offset:0 sc1
    buffer_load_dwordx4 a[36:39], v2, s[4:7], s34 offen offset:1024 sc1
    buffer_load_dwordx4 a[40:43], v2, s[4:7], s34 offen offset:2048 sc1
    buffer_load_dwordx4 a[44:47], v2, s[4:7], s34 offen offset:3072 sc1
    s_add_u32 s34, s34, 4096
    buffer_load_dwordx4 a[48:51], v2, s[4:7], s34 offen offset:0 sc1
    buffer_load_dwordx4 a[52:55], v2, s[4:7], s34 offen offset:1024 sc1
    buffer_load_dwordx4 a[56:59], v2, s[4:7], s34 offen offset:2048 sc1
    buffer_load_dwordx4 a[60:63], v2, s[4:7], s34 offen offset:3072 sc1
    s_add_u32 s34, s34, 4096
    buffer_load_dwordx4 a[64:67], v2, s[4:7], s34 offen offset:0 sc1
    buffer_load_dwordx4 a[68:71], v2, s[4:7], s34 offen offset:1024 sc1
    buffer_load_dwordx4 a[72:75], v2, s[4:7], s34 offen offset:2048 sc1
    buffer_load_dwordx4 a[76:79], v2, s[4:7], s34 offen offset:3072 sc1
    s_add_u32 s34, s34, 4096
    buffer_load_dwordx4 a[80:83], v2, s[4:7], s34 offen offset:0 sc1
    buffer_load_dwordx4 a[84:87], v2, s[4:7], s34 offen offset:1024 sc1
    buffer_load_dwordx4 a[88:91], v2, s[4:7], s34 offen offset:2048 sc1
    buffer_load_dwordx4 a[92:95], v2, s[4:7], s34 offen offset:3072 sc1
    s_add_u32 s34, s34, 4096
    buffer_load_dwordx4 a[96:99], v2, s[4:7], s34 offen offset:0 sc1
    buffer_load_dwordx4 a[100:103], v2, s[4:7], s34 offen offset:1024 sc1
    buffer_load_dwordx4 a[104:107], v2, s[4:7], s34 offen offset:2048 sc1
    buffer_load_dwordx4 a[108:111], v2, s[4:7], s34 offen offset:3072 sc1
    s_add_u32 s34, s34, 4096
    buffer_load_dwordx4 a[112:115], v2, s[4:7], s34 offen offset:0 sc1
    buffer_load_dwordx4 a[116:119], v2, s[4:7], s34 offen offset:1024 sc1
    buffer_load_dwordx4 a[120:123], v2, s[4:7], s34 offen offset:2048 sc1
    buffer_load_dwordx4 a[124:127], v2, s[4:7], s34 offen offset:3072 sc1
    s_add_u32 s34, s34, 4096
    buffer_load_dwordx4 a[128:131], v2, s[4:7], s34 offen offset:0 sc1
    buffer_load_dwordx4 a[132:135], v2, s[4:7], s34 offen offset:1024 sc1
    buffer_load_dwordx4 a[136:139], v2, s[4:7], s34 offen offset:2048 sc1
    buffer_load_dwordx4 a[140:143], v2, s[4:7], s34 offen offset:3072 sc1
    s_add_u32 s34, s34, 4096
    buffer_load_dwordx4 a[144:147], v2, s[4:7], s34 offen offset:0 sc1
    buffer_load_dwordx4 a[148:151], v2, s[4:7], s34 offen offset:1024 sc1
    buffer_load_dwordx4 a[152:155], v2, s[4:7], s34 offen offset:2048 sc1
    buffer_load_dwordx4 a[156:159], v2, s[4:7], s34 offen offset:3072 sc1
    s_add_u32 s34, s34, 4096
    buffer_load_dwordx4 a[160:163], v2, s[4:7], s34 offen offset:0 sc1
    buffer_load_dwordx4 a[164:167], v2, s[4:7], s34 offen offset:1024 sc1
    buffer_load_dwordx4 a[168:171], v2, s[4:7], s34 offen offset:2048 sc1
    buffer_load_dwordx4 a[172:175], v2, s[4:7], s34 offen offset:3072 sc1
    s_add_u32 s34, s34, 4096
    buffer_load_dwordx4 a[176:179], v2, s[4:7], s34 offen offset:0 sc1
    buffer_load_dwordx4 a[180:183], v2, s[4:7], s34 offen offset:1024 sc1
    buffer_load_dwordx4 a[184:187], v2, s[4:7], s34 offen offset:2048 sc1
    buffer_load_dwordx4 a[188:191], v2, s[4:7], s34 offen offset:3072 sc1
    s_add_u32 s34, s34, 4096
    buffer_load_dwordx4 a[192:195], v2, s[4:7], s34 offen offset:0 sc1
    buffer_load_dwordx4 a[196:199], v2, s[4:7], s34 offen offset:1024 sc1
    buffer_load_dwordx4 a[200:203], v2, s[4:7], s34 offen offset:2048 sc1
    buffer_load_dwordx4 a[204:207], v2, s[4:7], s34 offen offset:3072 sc1
    s_add_u32 s34, s34, 4096
    buffer_load_dwordx4 a[208:211], v2, s[4:7], s34 offen offset:0 sc1
    buffer_load_dwordx4 a[212:215], v2, s[4:7], s34 offen offset:1024 sc1
    buffer_load_dwordx4 a[216:219], v2, s[4:7], s34 offen offset:2048 sc1
    buffer_load_dwordx4 a[220:223], v2, s[4:7], s34 offen offset:3072 sc1
    s_add_u32 s34, s34, 4096
    buffer_load_dwordx4 a[224:227], v2, s[4:7], s34 offen offset:0 sc1
    buffer_load_dwordx4 a[228:231], v2, s[4:7], s34 offen offset:1024 sc1
    buffer_load_dwordx4 a[232:235], v2, s[4:7], s34 offen offset:2048 sc1
    buffer_load_dwordx4 a[236:239], v2, s[4:7], s34 offen offset:3072 sc1
    s_add_u32 s34, s34, 4096
    buffer_load_dwordx4 a[240:243], v2, s[4:7], s34 offen offset:0 sc1
    buffer_load_dwordx4 a[244:247], v2, s[4:7], s34 offen offset:1024 sc1
    buffer_load_dwordx4 a[248:251], v2, s[4:7], s34 offen offset:2048 sc1
    buffer_load_dwordx4 a[252:255], v2, s[4:7], s34 offen offset:3072 sc1
    s_add_u32 s34, s34, 4096
    buffer_load_dwordx4 v[120:123], v2, s[4:7], s34 offen offset:0 sc1
    buffer_load_dwordx4 v[124:127], v2, s[4:7], s34 offen offset:1024 sc1
    buffer_load_dwordx4 v[128:131], v2, s[4:7], s34 offen offset:2048 sc1
    buffer_load_dwordx4 v[132:135], v2, s[4:7], s34 offen offset:3072 sc1
    s_add_u32 s34, s34, 4096
    buffer_load_dwordx4 v[136:139], v2, s[4:7], s34 offen offset:0 sc1
    buffer_load_dwordx4 v[140:143], v2, s[4:7], s34 offen offset:1024 sc1
    buffer_load_dwordx4 v[144:147], v2, s[4:7], s34 offen offset:2048 sc1
    buffer_load_dwordx4 v[148:151], v2, s[4:7], s34 offen offset:3072 sc1
    s_add_u32 s34, s34, 4096
    buffer_load_dwordx4 v[152:155], v2, s[4:7], s34 offen offset:0 sc1
    buffer_load_dwordx4 v[156:159], v2, s[4:7], s34 offen offset:1024 sc1
    buffer_load_dwordx4 v[160:163], v2, s[4:7], s34 offen offset:2048 sc1
    buffer_load_dwordx4 v[164:167], v2, s[4:7], s34 offen offset:3072 sc1
    s_add_u32 s34, s34, 4096
    buffer_load_dwordx4 v[168:171], v2, s[4:7], s34 offen offset:0 sc1
    buffer_load_dwordx4 v[172:175], v2, s[4:7], s34 offen offset:1024 sc1
    buffer_load_dwordx4 v[176:179], v2, s[4:7], s34 offen offset:2048 sc1
    buffer_load_dwordx4 v[180:183], v2, s[4:7], s34 offen offset:3072 sc1
    s_add_u32 s34, s34, 4096
    buffer_load_dwordx4 v[184:187], v2, s[4:7], s34 offen offset:0 sc1
    buffer_load_dwordx4 v[188:191], v2, s[4:7], s34 offen offset:1024 sc1
    buffer_load_dwordx4 v[192:195], v2, s[4:7], s34 offen offset:2048 sc1
    buffer_load_dwordx4 v[196:199], v2, s[4:7], s34 offen offset:3072 sc1
    s_add_u32 s34, s34, 4096
    buffer_load_dwordx4 v[200:203], v2, s[4:7], s35 offen offset:0 sc1
    buffer_load_dwordx4 v[204:207], v2, s[4:7], s35 offen offset:1024 sc1
    buffer_load_dwordx4 v[208:211], v2, s[4:7], s35 offen offset:2048 sc1
    buffer_load_dwordx4 v[212:215], v2, s[4:7], s35 offen offset:3072 sc1
    s_add_u32 s35, s35, 4096
    buffer_load_dwordx4 v[216:219], v2, s[4:7], s35 offen offset:0 sc1
    buffer_load_dwordx4 v[220:223], v2, s[4:7], s35 offen offset:1024 sc1
    buffer_load_dwordx4 v[224:227], v2, s[4:7], s35 offen offset:2048 sc1
    buffer_load_dwordx4 v[228:231], v2, s[4:7], s35 offen offset:3072 sc1
    s_add_u32 s35, s35, 4096
    buffer_load_dwordx4 v[232:235], v2, s[4:7], s35 offen offset:0 sc1
    buffer_load_dwordx4 v[236:239], v2, s[4:7], s35 offen offset:1024 sc1
    buffer_load_dwordx4 v[240:243], v2, s[4:7], s35 offen offset:2048 sc1
    buffer_load_dwordx4 v[244:247], v2, s[4:7], s35 offen offset:3072 sc1
    s_add_u32 s35, s35, 4096
    buffer_load_dwordx4 v[248:251], v2, s[4:7], s35 offen offset:0 sc1
    buffer_load_dwordx4 v[252:255], v2, s[4:7], s35 offen offset:1024 sc1
    s_cmp_lg_u32 s26, 0
    s_cbranch_scc1 gated_mix__linear_attn_block__memory_aug_recurrent_mem_tr__prompt_kernel_RZ_iw_b
gated_mix__linear_attn_block__memory_aug_recurrent_mem_tr__prompt_kernel_RZ_iw:
    buffer_load_dword v5, off, s[84:87], 0 offset:24 sc1
    s_waitcnt vmcnt(0)
    v_readfirstlane_b32 s33, v5
    s_nop 0
    s_cmp_lg_u32 s33, 0
    s_cbranch_scc1 gated_mix__linear_attn_block__memory_aug_recurrent_mem_tr__prompt_kernel_RZ_iw_b
    s_sleep 6
    s_branch gated_mix__linear_attn_block__memory_aug_recurrent_mem_tr__prompt_kernel_RZ_iw
gated_mix__linear_attn_block__memory_aug_recurrent_mem_tr__prompt_kernel_RZ_iw_b:
    s_barrier
    s_add_u32 s36, s41, 0
    s_add_u32 m0, s42, 0
    s_nop 0
    buffer_load_dwordx4 v2, s[4:7], s36 offen offset:0 sc1 lds
    buffer_load_dwordx4 v2, s[4:7], s36 offen offset:1024 sc1 lds
    buffer_load_dwordx4 v2, s[4:7], s36 offen offset:2048 sc1 lds
    buffer_load_dwordx4 v2, s[4:7], s36 offen offset:3072 sc1 lds
    s_add_u32 s36, s41, 4096
    s_add_u32 m0, s42, 4096
    s_nop 0
    buffer_load_dwordx4 v2, s[4:7], s36 offen offset:0 sc1 lds
    buffer_load_dwordx4 v2, s[4:7], s36 offen offset:1024 sc1 lds
    buffer_load_dwordx4 v2, s[4:7], s36 offen offset:2048 sc1 lds
    v_mov_b32 v5, 1
    s_lshr_b32 s45, s27, 2
    s_lshl_b32 s45, s45, 10
    s_and_b32 s46, s27, 3
    s_lshl_b32 s46, s46, 2
    s_add_u32 s45, s45, s46
    s_add_u32 s45, s45, 0x1164000
    v_mov_b32 v6, 0
    s_waitcnt vmcnt(0)
gated_mix__linear_attn_block__memory_aug_recurrent_mem_tr__prompt_kernel_RZ_loop:
    s_waitcnt vmcnt(7)
    s_barrier
    s_sub_u32 s46, s40, 6
    s_cmp_lt_i32 s46, 0
    s_cbranch_scc1 gated_mix__linear_attn_block__memory_aug_recurrent_mem_tr__prompt_kernel_RZ_noflag
    s_cmp_lg_u32 s26, 0
    s_cbranch_scc1 gated_mix__linear_attn_block__memory_aug_recurrent_mem_tr__prompt_kernel_RZ_noflag
    s_lshl_b32 s46, s46, 4
    s_add_u32 s46, s46, s45
    s_mov_b64 exec, 1
    buffer_store_dword v5, v6, s[4:7], s46 offen sc1
    s_mov_b64 exec, -1
gated_mix__linear_attn_block__memory_aug_recurrent_mem_tr__prompt_kernel_RZ_noflag:
    v_add_u32 v7, s44, v2
    s_xor_b32 s44, s44, 28672
    s_add_u32 s42, s44, s43
    s_add_u32 s47, s40, 3
    s_min_u32 s47, s47, 63
    s_mul_i32 s41, s47, 28672
    s_add_u32 s41, s41, s43
    s_add_u32 s41, s41, 0xe00000
    s_add_u32 s36, s41, 0
    s_add_u32 m0, s42, 0
    s_nop 0
    buffer_load_dwordx4 v2, s[4:7], s36 offen offset:0 sc1 lds
    buffer_load_dwordx4 v2, s[4:7], s36 offen offset:1024 sc1 lds
    buffer_load_dwordx4 v2, s[4:7], s36 offen offset:2048 sc1 lds
    buffer_load_dwordx4 v2, s[4:7], s36 offen offset:3072 sc1 lds
    s_add_u32 s36, s41, 4096
    s_add_u32 m0, s42, 4096
    s_nop 0
    buffer_load_dwordx4 v2, s[4:7], s36 offen offset:0 sc1 lds
    buffer_load_dwordx4 v2, s[4:7], s36 offen offset:1024 sc1 lds
    buffer_load_dwordx4 v2, s[4:7], s36 offen offset:2048 sc1 lds
    ds_read_b128 v[16:19], v7 offset:0
    ds_read_b128 v[20:23], v7 offset:14336
    ds_read_b128 v[24:27], v7 offset:1024
    ds_read_b128 v[28:31], v7 offset:15360
    s_waitcnt lgkmcnt(2)
    v_mfma_f32_16x16x32_bf16 v[32:35], v[16:19], a[0:3], 0
    v_mfma_f32_16x16x32_bf16 v[36:39], v[20:23], a[0:3], 0
    v_mfma_f32_16x16x32_bf16 v[40:43], v[16:19], a[56:59], 0
    v_mfma_f32_16x16x32_bf16 v[44:47], v[20:23], a[56:59], 0
    v_mfma_f32_16x16x32_bf16 v[48:51], v[16:19], a[112:115], 0
    v_mfma_f32_16x16x32_bf16 v[52:55], v[20:23], a[112:115], 0
    v_mfma_f32_16x16x32_bf16 v[56:59], v[16:19], a[168:171], 0
    v_mfma_f32_16x16x32_bf16 v[60:63], v[20:23], a[168:171], 0
    v_mfma_f32_16x16x32_bf16 v[64:67], v[16:19], a[224:227], 0
    v_mfma_f32_16x16x32_bf16 v[68:71], v[20:23], a[224:227], 0
    v_mfma_f32_16x16x32_bf16 v[72:75], v[16:19], v[144:147], 0
    v_mfma_f32_16x16x32_bf16 v[76:79], v[20:23], v[144:147], 0
    v_mfma_f32_16x16x32_bf16 v[80:83], v[16:19], v[200:203], 0
    v_mfma_f32_16x16x32_bf16 v[84:87], v[20:23], v[200:203], 0
    ds_read_b128 v[16:19], v7 offset:2048
    ds_read_b128 v[20:23], v7 offset:16384
    s_waitcnt lgkmcnt(2)
    v_mfma_f32_16x16x32_bf16 v[32:35], v[24:27], a[4:7], v[32:35]
    v_mfma_f32_16x16x32_bf16 v[36:39], v[28:31], a[4:7], v[36:39]
    v_mfma_f32_16x16x32_bf16 v[40:43], v[24:27], a[60:63], v[40:43]
    v_mfma_f32_16x16x32_bf16 v[44:47], v[28:31], a[60:63], v[44:47]
    v_mfma_f32_16x16x32_bf16 v[48:51], v[24:27], a[116:119], v[48:51]
    v_mfma_f32_16x16x32_bf16 v[52:55], v[28:31], a[116:119], v[52:55]
    v_mfma_f32_16x16x32_bf16 v[56:59], v[24:27], a[172:175], v[56:59]
    v_mfma_f32_16x16x32_bf16 v[60:63], v[28:31], a[172:175], v[60:63]
    v_mfma_f32_16x16x32_bf16 v[64:67], v[24:27], a[228:231], v[64:67]
    v_mfma_f32_16x16x32_bf16 v[68:71], v[28:31], a[228:231], v[68:71]
    v_mfma_f32_16x16x32_bf16 v[72:75], v[24:27], v[148:151], v[72:75]
    v_mfma_f32_16x16x32_bf16 v[76:79], v[28:31], v[148:151], v[76:79]
    v_mfma_f32_16x16x32_bf16 v[80:83], v[24:27], v[204:207], v[80:83]
    v_mfma_f32_16x16x32_bf16 v[84:87], v[28:31], v[204:207], v[84:87]
    ds_read_b128 v[24:27], v7 offset:3072
    ds_read_b128 v[28:31], v7 offset:17408
    s_waitcnt lgkmcnt(2)
    v_mfma_f32_16x16x32_bf16 v[32:35], v[16:19], a[8:11], v[32:35]
    v_mfma_f32_16x16x32_bf16 v[36:39], v[20:23], a[8:11], v[36:39]
    v_mfma_f32_16x16x32_bf16 v[40:43], v[16:19], a[64:67], v[40:43]
    v_mfma_f32_16x16x32_bf16 v[44:47], v[20:23], a[64:67], v[44:47]
    v_mfma_f32_16x16x32_bf16 v[48:51], v[16:19], a[120:123], v[48:51]
    v_mfma_f32_16x16x32_bf16 v[52:55], v[20:23], a[120:123], v[52:55]
    v_mfma_f32_16x16x32_bf16 v[56:59], v[16:19], a[176:179], v[56:59]
    v_mfma_f32_16x16x32_bf16 v[60:63], v[20:23], a[176:179], v[60:63]
    v_mfma_f32_16x16x32_bf16 v[64:67], v[16:19], a[232:235], v[64:67]
    v_mfma_f32_16x16x32_bf16 v[68:71], v[20:23], a[232:235], v[68:71]
    v_mfma_f32_16x16x32_bf16 v[72:75], v[16:19], v[152:155], v[72:75]
    v_mfma_f32_16x16x32_bf16 v[76:79], v[20:23], v[152:155], v[76:79]
    v_mfma_f32_16x16x32_bf16 v[80:83], v[16:19], v[208:211], v[80:83]
    v_mfma_f32_16x16x32_bf16 v[84:87], v[20:23], v[208:211], v[84:87]
    ds_read_b128 v[16:19], v7 offset:4096
    ds_read_b128 v[20:23], v7 offset:18432
    s_waitcnt lgkmcnt(2)
    v_mfma_f32_16x16x32_bf16 v[32:35], v[24:27], a[12:15], v[32:35]
    v_mfma_f32_16x16x32_bf16 v[36:39], v[28:31], a[12:15], v[36:39]
    v_mfma_f32_16x16x32_bf16 v[40:43], v[24:27], a[68:71], v[40:43]
    v_mfma_f32_16x16x32_bf16 v[44:47], v[28:31], a[68:71], v[44:47]
    v_mfma_f32_16x16x32_bf16 v[48:51], v[24:27], a[124:127], v[48:51]
    v_mfma_f32_16x16x32_bf16 v[52:55], v[28:31], a[124:127], v[52:55]
    v_mfma_f32_16x16x32_bf16 v[56:59], v[24:27], a[180:183], v[56:59]
    v_mfma_f32_16x16x32_bf16 v[60:63], v[28:31], a[180:183], v[60:63]
    v_mfma_f32_16x16x32_bf16 v[64:67], v[24:27], a[236:239], v[64:67]
    v_mfma_f32_16x16x32_bf16 v[68:71], v[28:31], a[236:239], v[68:71]
    v_mfma_f32_16x16x32_bf16 v[72:75], v[24:27], v[156:159], v[72:75]
    v_mfma_f32_16x16x32_bf16 v[76:79], v[28:31], v[156:159], v[76:79]
    v_mfma_f32_16x16x32_bf16 v[80:83], v[24:27], v[212:215], v[80:83]
    v_mfma_f32_16x16x32_bf16 v[84:87], v[28:31], v[212:215], v[84:87]
    ds_read_b128 v[24:27], v7 offset:5120
    ds_read_b128 v[28:31], v7 offset:19456
    s_waitcnt lgkmcnt(2)
    v_mfma_f32_16x16x32_bf16 v[32:35], v[16:19], a[16:19], v[32:35]
    v_mfma_f32_16x16x32_bf16 v[36:39], v[20:23], a[16:19], v[36:39]
    v_mfma_f32_16x16x32_bf16 v[40:43], v[16:19], a[72:75], v[40:43]
    v_mfma_f32_16x16x32_bf16 v[44:47], v[20:23], a[72:75], v[44:47]
    v_mfma_f32_16x16x32_bf16 v[48:51], v[16:19], a[128:131], v[48:51]
    v_mfma_f32_16x16x32_bf16 v[52:55], v[20:23], a[128:131], v[52:55]
    v_mfma_f32_16x16x32_bf16 v[56:59], v[16:19], a[184:187], v[56:59]
    v_mfma_f32_16x16x32_bf16 v[60:63], v[20:23], a[184:187], v[60:63]
    v_mfma_f32_16x16x32_bf16 v[64:67], v[16:19], a[240:243], v[64:67]
    v_mfma_f32_16x16x32_bf16 v[68:71], v[20:23], a[240:243], v[68:71]
    v_mfma_f32_16x16x32_bf16 v[72:75], v[16:19], v[160:163], v[72:75]
    v_mfma_f32_16x16x32_bf16 v[76:79], v[20:23], v[160:163], v[76:79]
    v_mfma_f32_16x16x32_bf16 v[80:83], v[16:19], v[216:219], v[80:83]
    v_mfma_f32_16x16x32_bf16 v[84:87], v[20:23], v[216:219], v[84:87]
    ds_read_b128 v[16:19], v7 offset:6144
    ds_read_b128 v[20:23], v7 offset:20480
    s_waitcnt lgkmcnt(2)
    v_mfma_f32_16x16x32_bf16 v[32:35], v[24:27], a[20:23], v[32:35]
    v_mfma_f32_16x16x32_bf16 v[36:39], v[28:31], a[20:23], v[36:39]
    v_mfma_f32_16x16x32_bf16 v[40:43], v[24:27], a[76:79], v[40:43]
    v_mfma_f32_16x16x32_bf16 v[44:47], v[28:31], a[76:79], v[44:47]
    v_mfma_f32_16x16x32_bf16 v[48:51], v[24:27], a[132:135], v[48:51]
    v_mfma_f32_16x16x32_bf16 v[52:55], v[28:31], a[132:135], v[52:55]
    v_mfma_f32_16x16x32_bf16 v[56:59], v[24:27], a[188:191], v[56:59]
    v_mfma_f32_16x16x32_bf16 v[60:63], v[28:31], a[188:191], v[60:63]
    v_mfma_f32_16x16x32_bf16 v[64:67], v[24:27], a[244:247], v[64:67]
    v_mfma_f32_16x16x32_bf16 v[68:71], v[28:31], a[244:247], v[68:71]
    v_mfma_f32_16x16x32_bf16 v[72:75], v[24:27], v[164:167], v[72:75]
    v_mfma_f32_16x16x32_bf16 v[76:79], v[28:31], v[164:167], v[76:79]
    v_mfma_f32_16x16x32_bf16 v[80:83], v[24:27], v[220:223], v[80:83]
    v_mfma_f32_16x16x32_bf16 v[84:87], v[28:31], v[220:223], v[84:87]
    ds_read_b128 v[24:27], v7 offset:7168
    ds_read_b128 v[28:31], v7 offset:21504
    s_waitcnt lgkmcnt(2)
    v_mfma_f32_16x16x32_bf16 v[32:35], v[16:19], a[24:27], v[32:35]
    v_mfma_f32_16x16x32_bf16 v[36:39], v[20:23], a[24:27], v[36:39]
    v_mfma_f32_16x16x32_bf16 v[40:43], v[16:19], a[80:83], v[40:43]
    v_mfma_f32_16x16x32_bf16 v[44:47], v[20:23], a[80:83], v[44:47]
    v_mfma_f32_16x16x32_bf16 v[48:51], v[16:19], a[136:139], v[48:51]
    v_mfma_f32_16x16x32_bf16 v[52:55], v[20:23], a[136:139], v[52:55]
    v_mfma_f32_16x16x32_bf16 v[56:59], v[16:19], a[192:195], v[56:59]
    v_mfma_f32_16x16x32_bf16 v[60:63], v[20:23], a[192:195], v[60:63]
    v_mfma_f32_16x16x32_bf16 v[64:67], v[16:19], a[248:251], v[64:67]
    v_mfma_f32_16x16x32_bf16 v[68:71], v[20:23], a[248:251], v[68:71]
    v_mfma_f32_16x16x32_bf16 v[72:75], v[16:19], v[168:171], v[72:75]
    v_mfma_f32_16x16x32_bf16 v[76:79], v[20:23], v[168:171], v[76:79]
    v_mfma_f32_16x16x32_bf16 v[80:83], v[16:19], v[224:227], v[80:83]
    v_mfma_f32_16x16x32_bf16 v[84:87], v[20:23], v[224:227], v[84:87]
    ds_read_b128 v[16:19], v7 offset:8192
    ds_read_b128 v[20:23], v7 offset:22528
    s_waitcnt lgkmcnt(2)
    v_mfma_f32_16x16x32_bf16 v[32:35], v[24:27], a[28:31], v[32:35]
    v_mfma_f32_16x16x32_bf16 v[36:39], v[28:31], a[28:31], v[36:39]
    v_mfma_f32_16x16x32_bf16 v[40:43], v[24:27], a[84:87], v[40:43]
    v_mfma_f32_16x16x32_bf16 v[44:47], v[28:31], a[84:87], v[44:47]
    v_mfma_f32_16x16x32_bf16 v[48:51], v[24:27], a[140:143], v[48:51]
    v_mfma_f32_16x16x32_bf16 v[52:55], v[28:31], a[140:143], v[52:55]
    v_mfma_f32_16x16x32_bf16 v[56:59], v[24:27], a[196:199], v[56:59]
    v_mfma_f32_16x16x32_bf16 v[60:63], v[28:31], a[196:199], v[60:63]
    v_mfma_f32_16x16x32_bf16 v[64:67], v[24:27], a[252:255], v[64:67]
    v_mfma_f32_16x16x32_bf16 v[68:71], v[28:31], a[252:255], v[68:71]
    v_mfma_f32_16x16x32_bf16 v[72:75], v[24:27], v[172:175], v[72:75]
    v_mfma_f32_16x16x32_bf16 v[76:79], v[28:31], v[172:175], v[76:79]
    v_mfma_f32_16x16x32_bf16 v[80:83], v[24:27], v[228:231], v[80:83]
    v_mfma_f32_16x16x32_bf16 v[84:87], v[28:31], v[228:231], v[84:87]
    ds_read_b128 v[24:27], v7 offset:9216
    ds_read_b128 v[28:31], v7 offset:23552
    s_waitcnt lgkmcnt(2)
    v_mfma_f32_16x16x32_bf16 v[32:35], v[16:19], a[32:35], v[32:35]
    v_mfma_f32_16x16x32_bf16 v[36:39], v[20:23], a[32:35], v[36:39]
    v_mfma_f32_16x16x32_bf16 v[40:43], v[16:19], a[88:91], v[40:43]
    v_mfma_f32_16x16x32_bf16 v[44:47], v[20:23], a[88:91], v[44:47]
    v_mfma_f32_16x16x32_bf16 v[48:51], v[16:19], a[144:147], v[48:51]
    v_mfma_f32_16x16x32_bf16 v[52:55], v[20:23], a[144:147], v[52:55]
    v_mfma_f32_16x16x32_bf16 v[56:59], v[16:19], a[200:203], v[56:59]
    v_mfma_f32_16x16x32_bf16 v[60:63], v[20:23], a[200:203], v[60:63]
    v_mfma_f32_16x16x32_bf16 v[64:67], v[16:19], v[120:123], v[64:67]
    v_mfma_f32_16x16x32_bf16 v[68:71], v[20:23], v[120:123], v[68:71]
    v_mfma_f32_16x16x32_bf16 v[72:75], v[16:19], v[176:179], v[72:75]
    v_mfma_f32_16x16x32_bf16 v[76:79], v[20:23], v[176:179], v[76:79]
    v_mfma_f32_16x16x32_bf16 v[80:83], v[16:19], v[232:235], v[80:83]
    v_mfma_f32_16x16x32_bf16 v[84:87], v[20:23], v[232:235], v[84:87]
    ds_read_b128 v[16:19], v7 offset:10240
    ds_read_b128 v[20:23], v7 offset:24576
    s_waitcnt lgkmcnt(2)
    v_mfma_f32_16x16x32_bf16 v[32:35], v[24:27], a[36:39], v[32:35]
    v_mfma_f32_16x16x32_bf16 v[36:39], v[28:31], a[36:39], v[36:39]
    v_mfma_f32_16x16x32_bf16 v[40:43], v[24:27], a[92:95], v[40:43]
    v_mfma_f32_16x16x32_bf16 v[44:47], v[28:31], a[92:95], v[44:47]
    v_mfma_f32_16x16x32_bf16 v[48:51], v[24:27], a[148:151], v[48:51]
    v_mfma_f32_16x16x32_bf16 v[52:55], v[28:31], a[148:151], v[52:55]
    v_mfma_f32_16x16x32_bf16 v[56:59], v[24:27], a[204:207], v[56:59]
    v_mfma_f32_16x16x32_bf16 v[60:63], v[28:31], a[204:207], v[60:63]
    v_mfma_f32_16x16x32_bf16 v[64:67], v[24:27], v[124:127], v[64:67]
    v_mfma_f32_16x16x32_bf16 v[68:71], v[28:31], v[124:127], v[68:71]
    v_mfma_f32_16x16x32_bf16 v[72:75], v[24:27], v[180:183], v[72:75]
    v_mfma_f32_16x16x32_bf16 v[76:79], v[28:31], v[180:183], v[76:79]
    v_mfma_f32_16x16x32_bf16 v[80:83], v[24:27], v[236:239], v[80:83]
    v_mfma_f32_16x16x32_bf16 v[84:87], v[28:31], v[236:239], v[84:87]
    ds_read_b128 v[24:27], v7 offset:11264
    ds_read_b128 v[28:31], v7 offset:25600
    s_waitcnt lgkmcnt(2)
    v_mfma_f32_16x16x32_bf16 v[32:35], v[16:19], a[40:43], v[32:35]
    v_mfma_f32_16x16x32_bf16 v[36:39], v[20:23], a[40:43], v[36:39]
    v_mfma_f32_16x16x32_bf16 v[40:43], v[16:19], a[96:99], v[40:43]
    v_mfma_f32_16x16x32_bf16 v[44:47], v[20:23], a[96:99], v[44:47]
    v_mfma_f32_16x16x32_bf16 v[48:51], v[16:19], a[152:155], v[48:51]
    v_mfma_f32_16x16x32_bf16 v[52:55], v[20:23], a[152:155], v[52:55]
    v_mfma_f32_16x16x32_bf16 v[56:59], v[16:19], a[208:211], v[56:59]
    v_mfma_f32_16x16x32_bf16 v[60:63], v[20:23], a[208:211], v[60:63]
    v_mfma_f32_16x16x32_bf16 v[64:67], v[16:19], v[128:131], v[64:67]
    v_mfma_f32_16x16x32_bf16 v[68:71], v[20:23], v[128:131], v[68:71]
    v_mfma_f32_16x16x32_bf16 v[72:75], v[16:19], v[184:187], v[72:75]
    v_mfma_f32_16x16x32_bf16 v[76:79], v[20:23], v[184:187], v[76:79]
    v_mfma_f32_16x16x32_bf16 v[80:83], v[16:19], v[240:243], v[80:83]
    v_mfma_f32_16x16x32_bf16 v[84:87], v[20:23], v[240:243], v[84:87]
    ds_read_b128 v[16:19], v7 offset:12288
    ds_read_b128 v[20:23], v7 offset:26624
    s_waitcnt lgkmcnt(2)
    v_mfma_f32_16x16x32_bf16 v[32:35], v[24:27], a[44:47], v[32:35]
    v_mfma_f32_16x16x32_bf16 v[36:39], v[28:31], a[44:47], v[36:39]
    v_mfma_f32_16x16x32_bf16 v[40:43], v[24:27], a[100:103], v[40:43]
    v_mfma_f32_16x16x32_bf16 v[44:47], v[28:31], a[100:103], v[44:47]
    v_mfma_f32_16x16x32_bf16 v[48:51], v[24:27], a[156:159], v[48:51]
    v_mfma_f32_16x16x32_bf16 v[52:55], v[28:31], a[156:159], v[52:55]
    v_mfma_f32_16x16x32_bf16 v[56:59], v[24:27], a[212:215], v[56:59]
    v_mfma_f32_16x16x32_bf16 v[60:63], v[28:31], a[212:215], v[60:63]
    v_mfma_f32_16x16x32_bf16 v[64:67], v[24:27], v[132:135], v[64:67]
    v_mfma_f32_16x16x32_bf16 v[68:71], v[28:31], v[132:135], v[68:71]
    v_mfma_f32_16x16x32_bf16 v[72:75], v[24:27], v[188:191], v[72:75]
    v_mfma_f32_16x16x32_bf16 v[76:79], v[28:31], v[188:191], v[76:79]
    v_mfma_f32_16x16x32_bf16 v[80:83], v[24:27], v[244:247], v[80:83]
    v_mfma_f32_16x16x32_bf16 v[84:87], v[28:31], v[244:247], v[84:87]
    ds_read_b128 v[24:27], v7 offset:13312
    ds_read_b128 v[28:31], v7 offset:27648
    s_waitcnt lgkmcnt(2)
    v_mfma_f32_16x16x32_bf16 v[32:35], v[16:19], a[48:51], v[32:35]
    v_mfma_f32_16x16x32_bf16 v[36:39], v[20:23], a[48:51], v[36:39]
    v_mfma_f32_16x16x32_bf16 v[40:43], v[16:19], a[104:107], v[40:43]
    v_mfma_f32_16x16x32_bf16 v[44:47], v[20:23], a[104:107], v[44:47]
    v_mfma_f32_16x16x32_bf16 v[48:51], v[16:19], a[160:163], v[48:51]
    v_mfma_f32_16x16x32_bf16 v[52:55], v[20:23], a[160:163], v[52:55]
    v_mfma_f32_16x16x32_bf16 v[56:59], v[16:19], a[216:219], v[56:59]
    v_mfma_f32_16x16x32_bf16 v[60:63], v[20:23], a[216:219], v[60:63]
    v_mfma_f32_16x16x32_bf16 v[64:67], v[16:19], v[136:139], v[64:67]
    v_mfma_f32_16x16x32_bf16 v[68:71], v[20:23], v[136:139], v[68:71]
    v_mfma_f32_16x16x32_bf16 v[72:75], v[16:19], v[192:195], v[72:75]
    v_mfma_f32_16x16x32_bf16 v[76:79], v[20:23], v[192:195], v[76:79]
    v_mfma_f32_16x16x32_bf16 v[80:83], v[16:19], v[248:251], v[80:83]
    v_mfma_f32_16x16x32_bf16 v[84:87], v[20:23], v[248:251], v[84:87]
    s_waitcnt lgkmcnt(0)
    v_mfma_f32_16x16x32_bf16 v[32:35], v[24:27], a[52:55], v[32:35]
    v_mfma_f32_16x16x32_bf16 v[36:39], v[28:31], a[52:55], v[36:39]
    v_mfma_f32_16x16x32_bf16 v[40:43], v[24:27], a[108:111], v[40:43]
    v_mfma_f32_16x16x32_bf16 v[44:47], v[28:31], a[108:111], v[44:47]
    v_mfma_f32_16x16x32_bf16 v[48:51], v[24:27], a[164:167], v[48:51]
    v_mfma_f32_16x16x32_bf16 v[52:55], v[28:31], a[164:167], v[52:55]
    v_mfma_f32_16x16x32_bf16 v[56:59], v[24:27], a[220:223], v[56:59]
    v_mfma_f32_16x16x32_bf16 v[60:63], v[28:31], a[220:223], v[60:63]
    v_mfma_f32_16x16x32_bf16 v[64:67], v[24:27], v[140:143], v[64:67]
    v_mfma_f32_16x16x32_bf16 v[68:71], v[28:31], v[140:143], v[68:71]
    v_mfma_f32_16x16x32_bf16 v[72:75], v[24:27], v[196:199], v[72:75]
    v_mfma_f32_16x16x32_bf16 v[76:79], v[28:31], v[196:199], v[76:79]
    v_mfma_f32_16x16x32_bf16 v[80:83], v[24:27], v[252:255], v[80:83]
    v_mfma_f32_16x16x32_bf16 v[84:87], v[28:31], v[252:255], v[84:87]
    s_lshl_b32 s47, s40, 4
    s_add_u32 s47, s47, s27
    s_mul_i32 s47, s47, 28
    s_add_u32 s48, s47, s31
    s_add_u32 s47, s47, s30
    s_lshl_b32 s47, s47, 10
    s_lshl_b32 s48, s48, 10
    s_add_u32 s47, s47, 0x1ce0000
    s_add_u32 s48, s48, 0x1ce0000
    s_add_u32 s49, s47, 4096
    v_cvt_pk_bf16_f32 v32, v32, v33
    v_cvt_pk_bf16_f32 v33, v34, v35
    v_cvt_pk_bf16_f32 v34, v36, v37
    v_cvt_pk_bf16_f32 v35, v38, v39
    buffer_store_dwordx4 v[32:35], v2, s[4:7], s47 offen offset:0 sc1
    v_cvt_pk_bf16_f32 v40, v40, v41
    v_cvt_pk_bf16_f32 v41, v42, v43
    v_cvt_pk_bf16_f32 v42, v44, v45
    v_cvt_pk_bf16_f32 v43, v46, v47
    buffer_store_dwordx4 v[40:43], v2, s[4:7], s47 offen offset:1024 sc1
    v_cvt_pk_bf16_f32 v48, v48, v49
    v_cvt_pk_bf16_f32 v49, v50, v51
    v_cvt_pk_bf16_f32 v50, v52, v53
    v_cvt_pk_bf16_f32 v51, v54, v55
    buffer_store_dwordx4 v[48:51], v2, s[4:7], s47 offen offset:2048 sc1
    v_cvt_pk_bf16_f32 v56, v56, v57
    v_cvt_pk_bf16_f32 v57, v58, v59
    v_cvt_pk_bf16_f32 v58, v60, v61
    v_cvt_pk_bf16_f32 v59, v62, v63
    buffer_store_dwordx4 v[56:59], v2, s[4:7], s47 offen offset:3072 sc1
    v_cvt_pk_bf16_f32 v64, v64, v65
    v_cvt_pk_bf16_f32 v65, v66, v67
    v_cvt_pk_bf16_f32 v66, v68, v69
    v_cvt_pk_bf16_f32 v67, v70, v71
    buffer_store_dwordx4 v[64:67], v2, s[4:7], s49 offen offset:0 sc1
    v_cvt_pk_bf16_f32 v72, v72, v73
    v_cvt_pk_bf16_f32 v73, v74, v75
    v_cvt_pk_bf16_f32 v74, v76, v77
    v_cvt_pk_bf16_f32 v75, v78, v79
    buffer_store_dwordx4 v[72:75], v2, s[4:7], s49 offen offset:1024 sc1
    v_cvt_pk_bf16_f32 v80, v80, v81
    v_cvt_pk_bf16_f32 v81, v82, v83
    v_cvt_pk_bf16_f32 v82, v84, v85
    v_cvt_pk_bf16_f32 v83, v86, v87
    buffer_store_dwordx4 v[80:83], v2, s[4:7], s48 offen offset:0 sc1
    s_cmp_ge_u32 s40, 3
    s_cbranch_scc1 gated_mix__linear_attn_block__memory_aug_recurrent_mem_tr__prompt_kernel_RZ_nf
    s_waitcnt vmcnt(0)
    s_barrier
    s_cmp_lg_u32 s26, 0
    s_cbranch_scc1 gated_mix__linear_attn_block__memory_aug_recurrent_mem_tr__prompt_kernel_RZ_nf
    s_lshl_b32 s46, s40, 4
    s_add_u32 s46, s46, s45
    s_mov_b64 exec, 1
    buffer_store_dword v5, v6, s[4:7], s46 offen sc1
    s_mov_b64 exec, -1
gated_mix__linear_attn_block__memory_aug_recurrent_mem_tr__prompt_kernel_RZ_nf:
    s_add_u32 s40, s40, 3
    s_cmp_lt_u32 s40, 64
    s_cbranch_scc1 gated_mix__linear_attn_block__memory_aug_recurrent_mem_tr__prompt_kernel_RZ_loop
    s_waitcnt vmcnt(0)
    s_barrier
    s_cmp_lg_u32 s26, 0
    s_cbranch_scc1 gated_mix__linear_attn_block__memory_aug_recurrent_mem_tr__prompt_kernel_RZ_u
    s_mov_b64 exec, 1
    s_sub_u32 s46, s40, 6
    s_lshl_b32 s46, s46, 4
    s_add_u32 s46, s46, s45
    buffer_store_dword v5, v6, s[4:7], s46 offen sc1
    s_add_u32 s46, s46, 48
    buffer_store_dword v5, v6, s[4:7], s46 offen sc1
    s_mov_b64 exec, -1
gated_mix__linear_attn_block__memory_aug_recurrent_mem_tr__prompt_kernel_RZ_u:
    v_lshrrev_b32 v8, 2, v4
    v_lshlrev_b32 v9, 13, v8
    v_lshl_add_u32 v9, v3, 7, v9
    v_and_b32 v10, 3, v4
    v_lshl_add_u32 v9, v10, 4, v9
    v_mul_u32_u24 v10, 114688, v3
    v_lshl_add_u32 v10, v4, 4, v10
    s_and_b32 s33, s27, 3
    s_lshl_b32 s33, s33, 8
    v_add_u32 v10, s33, v10
    v_add_u32 v11, s43, v2
    s_lshr_b32 s50, s26, 1
    s_lshl_b32 s50, s50, 6
    s_mul_i32 s33, s32, 3584
    s_add_u32 s50, s50, s33
    s_add_u32 s50, s50, 0x1040000
    s_lshr_b32 s51, s27, 2
    s_mul_i32 s51, s51, 28
    s_lshl_b32 s52, s27, 2
    s_add_u32 s52, s52, 0x1166000
    s_mov_b32 s53, 0x1165000
    s_mov_b32 s40, s28
gated_mix__linear_attn_block__memory_aug_recurrent_mem_tr__prompt_kernel_RZ_ul:
    s_lshl_b32 s46, s40, 2
    s_add_u32 s46, s46, 4
    s_cmp_lg_u32 s26, 0
    s_cbranch_scc1 gated_mix__linear_attn_block__memory_aug_recurrent_mem_tr__prompt_kernel_RZ_pb
gated_mix__linear_attn_block__memory_aug_recurrent_mem_tr__prompt_kernel_RZ_pw:
    buffer_load_dword v12, off, s[4:7], s53 sc1
    s_waitcnt vmcnt(0)
    v_cmp_le_u32 vcc, s46, v12
    s_nop 0
    s_cbranch_vccnz gated_mix__linear_attn_block__memory_aug_recurrent_mem_tr__prompt_kernel_RZ_pb
    s_sleep 24
    s_branch gated_mix__linear_attn_block__memory_aug_recurrent_mem_tr__prompt_kernel_RZ_pw
gated_mix__linear_attn_block__memory_aug_recurrent_mem_tr__prompt_kernel_RZ_pb:
    s_barrier
    s_lshl_b32 s46, s40, 15
    s_add_u32 s46, s46, s50
gated_mix__linear_attn_block__memory_aug_recurrent_mem_tr__prompt_kernel_RZ_ld:
    buffer_load_dwordx4 v[88:91], v9, s[4:7], s46 offen offset:0 sc1
    buffer_load_dwordx4 v[92:95], v9, s[4:7], s46 offen offset:512 sc1
    buffer_load_dwordx4 v[96:99], v9, s[4:7], s46 offen offset:1024 sc1
    buffer_load_dwordx4 v[100:103], v9, s[4:7], s46 offen offset:1536 sc1
    buffer_load_dwordx4 v[104:107], v9, s[4:7], s46 offen offset:2048 sc1
    buffer_load_dwordx4 v[108:111], v9, s[4:7], s46 offen offset:2560 sc1
    buffer_load_dwordx4 v[112:115], v9, s[4:7], s46 offen offset:3072 sc1
    s_waitcnt vmcnt(0)
    v_max3_u32 v12, v88, v89, v90
    v_mov_b32 v13, v115
    v_max3_u32 v12, v91, v92, v12
    v_max3_u32 v13, v93, v94, v13
    v_max3_u32 v12, v95, v96, v12
    v_max3_u32 v13, v97, v98, v13
    v_max3_u32 v12, v99, v100, v12
    v_max3_u32 v13, v101, v102, v13
    v_max3_u32 v12, v103, v104, v12
    v_max3_u32 v13, v105, v106, v13
    v_max3_u32 v12, v107, v108, v12
    v_max3_u32 v13, v109, v110, v13
    v_max3_u32 v12, v111, v112, v12
    v_max3_u32 v13, v113, v114, v13
    v_max_u32 v12, v12, v13
    v_cmp_eq_u32 vcc, -1, v12
    s_nop 0
    s_cbranch_vccz gated_mix__linear_attn_block__memory_aug_recurrent_mem_tr__prompt_kernel_RZ_ok
    s_sleep 6
    s_branch gated_mix__linear_attn_block__memory_aug_recurrent_mem_tr__prompt_kernel_RZ_ld
gated_mix__linear_attn_block__memory_aug_recurrent_mem_tr__prompt_kernel_RZ_ok:
    v_permlane16_swap_b32 v88, v90
    v_permlane16_swap_b32 v89, v91
    v_swap_b32 v89, v90
    ds_write_b128 v11, v[88:91] offset:0
    v_permlane16_swap_b32 v92, v94
    v_permlane16_swap_b32 v93, v95
    v_swap_b32 v93, v94
    ds_write_b128 v11, v[92:95] offset:1024
    v_permlane16_swap_b32 v96, v98
    v_permlane16_swap_b32 v97, v99
    v_swap_b32 v97, v98
    ds_write_b128 v11, v[96:99] offset:2048
    v_permlane16_swap_b32 v100, v102
    v_permlane16_swap_b32 v101, v103
    v_swap_b32 v101, v102
    ds_write_b128 v11, v[100:103] offset:3072
    v_permlane16_swap_b32 v104, v106
    v_permlane16_swap_b32 v105, v107
    v_swap_b32 v105, v106
    ds_write_b128 v11, v[104:107] offset:4096
    v_permlane16_swap_b32 v108, v110
    v_permlane16_swap_b32 v109, v111
    v_swap_b32 v109, v110
    ds_write_b128 v11, v[108:111] offset:5120
    v_permlane16_swap_b32 v112, v114
    v_permlane16_swap_b32 v113, v115
    v_swap_b32 v113, v114
    ds_write_b128 v11, v[112:115] offset:6144
    s_waitcnt lgkmcnt(0)
    s_barrier
    ds_read_b128 v[16:19], v2 offset:0
    ds_read_b128 v[20:23], v2 offset:14336
    ds_read_b128 v[24:27], v2 offset:1024
    ds_read_b128 v[28:31], v2 offset:15360
    s_waitcnt lgkmcnt(2)
    v_mfma_f32_16x16x32_bf16 v[32:35], v[16:19], a[0:3], 0
    v_mfma_f32_16x16x32_bf16 v[36:39], v[20:23], a[0:3], 0
    v_mfma_f32_16x16x32_bf16 v[40:43], v[16:19], a[56:59], 0
    v_mfma_f32_16x16x32_bf16 v[44:47], v[20:23], a[56:59], 0
    v_mfma_f32_16x16x32_bf16 v[48:51], v[16:19], a[112:115], 0
    v_mfma_f32_16x16x32_bf16 v[52:55], v[20:23], a[112:115], 0
    v_mfma_f32_16x16x32_bf16 v[56:59], v[16:19], a[168:171], 0
    v_mfma_f32_16x16x32_bf16 v[60:63], v[20:23], a[168:171], 0
    v_mfma_f32_16x16x32_bf16 v[64:67], v[16:19], a[224:227], 0
    v_mfma_f32_16x16x32_bf16 v[68:71], v[20:23], a[224:227], 0
    v_mfma_f32_16x16x32_bf16 v[72:75], v[16:19], v[144:147], 0
    v_mfma_f32_16x16x32_bf16 v[76:79], v[20:23], v[144:147], 0
    v_mfma_f32_16x16x32_bf16 v[80:83], v[16:19], v[200:203], 0
    v_mfma_f32_16x16x32_bf16 v[84:87], v[20:23], v[200:203], 0
    ds_read_b128 v[16:19], v2 offset:2048
    ds_read_b128 v[20:23], v2 offset:16384
    s_waitcnt lgkmcnt(2)
    v_mfma_f32_16x16x32_bf16 v[32:35], v[24:27], a[4:7], v[32:35]
    v_mfma_f32_16x16x32_bf16 v[36:39], v[28:31], a[4:7], v[36:39]
    v_mfma_f32_16x16x32_bf16 v[40:43], v[24:27], a[60:63], v[40:43]
    v_mfma_f32_16x16x32_bf16 v[44:47], v[28:31], a[60:63], v[44:47]
    v_mfma_f32_16x16x32_bf16 v[48:51], v[24:27], a[116:119], v[48:51]
    v_mfma_f32_16x16x32_bf16 v[52:55], v[28:31], a[116:119], v[52:55]
    v_mfma_f32_16x16x32_bf16 v[56:59], v[24:27], a[172:175], v[56:59]
    v_mfma_f32_16x16x32_bf16 v[60:63], v[28:31], a[172:175], v[60:63]
    v_mfma_f32_16x16x32_bf16 v[64:67], v[24:27], a[228:231], v[64:67]
    v_mfma_f32_16x16x32_bf16 v[68:71], v[28:31], a[228:231], v[68:71]
    v_mfma_f32_16x16x32_bf16 v[72:75], v[24:27], v[148:151], v[72:75]
    v_mfma_f32_16x16x32_bf16 v[76:79], v[28:31], v[148:151], v[76:79]
    v_mfma_f32_16x16x32_bf16 v[80:83], v[24:27], v[204:207], v[80:83]
    v_mfma_f32_16x16x32_bf16 v[84:87], v[28:31], v[204:207], v[84:87]
    ds_read_b128 v[24:27], v2 offset:3072
    ds_read_b128 v[28:31], v2 offset:17408
    s_waitcnt lgkmcnt(2)
    v_mfma_f32_16x16x32_bf16 v[32:35], v[16:19], a[8:11], v[32:35]
    v_mfma_f32_16x16x32_bf16 v[36:39], v[20:23], a[8:11], v[36:39]
    v_mfma_f32_16x16x32_bf16 v[40:43], v[16:19], a[64:67], v[40:43]
    v_mfma_f32_16x16x32_bf16 v[44:47], v[20:23], a[64:67], v[44:47]
    v_mfma_f32_16x16x32_bf16 v[48:51], v[16:19], a[120:123], v[48:51]
    v_mfma_f32_16x16x32_bf16 v[52:55], v[20:23], a[120:123], v[52:55]
    v_mfma_f32_16x16x32_bf16 v[56:59], v[16:19], a[176:179], v[56:59]
    v_mfma_f32_16x16x32_bf16 v[60:63], v[20:23], a[176:179], v[60:63]
    v_mfma_f32_16x16x32_bf16 v[64:67], v[16:19], a[232:235], v[64:67]
    v_mfma_f32_16x16x32_bf16 v[68:71], v[20:23], a[232:235], v[68:71]
    v_mfma_f32_16x16x32_bf16 v[72:75], v[16:19], v[152:155], v[72:75]
    v_mfma_f32_16x16x32_bf16 v[76:79], v[20:23], v[152:155], v[76:79]
    v_mfma_f32_16x16x32_bf16 v[80:83], v[16:19], v[208:211], v[80:83]
    v_mfma_f32_16x16x32_bf16 v[84:87], v[20:23], v[208:211], v[84:87]
    ds_read_b128 v[16:19], v2 offset:4096
    ds_read_b128 v[20:23], v2 offset:18432
    s_waitcnt lgkmcnt(2)
    v_mfma_f32_16x16x32_bf16 v[32:35], v[24:27], a[12:15], v[32:35]
    v_mfma_f32_16x16x32_bf16 v[36:39], v[28:31], a[12:15], v[36:39]
    v_mfma_f32_16x16x32_bf16 v[40:43], v[24:27], a[68:71], v[40:43]
    v_mfma_f32_16x16x32_bf16 v[44:47], v[28:31], a[68:71], v[44:47]
    v_mfma_f32_16x16x32_bf16 v[48:51], v[24:27], a[124:127], v[48:51]
    v_mfma_f32_16x16x32_bf16 v[52:55], v[28:31], a[124:127], v[52:55]
    v_mfma_f32_16x16x32_bf16 v[56:59], v[24:27], a[180:183], v[56:59]
    v_mfma_f32_16x16x32_bf16 v[60:63], v[28:31], a[180:183], v[60:63]
    v_mfma_f32_16x16x32_bf16 v[64:67], v[24:27], a[236:239], v[64:67]
    v_mfma_f32_16x16x32_bf16 v[68:71], v[28:31], a[236:239], v[68:71]
    v_mfma_f32_16x16x32_bf16 v[72:75], v[24:27], v[156:159], v[72:75]
    v_mfma_f32_16x16x32_bf16 v[76:79], v[28:31], v[156:159], v[76:79]
    v_mfma_f32_16x16x32_bf16 v[80:83], v[24:27], v[212:215], v[80:83]
    v_mfma_f32_16x16x32_bf16 v[84:87], v[28:31], v[212:215], v[84:87]
    ds_read_b128 v[24:27], v2 offset:5120
    ds_read_b128 v[28:31], v2 offset:19456
    s_waitcnt lgkmcnt(2)
    v_mfma_f32_16x16x32_bf16 v[32:35], v[16:19], a[16:19], v[32:35]
    v_mfma_f32_16x16x32_bf16 v[36:39], v[20:23], a[16:19], v[36:39]
    v_mfma_f32_16x16x32_bf16 v[40:43], v[16:19], a[72:75], v[40:43]
    v_mfma_f32_16x16x32_bf16 v[44:47], v[20:23], a[72:75], v[44:47]
    v_mfma_f32_16x16x32_bf16 v[48:51], v[16:19], a[128:131], v[48:51]
    v_mfma_f32_16x16x32_bf16 v[52:55], v[20:23], a[128:131], v[52:55]
    v_mfma_f32_16x16x32_bf16 v[56:59], v[16:19], a[184:187], v[56:59]
    v_mfma_f32_16x16x32_bf16 v[60:63], v[20:23], a[184:187], v[60:63]
    v_mfma_f32_16x16x32_bf16 v[64:67], v[16:19], a[240:243], v[64:67]
    v_mfma_f32_16x16x32_bf16 v[68:71], v[20:23], a[240:243], v[68:71]
    v_mfma_f32_16x16x32_bf16 v[72:75], v[16:19], v[160:163], v[72:75]
    v_mfma_f32_16x16x32_bf16 v[76:79], v[20:23], v[160:163], v[76:79]
    v_mfma_f32_16x16x32_bf16 v[80:83], v[16:19], v[216:219], v[80:83]
    v_mfma_f32_16x16x32_bf16 v[84:87], v[20:23], v[216:219], v[84:87]
    ds_read_b128 v[16:19], v2 offset:6144
    ds_read_b128 v[20:23], v2 offset:20480
    s_waitcnt lgkmcnt(2)
    v_mfma_f32_16x16x32_bf16 v[32:35], v[24:27], a[20:23], v[32:35]
    v_mfma_f32_16x16x32_bf16 v[36:39], v[28:31], a[20:23], v[36:39]
    v_mfma_f32_16x16x32_bf16 v[40:43], v[24:27], a[76:79], v[40:43]
    v_mfma_f32_16x16x32_bf16 v[44:47], v[28:31], a[76:79], v[44:47]
    v_mfma_f32_16x16x32_bf16 v[48:51], v[24:27], a[132:135], v[48:51]
    v_mfma_f32_16x16x32_bf16 v[52:55], v[28:31], a[132:135], v[52:55]
    v_mfma_f32_16x16x32_bf16 v[56:59], v[24:27], a[188:191], v[56:59]
    v_mfma_f32_16x16x32_bf16 v[60:63], v[28:31], a[188:191], v[60:63]
    v_mfma_f32_16x16x32_bf16 v[64:67], v[24:27], a[244:247], v[64:67]
    v_mfma_f32_16x16x32_bf16 v[68:71], v[28:31], a[244:247], v[68:71]
    v_mfma_f32_16x16x32_bf16 v[72:75], v[24:27], v[164:167], v[72:75]
    v_mfma_f32_16x16x32_bf16 v[76:79], v[28:31], v[164:167], v[76:79]
    v_mfma_f32_16x16x32_bf16 v[80:83], v[24:27], v[220:223], v[80:83]
    v_mfma_f32_16x16x32_bf16 v[84:87], v[28:31], v[220:223], v[84:87]
    ds_read_b128 v[24:27], v2 offset:7168
    ds_read_b128 v[28:31], v2 offset:21504
    s_waitcnt lgkmcnt(2)
    v_mfma_f32_16x16x32_bf16 v[32:35], v[16:19], a[24:27], v[32:35]
    v_mfma_f32_16x16x32_bf16 v[36:39], v[20:23], a[24:27], v[36:39]
    v_mfma_f32_16x16x32_bf16 v[40:43], v[16:19], a[80:83], v[40:43]
    v_mfma_f32_16x16x32_bf16 v[44:47], v[20:23], a[80:83], v[44:47]
    v_mfma_f32_16x16x32_bf16 v[48:51], v[16:19], a[136:139], v[48:51]
    v_mfma_f32_16x16x32_bf16 v[52:55], v[20:23], a[136:139], v[52:55]
    v_mfma_f32_16x16x32_bf16 v[56:59], v[16:19], a[192:195], v[56:59]
    v_mfma_f32_16x16x32_bf16 v[60:63], v[20:23], a[192:195], v[60:63]
    v_mfma_f32_16x16x32_bf16 v[64:67], v[16:19], a[248:251], v[64:67]
    v_mfma_f32_16x16x32_bf16 v[68:71], v[20:23], a[248:251], v[68:71]
    v_mfma_f32_16x16x32_bf16 v[72:75], v[16:19], v[168:171], v[72:75]
    v_mfma_f32_16x16x32_bf16 v[76:79], v[20:23], v[168:171], v[76:79]
    v_mfma_f32_16x16x32_bf16 v[80:83], v[16:19], v[224:227], v[80:83]
    v_mfma_f32_16x16x32_bf16 v[84:87], v[20:23], v[224:227], v[84:87]
    ds_read_b128 v[16:19], v2 offset:8192
    ds_read_b128 v[20:23], v2 offset:22528
    s_waitcnt lgkmcnt(2)
    v_mfma_f32_16x16x32_bf16 v[32:35], v[24:27], a[28:31], v[32:35]
    v_mfma_f32_16x16x32_bf16 v[36:39], v[28:31], a[28:31], v[36:39]
    v_mfma_f32_16x16x32_bf16 v[40:43], v[24:27], a[84:87], v[40:43]
    v_mfma_f32_16x16x32_bf16 v[44:47], v[28:31], a[84:87], v[44:47]
    v_mfma_f32_16x16x32_bf16 v[48:51], v[24:27], a[140:143], v[48:51]
    v_mfma_f32_16x16x32_bf16 v[52:55], v[28:31], a[140:143], v[52:55]
    v_mfma_f32_16x16x32_bf16 v[56:59], v[24:27], a[196:199], v[56:59]
    v_mfma_f32_16x16x32_bf16 v[60:63], v[28:31], a[196:199], v[60:63]
    v_mfma_f32_16x16x32_bf16 v[64:67], v[24:27], a[252:255], v[64:67]
    v_mfma_f32_16x16x32_bf16 v[68:71], v[28:31], a[252:255], v[68:71]
    v_mfma_f32_16x16x32_bf16 v[72:75], v[24:27], v[172:175], v[72:75]
    v_mfma_f32_16x16x32_bf16 v[76:79], v[28:31], v[172:175], v[76:79]
    v_mfma_f32_16x16x32_bf16 v[80:83], v[24:27], v[228:231], v[80:83]
    v_mfma_f32_16x16x32_bf16 v[84:87], v[28:31], v[228:231], v[84:87]
    ds_read_b128 v[24:27], v2 offset:9216
    ds_read_b128 v[28:31], v2 offset:23552
    s_waitcnt lgkmcnt(2)
    v_mfma_f32_16x16x32_bf16 v[32:35], v[16:19], a[32:35], v[32:35]
    v_mfma_f32_16x16x32_bf16 v[36:39], v[20:23], a[32:35], v[36:39]
    v_mfma_f32_16x16x32_bf16 v[40:43], v[16:19], a[88:91], v[40:43]
    v_mfma_f32_16x16x32_bf16 v[44:47], v[20:23], a[88:91], v[44:47]
    v_mfma_f32_16x16x32_bf16 v[48:51], v[16:19], a[144:147], v[48:51]
    v_mfma_f32_16x16x32_bf16 v[52:55], v[20:23], a[144:147], v[52:55]
    v_mfma_f32_16x16x32_bf16 v[56:59], v[16:19], a[200:203], v[56:59]
    v_mfma_f32_16x16x32_bf16 v[60:63], v[20:23], a[200:203], v[60:63]
    v_mfma_f32_16x16x32_bf16 v[64:67], v[16:19], v[120:123], v[64:67]
    v_mfma_f32_16x16x32_bf16 v[68:71], v[20:23], v[120:123], v[68:71]
    v_mfma_f32_16x16x32_bf16 v[72:75], v[16:19], v[176:179], v[72:75]
    v_mfma_f32_16x16x32_bf16 v[76:79], v[20:23], v[176:179], v[76:79]
    v_mfma_f32_16x16x32_bf16 v[80:83], v[16:19], v[232:235], v[80:83]
    v_mfma_f32_16x16x32_bf16 v[84:87], v[20:23], v[232:235], v[84:87]
    ds_read_b128 v[16:19], v2 offset:10240
    ds_read_b128 v[20:23], v2 offset:24576
    s_waitcnt lgkmcnt(2)
    v_mfma_f32_16x16x32_bf16 v[32:35], v[24:27], a[36:39], v[32:35]
    v_mfma_f32_16x16x32_bf16 v[36:39], v[28:31], a[36:39], v[36:39]
    v_mfma_f32_16x16x32_bf16 v[40:43], v[24:27], a[92:95], v[40:43]
    v_mfma_f32_16x16x32_bf16 v[44:47], v[28:31], a[92:95], v[44:47]
    v_mfma_f32_16x16x32_bf16 v[48:51], v[24:27], a[148:151], v[48:51]
    v_mfma_f32_16x16x32_bf16 v[52:55], v[28:31], a[148:151], v[52:55]
    v_mfma_f32_16x16x32_bf16 v[56:59], v[24:27], a[204:207], v[56:59]
    v_mfma_f32_16x16x32_bf16 v[60:63], v[28:31], a[204:207], v[60:63]
    v_mfma_f32_16x16x32_bf16 v[64:67], v[24:27], v[124:127], v[64:67]
    v_mfma_f32_16x16x32_bf16 v[68:71], v[28:31], v[124:127], v[68:71]
    v_mfma_f32_16x16x32_bf16 v[72:75], v[24:27], v[180:183], v[72:75]
    v_mfma_f32_16x16x32_bf16 v[76:79], v[28:31], v[180:183], v[76:79]
    v_mfma_f32_16x16x32_bf16 v[80:83], v[24:27], v[236:239], v[80:83]
    v_mfma_f32_16x16x32_bf16 v[84:87], v[28:31], v[236:239], v[84:87]
    ds_read_b128 v[24:27], v2 offset:11264
    ds_read_b128 v[28:31], v2 offset:25600
    s_waitcnt lgkmcnt(2)
    v_mfma_f32_16x16x32_bf16 v[32:35], v[16:19], a[40:43], v[32:35]
    v_mfma_f32_16x16x32_bf16 v[36:39], v[20:23], a[40:43], v[36:39]
    v_mfma_f32_16x16x32_bf16 v[40:43], v[16:19], a[96:99], v[40:43]
    v_mfma_f32_16x16x32_bf16 v[44:47], v[20:23], a[96:99], v[44:47]
    v_mfma_f32_16x16x32_bf16 v[48:51], v[16:19], a[152:155], v[48:51]
    v_mfma_f32_16x16x32_bf16 v[52:55], v[20:23], a[152:155], v[52:55]
    v_mfma_f32_16x16x32_bf16 v[56:59], v[16:19], a[208:211], v[56:59]
    v_mfma_f32_16x16x32_bf16 v[60:63], v[20:23], a[208:211], v[60:63]
    v_mfma_f32_16x16x32_bf16 v[64:67], v[16:19], v[128:131], v[64:67]
    v_mfma_f32_16x16x32_bf16 v[68:71], v[20:23], v[128:131], v[68:71]
    v_mfma_f32_16x16x32_bf16 v[72:75], v[16:19], v[184:187], v[72:75]
    v_mfma_f32_16x16x32_bf16 v[76:79], v[20:23], v[184:187], v[76:79]
    v_mfma_f32_16x16x32_bf16 v[80:83], v[16:19], v[240:243], v[80:83]
    v_mfma_f32_16x16x32_bf16 v[84:87], v[20:23], v[240:243], v[84:87]
    ds_read_b128 v[16:19], v2 offset:12288
    ds_read_b128 v[20:23], v2 offset:26624
    s_waitcnt lgkmcnt(2)
    v_mfma_f32_16x16x32_bf16 v[32:35], v[24:27], a[44:47], v[32:35]
    v_mfma_f32_16x16x32_bf16 v[36:39], v[28:31], a[44:47], v[36:39]
    v_mfma_f32_16x16x32_bf16 v[40:43], v[24:27], a[100:103], v[40:43]
    v_mfma_f32_16x16x32_bf16 v[44:47], v[28:31], a[100:103], v[44:47]
    v_mfma_f32_16x16x32_bf16 v[48:51], v[24:27], a[156:159], v[48:51]
    v_mfma_f32_16x16x32_bf16 v[52:55], v[28:31], a[156:159], v[52:55]
    v_mfma_f32_16x16x32_bf16 v[56:59], v[24:27], a[212:215], v[56:59]
    v_mfma_f32_16x16x32_bf16 v[60:63], v[28:31], a[212:215], v[60:63]
    v_mfma_f32_16x16x32_bf16 v[64:67], v[24:27], v[132:135], v[64:67]
    v_mfma_f32_16x16x32_bf16 v[68:71], v[28:31], v[132:135], v[68:71]
    v_mfma_f32_16x16x32_bf16 v[72:75], v[24:27], v[188:191], v[72:75]
    v_mfma_f32_16x16x32_bf16 v[76:79], v[28:31], v[188:191], v[76:79]
    v_mfma_f32_16x16x32_bf16 v[80:83], v[24:27], v[244:247], v[80:83]
    v_mfma_f32_16x16x32_bf16 v[84:87], v[28:31], v[244:247], v[84:87]
    ds_read_b128 v[24:27], v2 offset:13312
    ds_read_b128 v[28:31], v2 offset:27648
    s_waitcnt lgkmcnt(2)
    v_mfma_f32_16x16x32_bf16 v[32:35], v[16:19], a[48:51], v[32:35]
    v_mfma_f32_16x16x32_bf16 v[36:39], v[20:23], a[48:51], v[36:39]
    v_mfma_f32_16x16x32_bf16 v[40:43], v[16:19], a[104:107], v[40:43]
    v_mfma_f32_16x16x32_bf16 v[44:47], v[20:23], a[104:107], v[44:47]
    v_mfma_f32_16x16x32_bf16 v[48:51], v[16:19], a[160:163], v[48:51]
    v_mfma_f32_16x16x32_bf16 v[52:55], v[20:23], a[160:163], v[52:55]
    v_mfma_f32_16x16x32_bf16 v[56:59], v[16:19], a[216:219], v[56:59]
    v_mfma_f32_16x16x32_bf16 v[60:63], v[20:23], a[216:219], v[60:63]
    v_mfma_f32_16x16x32_bf16 v[64:67], v[16:19], v[136:139], v[64:67]
    v_mfma_f32_16x16x32_bf16 v[68:71], v[20:23], v[136:139], v[68:71]
    v_mfma_f32_16x16x32_bf16 v[72:75], v[16:19], v[192:195], v[72:75]
    v_mfma_f32_16x16x32_bf16 v[76:79], v[20:23], v[192:195], v[76:79]
    v_mfma_f32_16x16x32_bf16 v[80:83], v[16:19], v[248:251], v[80:83]
    v_mfma_f32_16x16x32_bf16 v[84:87], v[20:23], v[248:251], v[84:87]
    s_waitcnt lgkmcnt(0)
    v_mfma_f32_16x16x32_bf16 v[32:35], v[24:27], a[52:55], v[32:35]
    v_mfma_f32_16x16x32_bf16 v[36:39], v[28:31], a[52:55], v[36:39]
    v_mfma_f32_16x16x32_bf16 v[40:43], v[24:27], a[108:111], v[40:43]
    v_mfma_f32_16x16x32_bf16 v[44:47], v[28:31], a[108:111], v[44:47]
    v_mfma_f32_16x16x32_bf16 v[48:51], v[24:27], a[164:167], v[48:51]
    v_mfma_f32_16x16x32_bf16 v[52:55], v[28:31], a[164:167], v[52:55]
    v_mfma_f32_16x16x32_bf16 v[56:59], v[24:27], a[220:223], v[56:59]
    v_mfma_f32_16x16x32_bf16 v[60:63], v[28:31], a[220:223], v[60:63]
    v_mfma_f32_16x16x32_bf16 v[64:67], v[24:27], v[140:143], v[64:67]
    v_mfma_f32_16x16x32_bf16 v[68:71], v[28:31], v[140:143], v[68:71]
    v_mfma_f32_16x16x32_bf16 v[72:75], v[24:27], v[196:199], v[72:75]
    v_mfma_f32_16x16x32_bf16 v[76:79], v[28:31], v[196:199], v[76:79]
    v_mfma_f32_16x16x32_bf16 v[80:83], v[24:27], v[252:255], v[80:83]
    v_mfma_f32_16x16x32_bf16 v[84:87], v[28:31], v[252:255], v[84:87]
    s_mul_i32 s47, s40, 448
    s_add_u32 s47, s47, s51
    s_add_u32 s48, s47, s31
    s_add_u32 s47, s47, s30
    s_lshl_b32 s47, s47, 10
    s_lshl_b32 s48, s48, 10
    s_add_u32 s47, s47, 0x15e0000
    s_add_u32 s48, s48, 0x15e0000
    s_add_u32 s49, s47, 4096
    v_cvt_pk_bf16_f32 v32, v32, v33
    v_cvt_pk_bf16_f32 v33, v34, v35
    v_cvt_pk_bf16_f32 v34, v36, v37
    v_cvt_pk_bf16_f32 v35, v38, v39
    buffer_store_dwordx4 v[32:35], v10, s[4:7], s47 offen offset:0 sc1
    v_cvt_pk_bf16_f32 v40, v40, v41
    v_cvt_pk_bf16_f32 v41, v42, v43
    v_cvt_pk_bf16_f32 v42, v44, v45
    v_cvt_pk_bf16_f32 v43, v46, v47
    buffer_store_dwordx4 v[40:43], v10, s[4:7], s47 offen offset:1024 sc1
    v_cvt_pk_bf16_f32 v48, v48, v49
    v_cvt_pk_bf16_f32 v49, v50, v51
    v_cvt_pk_bf16_f32 v50, v52, v53
    v_cvt_pk_bf16_f32 v51, v54, v55
    buffer_store_dwordx4 v[48:51], v10, s[4:7], s47 offen offset:2048 sc1
    v_cvt_pk_bf16_f32 v56, v56, v57
    v_cvt_pk_bf16_f32 v57, v58, v59
    v_cvt_pk_bf16_f32 v58, v60, v61
    v_cvt_pk_bf16_f32 v59, v62, v63
    buffer_store_dwordx4 v[56:59], v10, s[4:7], s47 offen offset:3072 sc1
    v_cvt_pk_bf16_f32 v64, v64, v65
    v_cvt_pk_bf16_f32 v65, v66, v67
    v_cvt_pk_bf16_f32 v66, v68, v69
    v_cvt_pk_bf16_f32 v67, v70, v71
    buffer_store_dwordx4 v[64:67], v10, s[4:7], s49 offen offset:0 sc1
    v_cvt_pk_bf16_f32 v72, v72, v73
    v_cvt_pk_bf16_f32 v73, v74, v75
    v_cvt_pk_bf16_f32 v74, v76, v77
    v_cvt_pk_bf16_f32 v75, v78, v79
    buffer_store_dwordx4 v[72:75], v10, s[4:7], s49 offen offset:1024 sc1
    v_cvt_pk_bf16_f32 v80, v80, v81
    v_cvt_pk_bf16_f32 v81, v82, v83
    v_cvt_pk_bf16_f32 v82, v84, v85
    v_cvt_pk_bf16_f32 v83, v86, v87
    buffer_store_dwordx4 v[80:83], v10, s[4:7], s48 offen offset:0 sc1
    s_lshl_b32 s46, s40, 6
    s_add_u32 s46, s46, s52
    s_waitcnt vmcnt(0)
    s_barrier
    s_cmp_lg_u32 s26, 0
    s_cbranch_scc1 gated_mix__linear_attn_block__memory_aug_recurrent_mem_tr__prompt_kernel_RZ_nf2
    s_mov_b64 exec, 1
    buffer_store_dword v5, v6, s[4:7], s46 offen sc1
    s_mov_b64 exec, -1
gated_mix__linear_attn_block__memory_aug_recurrent_mem_tr__prompt_kernel_RZ_nf2:
    s_add_u32 s40, s40, 3
    s_cmp_lt_u32 s40, 15
    s_cbranch_scc1 gated_mix__linear_attn_block__memory_aug_recurrent_mem_tr__prompt_kernel_RZ_ul
    s_endpgm
gated_mix__linear_attn_block__memory_aug_recurrent_mem_tr__prompt_kernel_R_T:
    s_cmp_lg_u32 s26, 0
    s_cbranch_scc1 gated_mix__linear_attn_block__memory_aug_recurrent_mem_tr__prompt_kernel_RT_latei_b
gated_mix__linear_attn_block__memory_aug_recurrent_mem_tr__prompt_kernel_RT_latei:
    buffer_load_dword v5, off, s[84:87], 0 offset:24 sc1
    s_waitcnt vmcnt(0)
    v_readfirstlane_b32 s33, v5
    s_nop 0
    s_cmp_lg_u32 s33, 0
    s_cbranch_scc1 gated_mix__linear_attn_block__memory_aug_recurrent_mem_tr__prompt_kernel_RT_latei_b
    s_sleep 6
    s_branch gated_mix__linear_attn_block__memory_aug_recurrent_mem_tr__prompt_kernel_RT_latei
gated_mix__linear_attn_block__memory_aug_recurrent_mem_tr__prompt_kernel_RT_latei_b:
    s_barrier
    s_mov_b32 s33, 0x1042000
gated_mix__linear_attn_block__memory_aug_recurrent_mem_tr__prompt_kernel_RT_late:
    buffer_load_dword v5, off, s[4:7], s33 sc1
    s_waitcnt vmcnt(0)
    v_cmp_eq_u32 vcc, -1, v5
    s_nop 0
    s_cbranch_vccz gated_mix__linear_attn_block__memory_aug_recurrent_mem_tr__prompt_kernel_RT_late_go
    s_sleep 32
    s_branch gated_mix__linear_attn_block__memory_aug_recurrent_mem_tr__prompt_kernel_RT_late
gated_mix__linear_attn_block__memory_aug_recurrent_mem_tr__prompt_kernel_RT_late_go:
    s_and_b32 s32, s26, 1
    s_mul_i32 s31, s26, 7
    s_add_u32 s30, s31, s32
    s_xor_b32 s33, s32, 1
    s_mul_i32 s33, s33, 6
    s_add_u32 s31, s31, s33
    s_mov_b32 s40, s28
    s_mul_i32 s43, s26, 7168
    s_mul_i32 s41, s40, 28672
    s_add_u32 s41, s41, s43
    s_add_u32 s41, s41, 0xe00000
    s_mov_b32 s42, s43
    s_mov_b32 s44, 0
    s_add_u32 s36, s41, 0
    s_add_u32 m0, s42, 0
    s_nop 0
    buffer_load_dwordx4 v2, s[4:7], s36 offen offset:0 sc1 lds
    buffer_load_dwordx4 v2, s[4:7], s36 offen offset:1024 sc1 lds
    buffer_load_dwordx4 v2, s[4:7], s36 offen offset:2048 sc1 lds
    buffer_load_dwordx4 v2, s[4:7], s36 offen offset:3072 sc1 lds
    s_add_u32 s36, s41, 4096
    s_add_u32 m0, s42, 4096
    s_nop 0
    buffer_load_dwordx4 v2, s[4:7], s36 offen offset:0 sc1 lds
    buffer_load_dwordx4 v2, s[4:7], s36 offen offset:1024 sc1 lds
    buffer_load_dwordx4 v2, s[4:7], s36 offen offset:2048 sc1 lds
    s_add_u32 s35, s27, 0
    s_cmp_lg_u32 s26, 0
    s_cbranch_scc1 gated_mix__linear_attn_block__memory_aug_recurrent_mem_tr__prompt_kernel_RT_wi_b
    s_lshl_b32 s36, s35, 7
    s_add_u32 s36, s36, 0x3aa0000
gated_mix__linear_attn_block__memory_aug_recurrent_mem_tr__prompt_kernel_RT_wi:
    buffer_load_dword v5, off, s[4:7], s36 sc1
    s_waitcnt vmcnt(0)
    v_readfirstlane_b32 s33, v5
    s_nop 0
    s_cmp_lg_u32 s33, 0
    s_cbranch_scc1 gated_mix__linear_attn_block__memory_aug_recurrent_mem_tr__prompt_kernel_RT_wi_b
    s_sleep 2
    s_branch gated_mix__linear_attn_block__memory_aug_recurrent_mem_tr__prompt_kernel_RT_wi
gated_mix__linear_attn_block__memory_aug_recurrent_mem_tr__prompt_kernel_RT_wi_b:
    s_barrier
    s_mul_i32 s34, s27, 28
    s_add_u32 s35, s34, s31
    s_add_u32 s34, s34, s30
    s_mul_i32 s34, s34, 14336
    s_mul_i32 s35, s35, 14336
    s_add_u32 s34, s34, 0x0
    s_add_u32 s35, s35, 0x0
    buffer_load_dwordx4 a[0:3], v2, s[4:7], s34 offen offset:0 sc1
    buffer_load_dwordx4 a[4:7], v2, s[4:7], s34 offen offset:1024 sc1
    buffer_load_dwordx4 a[8:11], v2, s[4:7], s34 offen offset:2048 sc1
    buffer_load_dwordx4 a[12:15], v2, s[4:7], s34 offen offset:3072 sc1
    s_add_u32 s34, s34, 4096
    buffer_load_dwordx4 a[16:19], v2, s[4:7], s34 offen offset:0 sc1
    buffer_load_dwordx4 a[20:23], v2, s[4:7], s34 offen offset:1024 sc1
    buffer_load_dwordx4 a[24:27], v2, s[4:7], s34 offen offset:2048 sc1
    buffer_load_dwordx4 a[28:31], v2, s[4:7], s34 offen offset:3072 sc1
    s_add_u32 s34, s34, 4096
    buffer_load_dwordx4 a[32:35], v2, s[4:7], s34 offen offset:0 sc1
    buffer_load_dwordx4 a[36:39], v2, s[4:7], s34 offen offset:1024 sc1
    buffer_load_dwordx4 a[40:43], v2, s[4:7], s34 offen offset:2048 sc1
    buffer_load_dwordx4 a[44:47], v2, s[4:7], s34 offen offset:3072 sc1
    s_add_u32 s34, s34, 4096
    buffer_load_dwordx4 a[48:51], v2, s[4:7], s34 offen offset:0 sc1
    buffer_load_dwordx4 a[52:55], v2, s[4:7], s34 offen offset:1024 sc1
    buffer_load_dwordx4 a[56:59], v2, s[4:7], s34 offen offset:2048 sc1
    buffer_load_dwordx4 a[60:63], v2, s[4:7], s34 offen offset:3072 sc1
    s_add_u32 s34, s34, 4096
    buffer_load_dwordx4 a[64:67], v2, s[4:7], s34 offen offset:0 sc1
    buffer_load_dwordx4 a[68:71], v2, s[4:7], s34 offen offset:1024 sc1
    buffer_load_dwordx4 a[72:75], v2, s[4:7], s34 offen offset:2048 sc1
    buffer_load_dwordx4 a[76:79], v2, s[4:7], s34 offen offset:3072 sc1
    s_add_u32 s34, s34, 4096
    buffer_load_dwordx4 a[80:83], v2, s[4:7], s34 offen offset:0 sc1
    buffer_load_dwordx4 a[84:87], v2, s[4:7], s34 offen offset:1024 sc1
    buffer_load_dwordx4 a[88:91], v2, s[4:7], s34 offen offset:2048 sc1
    buffer_load_dwordx4 a[92:95], v2, s[4:7], s34 offen offset:3072 sc1
    s_add_u32 s34, s34, 4096
    buffer_load_dwordx4 a[96:99], v2, s[4:7], s34 offen offset:0 sc1
    buffer_load_dwordx4 a[100:103], v2, s[4:7], s34 offen offset:1024 sc1
    buffer_load_dwordx4 a[104:107], v2, s[4:7], s34 offen offset:2048 sc1
    buffer_load_dwordx4 a[108:111], v2, s[4:7], s34 offen offset:3072 sc1
    s_add_u32 s34, s34, 4096
    buffer_load_dwordx4 a[112:115], v2, s[4:7], s34 offen offset:0 sc1
    buffer_load_dwordx4 a[116:119], v2, s[4:7], s34 offen offset:1024 sc1
    buffer_load_dwordx4 a[120:123], v2, s[4:7], s34 offen offset:2048 sc1
    buffer_load_dwordx4 a[124:127], v2, s[4:7], s34 offen offset:3072 sc1
    s_add_u32 s34, s34, 4096
    buffer_load_dwordx4 a[128:131], v2, s[4:7], s34 offen offset:0 sc1
    buffer_load_dwordx4 a[132:135], v2, s[4:7], s34 offen offset:1024 sc1
    buffer_load_dwordx4 a[136:139], v2, s[4:7], s34 offen offset:2048 sc1
    buffer_load_dwordx4 a[140:143], v2, s[4:7], s34 offen offset:3072 sc1
    s_add_u32 s34, s34, 4096
    buffer_load_dwordx4 a[144:147], v2, s[4:7], s34 offen offset:0 sc1
    buffer_load_dwordx4 a[148:151], v2, s[4:7], s34 offen offset:1024 sc1
    buffer_load_dwordx4 a[152:155], v2, s[4:7], s34 offen offset:2048 sc1
    buffer_load_dwordx4 a[156:159], v2, s[4:7], s34 offen offset:3072 sc1
    s_add_u32 s34, s34, 4096
    buffer_load_dwordx4 a[160:163], v2, s[4:7], s34 offen offset:0 sc1
    buffer_load_dwordx4 a[164:167], v2, s[4:7], s34 offen offset:1024 sc1
    buffer_load_dwordx4 a[168:171], v2, s[4:7], s34 offen offset:2048 sc1
    buffer_load_dwordx4 a[172:175], v2, s[4:7], s34 offen offset:3072 sc1
    s_add_u32 s34, s34, 4096
    buffer_load_dwordx4 a[176:179], v2, s[4:7], s34 offen offset:0 sc1
    buffer_load_dwordx4 a[180:183], v2, s[4:7], s34 offen offset:1024 sc1
    buffer_load_dwordx4 a[184:187], v2, s[4:7], s34 offen offset:2048 sc1
    buffer_load_dwordx4 a[188:191], v2, s[4:7], s34 offen offset:3072 sc1
    s_add_u32 s34, s34, 4096
    buffer_load_dwordx4 a[192:195], v2, s[4:7], s34 offen offset:0 sc1
    buffer_load_dwordx4 a[196:199], v2, s[4:7], s34 offen offset:1024 sc1
    buffer_load_dwordx4 a[200:203], v2, s[4:7], s34 offen offset:2048 sc1
    buffer_load_dwordx4 a[204:207], v2, s[4:7], s34 offen offset:3072 sc1
    s_add_u32 s34, s34, 4096
    buffer_load_dwordx4 a[208:211], v2, s[4:7], s34 offen offset:0 sc1
    buffer_load_dwordx4 a[212:215], v2, s[4:7], s34 offen offset:1024 sc1
    buffer_load_dwordx4 a[216:219], v2, s[4:7], s34 offen offset:2048 sc1
    buffer_load_dwordx4 a[220:223], v2, s[4:7], s34 offen offset:3072 sc1
    s_add_u32 s34, s34, 4096
    buffer_load_dwordx4 a[224:227], v2, s[4:7], s34 offen offset:0 sc1
    buffer_load_dwordx4 a[228:231], v2, s[4:7], s34 offen offset:1024 sc1
    buffer_load_dwordx4 a[232:235], v2, s[4:7], s34 offen offset:2048 sc1
    buffer_load_dwordx4 a[236:239], v2, s[4:7], s34 offen offset:3072 sc1
    s_add_u32 s34, s34, 4096
    buffer_load_dwordx4 a[240:243], v2, s[4:7], s34 offen offset:0 sc1
    buffer_load_dwordx4 a[244:247], v2, s[4:7], s34 offen offset:1024 sc1
    buffer_load_dwordx4 a[248:251], v2, s[4:7], s34 offen offset:2048 sc1
    buffer_load_dwordx4 a[252:255], v2, s[4:7], s34 offen offset:3072 sc1
    s_add_u32 s34, s34, 4096
    buffer_load_dwordx4 v[120:123], v2, s[4:7], s34 offen offset:0 sc1
    buffer_load_dwordx4 v[124:127], v2, s[4:7], s34 offen offset:1024 sc1
    buffer_load_dwordx4 v[128:131], v2, s[4:7], s34 offen offset:2048 sc1
    buffer_load_dwordx4 v[132:135], v2, s[4:7], s34 offen offset:3072 sc1
    s_add_u32 s34, s34, 4096
    buffer_load_dwordx4 v[136:139], v2, s[4:7], s34 offen offset:0 sc1
    buffer_load_dwordx4 v[140:143], v2, s[4:7], s34 offen offset:1024 sc1
    buffer_load_dwordx4 v[144:147], v2, s[4:7], s34 offen offset:2048 sc1
    buffer_load_dwordx4 v[148:151], v2, s[4:7], s34 offen offset:3072 sc1
    s_add_u32 s34, s34, 4096
    buffer_load_dwordx4 v[152:155], v2, s[4:7], s34 offen offset:0 sc1
    buffer_load_dwordx4 v[156:159], v2, s[4:7], s34 offen offset:1024 sc1
    buffer_load_dwordx4 v[160:163], v2, s[4:7], s34 offen offset:2048 sc1
    buffer_load_dwordx4 v[164:167], v2, s[4:7], s34 offen offset:3072 sc1
    s_add_u32 s34, s34, 4096
    buffer_load_dwordx4 v[168:171], v2, s[4:7], s34 offen offset:0 sc1
    buffer_load_dwordx4 v[172:175], v2, s[4:7], s34 offen offset:1024 sc1
    buffer_load_dwordx4 v[176:179], v2, s[4:7], s34 offen offset:2048 sc1
    buffer_load_dwordx4 v[180:183], v2, s[4:7], s34 offen offset:3072 sc1
    s_add_u32 s34, s34, 4096
    buffer_load_dwordx4 v[184:187], v2, s[4:7], s34 offen offset:0 sc1
    buffer_load_dwordx4 v[188:191], v2, s[4:7], s34 offen offset:1024 sc1
    buffer_load_dwordx4 v[192:195], v2, s[4:7], s34 offen offset:2048 sc1
    buffer_load_dwordx4 v[196:199], v2, s[4:7], s34 offen offset:3072 sc1
    s_add_u32 s34, s34, 4096
    buffer_load_dwordx4 v[200:203], v2, s[4:7], s35 offen offset:0 sc1
    buffer_load_dwordx4 v[204:207], v2, s[4:7], s35 offen offset:1024 sc1
    buffer_load_dwordx4 v[208:211], v2, s[4:7], s35 offen offset:2048 sc1
    buffer_load_dwordx4 v[212:215], v2, s[4:7], s35 offen offset:3072 sc1
    s_add_u32 s35, s35, 4096
    buffer_load_dwordx4 v[216:219], v2, s[4:7], s35 offen offset:0 sc1
    buffer_load_dwordx4 v[220:223], v2, s[4:7], s35 offen offset:1024 sc1
    buffer_load_dwordx4 v[224:227], v2, s[4:7], s35 offen offset:2048 sc1
    buffer_load_dwordx4 v[228:231], v2, s[4:7], s35 offen offset:3072 sc1
    s_add_u32 s35, s35, 4096
    buffer_load_dwordx4 v[232:235], v2, s[4:7], s35 offen offset:0 sc1
    buffer_load_dwordx4 v[236:239], v2, s[4:7], s35 offen offset:1024 sc1
    buffer_load_dwordx4 v[240:243], v2, s[4:7], s35 offen offset:2048 sc1
    buffer_load_dwordx4 v[244:247], v2, s[4:7], s35 offen offset:3072 sc1
    s_add_u32 s35, s35, 4096
    buffer_load_dwordx4 v[248:251], v2, s[4:7], s35 offen offset:0 sc1
    buffer_load_dwordx4 v[252:255], v2, s[4:7], s35 offen offset:1024 sc1
    s_lshr_b32 s37, s30, 1
    s_lshr_b32 s38, s31, 1
    s_lshl_b32 s33, s37, 10
    v_add_u32 v5, s33, v2
    s_lshl_b32 s33, s38, 10
    s_lshl_b32 s34, s32, 3
    s_add_u32 s33, s33, s34
    v_add_u32 v6, s33, v2
    v_lshrrev_b32 v16, 2, v4
    v_and_b32 v17, 1, v4
    v_lshl_add_u32 v17, v16, 1, v17
    v_lshlrev_b32 v17, 4, v17
    v_lshl_add_u32 v17, v3, 7, v17
    s_lshl_b32 s33, s37, 9
    v_add_u32 v8, s33, v17
    s_lshl_b32 s33, s38, 9
    s_add_u32 s33, s33, s34
    v_add_u32 v9, s33, v17
    s_lshl_b32 s33, s26, 12
    s_add_u32 s33, s33, 57344
    v_add_u32 v10, s33, v2
    s_lshl_b32 s33, s32, 10
    s_add_u32 s33, s33, 57344
    v_add_u32 v11, s33, v2
    v_and_b32 v18, 3, v4
    v_lshl_add_u32 v12, v16, 3, v18
    s_lshl_b32 s33, s32, 2
    v_add_u32 v12, s33, v12
    v_lshlrev_b32 v18, 3, v3
    v_sub_u32 v12, v12, v18
    s_and_b32 s33, s27, 3
    s_lshl_b32 s33, s33, 8
    s_lshr_b32 s34, s27, 2
    s_lshl_b32 s34, s34, 11
    s_add_u32 s33, s33, s34
    s_lshl_b32 s34, s32, 10
    s_add_u32 s33, s33, s34
    s_add_u32 s33, s33, 32768
    v_lshlrev_b32 v13, 4, v4
    v_lshl_add_u32 v13, v3, 2, v13
    v_add_u32 v13, s33, v13
    v_mov_b32 v16, 0x40000000
    v_cmp_eq_u32 vcc, 0, v0
    s_nop 1
    v_cndmask_b32 v14, v16, 0, vcc
    v_mov_b32 v15, 1
    s_lshl_b32 s45, s27, 2
    s_add_u32 s45, s45, 0x1160040
    s_lshl_b32 s50, s27, 1
    s_add_u32 s50, s50, s32
    s_lshl_b32 s50, s50, 10
    s_mov_b32 s51, 0xceabfb8f
    s_waitcnt vmcnt(0)
    s_barrier
gated_mix__linear_attn_block__memory_aug_recurrent_mem_tr__prompt_kernel_RT_loop:
    s_mul_i32 s46, s40, 28672
    s_add_u32 s46, s46, 0x38e0000
    s_add_u32 s47, s46, 14336
    buffer_load_dwordx4 v[88:91], v5, s[4:7], s46 offen offset:0 sc1
    buffer_load_dwordx4 v[92:95], v5, s[4:7], s46 offen offset:1024 sc1
    buffer_load_dwordx4 v[96:99], v5, s[4:7], s46 offen offset:2048 sc1
    buffer_load_dwordx2 v[100:101], v6, s[4:7], s46 offen sc1
    buffer_load_dwordx4 v[102:105], v5, s[4:7], s47 offen offset:0 sc1
    buffer_load_dwordx4 v[106:109], v5, s[4:7], s47 offen offset:1024 sc1
    buffer_load_dwordx4 v[110:113], v5, s[4:7], s47 offen offset:2048 sc1
    buffer_load_dwordx2 v[114:115], v6, s[4:7], s47 offen sc1
    v_add_u32 v7, s44, v2
    s_xor_b32 s44, s44, 28672
    s_add_u32 s42, s44, s43
    s_add_u32 s47, s40, 3
    s_min_u32 s47, s47, 63
    s_mul_i32 s41, s47, 28672
    s_add_u32 s41, s41, s43
    s_add_u32 s41, s41, 0xe00000
    s_add_u32 s36, s41, 0
    s_add_u32 m0, s42, 0
    s_nop 0
    buffer_load_dwordx4 v2, s[4:7], s36 offen offset:0 sc1 lds
    buffer_load_dwordx4 v2, s[4:7], s36 offen offset:1024 sc1 lds
    buffer_load_dwordx4 v2, s[4:7], s36 offen offset:2048 sc1 lds
    buffer_load_dwordx4 v2, s[4:7], s36 offen offset:3072 sc1 lds
    s_add_u32 s36, s41, 4096
    s_add_u32 m0, s42, 4096
    s_nop 0
    buffer_load_dwordx4 v2, s[4:7], s36 offen offset:0 sc1 lds
    buffer_load_dwordx4 v2, s[4:7], s36 offen offset:1024 sc1 lds
    buffer_load_dwordx4 v2, s[4:7], s36 offen offset:2048 sc1 lds
    ds_read_b128 v[16:19], v7 offset:0
    ds_read_b128 v[20:23], v7 offset:14336
    ds_read_b128 v[24:27], v7 offset:1024
    ds_read_b128 v[28:31], v7 offset:15360
    s_waitcnt lgkmcnt(2)
    v_mfma_f32_16x16x32_bf16 v[32:35], a[0:3], v[16:19], 0
    v_mfma_f32_16x16x32_bf16 v[36:39], a[0:3], v[20:23], 0
    v_mfma_f32_16x16x32_bf16 v[40:43], a[56:59], v[16:19], 0
    v_mfma_f32_16x16x32_bf16 v[44:47], a[56:59], v[20:23], 0
    v_mfma_f32_16x16x32_bf16 v[48:51], a[112:115], v[16:19], 0
    v_mfma_f32_16x16x32_bf16 v[52:55], a[112:115], v[20:23], 0
    v_mfma_f32_16x16x32_bf16 v[56:59], a[168:171], v[16:19], 0
    v_mfma_f32_16x16x32_bf16 v[60:63], a[168:171], v[20:23], 0
    v_mfma_f32_16x16x32_bf16 v[64:67], a[224:227], v[16:19], 0
    v_mfma_f32_16x16x32_bf16 v[68:71], a[224:227], v[20:23], 0
    v_mfma_f32_16x16x32_bf16 v[72:75], v[144:147], v[16:19], 0
    v_mfma_f32_16x16x32_bf16 v[76:79], v[144:147], v[20:23], 0
    v_mfma_f32_16x16x32_bf16 v[80:83], v[200:203], v[16:19], 0
    v_mfma_f32_16x16x32_bf16 v[84:87], v[200:203], v[20:23], 0
    ds_read_b128 v[16:19], v7 offset:2048
    ds_read_b128 v[20:23], v7 offset:16384
    s_waitcnt lgkmcnt(2)
    v_mfma_f32_16x16x32_bf16 v[32:35], a[4:7], v[24:27], v[32:35]
    v_mfma_f32_16x16x32_bf16 v[36:39], a[4:7], v[28:31], v[36:39]
    v_mfma_f32_16x16x32_bf16 v[40:43], a[60:63], v[24:27], v[40:43]
    v_mfma_f32_16x16x32_bf16 v[44:47], a[60:63], v[28:31], v[44:47]
    v_mfma_f32_16x16x32_bf16 v[48:51], a[116:119], v[24:27], v[48:51]
    v_mfma_f32_16x16x32_bf16 v[52:55], a[116:119], v[28:31], v[52:55]
    v_mfma_f32_16x16x32_bf16 v[56:59], a[172:175], v[24:27], v[56:59]
    v_mfma_f32_16x16x32_bf16 v[60:63], a[172:175], v[28:31], v[60:63]
    v_mfma_f32_16x16x32_bf16 v[64:67], a[228:231], v[24:27], v[64:67]
    v_mfma_f32_16x16x32_bf16 v[68:71], a[228:231], v[28:31], v[68:71]
    v_mfma_f32_16x16x32_bf16 v[72:75], v[148:151], v[24:27], v[72:75]
    v_mfma_f32_16x16x32_bf16 v[76:79], v[148:151], v[28:31], v[76:79]
    v_mfma_f32_16x16x32_bf16 v[80:83], v[204:207], v[24:27], v[80:83]
    v_mfma_f32_16x16x32_bf16 v[84:87], v[204:207], v[28:31], v[84:87]
    ds_read_b128 v[24:27], v7 offset:3072
    ds_read_b128 v[28:31], v7 offset:17408
    s_waitcnt lgkmcnt(2)
    v_mfma_f32_16x16x32_bf16 v[32:35], a[8:11], v[16:19], v[32:35]
    v_mfma_f32_16x16x32_bf16 v[36:39], a[8:11], v[20:23], v[36:39]
    v_mfma_f32_16x16x32_bf16 v[40:43], a[64:67], v[16:19], v[40:43]
    v_mfma_f32_16x16x32_bf16 v[44:47], a[64:67], v[20:23], v[44:47]
    v_mfma_f32_16x16x32_bf16 v[48:51], a[120:123], v[16:19], v[48:51]
    v_mfma_f32_16x16x32_bf16 v[52:55], a[120:123], v[20:23], v[52:55]
    v_mfma_f32_16x16x32_bf16 v[56:59], a[176:179], v[16:19], v[56:59]
    v_mfma_f32_16x16x32_bf16 v[60:63], a[176:179], v[20:23], v[60:63]
    v_mfma_f32_16x16x32_bf16 v[64:67], a[232:235], v[16:19], v[64:67]
    v_mfma_f32_16x16x32_bf16 v[68:71], a[232:235], v[20:23], v[68:71]
    v_mfma_f32_16x16x32_bf16 v[72:75], v[152:155], v[16:19], v[72:75]
    v_mfma_f32_16x16x32_bf16 v[76:79], v[152:155], v[20:23], v[76:79]
    v_mfma_f32_16x16x32_bf16 v[80:83], v[208:211], v[16:19], v[80:83]
    v_mfma_f32_16x16x32_bf16 v[84:87], v[208:211], v[20:23], v[84:87]
    ds_read_b128 v[16:19], v7 offset:4096
    ds_read_b128 v[20:23], v7 offset:18432
    s_waitcnt lgkmcnt(2)
    v_mfma_f32_16x16x32_bf16 v[32:35], a[12:15], v[24:27], v[32:35]
    v_mfma_f32_16x16x32_bf16 v[36:39], a[12:15], v[28:31], v[36:39]
    v_mfma_f32_16x16x32_bf16 v[40:43], a[68:71], v[24:27], v[40:43]
    v_mfma_f32_16x16x32_bf16 v[44:47], a[68:71], v[28:31], v[44:47]
    v_mfma_f32_16x16x32_bf16 v[48:51], a[124:127], v[24:27], v[48:51]
    v_mfma_f32_16x16x32_bf16 v[52:55], a[124:127], v[28:31], v[52:55]
    v_mfma_f32_16x16x32_bf16 v[56:59], a[180:183], v[24:27], v[56:59]
    v_mfma_f32_16x16x32_bf16 v[60:63], a[180:183], v[28:31], v[60:63]
    v_mfma_f32_16x16x32_bf16 v[64:67], a[236:239], v[24:27], v[64:67]
    v_mfma_f32_16x16x32_bf16 v[68:71], a[236:239], v[28:31], v[68:71]
    v_mfma_f32_16x16x32_bf16 v[72:75], v[156:159], v[24:27], v[72:75]
    v_mfma_f32_16x16x32_bf16 v[76:79], v[156:159], v[28:31], v[76:79]
    v_mfma_f32_16x16x32_bf16 v[80:83], v[212:215], v[24:27], v[80:83]
    v_mfma_f32_16x16x32_bf16 v[84:87], v[212:215], v[28:31], v[84:87]
    ds_read_b128 v[24:27], v7 offset:5120
    ds_read_b128 v[28:31], v7 offset:19456
    s_waitcnt lgkmcnt(2)
    v_mfma_f32_16x16x32_bf16 v[32:35], a[16:19], v[16:19], v[32:35]
    v_mfma_f32_16x16x32_bf16 v[36:39], a[16:19], v[20:23], v[36:39]
    v_mfma_f32_16x16x32_bf16 v[40:43], a[72:75], v[16:19], v[40:43]
    v_mfma_f32_16x16x32_bf16 v[44:47], a[72:75], v[20:23], v[44:47]
    v_mfma_f32_16x16x32_bf16 v[48:51], a[128:131], v[16:19], v[48:51]
    v_mfma_f32_16x16x32_bf16 v[52:55], a[128:131], v[20:23], v[52:55]
    v_mfma_f32_16x16x32_bf16 v[56:59], a[184:187], v[16:19], v[56:59]
    v_mfma_f32_16x16x32_bf16 v[60:63], a[184:187], v[20:23], v[60:63]
    v_mfma_f32_16x16x32_bf16 v[64:67], a[240:243], v[16:19], v[64:67]
    v_mfma_f32_16x16x32_bf16 v[68:71], a[240:243], v[20:23], v[68:71]
    v_mfma_f32_16x16x32_bf16 v[72:75], v[160:163], v[16:19], v[72:75]
    v_mfma_f32_16x16x32_bf16 v[76:79], v[160:163], v[20:23], v[76:79]
    v_mfma_f32_16x16x32_bf16 v[80:83], v[216:219], v[16:19], v[80:83]
    v_mfma_f32_16x16x32_bf16 v[84:87], v[216:219], v[20:23], v[84:87]
    ds_read_b128 v[16:19], v7 offset:6144
    ds_read_b128 v[20:23], v7 offset:20480
    s_waitcnt lgkmcnt(2)
    v_mfma_f32_16x16x32_bf16 v[32:35], a[20:23], v[24:27], v[32:35]
    v_mfma_f32_16x16x32_bf16 v[36:39], a[20:23], v[28:31], v[36:39]
    v_mfma_f32_16x16x32_bf16 v[40:43], a[76:79], v[24:27], v[40:43]
    v_mfma_f32_16x16x32_bf16 v[44:47], a[76:79], v[28:31], v[44:47]
    v_mfma_f32_16x16x32_bf16 v[48:51], a[132:135], v[24:27], v[48:51]
    v_mfma_f32_16x16x32_bf16 v[52:55], a[132:135], v[28:31], v[52:55]
    v_mfma_f32_16x16x32_bf16 v[56:59], a[188:191], v[24:27], v[56:59]
    v_mfma_f32_16x16x32_bf16 v[60:63], a[188:191], v[28:31], v[60:63]
    v_mfma_f32_16x16x32_bf16 v[64:67], a[244:247], v[24:27], v[64:67]
    v_mfma_f32_16x16x32_bf16 v[68:71], a[244:247], v[28:31], v[68:71]
    v_mfma_f32_16x16x32_bf16 v[72:75], v[164:167], v[24:27], v[72:75]
    v_mfma_f32_16x16x32_bf16 v[76:79], v[164:167], v[28:31], v[76:79]
    v_mfma_f32_16x16x32_bf16 v[80:83], v[220:223], v[24:27], v[80:83]
    v_mfma_f32_16x16x32_bf16 v[84:87], v[220:223], v[28:31], v[84:87]
    ds_read_b128 v[24:27], v7 offset:7168
    ds_read_b128 v[28:31], v7 offset:21504
    s_waitcnt lgkmcnt(2)
    v_mfma_f32_16x16x32_bf16 v[32:35], a[24:27], v[16:19], v[32:35]
    v_mfma_f32_16x16x32_bf16 v[36:39], a[24:27], v[20:23], v[36:39]
    v_mfma_f32_16x16x32_bf16 v[40:43], a[80:83], v[16:19], v[40:43]
    v_mfma_f32_16x16x32_bf16 v[44:47], a[80:83], v[20:23], v[44:47]
    v_mfma_f32_16x16x32_bf16 v[48:51], a[136:139], v[16:19], v[48:51]
    v_mfma_f32_16x16x32_bf16 v[52:55], a[136:139], v[20:23], v[52:55]
    v_mfma_f32_16x16x32_bf16 v[56:59], a[192:195], v[16:19], v[56:59]
    v_mfma_f32_16x16x32_bf16 v[60:63], a[192:195], v[20:23], v[60:63]
    v_mfma_f32_16x16x32_bf16 v[64:67], a[248:251], v[16:19], v[64:67]
    v_mfma_f32_16x16x32_bf16 v[68:71], a[248:251], v[20:23], v[68:71]
    v_mfma_f32_16x16x32_bf16 v[72:75], v[168:171], v[16:19], v[72:75]
    v_mfma_f32_16x16x32_bf16 v[76:79], v[168:171], v[20:23], v[76:79]
    v_mfma_f32_16x16x32_bf16 v[80:83], v[224:227], v[16:19], v[80:83]
    v_mfma_f32_16x16x32_bf16 v[84:87], v[224:227], v[20:23], v[84:87]
    ds_read_b128 v[16:19], v7 offset:8192
    ds_read_b128 v[20:23], v7 offset:22528
    s_waitcnt lgkmcnt(2)
    v_mfma_f32_16x16x32_bf16 v[32:35], a[28:31], v[24:27], v[32:35]
    v_mfma_f32_16x16x32_bf16 v[36:39], a[28:31], v[28:31], v[36:39]
    v_mfma_f32_16x16x32_bf16 v[40:43], a[84:87], v[24:27], v[40:43]
    v_mfma_f32_16x16x32_bf16 v[44:47], a[84:87], v[28:31], v[44:47]
    v_mfma_f32_16x16x32_bf16 v[48:51], a[140:143], v[24:27], v[48:51]
    v_mfma_f32_16x16x32_bf16 v[52:55], a[140:143], v[28:31], v[52:55]
    v_mfma_f32_16x16x32_bf16 v[56:59], a[196:199], v[24:27], v[56:59]
    v_mfma_f32_16x16x32_bf16 v[60:63], a[196:199], v[28:31], v[60:63]
    v_mfma_f32_16x16x32_bf16 v[64:67], a[252:255], v[24:27], v[64:67]
    v_mfma_f32_16x16x32_bf16 v[68:71], a[252:255], v[28:31], v[68:71]
    v_mfma_f32_16x16x32_bf16 v[72:75], v[172:175], v[24:27], v[72:75]
    v_mfma_f32_16x16x32_bf16 v[76:79], v[172:175], v[28:31], v[76:79]
    v_mfma_f32_16x16x32_bf16 v[80:83], v[228:231], v[24:27], v[80:83]
    v_mfma_f32_16x16x32_bf16 v[84:87], v[228:231], v[28:31], v[84:87]
    ds_read_b128 v[24:27], v7 offset:9216
    ds_read_b128 v[28:31], v7 offset:23552
    s_waitcnt lgkmcnt(2)
    v_mfma_f32_16x16x32_bf16 v[32:35], a[32:35], v[16:19], v[32:35]
    v_mfma_f32_16x16x32_bf16 v[36:39], a[32:35], v[20:23], v[36:39]
    v_mfma_f32_16x16x32_bf16 v[40:43], a[88:91], v[16:19], v[40:43]
    v_mfma_f32_16x16x32_bf16 v[44:47], a[88:91], v[20:23], v[44:47]
    v_mfma_f32_16x16x32_bf16 v[48:51], a[144:147], v[16:19], v[48:51]
    v_mfma_f32_16x16x32_bf16 v[52:55], a[144:147], v[20:23], v[52:55]
    v_mfma_f32_16x16x32_bf16 v[56:59], a[200:203], v[16:19], v[56:59]
    v_mfma_f32_16x16x32_bf16 v[60:63], a[200:203], v[20:23], v[60:63]
    v_mfma_f32_16x16x32_bf16 v[64:67], v[120:123], v[16:19], v[64:67]
    v_mfma_f32_16x16x32_bf16 v[68:71], v[120:123], v[20:23], v[68:71]
    v_mfma_f32_16x16x32_bf16 v[72:75], v[176:179], v[16:19], v[72:75]
    v_mfma_f32_16x16x32_bf16 v[76:79], v[176:179], v[20:23], v[76:79]
    v_mfma_f32_16x16x32_bf16 v[80:83], v[232:235], v[16:19], v[80:83]
    v_mfma_f32_16x16x32_bf16 v[84:87], v[232:235], v[20:23], v[84:87]
    ds_read_b128 v[16:19], v7 offset:10240
    ds_read_b128 v[20:23], v7 offset:24576
    s_waitcnt lgkmcnt(2)
    v_mfma_f32_16x16x32_bf16 v[32:35], a[36:39], v[24:27], v[32:35]
    v_mfma_f32_16x16x32_bf16 v[36:39], a[36:39], v[28:31], v[36:39]
    v_mfma_f32_16x16x32_bf16 v[40:43], a[92:95], v[24:27], v[40:43]
    v_mfma_f32_16x16x32_bf16 v[44:47], a[92:95], v[28:31], v[44:47]
    v_mfma_f32_16x16x32_bf16 v[48:51], a[148:151], v[24:27], v[48:51]
    v_mfma_f32_16x16x32_bf16 v[52:55], a[148:151], v[28:31], v[52:55]
    v_mfma_f32_16x16x32_bf16 v[56:59], a[204:207], v[24:27], v[56:59]
    v_mfma_f32_16x16x32_bf16 v[60:63], a[204:207], v[28:31], v[60:63]
    v_mfma_f32_16x16x32_bf16 v[64:67], v[124:127], v[24:27], v[64:67]
    v_mfma_f32_16x16x32_bf16 v[68:71], v[124:127], v[28:31], v[68:71]
    v_mfma_f32_16x16x32_bf16 v[72:75], v[180:183], v[24:27], v[72:75]
    v_mfma_f32_16x16x32_bf16 v[76:79], v[180:183], v[28:31], v[76:79]
    v_mfma_f32_16x16x32_bf16 v[80:83], v[236:239], v[24:27], v[80:83]
    v_mfma_f32_16x16x32_bf16 v[84:87], v[236:239], v[28:31], v[84:87]
    ds_read_b128 v[24:27], v7 offset:11264
    ds_read_b128 v[28:31], v7 offset:25600
    s_waitcnt lgkmcnt(2)
    v_mfma_f32_16x16x32_bf16 v[32:35], a[40:43], v[16:19], v[32:35]
    v_mfma_f32_16x16x32_bf16 v[36:39], a[40:43], v[20:23], v[36:39]
    v_mfma_f32_16x16x32_bf16 v[40:43], a[96:99], v[16:19], v[40:43]
    v_mfma_f32_16x16x32_bf16 v[44:47], a[96:99], v[20:23], v[44:47]
    v_mfma_f32_16x16x32_bf16 v[48:51], a[152:155], v[16:19], v[48:51]
    v_mfma_f32_16x16x32_bf16 v[52:55], a[152:155], v[20:23], v[52:55]
    v_mfma_f32_16x16x32_bf16 v[56:59], a[208:211], v[16:19], v[56:59]
    v_mfma_f32_16x16x32_bf16 v[60:63], a[208:211], v[20:23], v[60:63]
    v_mfma_f32_16x16x32_bf16 v[64:67], v[128:131], v[16:19], v[64:67]
    v_mfma_f32_16x16x32_bf16 v[68:71], v[128:131], v[20:23], v[68:71]
    v_mfma_f32_16x16x32_bf16 v[72:75], v[184:187], v[16:19], v[72:75]
    v_mfma_f32_16x16x32_bf16 v[76:79], v[184:187], v[20:23], v[76:79]
    v_mfma_f32_16x16x32_bf16 v[80:83], v[240:243], v[16:19], v[80:83]
    v_mfma_f32_16x16x32_bf16 v[84:87], v[240:243], v[20:23], v[84:87]
    ds_read_b128 v[16:19], v7 offset:12288
    ds_read_b128 v[20:23], v7 offset:26624
    s_waitcnt lgkmcnt(2)
    v_mfma_f32_16x16x32_bf16 v[32:35], a[44:47], v[24:27], v[32:35]
    v_mfma_f32_16x16x32_bf16 v[36:39], a[44:47], v[28:31], v[36:39]
    v_mfma_f32_16x16x32_bf16 v[40:43], a[100:103], v[24:27], v[40:43]
    v_mfma_f32_16x16x32_bf16 v[44:47], a[100:103], v[28:31], v[44:47]
    v_mfma_f32_16x16x32_bf16 v[48:51], a[156:159], v[24:27], v[48:51]
    v_mfma_f32_16x16x32_bf16 v[52:55], a[156:159], v[28:31], v[52:55]
    v_mfma_f32_16x16x32_bf16 v[56:59], a[212:215], v[24:27], v[56:59]
    v_mfma_f32_16x16x32_bf16 v[60:63], a[212:215], v[28:31], v[60:63]
    v_mfma_f32_16x16x32_bf16 v[64:67], v[132:135], v[24:27], v[64:67]
    v_mfma_f32_16x16x32_bf16 v[68:71], v[132:135], v[28:31], v[68:71]
    v_mfma_f32_16x16x32_bf16 v[72:75], v[188:191], v[24:27], v[72:75]
    v_mfma_f32_16x16x32_bf16 v[76:79], v[188:191], v[28:31], v[76:79]
    v_mfma_f32_16x16x32_bf16 v[80:83], v[244:247], v[24:27], v[80:83]
    v_mfma_f32_16x16x32_bf16 v[84:87], v[244:247], v[28:31], v[84:87]
    ds_read_b128 v[24:27], v7 offset:13312
    ds_read_b128 v[28:31], v7 offset:27648
    s_waitcnt lgkmcnt(2)
    v_mfma_f32_16x16x32_bf16 v[32:35], a[48:51], v[16:19], v[32:35]
    v_mfma_f32_16x16x32_bf16 v[36:39], a[48:51], v[20:23], v[36:39]
    v_mfma_f32_16x16x32_bf16 v[40:43], a[104:107], v[16:19], v[40:43]
    v_mfma_f32_16x16x32_bf16 v[44:47], a[104:107], v[20:23], v[44:47]
    v_mfma_f32_16x16x32_bf16 v[48:51], a[160:163], v[16:19], v[48:51]
    v_mfma_f32_16x16x32_bf16 v[52:55], a[160:163], v[20:23], v[52:55]
    v_mfma_f32_16x16x32_bf16 v[56:59], a[216:219], v[16:19], v[56:59]
    v_mfma_f32_16x16x32_bf16 v[60:63], a[216:219], v[20:23], v[60:63]
    v_mfma_f32_16x16x32_bf16 v[64:67], v[136:139], v[16:19], v[64:67]
    v_mfma_f32_16x16x32_bf16 v[68:71], v[136:139], v[20:23], v[68:71]
    v_mfma_f32_16x16x32_bf16 v[72:75], v[192:195], v[16:19], v[72:75]
    v_mfma_f32_16x16x32_bf16 v[76:79], v[192:195], v[20:23], v[76:79]
    v_mfma_f32_16x16x32_bf16 v[80:83], v[248:251], v[16:19], v[80:83]
    v_mfma_f32_16x16x32_bf16 v[84:87], v[248:251], v[20:23], v[84:87]
    s_waitcnt lgkmcnt(0)
    v_mfma_f32_16x16x32_bf16 v[32:35], a[52:55], v[24:27], v[32:35]
    v_mfma_f32_16x16x32_bf16 v[36:39], a[52:55], v[28:31], v[36:39]
    v_mfma_f32_16x16x32_bf16 v[40:43], a[108:111], v[24:27], v[40:43]
    v_mfma_f32_16x16x32_bf16 v[44:47], a[108:111], v[28:31], v[44:47]
    v_mfma_f32_16x16x32_bf16 v[48:51], a[164:167], v[24:27], v[48:51]
    v_mfma_f32_16x16x32_bf16 v[52:55], a[164:167], v[28:31], v[52:55]
    v_mfma_f32_16x16x32_bf16 v[56:59], a[220:223], v[24:27], v[56:59]
    v_mfma_f32_16x16x32_bf16 v[60:63], a[220:223], v[28:31], v[60:63]
    v_mfma_f32_16x16x32_bf16 v[64:67], v[140:143], v[24:27], v[64:67]
    v_mfma_f32_16x16x32_bf16 v[68:71], v[140:143], v[28:31], v[68:71]
    v_mfma_f32_16x16x32_bf16 v[72:75], v[196:199], v[24:27], v[72:75]
    v_mfma_f32_16x16x32_bf16 v[76:79], v[196:199], v[28:31], v[76:79]
    v_mfma_f32_16x16x32_bf16 v[80:83], v[252:255], v[24:27], v[80:83]
    v_mfma_f32_16x16x32_bf16 v[84:87], v[252:255], v[28:31], v[84:87]
    v_cvt_pk_bf16_f32 v32, v32, v33
    v_cvt_pk_bf16_f32 v33, v34, v35
    v_cvt_pk_bf16_f32 v34, v40, v41
    v_cvt_pk_bf16_f32 v35, v42, v43
    v_cvt_pk_bf16_f32 v48, v48, v49
    v_cvt_pk_bf16_f32 v49, v50, v51
    v_cvt_pk_bf16_f32 v50, v56, v57
    v_cvt_pk_bf16_f32 v51, v58, v59
    v_cvt_pk_bf16_f32 v64, v64, v65
    v_cvt_pk_bf16_f32 v65, v66, v67
    v_cvt_pk_bf16_f32 v66, v72, v73
    v_cvt_pk_bf16_f32 v67, v74, v75
    v_cvt_pk_bf16_f32 v80, v80, v81
    v_cvt_pk_bf16_f32 v81, v82, v83
    v_cvt_pk_bf16_f32 v36, v36, v37
    v_cvt_pk_bf16_f32 v37, v38, v39
    v_cvt_pk_bf16_f32 v38, v44, v45
    v_cvt_pk_bf16_f32 v39, v46, v47
    v_cvt_pk_bf16_f32 v52, v52, v53
    v_cvt_pk_bf16_f32 v53, v54, v55
    v_cvt_pk_bf16_f32 v54, v60, v61
    v_cvt_pk_bf16_f32 v55, v62, v63
    v_cvt_pk_bf16_f32 v68, v68, v69
    v_cvt_pk_bf16_f32 v69, v70, v71
    v_cvt_pk_bf16_f32 v70, v76, v77
    v_cvt_pk_bf16_f32 v71, v78, v79
    v_cvt_pk_bf16_f32 v84, v84, v85
    v_cvt_pk_bf16_f32 v85, v86, v87
    s_waitcnt vmcnt(7)
    v_mfma_f32_16x16x32_bf16 v[40:43], v[88:91], v[32:35], 0
    v_mfma_f32_16x16x32_bf16 v[44:47], v[88:91], v[36:39], 0
    v_mfma_f32_16x16x32_bf16 v[56:59], v[102:105], v[32:35], 0
    v_mfma_f32_16x16x32_bf16 v[60:63], v[102:105], v[36:39], 0
    v_mfma_f32_16x16x32_bf16 v[40:43], v[92:95], v[48:51], v[40:43]
    v_mfma_f32_16x16x32_bf16 v[44:47], v[92:95], v[52:55], v[44:47]
    v_mfma_f32_16x16x32_bf16 v[56:59], v[106:109], v[48:51], v[56:59]
    v_mfma_f32_16x16x32_bf16 v[60:63], v[106:109], v[52:55], v[60:63]
    v_mfma_f32_16x16x32_bf16 v[40:43], v[96:99], v[64:67], v[40:43]
    v_mfma_f32_16x16x32_bf16 v[44:47], v[96:99], v[68:71], v[44:47]
    v_mfma_f32_16x16x32_bf16 v[56:59], v[110:113], v[64:67], v[56:59]
    v_mfma_f32_16x16x32_bf16 v[60:63], v[110:113], v[68:71], v[60:63]
    v_mfma_f32_16x16x16_bf16 v[40:43], v[100:101], v[80:81], v[40:43]
    v_mfma_f32_16x16x16_bf16 v[44:47], v[100:101], v[84:85], v[44:47]
    v_mfma_f32_16x16x16_bf16 v[56:59], v[114:115], v[80:81], v[56:59]
    v_mfma_f32_16x16x16_bf16 v[60:63], v[114:115], v[84:85], v[60:63]
    s_nop 1
    ds_write_b128 v10, v[40:43] offset:0
    s_nop 0
    ds_write_b128 v10, v[44:47] offset:1024
    s_nop 0
    ds_write_b128 v10, v[56:59] offset:2048
    s_nop 0
    ds_write_b128 v10, v[60:63] offset:3072
    s_lshl_b32 s46, s40, 13
    s_add_u32 s46, s46, 0x1040000
    s_cmp_gt_u32 s26, 1
    s_waitcnt lgkmcnt(0)
    s_barrier
    s_cbranch_scc1 gated_mix__linear_attn_block__memory_aug_recurrent_mem_tr__prompt_kernel_RT_poll
    ds_read_b128 v[88:91], v11 offset:0
    ds_read_b128 v[96:99], v11 offset:4096
    ds_read_b128 v[100:103], v11 offset:8192
    ds_read_b128 v[104:107], v11 offset:12288
    s_waitcnt lgkmcnt(0)
    v_pk_add_f32 v[88:89], v[88:89], v[96:97]
    v_pk_add_f32 v[100:101], v[100:101], v[104:105]
    v_pk_add_f32 v[88:89], v[88:89], v[100:101]
    v_pk_add_f32 v[90:91], v[90:91], v[98:99]
    v_pk_add_f32 v[102:103], v[102:103], v[106:107]
    v_pk_add_f32 v[90:91], v[90:91], v[102:103]
    ds_read_b128 v[92:95], v11 offset:2048
    ds_read_b128 v[96:99], v11 offset:6144
    ds_read_b128 v[100:103], v11 offset:10240
    ds_read_b128 v[104:107], v11 offset:14336
    s_waitcnt lgkmcnt(0)
    v_pk_add_f32 v[92:93], v[92:93], v[96:97]
    v_pk_add_f32 v[100:101], v[100:101], v[104:105]
    v_pk_add_f32 v[92:93], v[92:93], v[100:101]
    v_pk_add_f32 v[94:95], v[94:95], v[98:99]
    v_pk_add_f32 v[102:103], v[102:103], v[106:107]
    v_pk_add_f32 v[94:95], v[94:95], v[102:103]
    v_mov_b32 v96, s51
    v_cmp_le_i32 vcc, 0, v12
    s_nop 1
    v_cndmask_b32 v88, v96, v88, vcc
    v_cmp_le_i32 vcc, 1, v12
    s_nop 1
    v_cndmask_b32 v89, v96, v89, vcc
    v_cmp_le_i32 vcc, 2, v12
    s_nop 1
    v_cndmask_b32 v90, v96, v90, vcc
    v_cmp_le_i32 vcc, 3, v12
    s_nop 1
    v_cndmask_b32 v91, v96, v91, vcc
    v_cmp_le_i32 vcc, 4, v12
    s_nop 1
    v_cndmask_b32 v92, v96, v92, vcc
    v_cmp_le_i32 vcc, 5, v12
    s_nop 1
    v_cndmask_b32 v93, v96, v93, vcc
    v_cmp_le_i32 vcc, 6, v12
    s_nop 1
    v_cndmask_b32 v94, v96, v94, vcc
    v_cmp_le_i32 vcc, 7, v12
    s_nop 1
    v_cndmask_b32 v95, v96, v95, vcc
gated_mix__linear_attn_block__memory_aug_recurrent_mem_tr__prompt_kernel_RT_poll:
    s_cmp_ge_u32 s40, 62
    s_cbranch_scc1 gated_mix__linear_attn_block__memory_aug_recurrent_mem_tr__prompt_kernel_RT_poll2
    s_cmp_lg_u32 s26, 2
    s_cbranch_scc1 gated_mix__linear_attn_block__memory_aug_recurrent_mem_tr__prompt_kernel_RT_cb
    s_mov_b32 s33, 0x1165000
    s_cmp_ge_u32 s40, 55
    s_cbranch_scc1 gated_mix__linear_attn_block__memory_aug_recurrent_mem_tr__prompt_kernel_RT_can
gated_mix__linear_attn_block__memory_aug_recurrent_mem_tr__prompt_kernel_RT_prog:
    buffer_load_dword v16, off, s[4:7], s33 sc1
    s_waitcnt vmcnt(0)
    v_cmp_lt_u32 vcc, s40, v16
    s_nop 0
    s_cbranch_vccnz gated_mix__linear_attn_block__memory_aug_recurrent_mem_tr__prompt_kernel_RT_cb
    s_sleep 40
    s_branch gated_mix__linear_attn_block__memory_aug_recurrent_mem_tr__prompt_kernel_RT_prog
gated_mix__linear_attn_block__memory_aug_recurrent_mem_tr__prompt_kernel_RT_can:
    buffer_load_dword v16, off, s[4:7], s46 offset:3584 sc1
    s_waitcnt vmcnt(0)
    v_cmp_eq_u32 vcc, -1, v16
    s_nop 0
    s_cbranch_vccz gated_mix__linear_attn_block__memory_aug_recurrent_mem_tr__prompt_kernel_RT_cb
    s_sleep 3
    s_branch gated_mix__linear_attn_block__memory_aug_recurrent_mem_tr__prompt_kernel_RT_can
gated_mix__linear_attn_block__memory_aug_recurrent_mem_tr__prompt_kernel_RT_cb:
    s_barrier
gated_mix__linear_attn_block__memory_aug_recurrent_mem_tr__prompt_kernel_RT_poll2:
    buffer_load_dwordx4 v[16:19], v8, s[4:7], s46 offen sc1
    buffer_load_dwordx4 v[20:23], v8, s[4:7], s46 offen offset:512 sc1
    buffer_load_dwordx4 v[24:27], v8, s[4:7], s46 offen offset:1024 sc1
    buffer_load_dwordx2 v[28:29], v9, s[4:7], s46 offen sc1
    s_waitcnt vmcnt(0)
    v_max3_u32 v30, v16, v17, v18
    v_max3_u32 v31, v19, v20, v21
    v_max3_u32 v30, v22, v23, v30
    v_max3_u32 v31, v24, v25, v31
    v_max3_u32 v30, v26, v27, v30
    v_max3_u32 v31, v28, v29, v31
    v_max_u32 v30, v30, v31
    v_cmp_eq_u32 vcc, -1, v30
    s_nop 0
    s_cbranch_vccz gated_mix__linear_attn_block__memory_aug_recurrent_mem_tr__prompt_kernel_RT_got
    s_sleep 1
    s_branch gated_mix__linear_attn_block__memory_aug_recurrent_mem_tr__prompt_kernel_RT_poll2
gated_mix__linear_attn_block__memory_aug_recurrent_mem_tr__prompt_kernel_RT_got:
    v_mfma_f32_16x16x32_bf16 v[72:75], v[16:19], v[32:35], 0
    v_mfma_f32_16x16x32_bf16 v[76:79], v[16:19], v[36:39], 0
    v_mfma_f32_16x16x32_bf16 v[72:75], v[20:23], v[48:51], v[72:75]
    v_mfma_f32_16x16x32_bf16 v[76:79], v[20:23], v[52:55], v[76:79]
    v_mfma_f32_16x16x32_bf16 v[72:75], v[24:27], v[64:67], v[72:75]
    v_mfma_f32_16x16x32_bf16 v[76:79], v[24:27], v[68:71], v[76:79]
    v_mfma_f32_16x16x16_bf16 v[72:75], v[28:29], v[80:81], v[72:75]
    v_mfma_f32_16x16x16_bf16 v[76:79], v[28:29], v[84:85], v[76:79]
    v_subrev_u32 v30, 57344, v10
    v_lshrrev_b32 v30, 1, v30
    v_add_u32 v30, 73728, v30
    s_nop 2
    ds_write_b64 v30, v[72:73] offset:0
    s_nop 0
    ds_write_b64 v30, v[76:77] offset:512
    s_mul_i32 s47, s40, 40960
    s_add_u32 s47, s47, 0x1360000
    s_add_u32 s48, s47, s50
    s_cmp_gt_u32 s26, 1
    s_waitcnt lgkmcnt(0)
    s_barrier
    s_cbranch_scc1 gated_mix__linear_attn_block__memory_aug_recurrent_mem_tr__prompt_kernel_RT_join
    v_subrev_u32 v30, 57344, v11
    v_lshrrev_b32 v30, 1, v30
    v_add_u32 v30, 73728, v30
    ds_read_b64 v[96:97], v30 offset:0
    ds_read_b64 v[98:99], v30 offset:2048
    ds_read_b64 v[100:101], v30 offset:4096
    ds_read_b64 v[102:103], v30 offset:6144
    v_max3_f32 v104, v88, v89, v90
    v_max3_f32 v105, v91, v92, v93
    v_max3_f32 v104, v94, v95, v104
    s_waitcnt lgkmcnt(0)
    v_pk_add_f32 v[96:97], v[96:97], v[98:99]
    v_pk_add_f32 v[100:101], v[100:101], v[102:103]
    v_pk_add_f32 v[96:97], v[96:97], v[100:101]
    v_max3_f32 v104, v104, v105, v96
    v_max_f32 v104, v104, v97
    v_mov_b32 v105, v104
    s_nop 1
    v_permlane16_swap_b32 v104, v105
    v_max_f32 v104, v104, v105
    v_mov_b32 v105, v104
    s_nop 1
    v_permlane32_swap_b32 v104, v105
    v_max_f32 v104, v104, v105
    v_sub_f32 v88, v88, v104
    v_sub_f32 v89, v89, v104
    v_sub_f32 v90, v90, v104
    v_sub_f32 v91, v91, v104
    v_sub_f32 v92, v92, v104
    v_sub_f32 v93, v93, v104
    v_sub_f32 v94, v94, v104
    v_sub_f32 v95, v95, v104
    v_sub_f32 v96, v96, v104
    v_sub_f32 v97, v97, v104
    v_exp_f32 v88, v88
    v_exp_f32 v89, v89
    v_exp_f32 v90, v90
    v_exp_f32 v91, v91
    v_exp_f32 v92, v92
    v_exp_f32 v93, v93
    v_exp_f32 v94, v94
    v_exp_f32 v95, v95
    v_exp_f32 v96, v96
    v_exp_f32 v97, v97
    v_pk_add_f32 v[98:99], v[88:89], v[90:91]
    v_pk_add_f32 v[100:101], v[92:93], v[94:95]
    v_pk_add_f32 v[98:99], v[98:99], v[96:97]
    v_pk_add_f32 v[98:99], v[98:99], v[100:101]
    v_add_f32 v104, v98, v99
    v_mov_b32 v105, v104
    s_nop 1
    v_permlane16_swap_b32 v104, v105
    v_add_f32 v104, v104, v105
    v_mov_b32 v105, v104
    s_nop 1
    v_permlane32_swap_b32 v104, v105
    v_add_f32 v104, v104, v105
    v_rcp_f32 v104, v104
    s_nop 0
    v_pk_mul_f32 v[88:89], v[88:89], v[104:105] op_sel_hi:[1,0]
    v_pk_mul_f32 v[90:91], v[90:91], v[104:105] op_sel_hi:[1,0]
    v_pk_mul_f32 v[92:93], v[92:93], v[104:105] op_sel_hi:[1,0]
    v_pk_mul_f32 v[94:95], v[94:95], v[104:105] op_sel_hi:[1,0]
    v_pk_mul_f32 v[96:97], v[96:97], v[104:105] op_sel_hi:[1,0]
    v_cvt_pk_bf16_f32 v88, v88, v89
    v_cvt_pk_bf16_f32 v89, v90, v91
    v_cvt_pk_bf16_f32 v90, v92, v93
    v_cvt_pk_bf16_f32 v91, v94, v95
    v_cvt_pk_bf16_f32 v92, v96, v97
    buffer_store_dwordx4 v[88:91], v2, s[4:7], s48 offen sc1
    buffer_store_dword v92, v13, s[4:7], s47 offen sc1
    s_waitcnt vmcnt(0)
gated_mix__linear_attn_block__memory_aug_recurrent_mem_tr__prompt_kernel_RT_join:
    s_lshl_b32 s46, s40, 8
    s_add_u32 s46, s46, s45
    s_barrier
    buffer_store_dword v15, v14, s[4:7], s46 offen sc1
    s_add_u32 s40, s40, 3
    s_cmp_lt_u32 s40, 64
    s_cbranch_scc1 gated_mix__linear_attn_block__memory_aug_recurrent_mem_tr__prompt_kernel_RT_loop
    s_endpgm
gated_mix__linear_attn_block__memory_aug_recurrent_mem_tr__prompt_kernel_R_L:
    s_cmp_lg_u32 s26, 0
    s_cbranch_scc1 gated_mix__linear_attn_block__memory_aug_recurrent_mem_tr__prompt_kernel_RL_latei_b
gated_mix__linear_attn_block__memory_aug_recurrent_mem_tr__prompt_kernel_RL_latei:
    buffer_load_dword v5, off, s[84:87], 0 offset:24 sc1
    s_waitcnt vmcnt(0)
    v_readfirstlane_b32 s33, v5
    s_nop 0
    s_cmp_lg_u32 s33, 0
    s_cbranch_scc1 gated_mix__linear_attn_block__memory_aug_recurrent_mem_tr__prompt_kernel_RL_latei_b
    s_sleep 6
    s_branch gated_mix__linear_attn_block__memory_aug_recurrent_mem_tr__prompt_kernel_RL_latei
gated_mix__linear_attn_block__memory_aug_recurrent_mem_tr__prompt_kernel_RL_latei_b:
    s_barrier
    s_mov_b32 s33, 0x1042000
gated_mix__linear_attn_block__memory_aug_recurrent_mem_tr__prompt_kernel_RL_late:
    buffer_load_dword v5, off, s[4:7], s33 sc1
    s_waitcnt vmcnt(0)
    v_cmp_eq_u32 vcc, -1, v5
    s_nop 0
    s_cbranch_vccz gated_mix__linear_attn_block__memory_aug_recurrent_mem_tr__prompt_kernel_RL_late_go
    s_sleep 32
    s_branch gated_mix__linear_attn_block__memory_aug_recurrent_mem_tr__prompt_kernel_RL_late
gated_mix__linear_attn_block__memory_aug_recurrent_mem_tr__prompt_kernel_RL_late_go:
    s_cmp_lg_u32 s26, 0
    s_cbranch_scc1 gated_mix__linear_attn_block__memory_aug_recurrent_mem_tr__prompt_kernel_RL_img_b
gated_mix__linear_attn_block__memory_aug_recurrent_mem_tr__prompt_kernel_RL_img:
    buffer_load_dword v5, off, s[84:87], 0 offset:16 sc1
    s_waitcnt vmcnt(0)
    v_readfirstlane_b32 s33, v5
    s_nop 0
    s_cmp_lg_u32 s33, 0
    s_cbranch_scc1 gated_mix__linear_attn_block__memory_aug_recurrent_mem_tr__prompt_kernel_RL_img_b
    s_sleep 6
    s_branch gated_mix__linear_attn_block__memory_aug_recurrent_mem_tr__prompt_kernel_RL_img
gated_mix__linear_attn_block__memory_aug_recurrent_mem_tr__prompt_kernel_RL_img_b:
    s_barrier
    s_load_dwordx2 s[12:13], s[0:1], 80
    s_mov_b32 s14, 0x380
    s_mov_b32 s15, 0x20000
    s_mul_i32 s40, s27, 28672
    s_add_u32 s40, s40, 0x38e0000
    s_mul_i32 s41, s26, 344064
    s_add_u32 s41, s41, 0xc40000
    v_lshlrev_b32 v5, 4, v3
    v_lshlrev_b32 v6, 2, v1
    v_cmp_eq_u32 vcc, 12, v4
    s_nop 1
    v_cndmask_b32 v124, 0, 1.0, vcc
    v_cndmask_b32 v125, 0, 1.0, vcc
    v_cndmask_b32 v126, 0, 1.0, vcc
    v_cndmask_b32 v127, 0, 1.0, vcc
    v_cmp_gt_u32 vcc, 3, v3
    s_nop 1
    v_cndmask_b32 v7, 0, -1, vcc
    s_mov_b32 s50, 0x3fb8aa3b
    s_mov_b32 s51, 0x3fb8aa3b
    s_mov_b32 s52, 0x358637bd
    s_mov_b32 s53, 0x358637bd
    s_mov_b32 s54, 0xffff0000
    s_lshl_b32 s42, s26, 14
    s_add_u32 s42, s42, 0x1168000
    s_waitcnt lgkmcnt(0)
    buffer_load_dwordx4 a[0:3], v2, s[4:7], s40 offen offset:0 sc1
    buffer_load_dwordx4 a[4:7], v2, s[4:7], s40 offen offset:1024 sc1
    buffer_load_dwordx4 a[8:11], v2, s[4:7], s40 offen offset:2048 sc1
    buffer_load_dwordx4 a[12:15], v2, s[4:7], s40 offen offset:3072 sc1
    s_add_u32 s40, s40, 4096
    buffer_load_dwordx4 a[16:19], v2, s[4:7], s40 offen offset:0 sc1
    buffer_load_dwordx4 a[20:23], v2, s[4:7], s40 offen offset:1024 sc1
    buffer_load_dwordx4 a[24:27], v2, s[4:7], s40 offen offset:2048 sc1
    buffer_load_dwordx4 a[28:31], v2, s[4:7], s40 offen offset:3072 sc1
    s_add_u32 s40, s40, 4096
    buffer_load_dwordx4 a[32:35], v2, s[4:7], s40 offen offset:0 sc1
    buffer_load_dwordx4 a[36:39], v2, s[4:7], s40 offen offset:1024 sc1
    buffer_load_dwordx4 a[40:43], v2, s[4:7], s40 offen offset:2048 sc1
    buffer_load_dwordx4 a[44:47], v2, s[4:7], s40 offen offset:3072 sc1
    s_add_u32 s40, s40, 4096
    buffer_load_dwordx4 a[48:51], v2, s[4:7], s40 offen offset:0 sc1
    buffer_load_dwordx4 a[52:55], v2, s[4:7], s40 offen offset:1024 sc1
    buffer_load_dwordx4 a[56:59], v2, s[4:7], s40 offen offset:2048 sc1
    buffer_load_dwordx4 a[60:63], v2, s[4:7], s40 offen offset:3072 sc1
    s_add_u32 s40, s40, 4096
    buffer_load_dwordx4 a[64:67], v2, s[4:7], s40 offen offset:0 sc1
    buffer_load_dwordx4 a[68:71], v2, s[4:7], s40 offen offset:1024 sc1
    buffer_load_dwordx4 a[72:75], v2, s[4:7], s40 offen offset:2048 sc1
    buffer_load_dwordx4 a[76:79], v2, s[4:7], s40 offen offset:3072 sc1
    s_add_u32 s40, s40, 4096
    buffer_load_dwordx4 a[80:83], v2, s[4:7], s40 offen offset:0 sc1
    buffer_load_dwordx4 a[84:87], v2, s[4:7], s40 offen offset:1024 sc1
    buffer_load_dwordx4 a[88:91], v2, s[4:7], s40 offen offset:2048 sc1
    buffer_load_dwordx4 a[92:95], v2, s[4:7], s40 offen offset:3072 sc1
    s_add_u32 s40, s40, 4096
    buffer_load_dwordx4 a[96:99], v2, s[4:7], s40 offen offset:0 sc1
    buffer_load_dwordx4 a[100:103], v2, s[4:7], s40 offen offset:1024 sc1
    buffer_load_dwordx4 a[104:107], v2, s[4:7], s40 offen offset:2048 sc1
    buffer_load_dwordx4 a[108:111], v2, s[4:7], s40 offen offset:3072 sc1
    s_add_u32 s40, s40, 4096
    buffer_load_dwordx4 v[64:67], v5, s[12:15], 0 offen offset:0
    buffer_load_dwordx4 v[68:71], v5, s[12:15], 0 offen offset:64
    buffer_load_dwordx4 v[72:75], v5, s[12:15], 0 offen offset:128
    buffer_load_dwordx4 v[76:79], v5, s[12:15], 0 offen offset:192
    buffer_load_dwordx4 v[80:83], v5, s[12:15], 0 offen offset:256
    buffer_load_dwordx4 v[84:87], v5, s[12:15], 0 offen offset:320
    buffer_load_dwordx4 v[88:91], v5, s[12:15], 0 offen offset:384
    buffer_load_dwordx4 v[92:95], v5, s[12:15], 0 offen offset:448
    buffer_load_dwordx4 v[96:99], v5, s[12:15], 0 offen offset:512
    buffer_load_dwordx4 v[100:103], v5, s[12:15], 0 offen offset:576
    buffer_load_dwordx4 v[104:107], v5, s[12:15], 0 offen offset:640
    buffer_load_dwordx4 v[108:111], v5, s[12:15], 0 offen offset:704
    buffer_load_dwordx4 v[112:115], v5, s[12:15], 0 offen offset:768
    buffer_load_dwordx4 v[116:119], v5, s[12:15], 0 offen offset:832
    buffer_load_dwordx4 a[112:115], v2, s[4:7], s41 offen offset:0 sc1
    buffer_load_dwordx4 a[116:119], v2, s[4:7], s41 offen offset:1024 sc1
    buffer_load_dwordx4 a[120:123], v2, s[4:7], s41 offen offset:2048 sc1
    buffer_load_dwordx4 a[124:127], v2, s[4:7], s41 offen offset:3072 sc1
    s_add_u32 s41, s41, 4096
    buffer_load_dwordx4 a[128:131], v2, s[4:7], s41 offen offset:0 sc1
    buffer_load_dwordx4 a[132:135], v2, s[4:7], s41 offen offset:1024 sc1
    buffer_load_dwordx4 a[136:139], v2, s[4:7], s41 offen offset:2048 sc1
    buffer_load_dwordx4 a[140:143], v2, s[4:7], s41 offen offset:3072 sc1
    s_add_u32 s41, s41, 4096
    buffer_load_dwordx4 a[144:147], v2, s[4:7], s41 offen offset:0 sc1
    buffer_load_dwordx4 a[148:151], v2, s[4:7], s41 offen offset:1024 sc1
    buffer_load_dwordx4 a[152:155], v2, s[4:7], s41 offen offset:2048 sc1
    buffer_load_dwordx4 a[156:159], v2, s[4:7], s41 offen offset:3072 sc1
    s_add_u32 s41, s41, 4096
    buffer_load_dwordx4 a[160:163], v2, s[4:7], s41 offen offset:0 sc1
    buffer_load_dwordx4 a[164:167], v2, s[4:7], s41 offen offset:1024 sc1
    buffer_load_dwordx4 a[168:171], v2, s[4:7], s41 offen offset:2048 sc1
    buffer_load_dwordx4 a[172:175], v2, s[4:7], s41 offen offset:3072 sc1
    s_add_u32 s41, s41, 4096
    buffer_load_dwordx4 a[176:179], v2, s[4:7], s41 offen offset:0 sc1
    buffer_load_dwordx4 a[180:183], v2, s[4:7], s41 offen offset:1024 sc1
    buffer_load_dwordx4 a[184:187], v2, s[4:7], s41 offen offset:2048 sc1
    buffer_load_dwordx4 a[188:191], v2, s[4:7], s41 offen offset:3072 sc1
    s_add_u32 s41, s41, 4096
    buffer_load_dwordx4 a[192:195], v2, s[4:7], s41 offen offset:0 sc1
    buffer_load_dwordx4 a[196:199], v2, s[4:7], s41 offen offset:1024 sc1
    buffer_load_dwordx4 a[200:203], v2, s[4:7], s41 offen offset:2048 sc1
    buffer_load_dwordx4 a[204:207], v2, s[4:7], s41 offen offset:3072 sc1
    s_add_u32 s41, s41, 4096
    buffer_load_dwordx4 a[208:211], v2, s[4:7], s41 offen offset:0 sc1
    buffer_load_dwordx4 a[212:215], v2, s[4:7], s41 offen offset:1024 sc1
    buffer_load_dwordx4 a[216:219], v2, s[4:7], s41 offen offset:2048 sc1
    buffer_load_dwordx4 a[220:223], v2, s[4:7], s41 offen offset:3072 sc1
    s_add_u32 s41, s41, 4096
    buffer_load_dwordx4 v[128:131], v2, s[4:7], s41 offen offset:0 sc1
    buffer_load_dwordx4 v[132:135], v2, s[4:7], s41 offen offset:1024 sc1
    buffer_load_dwordx4 v[136:139], v2, s[4:7], s41 offen offset:2048 sc1
    buffer_load_dwordx4 v[140:143], v2, s[4:7], s41 offen offset:3072 sc1
    s_add_u32 s41, s41, 4096
    buffer_load_dwordx4 v[144:147], v2, s[4:7], s41 offen offset:0 sc1
    buffer_load_dwordx4 v[148:151], v2, s[4:7], s41 offen offset:1024 sc1
    buffer_load_dwordx4 v[152:155], v2, s[4:7], s41 offen offset:2048 sc1
    buffer_load_dwordx4 v[156:159], v2, s[4:7], s41 offen offset:3072 sc1
    s_add_u32 s41, s41, 4096
    buffer_load_dwordx4 v[160:163], v2, s[4:7], s41 offen offset:0 sc1
    buffer_load_dwordx4 v[164:167], v2, s[4:7], s41 offen offset:1024 sc1
    buffer_load_dwordx4 v[168:171], v2, s[4:7], s41 offen offset:2048 sc1
    buffer_load_dwordx4 v[172:175], v2, s[4:7], s41 offen offset:3072 sc1
    s_add_u32 s41, s41, 4096
    buffer_load_dwordx4 v[176:179], v2, s[4:7], s41 offen offset:0 sc1
    buffer_load_dwordx4 v[180:183], v2, s[4:7], s41 offen offset:1024 sc1
    buffer_load_dwordx4 v[184:187], v2, s[4:7], s41 offen offset:2048 sc1
    buffer_load_dwordx4 v[188:191], v2, s[4:7], s41 offen offset:3072 sc1
    s_add_u32 s41, s41, 4096
    buffer_load_dwordx4 v[192:195], v2, s[4:7], s41 offen offset:0 sc1
    buffer_load_dwordx4 v[196:199], v2, s[4:7], s41 offen offset:1024 sc1
    buffer_load_dwordx4 v[200:203], v2, s[4:7], s41 offen offset:2048 sc1
    buffer_load_dwordx4 v[204:207], v2, s[4:7], s41 offen offset:3072 sc1
    s_add_u32 s41, s41, 4096
    buffer_load_dwordx4 v[208:211], v2, s[4:7], s41 offen offset:0 sc1
    buffer_load_dwordx4 v[212:215], v2, s[4:7], s41 offen offset:1024 sc1
    buffer_load_dwordx4 v[216:219], v2, s[4:7], s41 offen offset:2048 sc1
    buffer_load_dwordx4 v[220:223], v2, s[4:7], s41 offen offset:3072 sc1
    s_add_u32 s41, s41, 4096
    buffer_load_dwordx4 v[224:227], v2, s[4:7], s41 offen offset:0 sc1
    buffer_load_dwordx4 v[228:231], v2, s[4:7], s41 offen offset:1024 sc1
    buffer_load_dwordx4 v[232:235], v2, s[4:7], s41 offen offset:2048 sc1
    buffer_load_dwordx4 v[236:239], v2, s[4:7], s41 offen offset:3072 sc1
    s_add_u32 s41, s41, 4096
    s_waitcnt vmcnt(56)
    v_mov_b32 v16, 0
    v_mov_b32 v20, 0
    s_mov_b32 s55, 0x3f803f80
    v_lshlrev_b32 v32, 16, v64
    v_and_b32 v33, s54, v64
    v_accvgpr_read_b32 v36, a0
    v_lshlrev_b32 v34, 16, v36
    v_and_b32 v35, s54, v36
    v_pk_mul_f32 v[34:35], v[34:35], v[32:33]
    v_cvt_pk_bf16_f32 v36, v34, v35
    v_dot2_f32_bf16 v16, v36, s55, v16
    v_accvgpr_read_b32 v40, a56
    v_lshlrev_b32 v38, 16, v40
    v_and_b32 v39, s54, v40
    v_pk_mul_f32 v[38:39], v[38:39], v[32:33]
    v_cvt_pk_bf16_f32 v40, v38, v39
    v_dot2_f32_bf16 v20, v40, s55, v20
    v_lshlrev_b32 v32, 16, v65
    v_and_b32 v33, s54, v65
    v_accvgpr_read_b32 v36, a1
    v_lshlrev_b32 v34, 16, v36
    v_and_b32 v35, s54, v36
    v_pk_mul_f32 v[34:35], v[34:35], v[32:33]
    v_cvt_pk_bf16_f32 v36, v34, v35
    v_dot2_f32_bf16 v16, v36, s55, v16
    v_accvgpr_read_b32 v40, a57
    v_lshlrev_b32 v38, 16, v40
    v_and_b32 v39, s54, v40
    v_pk_mul_f32 v[38:39], v[38:39], v[32:33]
    v_cvt_pk_bf16_f32 v40, v38, v39
    v_dot2_f32_bf16 v20, v40, s55, v20
    v_lshlrev_b32 v32, 16, v66
    v_and_b32 v33, s54, v66
    v_accvgpr_read_b32 v36, a2
    v_lshlrev_b32 v34, 16, v36
    v_and_b32 v35, s54, v36
    v_pk_mul_f32 v[34:35], v[34:35], v[32:33]
    v_cvt_pk_bf16_f32 v36, v34, v35
    v_dot2_f32_bf16 v16, v36, s55, v16
    v_accvgpr_read_b32 v40, a58
    v_lshlrev_b32 v38, 16, v40
    v_and_b32 v39, s54, v40
    v_pk_mul_f32 v[38:39], v[38:39], v[32:33]
    v_cvt_pk_bf16_f32 v40, v38, v39
    v_dot2_f32_bf16 v20, v40, s55, v20
    v_lshlrev_b32 v32, 16, v67
    v_and_b32 v33, s54, v67
    v_accvgpr_read_b32 v36, a3
    v_lshlrev_b32 v34, 16, v36
    v_and_b32 v35, s54, v36
    v_pk_mul_f32 v[34:35], v[34:35], v[32:33]
    v_cvt_pk_bf16_f32 v36, v34, v35
    v_dot2_f32_bf16 v16, v36, s55, v16
    v_accvgpr_read_b32 v40, a59
    v_lshlrev_b32 v38, 16, v40
    v_and_b32 v39, s54, v40
    v_pk_mul_f32 v[38:39], v[38:39], v[32:33]
    v_cvt_pk_bf16_f32 v40, v38, v39
    v_dot2_f32_bf16 v20, v40, s55, v20
    v_lshlrev_b32 v32, 16, v68
    v_and_b32 v33, s54, v68
    v_accvgpr_read_b32 v36, a4
    v_lshlrev_b32 v34, 16, v36
    v_and_b32 v35, s54, v36
    v_pk_mul_f32 v[34:35], v[34:35], v[32:33]
    v_cvt_pk_bf16_f32 v36, v34, v35
    v_dot2_f32_bf16 v16, v36, s55, v16
    v_accvgpr_read_b32 v40, a60
    v_lshlrev_b32 v38, 16, v40
    v_and_b32 v39, s54, v40
    v_pk_mul_f32 v[38:39], v[38:39], v[32:33]
    v_cvt_pk_bf16_f32 v40, v38, v39
    v_dot2_f32_bf16 v20, v40, s55, v20
    v_lshlrev_b32 v32, 16, v69
    v_and_b32 v33, s54, v69
    v_accvgpr_read_b32 v36, a5
    v_lshlrev_b32 v34, 16, v36
    v_and_b32 v35, s54, v36
    v_pk_mul_f32 v[34:35], v[34:35], v[32:33]
    v_cvt_pk_bf16_f32 v36, v34, v35
    v_dot2_f32_bf16 v16, v36, s55, v16
    v_accvgpr_read_b32 v40, a61
    v_lshlrev_b32 v38, 16, v40
    v_and_b32 v39, s54, v40
    v_pk_mul_f32 v[38:39], v[38:39], v[32:33]
    v_cvt_pk_bf16_f32 v40, v38, v39
    v_dot2_f32_bf16 v20, v40, s55, v20
    v_lshlrev_b32 v32, 16, v70
    v_and_b32 v33, s54, v70
    v_accvgpr_read_b32 v36, a6
    v_lshlrev_b32 v34, 16, v36
    v_and_b32 v35, s54, v36
    v_pk_mul_f32 v[34:35], v[34:35], v[32:33]
    v_cvt_pk_bf16_f32 v36, v34, v35
    v_dot2_f32_bf16 v16, v36, s55, v16
    v_accvgpr_read_b32 v40, a62
    v_lshlrev_b32 v38, 16, v40
    v_and_b32 v39, s54, v40
    v_pk_mul_f32 v[38:39], v[38:39], v[32:33]
    v_cvt_pk_bf16_f32 v40, v38, v39
    v_dot2_f32_bf16 v20, v40, s55, v20
    v_lshlrev_b32 v32, 16, v71
    v_and_b32 v33, s54, v71
    v_accvgpr_read_b32 v36, a7
    v_lshlrev_b32 v34, 16, v36
    v_and_b32 v35, s54, v36
    v_pk_mul_f32 v[34:35], v[34:35], v[32:33]
    v_cvt_pk_bf16_f32 v36, v34, v35
    v_dot2_f32_bf16 v16, v36, s55, v16
    v_accvgpr_read_b32 v40, a63
    v_lshlrev_b32 v38, 16, v40
    v_and_b32 v39, s54, v40
    v_pk_mul_f32 v[38:39], v[38:39], v[32:33]
    v_cvt_pk_bf16_f32 v40, v38, v39
    v_dot2_f32_bf16 v20, v40, s55, v20
    v_lshlrev_b32 v32, 16, v72
    v_and_b32 v33, s54, v72
    v_accvgpr_read_b32 v36, a8
    v_lshlrev_b32 v34, 16, v36
    v_and_b32 v35, s54, v36
    v_pk_mul_f32 v[34:35], v[34:35], v[32:33]
    v_cvt_pk_bf16_f32 v36, v34, v35
    v_dot2_f32_bf16 v16, v36, s55, v16
    v_accvgpr_read_b32 v40, a64
    v_lshlrev_b32 v38, 16, v40
    v_and_b32 v39, s54, v40
    v_pk_mul_f32 v[38:39], v[38:39], v[32:33]
    v_cvt_pk_bf16_f32 v40, v38, v39
    v_dot2_f32_bf16 v20, v40, s55, v20
    v_lshlrev_b32 v32, 16, v73
    v_and_b32 v33, s54, v73
    v_accvgpr_read_b32 v36, a9
    v_lshlrev_b32 v34, 16, v36
    v_and_b32 v35, s54, v36
    v_pk_mul_f32 v[34:35], v[34:35], v[32:33]
    v_cvt_pk_bf16_f32 v36, v34, v35
    v_dot2_f32_bf16 v16, v36, s55, v16
    v_accvgpr_read_b32 v40, a65
    v_lshlrev_b32 v38, 16, v40
    v_and_b32 v39, s54, v40
    v_pk_mul_f32 v[38:39], v[38:39], v[32:33]
    v_cvt_pk_bf16_f32 v40, v38, v39
    v_dot2_f32_bf16 v20, v40, s55, v20
    v_lshlrev_b32 v32, 16, v74
    v_and_b32 v33, s54, v74
    v_accvgpr_read_b32 v36, a10
    v_lshlrev_b32 v34, 16, v36
    v_and_b32 v35, s54, v36
    v_pk_mul_f32 v[34:35], v[34:35], v[32:33]
    v_cvt_pk_bf16_f32 v36, v34, v35
    v_dot2_f32_bf16 v16, v36, s55, v16
    v_accvgpr_read_b32 v40, a66
    v_lshlrev_b32 v38, 16, v40
    v_and_b32 v39, s54, v40
    v_pk_mul_f32 v[38:39], v[38:39], v[32:33]
    v_cvt_pk_bf16_f32 v40, v38, v39
    v_dot2_f32_bf16 v20, v40, s55, v20
    v_lshlrev_b32 v32, 16, v75
    v_and_b32 v33, s54, v75
    v_accvgpr_read_b32 v36, a11
    v_lshlrev_b32 v34, 16, v36
    v_and_b32 v35, s54, v36
    v_pk_mul_f32 v[34:35], v[34:35], v[32:33]
    v_cvt_pk_bf16_f32 v36, v34, v35
    v_dot2_f32_bf16 v16, v36, s55, v16
    v_accvgpr_read_b32 v40, a67
    v_lshlrev_b32 v38, 16, v40
    v_and_b32 v39, s54, v40
    v_pk_mul_f32 v[38:39], v[38:39], v[32:33]
    v_cvt_pk_bf16_f32 v40, v38, v39
    v_dot2_f32_bf16 v20, v40, s55, v20
    v_lshlrev_b32 v32, 16, v76
    v_and_b32 v33, s54, v76
    v_accvgpr_read_b32 v36, a12
    v_lshlrev_b32 v34, 16, v36
    v_and_b32 v35, s54, v36
    v_pk_mul_f32 v[34:35], v[34:35], v[32:33]
    v_cvt_pk_bf16_f32 v36, v34, v35
    v_dot2_f32_bf16 v16, v36, s55, v16
    v_accvgpr_read_b32 v40, a68
    v_lshlrev_b32 v38, 16, v40
    v_and_b32 v39, s54, v40
    v_pk_mul_f32 v[38:39], v[38:39], v[32:33]
    v_cvt_pk_bf16_f32 v40, v38, v39
    v_dot2_f32_bf16 v20, v40, s55, v20
    v_lshlrev_b32 v32, 16, v77
    v_and_b32 v33, s54, v77
    v_accvgpr_read_b32 v36, a13
    v_lshlrev_b32 v34, 16, v36
    v_and_b32 v35, s54, v36
    v_pk_mul_f32 v[34:35], v[34:35], v[32:33]
    v_cvt_pk_bf16_f32 v36, v34, v35
    v_dot2_f32_bf16 v16, v36, s55, v16
    v_accvgpr_read_b32 v40, a69
    v_lshlrev_b32 v38, 16, v40
    v_and_b32 v39, s54, v40
    v_pk_mul_f32 v[38:39], v[38:39], v[32:33]
    v_cvt_pk_bf16_f32 v40, v38, v39
    v_dot2_f32_bf16 v20, v40, s55, v20
    v_lshlrev_b32 v32, 16, v78
    v_and_b32 v33, s54, v78
    v_accvgpr_read_b32 v36, a14
    v_lshlrev_b32 v34, 16, v36
    v_and_b32 v35, s54, v36
    v_pk_mul_f32 v[34:35], v[34:35], v[32:33]
    v_cvt_pk_bf16_f32 v36, v34, v35
    v_dot2_f32_bf16 v16, v36, s55, v16
    v_accvgpr_read_b32 v40, a70
    v_lshlrev_b32 v38, 16, v40
    v_and_b32 v39, s54, v40
    v_pk_mul_f32 v[38:39], v[38:39], v[32:33]
    v_cvt_pk_bf16_f32 v40, v38, v39
    v_dot2_f32_bf16 v20, v40, s55, v20
    v_lshlrev_b32 v32, 16, v79
    v_and_b32 v33, s54, v79
    v_accvgpr_read_b32 v36, a15
    v_lshlrev_b32 v34, 16, v36
    v_and_b32 v35, s54, v36
    v_pk_mul_f32 v[34:35], v[34:35], v[32:33]
    v_cvt_pk_bf16_f32 v36, v34, v35
    v_dot2_f32_bf16 v16, v36, s55, v16
    v_accvgpr_read_b32 v40, a71
    v_lshlrev_b32 v38, 16, v40
    v_and_b32 v39, s54, v40
    v_pk_mul_f32 v[38:39], v[38:39], v[32:33]
    v_cvt_pk_bf16_f32 v40, v38, v39
    v_dot2_f32_bf16 v20, v40, s55, v20
    v_lshlrev_b32 v32, 16, v80
    v_and_b32 v33, s54, v80
    v_accvgpr_read_b32 v36, a16
    v_lshlrev_b32 v34, 16, v36
    v_and_b32 v35, s54, v36
    v_pk_mul_f32 v[34:35], v[34:35], v[32:33]
    v_cvt_pk_bf16_f32 v36, v34, v35
    v_dot2_f32_bf16 v16, v36, s55, v16
    v_accvgpr_read_b32 v40, a72
    v_lshlrev_b32 v38, 16, v40
    v_and_b32 v39, s54, v40
    v_pk_mul_f32 v[38:39], v[38:39], v[32:33]
    v_cvt_pk_bf16_f32 v40, v38, v39
    v_dot2_f32_bf16 v20, v40, s55, v20
    v_lshlrev_b32 v32, 16, v81
    v_and_b32 v33, s54, v81
    v_accvgpr_read_b32 v36, a17
    v_lshlrev_b32 v34, 16, v36
    v_and_b32 v35, s54, v36
    v_pk_mul_f32 v[34:35], v[34:35], v[32:33]
    v_cvt_pk_bf16_f32 v36, v34, v35
    v_dot2_f32_bf16 v16, v36, s55, v16
    v_accvgpr_read_b32 v40, a73
    v_lshlrev_b32 v38, 16, v40
    v_and_b32 v39, s54, v40
    v_pk_mul_f32 v[38:39], v[38:39], v[32:33]
    v_cvt_pk_bf16_f32 v40, v38, v39
    v_dot2_f32_bf16 v20, v40, s55, v20
    v_lshlrev_b32 v32, 16, v82
    v_and_b32 v33, s54, v82
    v_accvgpr_read_b32 v36, a18
    v_lshlrev_b32 v34, 16, v36
    v_and_b32 v35, s54, v36
    v_pk_mul_f32 v[34:35], v[34:35], v[32:33]
    v_cvt_pk_bf16_f32 v36, v34, v35
    v_dot2_f32_bf16 v16, v36, s55, v16
    v_accvgpr_read_b32 v40, a74
    v_lshlrev_b32 v38, 16, v40
    v_and_b32 v39, s54, v40
    v_pk_mul_f32 v[38:39], v[38:39], v[32:33]
    v_cvt_pk_bf16_f32 v40, v38, v39
    v_dot2_f32_bf16 v20, v40, s55, v20
    v_lshlrev_b32 v32, 16, v83
    v_and_b32 v33, s54, v83
    v_accvgpr_read_b32 v36, a19
    v_lshlrev_b32 v34, 16, v36
    v_and_b32 v35, s54, v36
    v_pk_mul_f32 v[34:35], v[34:35], v[32:33]
    v_cvt_pk_bf16_f32 v36, v34, v35
    v_dot2_f32_bf16 v16, v36, s55, v16
    v_accvgpr_read_b32 v40, a75
    v_lshlrev_b32 v38, 16, v40
    v_and_b32 v39, s54, v40
    v_pk_mul_f32 v[38:39], v[38:39], v[32:33]
    v_cvt_pk_bf16_f32 v40, v38, v39
    v_dot2_f32_bf16 v20, v40, s55, v20
    v_lshlrev_b32 v32, 16, v84
    v_and_b32 v33, s54, v84
    v_accvgpr_read_b32 v36, a20
    v_lshlrev_b32 v34, 16, v36
    v_and_b32 v35, s54, v36
    v_pk_mul_f32 v[34:35], v[34:35], v[32:33]
    v_cvt_pk_bf16_f32 v36, v34, v35
    v_dot2_f32_bf16 v16, v36, s55, v16
    v_accvgpr_read_b32 v40, a76
    v_lshlrev_b32 v38, 16, v40
    v_and_b32 v39, s54, v40
    v_pk_mul_f32 v[38:39], v[38:39], v[32:33]
    v_cvt_pk_bf16_f32 v40, v38, v39
    v_dot2_f32_bf16 v20, v40, s55, v20
    v_lshlrev_b32 v32, 16, v85
    v_and_b32 v33, s54, v85
    v_accvgpr_read_b32 v36, a21
    v_lshlrev_b32 v34, 16, v36
    v_and_b32 v35, s54, v36
    v_pk_mul_f32 v[34:35], v[34:35], v[32:33]
    v_cvt_pk_bf16_f32 v36, v34, v35
    v_dot2_f32_bf16 v16, v36, s55, v16
    v_accvgpr_read_b32 v40, a77
    v_lshlrev_b32 v38, 16, v40
    v_and_b32 v39, s54, v40
    v_pk_mul_f32 v[38:39], v[38:39], v[32:33]
    v_cvt_pk_bf16_f32 v40, v38, v39
    v_dot2_f32_bf16 v20, v40, s55, v20
    v_lshlrev_b32 v32, 16, v86
    v_and_b32 v33, s54, v86
    v_accvgpr_read_b32 v36, a22
    v_lshlrev_b32 v34, 16, v36
    v_and_b32 v35, s54, v36
    v_pk_mul_f32 v[34:35], v[34:35], v[32:33]
    v_cvt_pk_bf16_f32 v36, v34, v35
    v_dot2_f32_bf16 v16, v36, s55, v16
    v_accvgpr_read_b32 v40, a78
    v_lshlrev_b32 v38, 16, v40
    v_and_b32 v39, s54, v40
    v_pk_mul_f32 v[38:39], v[38:39], v[32:33]
    v_cvt_pk_bf16_f32 v40, v38, v39
    v_dot2_f32_bf16 v20, v40, s55, v20
    v_lshlrev_b32 v32, 16, v87
    v_and_b32 v33, s54, v87
    v_accvgpr_read_b32 v36, a23
    v_lshlrev_b32 v34, 16, v36
    v_and_b32 v35, s54, v36
    v_pk_mul_f32 v[34:35], v[34:35], v[32:33]
    v_cvt_pk_bf16_f32 v36, v34, v35
    v_dot2_f32_bf16 v16, v36, s55, v16
    v_accvgpr_read_b32 v40, a79
    v_lshlrev_b32 v38, 16, v40
    v_and_b32 v39, s54, v40
    v_pk_mul_f32 v[38:39], v[38:39], v[32:33]
    v_cvt_pk_bf16_f32 v40, v38, v39
    v_dot2_f32_bf16 v20, v40, s55, v20
    v_lshlrev_b32 v32, 16, v88
    v_and_b32 v33, s54, v88
    v_accvgpr_read_b32 v36, a24
    v_lshlrev_b32 v34, 16, v36
    v_and_b32 v35, s54, v36
    v_pk_mul_f32 v[34:35], v[34:35], v[32:33]
    v_cvt_pk_bf16_f32 v36, v34, v35
    v_dot2_f32_bf16 v16, v36, s55, v16
    v_accvgpr_read_b32 v40, a80
    v_lshlrev_b32 v38, 16, v40
    v_and_b32 v39, s54, v40
    v_pk_mul_f32 v[38:39], v[38:39], v[32:33]
    v_cvt_pk_bf16_f32 v40, v38, v39
    v_dot2_f32_bf16 v20, v40, s55, v20
    v_lshlrev_b32 v32, 16, v89
    v_and_b32 v33, s54, v89
    v_accvgpr_read_b32 v36, a25
    v_lshlrev_b32 v34, 16, v36
    v_and_b32 v35, s54, v36
    v_pk_mul_f32 v[34:35], v[34:35], v[32:33]
    v_cvt_pk_bf16_f32 v36, v34, v35
    v_dot2_f32_bf16 v16, v36, s55, v16
    v_accvgpr_read_b32 v40, a81
    v_lshlrev_b32 v38, 16, v40
    v_and_b32 v39, s54, v40
    v_pk_mul_f32 v[38:39], v[38:39], v[32:33]
    v_cvt_pk_bf16_f32 v40, v38, v39
    v_dot2_f32_bf16 v20, v40, s55, v20
    v_lshlrev_b32 v32, 16, v90
    v_and_b32 v33, s54, v90
    v_accvgpr_read_b32 v36, a26
    v_lshlrev_b32 v34, 16, v36
    v_and_b32 v35, s54, v36
    v_pk_mul_f32 v[34:35], v[34:35], v[32:33]
    v_cvt_pk_bf16_f32 v36, v34, v35
    v_dot2_f32_bf16 v16, v36, s55, v16
    v_accvgpr_read_b32 v40, a82
    v_lshlrev_b32 v38, 16, v40
    v_and_b32 v39, s54, v40
    v_pk_mul_f32 v[38:39], v[38:39], v[32:33]
    v_cvt_pk_bf16_f32 v40, v38, v39
    v_dot2_f32_bf16 v20, v40, s55, v20
    v_lshlrev_b32 v32, 16, v91
    v_and_b32 v33, s54, v91
    v_accvgpr_read_b32 v36, a27
    v_lshlrev_b32 v34, 16, v36
    v_and_b32 v35, s54, v36
    v_pk_mul_f32 v[34:35], v[34:35], v[32:33]
    v_cvt_pk_bf16_f32 v36, v34, v35
    v_dot2_f32_bf16 v16, v36, s55, v16
    v_accvgpr_read_b32 v40, a83
    v_lshlrev_b32 v38, 16, v40
    v_and_b32 v39, s54, v40
    v_pk_mul_f32 v[38:39], v[38:39], v[32:33]
    v_cvt_pk_bf16_f32 v40, v38, v39
    v_dot2_f32_bf16 v20, v40, s55, v20
    v_lshlrev_b32 v32, 16, v92
    v_and_b32 v33, s54, v92
    v_accvgpr_read_b32 v36, a28
    v_lshlrev_b32 v34, 16, v36
    v_and_b32 v35, s54, v36
    v_pk_mul_f32 v[34:35], v[34:35], v[32:33]
    v_cvt_pk_bf16_f32 v36, v34, v35
    v_dot2_f32_bf16 v16, v36, s55, v16
    v_accvgpr_read_b32 v40, a84
    v_lshlrev_b32 v38, 16, v40
    v_and_b32 v39, s54, v40
    v_pk_mul_f32 v[38:39], v[38:39], v[32:33]
    v_cvt_pk_bf16_f32 v40, v38, v39
    v_dot2_f32_bf16 v20, v40, s55, v20
    v_lshlrev_b32 v32, 16, v93
    v_and_b32 v33, s54, v93
    v_accvgpr_read_b32 v36, a29
    v_lshlrev_b32 v34, 16, v36
    v_and_b32 v35, s54, v36
    v_pk_mul_f32 v[34:35], v[34:35], v[32:33]
    v_cvt_pk_bf16_f32 v36, v34, v35
    v_dot2_f32_bf16 v16, v36, s55, v16
    v_accvgpr_read_b32 v40, a85
    v_lshlrev_b32 v38, 16, v40
    v_and_b32 v39, s54, v40
    v_pk_mul_f32 v[38:39], v[38:39], v[32:33]
    v_cvt_pk_bf16_f32 v40, v38, v39
    v_dot2_f32_bf16 v20, v40, s55, v20
    v_lshlrev_b32 v32, 16, v94
    v_and_b32 v33, s54, v94
    v_accvgpr_read_b32 v36, a30
    v_lshlrev_b32 v34, 16, v36
    v_and_b32 v35, s54, v36
    v_pk_mul_f32 v[34:35], v[34:35], v[32:33]
    v_cvt_pk_bf16_f32 v36, v34, v35
    v_dot2_f32_bf16 v16, v36, s55, v16
    v_accvgpr_read_b32 v40, a86
    v_lshlrev_b32 v38, 16, v40
    v_and_b32 v39, s54, v40
    v_pk_mul_f32 v[38:39], v[38:39], v[32:33]
    v_cvt_pk_bf16_f32 v40, v38, v39
    v_dot2_f32_bf16 v20, v40, s55, v20
    v_lshlrev_b32 v32, 16, v95
    v_and_b32 v33, s54, v95
    v_accvgpr_read_b32 v36, a31
    v_lshlrev_b32 v34, 16, v36
    v_and_b32 v35, s54, v36
    v_pk_mul_f32 v[34:35], v[34:35], v[32:33]
    v_cvt_pk_bf16_f32 v36, v34, v35
    v_dot2_f32_bf16 v16, v36, s55, v16
    v_accvgpr_read_b32 v40, a87
    v_lshlrev_b32 v38, 16, v40
    v_and_b32 v39, s54, v40
    v_pk_mul_f32 v[38:39], v[38:39], v[32:33]
    v_cvt_pk_bf16_f32 v40, v38, v39
    v_dot2_f32_bf16 v20, v40, s55, v20
    v_lshlrev_b32 v32, 16, v96
    v_and_b32 v33, s54, v96
    v_accvgpr_read_b32 v36, a32
    v_lshlrev_b32 v34, 16, v36
    v_and_b32 v35, s54, v36
    v_pk_mul_f32 v[34:35], v[34:35], v[32:33]
    v_cvt_pk_bf16_f32 v36, v34, v35
    v_dot2_f32_bf16 v16, v36, s55, v16
    v_accvgpr_read_b32 v40, a88
    v_lshlrev_b32 v38, 16, v40
    v_and_b32 v39, s54, v40
    v_pk_mul_f32 v[38:39], v[38:39], v[32:33]
    v_cvt_pk_bf16_f32 v40, v38, v39
    v_dot2_f32_bf16 v20, v40, s55, v20
    v_lshlrev_b32 v32, 16, v97
    v_and_b32 v33, s54, v97
    v_accvgpr_read_b32 v36, a33
    v_lshlrev_b32 v34, 16, v36
    v_and_b32 v35, s54, v36
    v_pk_mul_f32 v[34:35], v[34:35], v[32:33]
    v_cvt_pk_bf16_f32 v36, v34, v35
    v_dot2_f32_bf16 v16, v36, s55, v16
    v_accvgpr_read_b32 v40, a89
    v_lshlrev_b32 v38, 16, v40
    v_and_b32 v39, s54, v40
    v_pk_mul_f32 v[38:39], v[38:39], v[32:33]
    v_cvt_pk_bf16_f32 v40, v38, v39
    v_dot2_f32_bf16 v20, v40, s55, v20
    v_lshlrev_b32 v32, 16, v98
    v_and_b32 v33, s54, v98
    v_accvgpr_read_b32 v36, a34
    v_lshlrev_b32 v34, 16, v36
    v_and_b32 v35, s54, v36
    v_pk_mul_f32 v[34:35], v[34:35], v[32:33]
    v_cvt_pk_bf16_f32 v36, v34, v35
    v_dot2_f32_bf16 v16, v36, s55, v16
    v_accvgpr_read_b32 v40, a90
    v_lshlrev_b32 v38, 16, v40
    v_and_b32 v39, s54, v40
    v_pk_mul_f32 v[38:39], v[38:39], v[32:33]
    v_cvt_pk_bf16_f32 v40, v38, v39
    v_dot2_f32_bf16 v20, v40, s55, v20
    v_lshlrev_b32 v32, 16, v99
    v_and_b32 v33, s54, v99
    v_accvgpr_read_b32 v36, a35
    v_lshlrev_b32 v34, 16, v36
    v_and_b32 v35, s54, v36
    v_pk_mul_f32 v[34:35], v[34:35], v[32:33]
    v_cvt_pk_bf16_f32 v36, v34, v35
    v_dot2_f32_bf16 v16, v36, s55, v16
    v_accvgpr_read_b32 v40, a91
    v_lshlrev_b32 v38, 16, v40
    v_and_b32 v39, s54, v40
    v_pk_mul_f32 v[38:39], v[38:39], v[32:33]
    v_cvt_pk_bf16_f32 v40, v38, v39
    v_dot2_f32_bf16 v20, v40, s55, v20
    v_lshlrev_b32 v32, 16, v100
    v_and_b32 v33, s54, v100
    v_accvgpr_read_b32 v36, a36
    v_lshlrev_b32 v34, 16, v36
    v_and_b32 v35, s54, v36
    v_pk_mul_f32 v[34:35], v[34:35], v[32:33]
    v_cvt_pk_bf16_f32 v36, v34, v35
    v_dot2_f32_bf16 v16, v36, s55, v16
    v_accvgpr_read_b32 v40, a92
    v_lshlrev_b32 v38, 16, v40
    v_and_b32 v39, s54, v40
    v_pk_mul_f32 v[38:39], v[38:39], v[32:33]
    v_cvt_pk_bf16_f32 v40, v38, v39
    v_dot2_f32_bf16 v20, v40, s55, v20
    v_lshlrev_b32 v32, 16, v101
    v_and_b32 v33, s54, v101
    v_accvgpr_read_b32 v36, a37
    v_lshlrev_b32 v34, 16, v36
    v_and_b32 v35, s54, v36
    v_pk_mul_f32 v[34:35], v[34:35], v[32:33]
    v_cvt_pk_bf16_f32 v36, v34, v35
    v_dot2_f32_bf16 v16, v36, s55, v16
    v_accvgpr_read_b32 v40, a93
    v_lshlrev_b32 v38, 16, v40
    v_and_b32 v39, s54, v40
    v_pk_mul_f32 v[38:39], v[38:39], v[32:33]
    v_cvt_pk_bf16_f32 v40, v38, v39
    v_dot2_f32_bf16 v20, v40, s55, v20
    v_lshlrev_b32 v32, 16, v102
    v_and_b32 v33, s54, v102
    v_accvgpr_read_b32 v36, a38
    v_lshlrev_b32 v34, 16, v36
    v_and_b32 v35, s54, v36
    v_pk_mul_f32 v[34:35], v[34:35], v[32:33]
    v_cvt_pk_bf16_f32 v36, v34, v35
    v_dot2_f32_bf16 v16, v36, s55, v16
    v_accvgpr_read_b32 v40, a94
    v_lshlrev_b32 v38, 16, v40
    v_and_b32 v39, s54, v40
    v_pk_mul_f32 v[38:39], v[38:39], v[32:33]
    v_cvt_pk_bf16_f32 v40, v38, v39
    v_dot2_f32_bf16 v20, v40, s55, v20
    v_lshlrev_b32 v32, 16, v103
    v_and_b32 v33, s54, v103
    v_accvgpr_read_b32 v36, a39
    v_lshlrev_b32 v34, 16, v36
    v_and_b32 v35, s54, v36
    v_pk_mul_f32 v[34:35], v[34:35], v[32:33]
    v_cvt_pk_bf16_f32 v36, v34, v35
    v_dot2_f32_bf16 v16, v36, s55, v16
    v_accvgpr_read_b32 v40, a95
    v_lshlrev_b32 v38, 16, v40
    v_and_b32 v39, s54, v40
    v_pk_mul_f32 v[38:39], v[38:39], v[32:33]
    v_cvt_pk_bf16_f32 v40, v38, v39
    v_dot2_f32_bf16 v20, v40, s55, v20
    v_lshlrev_b32 v32, 16, v104
    v_and_b32 v33, s54, v104
    v_accvgpr_read_b32 v36, a40
    v_lshlrev_b32 v34, 16, v36
    v_and_b32 v35, s54, v36
    v_pk_mul_f32 v[34:35], v[34:35], v[32:33]
    v_cvt_pk_bf16_f32 v36, v34, v35
    v_dot2_f32_bf16 v16, v36, s55, v16
    v_accvgpr_read_b32 v40, a96
    v_lshlrev_b32 v38, 16, v40
    v_and_b32 v39, s54, v40
    v_pk_mul_f32 v[38:39], v[38:39], v[32:33]
    v_cvt_pk_bf16_f32 v40, v38, v39
    v_dot2_f32_bf16 v20, v40, s55, v20
    v_lshlrev_b32 v32, 16, v105
    v_and_b32 v33, s54, v105
    v_accvgpr_read_b32 v36, a41
    v_lshlrev_b32 v34, 16, v36
    v_and_b32 v35, s54, v36
    v_pk_mul_f32 v[34:35], v[34:35], v[32:33]
    v_cvt_pk_bf16_f32 v36, v34, v35
    v_dot2_f32_bf16 v16, v36, s55, v16
    v_accvgpr_read_b32 v40, a97
    v_lshlrev_b32 v38, 16, v40
    v_and_b32 v39, s54, v40
    v_pk_mul_f32 v[38:39], v[38:39], v[32:33]
    v_cvt_pk_bf16_f32 v40, v38, v39
    v_dot2_f32_bf16 v20, v40, s55, v20
    v_lshlrev_b32 v32, 16, v106
    v_and_b32 v33, s54, v106
    v_accvgpr_read_b32 v36, a42
    v_lshlrev_b32 v34, 16, v36
    v_and_b32 v35, s54, v36
    v_pk_mul_f32 v[34:35], v[34:35], v[32:33]
    v_cvt_pk_bf16_f32 v36, v34, v35
    v_dot2_f32_bf16 v16, v36, s55, v16
    v_accvgpr_read_b32 v40, a98
    v_lshlrev_b32 v38, 16, v40
    v_and_b32 v39, s54, v40
    v_pk_mul_f32 v[38:39], v[38:39], v[32:33]
    v_cvt_pk_bf16_f32 v40, v38, v39
    v_dot2_f32_bf16 v20, v40, s55, v20
    v_lshlrev_b32 v32, 16, v107
    v_and_b32 v33, s54, v107
    v_accvgpr_read_b32 v36, a43
    v_lshlrev_b32 v34, 16, v36
    v_and_b32 v35, s54, v36
    v_pk_mul_f32 v[34:35], v[34:35], v[32:33]
    v_cvt_pk_bf16_f32 v36, v34, v35
    v_dot2_f32_bf16 v16, v36, s55, v16
    v_accvgpr_read_b32 v40, a99
    v_lshlrev_b32 v38, 16, v40
    v_and_b32 v39, s54, v40
    v_pk_mul_f32 v[38:39], v[38:39], v[32:33]
    v_cvt_pk_bf16_f32 v40, v38, v39
    v_dot2_f32_bf16 v20, v40, s55, v20
    v_lshlrev_b32 v32, 16, v108
    v_and_b32 v33, s54, v108
    v_accvgpr_read_b32 v36, a44
    v_lshlrev_b32 v34, 16, v36
    v_and_b32 v35, s54, v36
    v_pk_mul_f32 v[34:35], v[34:35], v[32:33]
    v_cvt_pk_bf16_f32 v36, v34, v35
    v_dot2_f32_bf16 v16, v36, s55, v16
    v_accvgpr_read_b32 v40, a100
    v_lshlrev_b32 v38, 16, v40
    v_and_b32 v39, s54, v40
    v_pk_mul_f32 v[38:39], v[38:39], v[32:33]
    v_cvt_pk_bf16_f32 v40, v38, v39
    v_dot2_f32_bf16 v20, v40, s55, v20
    v_lshlrev_b32 v32, 16, v109
    v_and_b32 v33, s54, v109
    v_accvgpr_read_b32 v36, a45
    v_lshlrev_b32 v34, 16, v36
    v_and_b32 v35, s54, v36
    v_pk_mul_f32 v[34:35], v[34:35], v[32:33]
    v_cvt_pk_bf16_f32 v36, v34, v35
    v_dot2_f32_bf16 v16, v36, s55, v16
    v_accvgpr_read_b32 v40, a101
    v_lshlrev_b32 v38, 16, v40
    v_and_b32 v39, s54, v40
    v_pk_mul_f32 v[38:39], v[38:39], v[32:33]
    v_cvt_pk_bf16_f32 v40, v38, v39
    v_dot2_f32_bf16 v20, v40, s55, v20
    v_lshlrev_b32 v32, 16, v110
    v_and_b32 v33, s54, v110
    v_accvgpr_read_b32 v36, a46
    v_lshlrev_b32 v34, 16, v36
    v_and_b32 v35, s54, v36
    v_pk_mul_f32 v[34:35], v[34:35], v[32:33]
    v_cvt_pk_bf16_f32 v36, v34, v35
    v_dot2_f32_bf16 v16, v36, s55, v16
    v_accvgpr_read_b32 v40, a102
    v_lshlrev_b32 v38, 16, v40
    v_and_b32 v39, s54, v40
    v_pk_mul_f32 v[38:39], v[38:39], v[32:33]
    v_cvt_pk_bf16_f32 v40, v38, v39
    v_dot2_f32_bf16 v20, v40, s55, v20
    v_lshlrev_b32 v32, 16, v111
    v_and_b32 v33, s54, v111
    v_accvgpr_read_b32 v36, a47
    v_lshlrev_b32 v34, 16, v36
    v_and_b32 v35, s54, v36
    v_pk_mul_f32 v[34:35], v[34:35], v[32:33]
    v_cvt_pk_bf16_f32 v36, v34, v35
    v_dot2_f32_bf16 v16, v36, s55, v16
    v_accvgpr_read_b32 v40, a103
    v_lshlrev_b32 v38, 16, v40
    v_and_b32 v39, s54, v40
    v_pk_mul_f32 v[38:39], v[38:39], v[32:33]
    v_cvt_pk_bf16_f32 v40, v38, v39
    v_dot2_f32_bf16 v20, v40, s55, v20
    v_lshlrev_b32 v32, 16, v112
    v_and_b32 v33, s54, v112
    v_accvgpr_read_b32 v36, a48
    v_lshlrev_b32 v34, 16, v36
    v_and_b32 v35, s54, v36
    v_pk_mul_f32 v[34:35], v[34:35], v[32:33]
    v_cvt_pk_bf16_f32 v36, v34, v35
    v_dot2_f32_bf16 v16, v36, s55, v16
    v_accvgpr_read_b32 v40, a104
    v_lshlrev_b32 v38, 16, v40
    v_and_b32 v39, s54, v40
    v_pk_mul_f32 v[38:39], v[38:39], v[32:33]
    v_cvt_pk_bf16_f32 v40, v38, v39
    v_dot2_f32_bf16 v20, v40, s55, v20
    v_lshlrev_b32 v32, 16, v113
    v_and_b32 v33, s54, v113
    v_accvgpr_read_b32 v36, a49
    v_lshlrev_b32 v34, 16, v36
    v_and_b32 v35, s54, v36
    v_pk_mul_f32 v[34:35], v[34:35], v[32:33]
    v_cvt_pk_bf16_f32 v36, v34, v35
    v_dot2_f32_bf16 v16, v36, s55, v16
    v_accvgpr_read_b32 v40, a105
    v_lshlrev_b32 v38, 16, v40
    v_and_b32 v39, s54, v40
    v_pk_mul_f32 v[38:39], v[38:39], v[32:33]
    v_cvt_pk_bf16_f32 v40, v38, v39
    v_dot2_f32_bf16 v20, v40, s55, v20
    v_lshlrev_b32 v32, 16, v114
    v_and_b32 v33, s54, v114
    v_accvgpr_read_b32 v36, a50
    v_lshlrev_b32 v34, 16, v36
    v_and_b32 v35, s54, v36
    v_pk_mul_f32 v[34:35], v[34:35], v[32:33]
    v_cvt_pk_bf16_f32 v36, v34, v35
    v_dot2_f32_bf16 v16, v36, s55, v16
    v_accvgpr_read_b32 v40, a106
    v_lshlrev_b32 v38, 16, v40
    v_and_b32 v39, s54, v40
    v_pk_mul_f32 v[38:39], v[38:39], v[32:33]
    v_cvt_pk_bf16_f32 v40, v38, v39
    v_dot2_f32_bf16 v20, v40, s55, v20
    v_lshlrev_b32 v32, 16, v115
    v_and_b32 v33, s54, v115
    v_accvgpr_read_b32 v36, a51
    v_lshlrev_b32 v34, 16, v36
    v_and_b32 v35, s54, v36
    v_pk_mul_f32 v[34:35], v[34:35], v[32:33]
    v_cvt_pk_bf16_f32 v36, v34, v35
    v_dot2_f32_bf16 v16, v36, s55, v16
    v_accvgpr_read_b32 v40, a107
    v_lshlrev_b32 v38, 16, v40
    v_and_b32 v39, s54, v40
    v_pk_mul_f32 v[38:39], v[38:39], v[32:33]
    v_cvt_pk_bf16_f32 v40, v38, v39
    v_dot2_f32_bf16 v20, v40, s55, v20
    v_lshlrev_b32 v32, 16, v116
    v_and_b32 v33, s54, v116
    v_accvgpr_read_b32 v36, a52
    v_lshlrev_b32 v34, 16, v36
    v_and_b32 v35, s54, v36
    v_pk_mul_f32 v[34:35], v[34:35], v[32:33]
    v_cvt_pk_bf16_f32 v36, v34, v35
    v_dot2_f32_bf16 v16, v36, s55, v16
    v_accvgpr_read_b32 v40, a108
    v_lshlrev_b32 v38, 16, v40
    v_and_b32 v39, s54, v40
    v_pk_mul_f32 v[38:39], v[38:39], v[32:33]
    v_cvt_pk_bf16_f32 v40, v38, v39
    v_dot2_f32_bf16 v20, v40, s55, v20
    v_lshlrev_b32 v32, 16, v117
    v_and_b32 v33, s54, v117
    v_accvgpr_read_b32 v36, a53
    v_lshlrev_b32 v34, 16, v36
    v_and_b32 v35, s54, v36
    v_pk_mul_f32 v[34:35], v[34:35], v[32:33]
    v_cvt_pk_bf16_f32 v36, v34, v35
    v_dot2_f32_bf16 v16, v36, s55, v16
    v_accvgpr_read_b32 v40, a109
    v_lshlrev_b32 v38, 16, v40
    v_and_b32 v39, s54, v40
    v_pk_mul_f32 v[38:39], v[38:39], v[32:33]
    v_cvt_pk_bf16_f32 v40, v38, v39
    v_dot2_f32_bf16 v20, v40, s55, v20
    v_lshlrev_b32 v32, 16, v118
    v_and_b32 v33, s54, v118
    v_accvgpr_read_b32 v36, a54
    v_lshlrev_b32 v34, 16, v36
    v_and_b32 v35, s54, v36
    v_pk_mul_f32 v[34:35], v[34:35], v[32:33]
    v_cvt_pk_bf16_f32 v36, v34, v35
    v_dot2_f32_bf16 v16, v36, s55, v16
    v_accvgpr_read_b32 v40, a110
    v_lshlrev_b32 v38, 16, v40
    v_and_b32 v39, s54, v40
    v_pk_mul_f32 v[38:39], v[38:39], v[32:33]
    v_cvt_pk_bf16_f32 v40, v38, v39
    v_dot2_f32_bf16 v20, v40, s55, v20
    v_lshlrev_b32 v32, 16, v119
    v_and_b32 v33, s54, v119
    v_accvgpr_read_b32 v36, a55
    v_lshlrev_b32 v34, 16, v36
    v_and_b32 v35, s54, v36
    v_pk_mul_f32 v[34:35], v[34:35], v[32:33]
    v_cvt_pk_bf16_f32 v36, v34, v35
    v_dot2_f32_bf16 v16, v36, s55, v16
    v_accvgpr_read_b32 v40, a111
    v_lshlrev_b32 v38, 16, v40
    v_and_b32 v39, s54, v40
    v_pk_mul_f32 v[38:39], v[38:39], v[32:33]
    v_cvt_pk_bf16_f32 v40, v38, v39
    v_dot2_f32_bf16 v20, v40, s55, v20
    v_mov_b32 v32, v16
    s_nop 1
    v_permlane16_swap_b32 v16, v32
    v_add_f32 v16, v16, v32
    v_mov_b32 v32, v16
    s_nop 1
    v_permlane32_swap_b32 v16, v32
    v_add_f32 v16, v16, v32
    v_mov_b32 v32, v20
    s_nop 1
    v_permlane16_swap_b32 v20, v32
    v_add_f32 v20, v20, v32
    v_mov_b32 v32, v20
    s_nop 1
    v_permlane32_swap_b32 v20, v32
    v_add_f32 v20, v20, v32
    v_cvt_pk_bf16_f32 v96, v16, v20
    v_lshlrev_b32 v120, 16, v96
    v_and_b32 v121, s54, v96
    v_pk_mul_f32 v[120:121], v[120:121], s[50:51] neg_lo:[1,0] neg_hi:[1,0]
    v_exp_f32 v120, v120
    v_exp_f32 v121, v121
    s_nop 0
    v_pk_add_f32 v[120:121], v[120:121], 1.0 op_sel_hi:[1,0]
    v_rcp_f32 v120, v120
    v_rcp_f32 v121, v121
    s_nop 0
    v_cvt_pk_bf16_f32 v96, v120, v121
    v_lshlrev_b32 v120, 16, v96
    v_and_b32 v121, s54, v96
    v_sub_f32 v96, 1.0, v120
    v_sub_f32 v97, 1.0, v121
    v_cvt_pk_bf16_f32 v96, v96, v97
    v_lshlrev_b32 v122, 16, v96
    v_and_b32 v123, s54, v96
    v_mov_b32 v96, 0x40000000
    v_cmp_gt_u32 vcc, 16, v0
    s_nop 1
    v_cndmask_b32 v8, v96, v6, vcc
    v_cmp_eq_u32 vcc, 0, v0
    s_nop 1
    v_cndmask_b32 v9, v96, 0, vcc
    s_lshl_b32 s43, s27, 7
    s_add_u32 s43, s43, 0x1340000
    buffer_store_dword v122, v8, s[4:7], s43 offen sc1
    buffer_store_dword v123, v8, s[4:7], s43 offen offset:64 sc1
    s_waitcnt vmcnt(57)
    v_mfma_f32_16x16x32_bf16 v[16:19], a[112:115], a[0:3], 0
    v_mfma_f32_16x16x32_bf16 v[20:23], a[112:115], a[56:59], 0
    buffer_load_dwordx4 a[112:115], v2, s[4:7], s41 offen offset:0 sc1
    s_waitcnt vmcnt(57)
    v_mfma_f32_16x16x32_bf16 v[16:19], a[116:119], a[4:7], v[16:19]
    v_mfma_f32_16x16x32_bf16 v[20:23], a[116:119], a[60:63], v[20:23]
    buffer_load_dwordx4 a[116:119], v2, s[4:7], s41 offen offset:1024 sc1
    s_waitcnt vmcnt(57)
    v_mfma_f32_16x16x32_bf16 v[16:19], a[120:123], a[8:11], v[16:19]
    v_mfma_f32_16x16x32_bf16 v[20:23], a[120:123], a[64:67], v[20:23]
    buffer_load_dwordx4 a[120:123], v2, s[4:7], s41 offen offset:2048 sc1
    s_waitcnt vmcnt(57)
    v_mfma_f32_16x16x32_bf16 v[16:19], a[124:127], a[12:15], v[16:19]
    v_mfma_f32_16x16x32_bf16 v[20:23], a[124:127], a[68:71], v[20:23]
    buffer_load_dwordx4 a[124:127], v2, s[4:7], s41 offen offset:3072 sc1
    s_add_u32 s41, s41, 4096
    s_waitcnt vmcnt(57)
    v_mfma_f32_16x16x32_bf16 v[16:19], a[128:131], a[16:19], v[16:19]
    v_mfma_f32_16x16x32_bf16 v[20:23], a[128:131], a[72:75], v[20:23]
    buffer_load_dwordx4 a[128:131], v2, s[4:7], s41 offen offset:0 sc1
    s_waitcnt vmcnt(57)
    v_mfma_f32_16x16x32_bf16 v[16:19], a[132:135], a[20:23], v[16:19]
    v_mfma_f32_16x16x32_bf16 v[20:23], a[132:135], a[76:79], v[20:23]
    buffer_load_dwordx4 a[132:135], v2, s[4:7], s41 offen offset:1024 sc1
    s_waitcnt vmcnt(57)
    v_mfma_f32_16x16x32_bf16 v[16:19], a[136:139], a[24:27], v[16:19]
    v_mfma_f32_16x16x32_bf16 v[20:23], a[136:139], a[80:83], v[20:23]
    buffer_load_dwordx4 a[136:139], v2, s[4:7], s41 offen offset:2048 sc1
    s_waitcnt vmcnt(57)
    v_mfma_f32_16x16x32_bf16 v[16:19], a[140:143], a[28:31], v[16:19]
    v_mfma_f32_16x16x32_bf16 v[20:23], a[140:143], a[84:87], v[20:23]
    buffer_load_dwordx4 a[140:143], v2, s[4:7], s41 offen offset:3072 sc1
    s_add_u32 s41, s41, 4096
    s_waitcnt vmcnt(57)
    v_mfma_f32_16x16x32_bf16 v[16:19], a[144:147], a[32:35], v[16:19]
    v_mfma_f32_16x16x32_bf16 v[20:23], a[144:147], a[88:91], v[20:23]
    buffer_load_dwordx4 a[144:147], v2, s[4:7], s41 offen offset:0 sc1
    s_waitcnt vmcnt(57)
    v_mfma_f32_16x16x32_bf16 v[16:19], a[148:151], a[36:39], v[16:19]
    v_mfma_f32_16x16x32_bf16 v[20:23], a[148:151], a[92:95], v[20:23]
    buffer_load_dwordx4 a[148:151], v2, s[4:7], s41 offen offset:1024 sc1
    s_waitcnt vmcnt(57)
    v_mfma_f32_16x16x32_bf16 v[16:19], a[152:155], a[40:43], v[16:19]
    v_mfma_f32_16x16x32_bf16 v[20:23], a[152:155], a[96:99], v[20:23]
    buffer_load_dwordx4 a[152:155], v2, s[4:7], s41 offen offset:2048 sc1
    s_waitcnt vmcnt(57)
    v_mfma_f32_16x16x32_bf16 v[16:19], a[156:159], a[44:47], v[16:19]
    v_mfma_f32_16x16x32_bf16 v[20:23], a[156:159], a[100:103], v[20:23]
    buffer_load_dwordx4 a[156:159], v2, s[4:7], s41 offen offset:3072 sc1
    s_add_u32 s41, s41, 4096
    s_waitcnt vmcnt(57)
    v_mfma_f32_16x16x32_bf16 v[16:19], a[160:163], a[48:51], v[16:19]
    v_mfma_f32_16x16x32_bf16 v[20:23], a[160:163], a[104:107], v[20:23]
    buffer_load_dwordx4 a[160:163], v2, s[4:7], s41 offen offset:0 sc1
    s_waitcnt vmcnt(57)
    v_mfma_f32_16x16x32_bf16 v[16:19], a[164:167], a[52:55], v[16:19]
    v_mfma_f32_16x16x32_bf16 v[20:23], a[164:167], a[108:111], v[20:23]
    buffer_load_dwordx4 a[164:167], v2, s[4:7], s41 offen offset:1024 sc1
    s_waitcnt vmcnt(57)
    v_mfma_f32_16x16x32_bf16 v[24:27], a[168:171], a[0:3], 0
    v_mfma_f32_16x16x32_bf16 v[28:31], a[168:171], a[56:59], 0
    buffer_load_dwordx4 a[168:171], v2, s[4:7], s41 offen offset:2048 sc1
    s_waitcnt vmcnt(57)
    v_mfma_f32_16x16x32_bf16 v[24:27], a[172:175], a[4:7], v[24:27]
    v_mfma_f32_16x16x32_bf16 v[28:31], a[172:175], a[60:63], v[28:31]
    buffer_load_dwordx4 a[172:175], v2, s[4:7], s41 offen offset:3072 sc1
    s_add_u32 s41, s41, 4096
    s_waitcnt vmcnt(57)
    v_mfma_f32_16x16x32_bf16 v[24:27], a[176:179], a[8:11], v[24:27]
    v_mfma_f32_16x16x32_bf16 v[28:31], a[176:179], a[64:67], v[28:31]
    buffer_load_dwordx4 a[176:179], v2, s[4:7], s41 offen offset:0 sc1
    s_waitcnt vmcnt(57)
    v_mfma_f32_16x16x32_bf16 v[24:27], a[180:183], a[12:15], v[24:27]
    v_mfma_f32_16x16x32_bf16 v[28:31], a[180:183], a[68:71], v[28:31]
    buffer_load_dwordx4 a[180:183], v2, s[4:7], s41 offen offset:1024 sc1
    s_waitcnt vmcnt(57)
    v_mfma_f32_16x16x32_bf16 v[24:27], a[184:187], a[16:19], v[24:27]
    v_mfma_f32_16x16x32_bf16 v[28:31], a[184:187], a[72:75], v[28:31]
    buffer_load_dwordx4 a[184:187], v2, s[4:7], s41 offen offset:2048 sc1
    s_waitcnt vmcnt(57)
    v_mfma_f32_16x16x32_bf16 v[24:27], a[188:191], a[20:23], v[24:27]
    v_mfma_f32_16x16x32_bf16 v[28:31], a[188:191], a[76:79], v[28:31]
    buffer_load_dwordx4 a[188:191], v2, s[4:7], s41 offen offset:3072 sc1
    s_add_u32 s41, s41, 4096
    s_waitcnt vmcnt(57)
    v_mfma_f32_16x16x32_bf16 v[24:27], a[192:195], a[24:27], v[24:27]
    v_mfma_f32_16x16x32_bf16 v[28:31], a[192:195], a[80:83], v[28:31]
    buffer_load_dwordx4 a[192:195], v2, s[4:7], s41 offen offset:0 sc1
    s_waitcnt vmcnt(57)
    v_mfma_f32_16x16x32_bf16 v[24:27], a[196:199], a[28:31], v[24:27]
    v_mfma_f32_16x16x32_bf16 v[28:31], a[196:199], a[84:87], v[28:31]
    buffer_load_dwordx4 a[196:199], v2, s[4:7], s41 offen offset:1024 sc1
    s_waitcnt vmcnt(57)
    v_mfma_f32_16x16x32_bf16 v[24:27], a[200:203], a[32:35], v[24:27]
    v_mfma_f32_16x16x32_bf16 v[28:31], a[200:203], a[88:91], v[28:31]
    buffer_load_dwordx4 a[200:203], v2, s[4:7], s41 offen offset:2048 sc1
    s_waitcnt vmcnt(57)
    v_mfma_f32_16x16x32_bf16 v[24:27], a[204:207], a[36:39], v[24:27]
    v_mfma_f32_16x16x32_bf16 v[28:31], a[204:207], a[92:95], v[28:31]
    buffer_load_dwordx4 a[204:207], v2, s[4:7], s41 offen offset:3072 sc1
    s_add_u32 s41, s41, 4096
    s_waitcnt vmcnt(57)
    v_mfma_f32_16x16x32_bf16 v[24:27], a[208:211], a[40:43], v[24:27]
    v_mfma_f32_16x16x32_bf16 v[28:31], a[208:211], a[96:99], v[28:31]
    buffer_load_dwordx4 a[208:211], v2, s[4:7], s41 offen offset:0 sc1
    s_waitcnt vmcnt(57)
    v_mfma_f32_16x16x32_bf16 v[24:27], a[212:215], a[44:47], v[24:27]
    v_mfma_f32_16x16x32_bf16 v[28:31], a[212:215], a[100:103], v[28:31]
    buffer_load_dwordx4 a[212:215], v2, s[4:7], s41 offen offset:1024 sc1
    s_waitcnt vmcnt(57)
    v_mfma_f32_16x16x32_bf16 v[24:27], a[216:219], a[48:51], v[24:27]
    v_mfma_f32_16x16x32_bf16 v[28:31], a[216:219], a[104:107], v[28:31]
    buffer_load_dwordx4 a[216:219], v2, s[4:7], s41 offen offset:2048 sc1
    s_waitcnt vmcnt(57)
    v_mfma_f32_16x16x32_bf16 v[24:27], a[220:223], a[52:55], v[24:27]
    v_mfma_f32_16x16x32_bf16 v[28:31], a[220:223], a[108:111], v[28:31]
    buffer_load_dwordx4 a[220:223], v2, s[4:7], s41 offen offset:3072 sc1
    s_add_u32 s41, s41, 4096
    v_cvt_pk_bf16_f32 v96, v16, v17
    v_lshlrev_b32 v98, 16, v96
    v_and_b32 v99, s54, v96
    v_pk_mul_f32 v[100:101], v[98:99], s[50:51]
    v_max_f32 v98, 0, v98
    v_min_f32 v100, 0, v100
    v_min_f32 v101, 0, v101
    v_exp_f32 v100, v100
    v_exp_f32 v101, v101
    v_max_f32 v99, 0, v99
    v_pk_add_f32 v[98:99], v[98:99], v[100:101]
    v_cvt_pk_bf16_f32 v96, v98, v99
    v_lshlrev_b32 v98, 16, v96
    v_and_b32 v99, s54, v96
    v_pk_add_f32 v[98:99], v[98:99], s[52:53]
    v_cvt_pk_bf16_f32 v64, v98, v99
    v_cvt_pk_bf16_f32 v96, v18, v19
    v_lshlrev_b32 v98, 16, v96
    v_and_b32 v99, s54, v96
    v_pk_mul_f32 v[100:101], v[98:99], s[50:51]
    v_max_f32 v98, 0, v98
    v_min_f32 v100, 0, v100
    v_min_f32 v101, 0, v101
    v_exp_f32 v100, v100
    v_exp_f32 v101, v101
    v_max_f32 v99, 0, v99
    v_pk_add_f32 v[98:99], v[98:99], v[100:101]
    v_cvt_pk_bf16_f32 v96, v98, v99
    v_lshlrev_b32 v98, 16, v96
    v_and_b32 v99, s54, v96
    v_pk_add_f32 v[98:99], v[98:99], s[52:53]
    v_cvt_pk_bf16_f32 v65, v98, v99
    v_cvt_pk_bf16_f32 v96, v20, v21
    v_lshlrev_b32 v98, 16, v96
    v_and_b32 v99, s54, v96
    v_pk_mul_f32 v[100:101], v[98:99], s[50:51]
    v_max_f32 v98, 0, v98
    v_min_f32 v100, 0, v100
    v_min_f32 v101, 0, v101
    v_exp_f32 v100, v100
    v_exp_f32 v101, v101
    v_max_f32 v99, 0, v99
    v_pk_add_f32 v[98:99], v[98:99], v[100:101]
    v_cvt_pk_bf16_f32 v96, v98, v99
    v_lshlrev_b32 v98, 16, v96
    v_and_b32 v99, s54, v96
    v_pk_add_f32 v[98:99], v[98:99], s[52:53]
    v_cvt_pk_bf16_f32 v68, v98, v99
    v_cvt_pk_bf16_f32 v96, v22, v23
    v_lshlrev_b32 v98, 16, v96
    v_and_b32 v99, s54, v96
    v_pk_mul_f32 v[100:101], v[98:99], s[50:51]
    v_max_f32 v98, 0, v98
    v_min_f32 v100, 0, v100
    v_min_f32 v101, 0, v101
    v_exp_f32 v100, v100
    v_exp_f32 v101, v101
    v_max_f32 v99, 0, v99
    v_pk_add_f32 v[98:99], v[98:99], v[100:101]
    v_cvt_pk_bf16_f32 v96, v98, v99
    v_lshlrev_b32 v98, 16, v96
    v_and_b32 v99, s54, v96
    v_pk_add_f32 v[98:99], v[98:99], s[52:53]
    v_cvt_pk_bf16_f32 v69, v98, v99
    v_cvt_pk_bf16_f32 v96, v24, v25
    v_lshlrev_b32 v98, 16, v96
    v_and_b32 v99, s54, v96
    v_pk_mul_f32 v[100:101], v[98:99], s[50:51]
    v_max_f32 v98, 0, v98
    v_min_f32 v100, 0, v100
    v_min_f32 v101, 0, v101
    v_exp_f32 v100, v100
    v_exp_f32 v101, v101
    v_max_f32 v99, 0, v99
    v_pk_add_f32 v[98:99], v[98:99], v[100:101]
    v_cvt_pk_bf16_f32 v96, v98, v99
    v_lshlrev_b32 v98, 16, v96
    v_and_b32 v99, s54, v96
    v_pk_add_f32 v[98:99], v[98:99], s[52:53]
    v_cvt_pk_bf16_f32 v66, v98, v99
    v_cvt_pk_bf16_f32 v96, v26, v27
    v_lshlrev_b32 v98, 16, v96
    v_and_b32 v99, s54, v96
    v_pk_mul_f32 v[100:101], v[98:99], s[50:51]
    v_max_f32 v98, 0, v98
    v_min_f32 v100, 0, v100
    v_min_f32 v101, 0, v101
    v_exp_f32 v100, v100
    v_exp_f32 v101, v101
    v_max_f32 v99, 0, v99
    v_pk_add_f32 v[98:99], v[98:99], v[100:101]
    v_cvt_pk_bf16_f32 v96, v98, v99
    v_lshlrev_b32 v98, 16, v96
    v_and_b32 v99, s54, v96
    v_pk_add_f32 v[98:99], v[98:99], s[52:53]
    v_cvt_pk_bf16_f32 v67, v98, v99
    v_cvt_pk_bf16_f32 v96, v28, v29
    v_lshlrev_b32 v98, 16, v96
    v_and_b32 v99, s54, v96
    v_pk_mul_f32 v[100:101], v[98:99], s[50:51]
    v_max_f32 v98, 0, v98
    v_min_f32 v100, 0, v100
    v_min_f32 v101, 0, v101
    v_exp_f32 v100, v100
    v_exp_f32 v101, v101
    v_max_f32 v99, 0, v99
    v_pk_add_f32 v[98:99], v[98:99], v[100:101]
    v_cvt_pk_bf16_f32 v96, v98, v99
    v_lshlrev_b32 v98, 16, v96
    v_and_b32 v99, s54, v96
    v_pk_add_f32 v[98:99], v[98:99], s[52:53]
    v_cvt_pk_bf16_f32 v70, v98, v99
    v_cvt_pk_bf16_f32 v96, v30, v31
    v_lshlrev_b32 v98, 16, v96
    v_and_b32 v99, s54, v96
    v_pk_mul_f32 v[100:101], v[98:99], s[50:51]
    v_max_f32 v98, 0, v98
    v_min_f32 v100, 0, v100
    v_min_f32 v101, 0, v101
    v_exp_f32 v100, v100
    v_exp_f32 v101, v101
    v_max_f32 v99, 0, v99
    v_pk_add_f32 v[98:99], v[98:99], v[100:101]
    v_cvt_pk_bf16_f32 v96, v98, v99
    v_lshlrev_b32 v98, 16, v96
    v_and_b32 v99, s54, v96
    v_pk_add_f32 v[98:99], v[98:99], s[52:53]
    v_cvt_pk_bf16_f32 v71, v98, v99
    s_waitcnt vmcnt(57)
    v_mfma_f32_16x16x32_bf16 v[16:19], a[0:3], v[128:131], 0
    v_mfma_f32_16x16x32_bf16 v[20:23], a[56:59], v[128:131], 0
    buffer_load_dwordx4 v[128:131], v2, s[4:7], s41 offen offset:0 sc1
    s_waitcnt vmcnt(57)
    v_mfma_f32_16x16x32_bf16 v[16:19], a[4:7], v[132:135], v[16:19]
    v_mfma_f32_16x16x32_bf16 v[20:23], a[60:63], v[132:135], v[20:23]
    buffer_load_dwordx4 v[132:135], v2, s[4:7], s41 offen offset:1024 sc1
    s_waitcnt vmcnt(57)
    v_mfma_f32_16x16x32_bf16 v[16:19], a[8:11], v[136:139], v[16:19]
    v_mfma_f32_16x16x32_bf16 v[20:23], a[64:67], v[136:139], v[20:23]
    buffer_load_dwordx4 v[136:139], v2, s[4:7], s41 offen offset:2048 sc1
    s_waitcnt vmcnt(57)
    v_mfma_f32_16x16x32_bf16 v[16:19], a[12:15], v[140:143], v[16:19]
    v_mfma_f32_16x16x32_bf16 v[20:23], a[68:71], v[140:143], v[20:23]
    buffer_load_dwordx4 v[140:143], v2, s[4:7], s41 offen offset:3072 sc1
    s_add_u32 s41, s41, 4096
    s_waitcnt vmcnt(57)
    v_mfma_f32_16x16x32_bf16 v[16:19], a[16:19], v[144:147], v[16:19]
    v_mfma_f32_16x16x32_bf16 v[20:23], a[72:75], v[144:147], v[20:23]
    buffer_load_dwordx4 v[144:147], v2, s[4:7], s41 offen offset:0 sc1
    s_waitcnt vmcnt(57)
    v_mfma_f32_16x16x32_bf16 v[16:19], a[20:23], v[148:151], v[16:19]
    v_mfma_f32_16x16x32_bf16 v[20:23], a[76:79], v[148:151], v[20:23]
    buffer_load_dwordx4 v[148:151], v2, s[4:7], s41 offen offset:1024 sc1
    s_waitcnt vmcnt(57)
    v_mfma_f32_16x16x32_bf16 v[16:19], a[24:27], v[152:155], v[16:19]
    v_mfma_f32_16x16x32_bf16 v[20:23], a[80:83], v[152:155], v[20:23]
    buffer_load_dwordx4 v[152:155], v2, s[4:7], s41 offen offset:2048 sc1
    s_waitcnt vmcnt(57)
    v_mfma_f32_16x16x32_bf16 v[16:19], a[28:31], v[156:159], v[16:19]
    v_mfma_f32_16x16x32_bf16 v[20:23], a[84:87], v[156:159], v[20:23]
    buffer_load_dwordx4 v[156:159], v2, s[4:7], s41 offen offset:3072 sc1
    s_add_u32 s41, s41, 4096
    s_waitcnt vmcnt(57)
    v_mfma_f32_16x16x32_bf16 v[16:19], a[32:35], v[160:163], v[16:19]
    v_mfma_f32_16x16x32_bf16 v[20:23], a[88:91], v[160:163], v[20:23]
    buffer_load_dwordx4 v[160:163], v2, s[4:7], s41 offen offset:0 sc1
    s_waitcnt vmcnt(57)
    v_mfma_f32_16x16x32_bf16 v[16:19], a[36:39], v[164:167], v[16:19]
    v_mfma_f32_16x16x32_bf16 v[20:23], a[92:95], v[164:167], v[20:23]
    buffer_load_dwordx4 v[164:167], v2, s[4:7], s41 offen offset:1024 sc1
    s_waitcnt vmcnt(57)
    v_mfma_f32_16x16x32_bf16 v[16:19], a[40:43], v[168:171], v[16:19]
    v_mfma_f32_16x16x32_bf16 v[20:23], a[96:99], v[168:171], v[20:23]
    buffer_load_dwordx4 v[168:171], v2, s[4:7], s41 offen offset:2048 sc1
    s_waitcnt vmcnt(57)
    v_mfma_f32_16x16x32_bf16 v[16:19], a[44:47], v[172:175], v[16:19]
    v_mfma_f32_16x16x32_bf16 v[20:23], a[100:103], v[172:175], v[20:23]
    buffer_load_dwordx4 v[172:175], v2, s[4:7], s41 offen offset:3072 sc1
    s_add_u32 s41, s41, 4096
    s_waitcnt vmcnt(57)
    v_mfma_f32_16x16x32_bf16 v[16:19], a[48:51], v[176:179], v[16:19]
    v_mfma_f32_16x16x32_bf16 v[20:23], a[104:107], v[176:179], v[20:23]
    buffer_load_dwordx4 v[176:179], v2, s[4:7], s41 offen offset:0 sc1
    s_waitcnt vmcnt(57)
    v_mfma_f32_16x16x32_bf16 v[16:19], a[52:55], v[180:183], v[16:19]
    v_mfma_f32_16x16x32_bf16 v[20:23], a[108:111], v[180:183], v[20:23]
    buffer_load_dwordx4 v[180:183], v2, s[4:7], s41 offen offset:1024 sc1
    s_waitcnt vmcnt(57)
    v_mfma_f32_16x16x32_bf16 v[24:27], a[0:3], v[184:187], 0
    v_mfma_f32_16x16x32_bf16 v[28:31], a[56:59], v[184:187], 0
    buffer_load_dwordx4 v[184:187], v2, s[4:7], s41 offen offset:2048 sc1
    s_waitcnt vmcnt(57)
    v_mfma_f32_16x16x32_bf16 v[24:27], a[4:7], v[188:191], v[24:27]
    v_mfma_f32_16x16x32_bf16 v[28:31], a[60:63], v[188:191], v[28:31]
    buffer_load_dwordx4 v[188:191], v2, s[4:7], s41 offen offset:3072 sc1
    s_add_u32 s41, s41, 4096
    s_waitcnt vmcnt(57)
    v_mfma_f32_16x16x32_bf16 v[24:27], a[8:11], v[192:195], v[24:27]
    v_mfma_f32_16x16x32_bf16 v[28:31], a[64:67], v[192:195], v[28:31]
    buffer_load_dwordx4 v[192:195], v2, s[4:7], s41 offen offset:0 sc1
    s_waitcnt vmcnt(57)
    v_mfma_f32_16x16x32_bf16 v[24:27], a[12:15], v[196:199], v[24:27]
    v_mfma_f32_16x16x32_bf16 v[28:31], a[68:71], v[196:199], v[28:31]
    buffer_load_dwordx4 v[196:199], v2, s[4:7], s41 offen offset:1024 sc1
    s_waitcnt vmcnt(57)
    v_mfma_f32_16x16x32_bf16 v[24:27], a[16:19], v[200:203], v[24:27]
    v_mfma_f32_16x16x32_bf16 v[28:31], a[72:75], v[200:203], v[28:31]
    buffer_load_dwordx4 v[200:203], v2, s[4:7], s41 offen offset:2048 sc1
    s_waitcnt vmcnt(57)
    v_mfma_f32_16x16x32_bf16 v[24:27], a[20:23], v[204:207], v[24:27]
    v_mfma_f32_16x16x32_bf16 v[28:31], a[76:79], v[204:207], v[28:31]
    buffer_load_dwordx4 v[204:207], v2, s[4:7], s41 offen offset:3072 sc1
    s_add_u32 s41, s41, 4096
    s_waitcnt vmcnt(57)
    v_mfma_f32_16x16x32_bf16 v[24:27], a[24:27], v[208:211], v[24:27]
    v_mfma_f32_16x16x32_bf16 v[28:31], a[80:83], v[208:211], v[28:31]
    buffer_load_dwordx4 v[208:211], v2, s[4:7], s41 offen offset:0 sc1
    s_waitcnt vmcnt(57)
    v_mfma_f32_16x16x32_bf16 v[24:27], a[28:31], v[212:215], v[24:27]
    v_mfma_f32_16x16x32_bf16 v[28:31], a[84:87], v[212:215], v[28:31]
    buffer_load_dwordx4 v[212:215], v2, s[4:7], s41 offen offset:1024 sc1
    s_waitcnt vmcnt(57)
    v_mfma_f32_16x16x32_bf16 v[24:27], a[32:35], v[216:219], v[24:27]
    v_mfma_f32_16x16x32_bf16 v[28:31], a[88:91], v[216:219], v[28:31]
    buffer_load_dwordx4 v[216:219], v2, s[4:7], s41 offen offset:2048 sc1
    s_waitcnt vmcnt(57)
    v_mfma_f32_16x16x32_bf16 v[24:27], a[36:39], v[220:223], v[24:27]
    v_mfma_f32_16x16x32_bf16 v[28:31], a[92:95], v[220:223], v[28:31]
    buffer_load_dwordx4 v[220:223], v2, s[4:7], s41 offen offset:3072 sc1
    s_add_u32 s41, s41, 4096
    s_waitcnt vmcnt(57)
    v_mfma_f32_16x16x32_bf16 v[24:27], a[40:43], v[224:227], v[24:27]
    v_mfma_f32_16x16x32_bf16 v[28:31], a[96:99], v[224:227], v[28:31]
    buffer_load_dwordx4 v[224:227], v2, s[4:7], s41 offen offset:0 sc1
    s_waitcnt vmcnt(57)
    v_mfma_f32_16x16x32_bf16 v[24:27], a[44:47], v[228:231], v[24:27]
    v_mfma_f32_16x16x32_bf16 v[28:31], a[100:103], v[228:231], v[28:31]
    buffer_load_dwordx4 v[228:231], v2, s[4:7], s41 offen offset:1024 sc1
    s_waitcnt vmcnt(57)
    v_mfma_f32_16x16x32_bf16 v[24:27], a[48:51], v[232:235], v[24:27]
    v_mfma_f32_16x16x32_bf16 v[28:31], a[104:107], v[232:235], v[28:31]
    buffer_load_dwordx4 v[232:235], v2, s[4:7], s41 offen offset:2048 sc1
    s_waitcnt vmcnt(57)
    v_mfma_f32_16x16x32_bf16 v[24:27], a[52:55], v[236:239], v[24:27]
    v_mfma_f32_16x16x32_bf16 v[28:31], a[108:111], v[236:239], v[28:31]
    buffer_load_dwordx4 v[236:239], v2, s[4:7], s41 offen offset:3072 sc1
    s_add_u32 s41, s41, 4096
    v_cvt_pk_bf16_f32 v96, v16, v17
    v_lshlrev_b32 v98, 16, v96
    v_and_b32 v99, s54, v96
    v_pk_mul_f32 v[100:101], v[98:99], s[50:51]
    v_max_f32 v98, 0, v98
    v_min_f32 v100, 0, v100
    v_min_f32 v101, 0, v101
    v_exp_f32 v100, v100
    v_exp_f32 v101, v101
    v_max_f32 v99, 0, v99
    v_pk_add_f32 v[98:99], v[98:99], v[100:101]
    v_cvt_pk_bf16_f32 v96, v98, v99
    v_lshlrev_b32 v98, 16, v96
    v_and_b32 v99, s54, v96
    v_pk_add_f32 v[98:99], v[98:99], s[52:53]
    v_cvt_pk_bf16_f32 v32, v98, v99
    v_cvt_pk_bf16_f32 v96, v18, v19
    v_lshlrev_b32 v98, 16, v96
    v_and_b32 v99, s54, v96
    v_pk_mul_f32 v[100:101], v[98:99], s[50:51]
    v_max_f32 v98, 0, v98
    v_min_f32 v100, 0, v100
    v_min_f32 v101, 0, v101
    v_exp_f32 v100, v100
    v_exp_f32 v101, v101
    v_max_f32 v99, 0, v99
    v_pk_add_f32 v[98:99], v[98:99], v[100:101]
    v_cvt_pk_bf16_f32 v96, v98, v99
    v_lshlrev_b32 v98, 16, v96
    v_and_b32 v99, s54, v96
    v_pk_add_f32 v[98:99], v[98:99], s[52:53]
    v_cvt_pk_bf16_f32 v33, v98, v99
    v_cvt_pk_bf16_f32 v96, v20, v21
    v_lshlrev_b32 v98, 16, v96
    v_and_b32 v99, s54, v96
    v_pk_mul_f32 v[100:101], v[98:99], s[50:51]
    v_max_f32 v98, 0, v98
    v_min_f32 v100, 0, v100
    v_min_f32 v101, 0, v101
    v_exp_f32 v100, v100
    v_exp_f32 v101, v101
    v_max_f32 v99, 0, v99
    v_pk_add_f32 v[98:99], v[98:99], v[100:101]
    v_cvt_pk_bf16_f32 v96, v98, v99
    v_lshlrev_b32 v98, 16, v96
    v_and_b32 v99, s54, v96
    v_pk_add_f32 v[98:99], v[98:99], s[52:53]
    v_cvt_pk_bf16_f32 v34, v98, v99
    v_cvt_pk_bf16_f32 v96, v22, v23
    v_lshlrev_b32 v98, 16, v96
    v_and_b32 v99, s54, v96
    v_pk_mul_f32 v[100:101], v[98:99], s[50:51]
    v_max_f32 v98, 0, v98
    v_min_f32 v100, 0, v100
    v_min_f32 v101, 0, v101
    v_exp_f32 v100, v100
    v_exp_f32 v101, v101
    v_max_f32 v99, 0, v99
    v_pk_add_f32 v[98:99], v[98:99], v[100:101]
    v_cvt_pk_bf16_f32 v96, v98, v99
    v_lshlrev_b32 v98, 16, v96
    v_and_b32 v99, s54, v96
    v_pk_add_f32 v[98:99], v[98:99], s[52:53]
    v_cvt_pk_bf16_f32 v35, v98, v99
    v_cvt_pk_bf16_f32 v96, v24, v25
    v_lshlrev_b32 v98, 16, v96
    v_and_b32 v99, s54, v96
    v_pk_mul_f32 v[100:101], v[98:99], s[50:51]
    v_max_f32 v98, 0, v98
    v_min_f32 v100, 0, v100
    v_min_f32 v101, 0, v101
    v_exp_f32 v100, v100
    v_exp_f32 v101, v101
    v_max_f32 v99, 0, v99
    v_pk_add_f32 v[98:99], v[98:99], v[100:101]
    v_cvt_pk_bf16_f32 v96, v98, v99
    v_lshlrev_b32 v98, 16, v96
    v_and_b32 v99, s54, v96
    v_pk_add_f32 v[98:99], v[98:99], s[52:53]
    v_cvt_pk_bf16_f32 v36, v98, v99
    v_cvt_pk_bf16_f32 v96, v26, v27
    v_lshlrev_b32 v98, 16, v96
    v_and_b32 v99, s54, v96
    v_pk_mul_f32 v[100:101], v[98:99], s[50:51]
    v_max_f32 v98, 0, v98
    v_min_f32 v100, 0, v100
    v_min_f32 v101, 0, v101
    v_exp_f32 v100, v100
    v_exp_f32 v101, v101
    v_max_f32 v99, 0, v99
    v_pk_add_f32 v[98:99], v[98:99], v[100:101]
    v_cvt_pk_bf16_f32 v96, v98, v99
    v_lshlrev_b32 v98, 16, v96
    v_and_b32 v99, s54, v96
    v_pk_add_f32 v[98:99], v[98:99], s[52:53]
    v_cvt_pk_bf16_f32 v37, v98, v99
    v_cvt_pk_bf16_f32 v96, v28, v29
    v_lshlrev_b32 v98, 16, v96
    v_and_b32 v99, s54, v96
    v_pk_mul_f32 v[100:101], v[98:99], s[50:51]
    v_max_f32 v98, 0, v98
    v_min_f32 v100, 0, v100
    v_min_f32 v101, 0, v101
    v_exp_f32 v100, v100
    v_exp_f32 v101, v101
    v_max_f32 v99, 0, v99
    v_pk_add_f32 v[98:99], v[98:99], v[100:101]
    v_cvt_pk_bf16_f32 v96, v98, v99
    v_lshlrev_b32 v98, 16, v96
    v_and_b32 v99, s54, v96
    v_pk_add_f32 v[98:99], v[98:99], s[52:53]
    v_cvt_pk_bf16_f32 v38, v98, v99
    v_cvt_pk_bf16_f32 v96, v30, v31
    v_lshlrev_b32 v98, 16, v96
    v_and_b32 v99, s54, v96
    v_pk_mul_f32 v[100:101], v[98:99], s[50:51]
    v_max_f32 v98, 0, v98
    v_min_f32 v100, 0, v100
    v_min_f32 v101, 0, v101
    v_exp_f32 v100, v100
    v_exp_f32 v101, v101
    v_max_f32 v99, 0, v99
    v_pk_add_f32 v[98:99], v[98:99], v[100:101]
    v_cvt_pk_bf16_f32 v96, v98, v99
    v_lshlrev_b32 v98, 16, v96
    v_and_b32 v99, s54, v96
    v_pk_add_f32 v[98:99], v[98:99], s[52:53]
    v_cvt_pk_bf16_f32 v39, v98, v99
    s_waitcnt vmcnt(55)
    v_mfma_f32_16x16x32_bf16 v[16:19], a[0:3], a[112:115], 0
    v_mfma_f32_16x16x32_bf16 v[20:23], a[56:59], a[112:115], 0
    buffer_load_dwordx4 a[112:115], v2, s[4:7], s41 offen offset:0 sc1
    s_waitcnt vmcnt(55)
    v_mfma_f32_16x16x32_bf16 v[16:19], a[4:7], a[116:119], v[16:19]
    v_mfma_f32_16x16x32_bf16 v[20:23], a[60:63], a[116:119], v[20:23]
    buffer_load_dwordx4 a[116:119], v2, s[4:7], s41 offen offset:1024 sc1
    s_waitcnt vmcnt(55)
    v_mfma_f32_16x16x32_bf16 v[16:19], a[8:11], a[120:123], v[16:19]
    v_mfma_f32_16x16x32_bf16 v[20:23], a[64:67], a[120:123], v[20:23]
    buffer_load_dwordx4 a[120:123], v2, s[4:7], s41 offen offset:2048 sc1
    s_waitcnt vmcnt(55)
    v_mfma_f32_16x16x32_bf16 v[16:19], a[12:15], a[124:127], v[16:19]
    v_mfma_f32_16x16x32_bf16 v[20:23], a[68:71], a[124:127], v[20:23]
    buffer_load_dwordx4 a[124:127], v2, s[4:7], s41 offen offset:3072 sc1
    s_add_u32 s41, s41, 4096
    s_waitcnt vmcnt(55)
    v_mfma_f32_16x16x32_bf16 v[16:19], a[16:19], a[128:131], v[16:19]
    v_mfma_f32_16x16x32_bf16 v[20:23], a[72:75], a[128:131], v[20:23]
    buffer_load_dwordx4 a[128:131], v2, s[4:7], s41 offen offset:0 sc1
    s_waitcnt vmcnt(55)
    v_mfma_f32_16x16x32_bf16 v[16:19], a[20:23], a[132:135], v[16:19]
    v_mfma_f32_16x16x32_bf16 v[20:23], a[76:79], a[132:135], v[20:23]
    buffer_load_dwordx4 a[132:135], v2, s[4:7], s41 offen offset:1024 sc1
    s_waitcnt vmcnt(55)
    v_mfma_f32_16x16x32_bf16 v[16:19], a[24:27], a[136:139], v[16:19]
    v_mfma_f32_16x16x32_bf16 v[20:23], a[80:83], a[136:139], v[20:23]
    buffer_load_dwordx4 a[136:139], v2, s[4:7], s41 offen offset:2048 sc1
    s_waitcnt vmcnt(55)
    v_mfma_f32_16x16x32_bf16 v[16:19], a[28:31], a[140:143], v[16:19]
    v_mfma_f32_16x16x32_bf16 v[20:23], a[84:87], a[140:143], v[20:23]
    buffer_load_dwordx4 a[140:143], v2, s[4:7], s41 offen offset:3072 sc1
    s_add_u32 s41, s41, 4096
    s_waitcnt vmcnt(55)
    v_mfma_f32_16x16x32_bf16 v[16:19], a[32:35], a[144:147], v[16:19]
    v_mfma_f32_16x16x32_bf16 v[20:23], a[88:91], a[144:147], v[20:23]
    buffer_load_dwordx4 a[144:147], v2, s[4:7], s41 offen offset:0 sc1
    s_waitcnt vmcnt(55)
    v_mfma_f32_16x16x32_bf16 v[16:19], a[36:39], a[148:151], v[16:19]
    v_mfma_f32_16x16x32_bf16 v[20:23], a[92:95], a[148:151], v[20:23]
    buffer_load_dwordx4 a[148:151], v2, s[4:7], s41 offen offset:1024 sc1
    s_waitcnt vmcnt(55)
    v_mfma_f32_16x16x32_bf16 v[16:19], a[40:43], a[152:155], v[16:19]
    v_mfma_f32_16x16x32_bf16 v[20:23], a[96:99], a[152:155], v[20:23]
    buffer_load_dwordx4 a[152:155], v2, s[4:7], s41 offen offset:2048 sc1
    s_waitcnt vmcnt(55)
    v_mfma_f32_16x16x32_bf16 v[16:19], a[44:47], a[156:159], v[16:19]
    v_mfma_f32_16x16x32_bf16 v[20:23], a[100:103], a[156:159], v[20:23]
    buffer_load_dwordx4 a[156:159], v2, s[4:7], s41 offen offset:3072 sc1
    s_add_u32 s41, s41, 4096
    s_waitcnt vmcnt(55)
    v_mfma_f32_16x16x32_bf16 v[16:19], a[48:51], a[160:163], v[16:19]
    v_mfma_f32_16x16x32_bf16 v[20:23], a[104:107], a[160:163], v[20:23]
    buffer_load_dwordx4 a[160:163], v2, s[4:7], s41 offen offset:0 sc1
    s_waitcnt vmcnt(55)
    v_mfma_f32_16x16x32_bf16 v[16:19], a[52:55], a[164:167], v[16:19]
    v_mfma_f32_16x16x32_bf16 v[20:23], a[108:111], a[164:167], v[20:23]
    buffer_load_dwordx4 a[164:167], v2, s[4:7], s41 offen offset:1024 sc1
    s_waitcnt vmcnt(55)
    v_mfma_f32_16x16x32_bf16 v[24:27], a[0:3], a[168:171], v[124:127]
    v_mfma_f32_16x16x32_bf16 v[28:31], a[56:59], a[168:171], v[124:127]
    buffer_load_dwordx4 a[168:171], v2, s[4:7], s41 offen offset:2048 sc1
    s_waitcnt vmcnt(55)
    v_mfma_f32_16x16x32_bf16 v[24:27], a[4:7], a[172:175], v[24:27]
    v_mfma_f32_16x16x32_bf16 v[28:31], a[60:63], a[172:175], v[28:31]
    buffer_load_dwordx4 a[172:175], v2, s[4:7], s41 offen offset:3072 sc1
    s_add_u32 s41, s41, 4096
    s_waitcnt vmcnt(55)
    v_mfma_f32_16x16x32_bf16 v[24:27], a[8:11], a[176:179], v[24:27]
    v_mfma_f32_16x16x32_bf16 v[28:31], a[64:67], a[176:179], v[28:31]
    buffer_load_dwordx4 a[176:179], v2, s[4:7], s41 offen offset:0 sc1
    s_waitcnt vmcnt(55)
    v_mfma_f32_16x16x32_bf16 v[24:27], a[12:15], a[180:183], v[24:27]
    v_mfma_f32_16x16x32_bf16 v[28:31], a[68:71], a[180:183], v[28:31]
    buffer_load_dwordx4 a[180:183], v2, s[4:7], s41 offen offset:1024 sc1
    s_waitcnt vmcnt(55)
    v_mfma_f32_16x16x32_bf16 v[24:27], a[16:19], a[184:187], v[24:27]
    v_mfma_f32_16x16x32_bf16 v[28:31], a[72:75], a[184:187], v[28:31]
    buffer_load_dwordx4 a[184:187], v2, s[4:7], s41 offen offset:2048 sc1
    s_waitcnt vmcnt(55)
    v_mfma_f32_16x16x32_bf16 v[24:27], a[20:23], a[188:191], v[24:27]
    v_mfma_f32_16x16x32_bf16 v[28:31], a[76:79], a[188:191], v[28:31]
    buffer_load_dwordx4 a[188:191], v2, s[4:7], s41 offen offset:3072 sc1
    s_add_u32 s41, s41, 4096
    s_waitcnt vmcnt(55)
    v_mfma_f32_16x16x32_bf16 v[24:27], a[24:27], a[192:195], v[24:27]
    v_mfma_f32_16x16x32_bf16 v[28:31], a[80:83], a[192:195], v[28:31]
    buffer_load_dwordx4 a[192:195], v2, s[4:7], s41 offen offset:0 sc1
    s_waitcnt vmcnt(55)
    v_mfma_f32_16x16x32_bf16 v[24:27], a[28:31], a[196:199], v[24:27]
    v_mfma_f32_16x16x32_bf16 v[28:31], a[84:87], a[196:199], v[28:31]
    buffer_load_dwordx4 a[196:199], v2, s[4:7], s41 offen offset:1024 sc1
    s_waitcnt vmcnt(55)
    v_mfma_f32_16x16x32_bf16 v[24:27], a[32:35], a[200:203], v[24:27]
    v_mfma_f32_16x16x32_bf16 v[28:31], a[88:91], a[200:203], v[28:31]
    buffer_load_dwordx4 a[200:203], v2, s[4:7], s41 offen offset:2048 sc1
    s_waitcnt vmcnt(55)
    v_mfma_f32_16x16x32_bf16 v[24:27], a[36:39], a[204:207], v[24:27]
    v_mfma_f32_16x16x32_bf16 v[28:31], a[92:95], a[204:207], v[28:31]
    buffer_load_dwordx4 a[204:207], v2, s[4:7], s41 offen offset:3072 sc1
    s_add_u32 s41, s41, 4096
    s_waitcnt vmcnt(55)
    v_mfma_f32_16x16x32_bf16 v[24:27], a[40:43], a[208:211], v[24:27]
    v_mfma_f32_16x16x32_bf16 v[28:31], a[96:99], a[208:211], v[28:31]
    buffer_load_dwordx4 a[208:211], v2, s[4:7], s41 offen offset:0 sc1
    s_waitcnt vmcnt(55)
    v_mfma_f32_16x16x32_bf16 v[24:27], a[44:47], a[212:215], v[24:27]
    v_mfma_f32_16x16x32_bf16 v[28:31], a[100:103], a[212:215], v[28:31]
    buffer_load_dwordx4 a[212:215], v2, s[4:7], s41 offen offset:1024 sc1
    s_waitcnt vmcnt(55)
    v_mfma_f32_16x16x32_bf16 v[24:27], a[48:51], a[216:219], v[24:27]
    v_mfma_f32_16x16x32_bf16 v[28:31], a[104:107], a[216:219], v[28:31]
    buffer_load_dwordx4 a[216:219], v2, s[4:7], s41 offen offset:2048 sc1
    s_waitcnt vmcnt(55)
    v_mfma_f32_16x16x32_bf16 v[24:27], a[52:55], a[220:223], v[24:27]
    v_mfma_f32_16x16x32_bf16 v[28:31], a[108:111], a[220:223], v[28:31]
    buffer_load_dwordx4 a[220:223], v2, s[4:7], s41 offen offset:3072 sc1
    s_add_u32 s41, s41, 4096
    v_cvt_pk_bf16_f32 v40, v16, v17
    v_cvt_pk_bf16_f32 v41, v18, v19
    v_cvt_pk_bf16_f32 v42, v20, v21
    v_cvt_pk_bf16_f32 v43, v22, v23
    v_cvt_pk_bf16_f32 v44, v24, v25
    v_cvt_pk_bf16_f32 v45, v26, v27
    v_cvt_pk_bf16_f32 v46, v28, v29
    v_cvt_pk_bf16_f32 v47, v30, v31
    v_mfma_f32_16x16x32_bf16 v[48:51], v[32:35], v[40:43], 0
    v_mfma_f32_16x16x32_bf16 v[52:55], v[32:35], v[44:47], 0
    v_mfma_f32_16x16x32_bf16 v[56:59], v[36:39], v[40:43], 0
    v_mfma_f32_16x16x32_bf16 v[60:63], v[36:39], v[44:47], 0
    s_nop 1
    buffer_atomic_add_f32 v48, v6, s[4:7], s42 offen offset:0
    buffer_atomic_add_f32 v49, v6, s[4:7], s42 offen offset:256
    buffer_atomic_add_f32 v50, v6, s[4:7], s42 offen offset:512
    buffer_atomic_add_f32 v51, v6, s[4:7], s42 offen offset:768
    buffer_atomic_add_f32 v52, v6, s[4:7], s42 offen offset:1024
    buffer_atomic_add_f32 v53, v6, s[4:7], s42 offen offset:1280
    buffer_atomic_add_f32 v54, v6, s[4:7], s42 offen offset:1536
    buffer_atomic_add_f32 v55, v6, s[4:7], s42 offen offset:1792
    buffer_atomic_add_f32 v56, v6, s[4:7], s42 offen offset:2048
    buffer_atomic_add_f32 v57, v6, s[4:7], s42 offen offset:2304
    buffer_atomic_add_f32 v58, v6, s[4:7], s42 offen offset:2560
    buffer_atomic_add_f32 v59, v6, s[4:7], s42 offen offset:2816
    buffer_atomic_add_f32 v60, v6, s[4:7], s42 offen offset:3072
    buffer_atomic_add_f32 v61, v6, s[4:7], s42 offen offset:3328
    buffer_atomic_add_f32 v62, v6, s[4:7], s42 offen offset:3584
    buffer_atomic_add_f32 v63, v6, s[4:7], s42 offen offset:3840
    s_add_u32 s42, s42, 4096
    s_waitcnt vmcnt(63)
    v_mfma_f32_16x16x32_bf16 v[16:19], v[128:131], a[0:3], 0
    v_mfma_f32_16x16x32_bf16 v[20:23], v[128:131], a[56:59], 0
    buffer_load_dwordx4 v[128:131], v2, s[4:7], s41 offen offset:0 sc1
    s_waitcnt vmcnt(63)
    v_mfma_f32_16x16x32_bf16 v[16:19], v[132:135], a[4:7], v[16:19]
    v_mfma_f32_16x16x32_bf16 v[20:23], v[132:135], a[60:63], v[20:23]
    buffer_load_dwordx4 v[132:135], v2, s[4:7], s41 offen offset:1024 sc1
    s_waitcnt vmcnt(63)
    v_mfma_f32_16x16x32_bf16 v[16:19], v[136:139], a[8:11], v[16:19]
    v_mfma_f32_16x16x32_bf16 v[20:23], v[136:139], a[64:67], v[20:23]
    buffer_load_dwordx4 v[136:139], v2, s[4:7], s41 offen offset:2048 sc1
    s_waitcnt vmcnt(63)
    v_mfma_f32_16x16x32_bf16 v[16:19], v[140:143], a[12:15], v[16:19]
    v_mfma_f32_16x16x32_bf16 v[20:23], v[140:143], a[68:71], v[20:23]
    buffer_load_dwordx4 v[140:143], v2, s[4:7], s41 offen offset:3072 sc1
    s_add_u32 s41, s41, 4096
    s_waitcnt vmcnt(63)
    v_mfma_f32_16x16x32_bf16 v[16:19], v[144:147], a[16:19], v[16:19]
    v_mfma_f32_16x16x32_bf16 v[20:23], v[144:147], a[72:75], v[20:23]
    buffer_load_dwordx4 v[144:147], v2, s[4:7], s41 offen offset:0 sc1
    s_waitcnt vmcnt(63)
    v_mfma_f32_16x16x32_bf16 v[16:19], v[148:151], a[20:23], v[16:19]
    v_mfma_f32_16x16x32_bf16 v[20:23], v[148:151], a[76:79], v[20:23]
    buffer_load_dwordx4 v[148:151], v2, s[4:7], s41 offen offset:1024 sc1
    s_waitcnt vmcnt(63)
    v_mfma_f32_16x16x32_bf16 v[16:19], v[152:155], a[24:27], v[16:19]
    v_mfma_f32_16x16x32_bf16 v[20:23], v[152:155], a[80:83], v[20:23]
    buffer_load_dwordx4 v[152:155], v2, s[4:7], s41 offen offset:2048 sc1
    s_waitcnt vmcnt(63)
    v_mfma_f32_16x16x32_bf16 v[16:19], v[156:159], a[28:31], v[16:19]
    v_mfma_f32_16x16x32_bf16 v[20:23], v[156:159], a[84:87], v[20:23]
    buffer_load_dwordx4 v[156:159], v2, s[4:7], s41 offen offset:3072 sc1
    s_add_u32 s41, s41, 4096
    s_waitcnt vmcnt(63)
    v_mfma_f32_16x16x32_bf16 v[16:19], v[160:163], a[32:35], v[16:19]
    v_mfma_f32_16x16x32_bf16 v[20:23], v[160:163], a[88:91], v[20:23]
    buffer_load_dwordx4 v[160:163], v2, s[4:7], s41 offen offset:0 sc1
    s_waitcnt vmcnt(63)
    v_mfma_f32_16x16x32_bf16 v[16:19], v[164:167], a[36:39], v[16:19]
    v_mfma_f32_16x16x32_bf16 v[20:23], v[164:167], a[92:95], v[20:23]
    buffer_load_dwordx4 v[164:167], v2, s[4:7], s41 offen offset:1024 sc1
    s_waitcnt vmcnt(63)
    v_mfma_f32_16x16x32_bf16 v[16:19], v[168:171], a[40:43], v[16:19]
    v_mfma_f32_16x16x32_bf16 v[20:23], v[168:171], a[96:99], v[20:23]
    buffer_load_dwordx4 v[168:171], v2, s[4:7], s41 offen offset:2048 sc1
    s_waitcnt vmcnt(63)
    v_mfma_f32_16x16x32_bf16 v[16:19], v[172:175], a[44:47], v[16:19]
    v_mfma_f32_16x16x32_bf16 v[20:23], v[172:175], a[100:103], v[20:23]
    buffer_load_dwordx4 v[172:175], v2, s[4:7], s41 offen offset:3072 sc1
    s_add_u32 s41, s41, 4096
    s_waitcnt vmcnt(63)
    v_mfma_f32_16x16x32_bf16 v[16:19], v[176:179], a[48:51], v[16:19]
    v_mfma_f32_16x16x32_bf16 v[20:23], v[176:179], a[104:107], v[20:23]
    buffer_load_dwordx4 v[176:179], v2, s[4:7], s41 offen offset:0 sc1
    s_waitcnt vmcnt(63)
    v_mfma_f32_16x16x32_bf16 v[16:19], v[180:183], a[52:55], v[16:19]
    v_mfma_f32_16x16x32_bf16 v[20:23], v[180:183], a[108:111], v[20:23]
    buffer_load_dwordx4 v[180:183], v2, s[4:7], s41 offen offset:1024 sc1
    s_waitcnt vmcnt(63)
    v_mfma_f32_16x16x32_bf16 v[24:27], v[184:187], a[0:3], 0
    v_mfma_f32_16x16x32_bf16 v[28:31], v[184:187], a[56:59], 0
    buffer_load_dwordx4 v[184:187], v2, s[4:7], s41 offen offset:2048 sc1
    s_waitcnt vmcnt(63)
    v_mfma_f32_16x16x32_bf16 v[24:27], v[188:191], a[4:7], v[24:27]
    v_mfma_f32_16x16x32_bf16 v[28:31], v[188:191], a[60:63], v[28:31]
    buffer_load_dwordx4 v[188:191], v2, s[4:7], s41 offen offset:3072 sc1
    s_add_u32 s41, s41, 4096
    s_waitcnt vmcnt(63)
    v_mfma_f32_16x16x32_bf16 v[24:27], v[192:195], a[8:11], v[24:27]
    v_mfma_f32_16x16x32_bf16 v[28:31], v[192:195], a[64:67], v[28:31]
    buffer_load_dwordx4 v[192:195], v2, s[4:7], s41 offen offset:0 sc1
    s_waitcnt vmcnt(63)
    v_mfma_f32_16x16x32_bf16 v[24:27], v[196:199], a[12:15], v[24:27]
    v_mfma_f32_16x16x32_bf16 v[28:31], v[196:199], a[68:71], v[28:31]
    buffer_load_dwordx4 v[196:199], v2, s[4:7], s41 offen offset:1024 sc1
    s_waitcnt vmcnt(63)
    v_mfma_f32_16x16x32_bf16 v[24:27], v[200:203], a[16:19], v[24:27]
    v_mfma_f32_16x16x32_bf16 v[28:31], v[200:203], a[72:75], v[28:31]
    buffer_load_dwordx4 v[200:203], v2, s[4:7], s41 offen offset:2048 sc1
    s_waitcnt vmcnt(63)
    v_mfma_f32_16x16x32_bf16 v[24:27], v[204:207], a[20:23], v[24:27]
    v_mfma_f32_16x16x32_bf16 v[28:31], v[204:207], a[76:79], v[28:31]
    buffer_load_dwordx4 v[204:207], v2, s[4:7], s41 offen offset:3072 sc1
    s_add_u32 s41, s41, 4096
    s_waitcnt vmcnt(63)
    v_mfma_f32_16x16x32_bf16 v[24:27], v[208:211], a[24:27], v[24:27]
    v_mfma_f32_16x16x32_bf16 v[28:31], v[208:211], a[80:83], v[28:31]
    buffer_load_dwordx4 v[208:211], v2, s[4:7], s41 offen offset:0 sc1
    s_waitcnt vmcnt(63)
    v_mfma_f32_16x16x32_bf16 v[24:27], v[212:215], a[28:31], v[24:27]
    v_mfma_f32_16x16x32_bf16 v[28:31], v[212:215], a[84:87], v[28:31]
    buffer_load_dwordx4 v[212:215], v2, s[4:7], s41 offen offset:1024 sc1
    s_waitcnt vmcnt(63)
    v_mfma_f32_16x16x32_bf16 v[24:27], v[216:219], a[32:35], v[24:27]
    v_mfma_f32_16x16x32_bf16 v[28:31], v[216:219], a[88:91], v[28:31]
    buffer_load_dwordx4 v[216:219], v2, s[4:7], s41 offen offset:2048 sc1
    s_waitcnt vmcnt(63)
    v_mfma_f32_16x16x32_bf16 v[24:27], v[220:223], a[36:39], v[24:27]
    v_mfma_f32_16x16x32_bf16 v[28:31], v[220:223], a[92:95], v[28:31]
    buffer_load_dwordx4 v[220:223], v2, s[4:7], s41 offen offset:3072 sc1
    s_add_u32 s41, s41, 4096
    s_waitcnt vmcnt(63)
    v_mfma_f32_16x16x32_bf16 v[24:27], v[224:227], a[40:43], v[24:27]
    v_mfma_f32_16x16x32_bf16 v[28:31], v[224:227], a[96:99], v[28:31]
    buffer_load_dwordx4 v[224:227], v2, s[4:7], s41 offen offset:0 sc1
    s_waitcnt vmcnt(63)
    v_mfma_f32_16x16x32_bf16 v[24:27], v[228:231], a[44:47], v[24:27]
    v_mfma_f32_16x16x32_bf16 v[28:31], v[228:231], a[100:103], v[28:31]
    buffer_load_dwordx4 v[228:231], v2, s[4:7], s41 offen offset:1024 sc1
    s_waitcnt vmcnt(63)
    v_mfma_f32_16x16x32_bf16 v[24:27], v[232:235], a[48:51], v[24:27]
    v_mfma_f32_16x16x32_bf16 v[28:31], v[232:235], a[104:107], v[28:31]
    buffer_load_dwordx4 v[232:235], v2, s[4:7], s41 offen offset:2048 sc1
    s_waitcnt vmcnt(63)
    v_mfma_f32_16x16x32_bf16 v[24:27], v[236:239], a[52:55], v[24:27]
    v_mfma_f32_16x16x32_bf16 v[28:31], v[236:239], a[108:111], v[28:31]
    buffer_load_dwordx4 v[236:239], v2, s[4:7], s41 offen offset:3072 sc1
    s_add_u32 s41, s41, 4096
    v_cvt_pk_bf16_f32 v96, v16, v17
    v_lshlrev_b32 v98, 16, v96
    v_and_b32 v99, s54, v96
    v_pk_mul_f32 v[100:101], v[98:99], s[50:51]
    v_max_f32 v98, 0, v98
    v_min_f32 v100, 0, v100
    v_min_f32 v101, 0, v101
    v_exp_f32 v100, v100
    v_exp_f32 v101, v101
    v_max_f32 v99, 0, v99
    v_pk_add_f32 v[98:99], v[98:99], v[100:101]
    v_cvt_pk_bf16_f32 v96, v98, v99
    v_lshlrev_b32 v98, 16, v96
    v_and_b32 v99, s54, v96
    v_pk_add_f32 v[98:99], v[98:99], s[52:53]
    v_cvt_pk_bf16_f32 v72, v98, v99
    v_cvt_pk_bf16_f32 v96, v18, v19
    v_lshlrev_b32 v98, 16, v96
    v_and_b32 v99, s54, v96
    v_pk_mul_f32 v[100:101], v[98:99], s[50:51]
    v_max_f32 v98, 0, v98
    v_min_f32 v100, 0, v100
    v_min_f32 v101, 0, v101
    v_exp_f32 v100, v100
    v_exp_f32 v101, v101
    v_max_f32 v99, 0, v99
    v_pk_add_f32 v[98:99], v[98:99], v[100:101]
    v_cvt_pk_bf16_f32 v96, v98, v99
    v_lshlrev_b32 v98, 16, v96
    v_and_b32 v99, s54, v96
    v_pk_add_f32 v[98:99], v[98:99], s[52:53]
    v_cvt_pk_bf16_f32 v73, v98, v99
    v_cvt_pk_bf16_f32 v96, v20, v21
    v_lshlrev_b32 v98, 16, v96
    v_and_b32 v99, s54, v96
    v_pk_mul_f32 v[100:101], v[98:99], s[50:51]
    v_max_f32 v98, 0, v98
    v_min_f32 v100, 0, v100
    v_min_f32 v101, 0, v101
    v_exp_f32 v100, v100
    v_exp_f32 v101, v101
    v_max_f32 v99, 0, v99
    v_pk_add_f32 v[98:99], v[98:99], v[100:101]
    v_cvt_pk_bf16_f32 v96, v98, v99
    v_lshlrev_b32 v98, 16, v96
    v_and_b32 v99, s54, v96
    v_pk_add_f32 v[98:99], v[98:99], s[52:53]
    v_cvt_pk_bf16_f32 v76, v98, v99
    v_cvt_pk_bf16_f32 v96, v22, v23
    v_lshlrev_b32 v98, 16, v96
    v_and_b32 v99, s54, v96
    v_pk_mul_f32 v[100:101], v[98:99], s[50:51]
    v_max_f32 v98, 0, v98
    v_min_f32 v100, 0, v100
    v_min_f32 v101, 0, v101
    v_exp_f32 v100, v100
    v_exp_f32 v101, v101
    v_max_f32 v99, 0, v99
    v_pk_add_f32 v[98:99], v[98:99], v[100:101]
    v_cvt_pk_bf16_f32 v96, v98, v99
    v_lshlrev_b32 v98, 16, v96
    v_and_b32 v99, s54, v96
    v_pk_add_f32 v[98:99], v[98:99], s[52:53]
    v_cvt_pk_bf16_f32 v77, v98, v99
    v_cvt_pk_bf16_f32 v96, v24, v25
    v_lshlrev_b32 v98, 16, v96
    v_and_b32 v99, s54, v96
    v_pk_mul_f32 v[100:101], v[98:99], s[50:51]
    v_max_f32 v98, 0, v98
    v_min_f32 v100, 0, v100
    v_min_f32 v101, 0, v101
    v_exp_f32 v100, v100
    v_exp_f32 v101, v101
    v_max_f32 v99, 0, v99
    v_pk_add_f32 v[98:99], v[98:99], v[100:101]
    v_cvt_pk_bf16_f32 v96, v98, v99
    v_lshlrev_b32 v98, 16, v96
    v_and_b32 v99, s54, v96
    v_pk_add_f32 v[98:99], v[98:99], s[52:53]
    v_cvt_pk_bf16_f32 v74, v98, v99
    v_cvt_pk_bf16_f32 v96, v26, v27
    v_lshlrev_b32 v98, 16, v96
    v_and_b32 v99, s54, v96
    v_pk_mul_f32 v[100:101], v[98:99], s[50:51]
    v_max_f32 v98, 0, v98
    v_min_f32 v100, 0, v100
    v_min_f32 v101, 0, v101
    v_exp_f32 v100, v100
    v_exp_f32 v101, v101
    v_max_f32 v99, 0, v99
    v_pk_add_f32 v[98:99], v[98:99], v[100:101]
    v_cvt_pk_bf16_f32 v96, v98, v99
    v_lshlrev_b32 v98, 16, v96
    v_and_b32 v99, s54, v96
    v_pk_add_f32 v[98:99], v[98:99], s[52:53]
    v_cvt_pk_bf16_f32 v75, v98, v99
    v_cvt_pk_bf16_f32 v96, v28, v29
    v_lshlrev_b32 v98, 16, v96
    v_and_b32 v99, s54, v96
    v_pk_mul_f32 v[100:101], v[98:99], s[50:51]
    v_max_f32 v98, 0, v98
    v_min_f32 v100, 0, v100
    v_min_f32 v101, 0, v101
    v_exp_f32 v100, v100
    v_exp_f32 v101, v101
    v_max_f32 v99, 0, v99
    v_pk_add_f32 v[98:99], v[98:99], v[100:101]
    v_cvt_pk_bf16_f32 v96, v98, v99
    v_lshlrev_b32 v98, 16, v96
    v_and_b32 v99, s54, v96
    v_pk_add_f32 v[98:99], v[98:99], s[52:53]
    v_cvt_pk_bf16_f32 v78, v98, v99
    v_cvt_pk_bf16_f32 v96, v30, v31
    v_lshlrev_b32 v98, 16, v96
    v_and_b32 v99, s54, v96
    v_pk_mul_f32 v[100:101], v[98:99], s[50:51]
    v_max_f32 v98, 0, v98
    v_min_f32 v100, 0, v100
    v_min_f32 v101, 0, v101
    v_exp_f32 v100, v100
    v_exp_f32 v101, v101
    v_max_f32 v99, 0, v99
    v_pk_add_f32 v[98:99], v[98:99], v[100:101]
    v_cvt_pk_bf16_f32 v96, v98, v99
    v_lshlrev_b32 v98, 16, v96
    v_and_b32 v99, s54, v96
    v_pk_add_f32 v[98:99], v[98:99], s[52:53]
    v_cvt_pk_bf16_f32 v79, v98, v99
    s_waitcnt vmcnt(63)
    v_mfma_f32_16x16x32_bf16 v[16:19], a[0:3], a[112:115], 0
    v_mfma_f32_16x16x32_bf16 v[20:23], a[56:59], a[112:115], 0
    buffer_load_dwordx4 a[112:115], v2, s[4:7], s41 offen offset:0 sc1
    s_waitcnt vmcnt(63)
    v_mfma_f32_16x16x32_bf16 v[16:19], a[4:7], a[116:119], v[16:19]
    v_mfma_f32_16x16x32_bf16 v[20:23], a[60:63], a[116:119], v[20:23]
    buffer_load_dwordx4 a[116:119], v2, s[4:7], s41 offen offset:1024 sc1
    s_waitcnt vmcnt(63)
    v_mfma_f32_16x16x32_bf16 v[16:19], a[8:11], a[120:123], v[16:19]
    v_mfma_f32_16x16x32_bf16 v[20:23], a[64:67], a[120:123], v[20:23]
    buffer_load_dwordx4 a[120:123], v2, s[4:7], s41 offen offset:2048 sc1
    s_waitcnt vmcnt(63)
    v_mfma_f32_16x16x32_bf16 v[16:19], a[12:15], a[124:127], v[16:19]
    v_mfma_f32_16x16x32_bf16 v[20:23], a[68:71], a[124:127], v[20:23]
    buffer_load_dwordx4 a[124:127], v2, s[4:7], s41 offen offset:3072 sc1
    s_add_u32 s41, s41, 4096
    s_waitcnt vmcnt(63)
    v_mfma_f32_16x16x32_bf16 v[16:19], a[16:19], a[128:131], v[16:19]
    v_mfma_f32_16x16x32_bf16 v[20:23], a[72:75], a[128:131], v[20:23]
    buffer_load_dwordx4 a[128:131], v2, s[4:7], s41 offen offset:0 sc1
    s_waitcnt vmcnt(63)
    v_mfma_f32_16x16x32_bf16 v[16:19], a[20:23], a[132:135], v[16:19]
    v_mfma_f32_16x16x32_bf16 v[20:23], a[76:79], a[132:135], v[20:23]
    buffer_load_dwordx4 a[132:135], v2, s[4:7], s41 offen offset:1024 sc1
    s_waitcnt vmcnt(63)
    v_mfma_f32_16x16x32_bf16 v[16:19], a[24:27], a[136:139], v[16:19]
    v_mfma_f32_16x16x32_bf16 v[20:23], a[80:83], a[136:139], v[20:23]
    buffer_load_dwordx4 a[136:139], v2, s[4:7], s41 offen offset:2048 sc1
    s_waitcnt vmcnt(63)
    v_mfma_f32_16x16x32_bf16 v[16:19], a[28:31], a[140:143], v[16:19]
    v_mfma_f32_16x16x32_bf16 v[20:23], a[84:87], a[140:143], v[20:23]
    buffer_load_dwordx4 a[140:143], v2, s[4:7], s41 offen offset:3072 sc1
    s_add_u32 s41, s41, 4096
    s_waitcnt vmcnt(63)
    v_mfma_f32_16x16x32_bf16 v[16:19], a[32:35], a[144:147], v[16:19]
    v_mfma_f32_16x16x32_bf16 v[20:23], a[88:91], a[144:147], v[20:23]
    buffer_load_dwordx4 a[144:147], v2, s[4:7], s41 offen offset:0 sc1
    s_waitcnt vmcnt(63)
    v_mfma_f32_16x16x32_bf16 v[16:19], a[36:39], a[148:151], v[16:19]
    v_mfma_f32_16x16x32_bf16 v[20:23], a[92:95], a[148:151], v[20:23]
    buffer_load_dwordx4 a[148:151], v2, s[4:7], s41 offen offset:1024 sc1
    s_waitcnt vmcnt(63)
    v_mfma_f32_16x16x32_bf16 v[16:19], a[40:43], a[152:155], v[16:19]
    v_mfma_f32_16x16x32_bf16 v[20:23], a[96:99], a[152:155], v[20:23]
    buffer_load_dwordx4 a[152:155], v2, s[4:7], s41 offen offset:2048 sc1
    s_waitcnt vmcnt(63)
    v_mfma_f32_16x16x32_bf16 v[16:19], a[44:47], a[156:159], v[16:19]
    v_mfma_f32_16x16x32_bf16 v[20:23], a[100:103], a[156:159], v[20:23]
    buffer_load_dwordx4 a[156:159], v2, s[4:7], s41 offen offset:3072 sc1
    s_add_u32 s41, s41, 4096
    s_waitcnt vmcnt(63)
    v_mfma_f32_16x16x32_bf16 v[16:19], a[48:51], a[160:163], v[16:19]
    v_mfma_f32_16x16x32_bf16 v[20:23], a[104:107], a[160:163], v[20:23]
    buffer_load_dwordx4 a[160:163], v2, s[4:7], s41 offen offset:0 sc1
    s_waitcnt vmcnt(63)
    v_mfma_f32_16x16x32_bf16 v[16:19], a[52:55], a[164:167], v[16:19]
    v_mfma_f32_16x16x32_bf16 v[20:23], a[108:111], a[164:167], v[20:23]
    buffer_load_dwordx4 a[164:167], v2, s[4:7], s41 offen offset:1024 sc1
    s_waitcnt vmcnt(63)
    v_mfma_f32_16x16x32_bf16 v[24:27], a[0:3], a[168:171], 0
    v_mfma_f32_16x16x32_bf16 v[28:31], a[56:59], a[168:171], 0
    buffer_load_dwordx4 a[168:171], v2, s[4:7], s41 offen offset:2048 sc1
    s_waitcnt vmcnt(63)
    v_mfma_f32_16x16x32_bf16 v[24:27], a[4:7], a[172:175], v[24:27]
    v_mfma_f32_16x16x32_bf16 v[28:31], a[60:63], a[172:175], v[28:31]
    buffer_load_dwordx4 a[172:175], v2, s[4:7], s41 offen offset:3072 sc1
    s_add_u32 s41, s41, 4096
    s_waitcnt vmcnt(63)
    v_mfma_f32_16x16x32_bf16 v[24:27], a[8:11], a[176:179], v[24:27]
    v_mfma_f32_16x16x32_bf16 v[28:31], a[64:67], a[176:179], v[28:31]
    buffer_load_dwordx4 a[176:179], v2, s[4:7], s41 offen offset:0 sc1
    s_waitcnt vmcnt(63)
    v_mfma_f32_16x16x32_bf16 v[24:27], a[12:15], a[180:183], v[24:27]
    v_mfma_f32_16x16x32_bf16 v[28:31], a[68:71], a[180:183], v[28:31]
    buffer_load_dwordx4 a[180:183], v2, s[4:7], s41 offen offset:1024 sc1
    s_waitcnt vmcnt(63)
    v_mfma_f32_16x16x32_bf16 v[24:27], a[16:19], a[184:187], v[24:27]
    v_mfma_f32_16x16x32_bf16 v[28:31], a[72:75], a[184:187], v[28:31]
    buffer_load_dwordx4 a[184:187], v2, s[4:7], s41 offen offset:2048 sc1
    s_waitcnt vmcnt(63)
    v_mfma_f32_16x16x32_bf16 v[24:27], a[20:23], a[188:191], v[24:27]
    v_mfma_f32_16x16x32_bf16 v[28:31], a[76:79], a[188:191], v[28:31]
    buffer_load_dwordx4 a[188:191], v2, s[4:7], s41 offen offset:3072 sc1
    s_add_u32 s41, s41, 4096
    s_waitcnt vmcnt(63)
    v_mfma_f32_16x16x32_bf16 v[24:27], a[24:27], a[192:195], v[24:27]
    v_mfma_f32_16x16x32_bf16 v[28:31], a[80:83], a[192:195], v[28:31]
    buffer_load_dwordx4 a[192:195], v2, s[4:7], s41 offen offset:0 sc1
    s_waitcnt vmcnt(63)
    v_mfma_f32_16x16x32_bf16 v[24:27], a[28:31], a[196:199], v[24:27]
    v_mfma_f32_16x16x32_bf16 v[28:31], a[84:87], a[196:199], v[28:31]
    buffer_load_dwordx4 a[196:199], v2, s[4:7], s41 offen offset:1024 sc1
    s_waitcnt vmcnt(63)
    v_mfma_f32_16x16x32_bf16 v[24:27], a[32:35], a[200:203], v[24:27]
    v_mfma_f32_16x16x32_bf16 v[28:31], a[88:91], a[200:203], v[28:31]
    buffer_load_dwordx4 a[200:203], v2, s[4:7], s41 offen offset:2048 sc1
    s_waitcnt vmcnt(63)
    v_mfma_f32_16x16x32_bf16 v[24:27], a[36:39], a[204:207], v[24:27]
    v_mfma_f32_16x16x32_bf16 v[28:31], a[92:95], a[204:207], v[28:31]
    buffer_load_dwordx4 a[204:207], v2, s[4:7], s41 offen offset:3072 sc1
    s_add_u32 s41, s41, 4096
    s_waitcnt vmcnt(63)
    v_mfma_f32_16x16x32_bf16 v[24:27], a[40:43], a[208:211], v[24:27]
    v_mfma_f32_16x16x32_bf16 v[28:31], a[96:99], a[208:211], v[28:31]
    buffer_load_dwordx4 a[208:211], v2, s[4:7], s41 offen offset:0 sc1
    s_waitcnt vmcnt(63)
    v_mfma_f32_16x16x32_bf16 v[24:27], a[44:47], a[212:215], v[24:27]
    v_mfma_f32_16x16x32_bf16 v[28:31], a[100:103], a[212:215], v[28:31]
    buffer_load_dwordx4 a[212:215], v2, s[4:7], s41 offen offset:1024 sc1
    s_waitcnt vmcnt(63)
    v_mfma_f32_16x16x32_bf16 v[24:27], a[48:51], a[216:219], v[24:27]
    v_mfma_f32_16x16x32_bf16 v[28:31], a[104:107], a[216:219], v[28:31]
    buffer_load_dwordx4 a[216:219], v2, s[4:7], s41 offen offset:2048 sc1
    s_waitcnt vmcnt(63)
    v_mfma_f32_16x16x32_bf16 v[24:27], a[52:55], a[220:223], v[24:27]
    v_mfma_f32_16x16x32_bf16 v[28:31], a[108:111], a[220:223], v[28:31]
    buffer_load_dwordx4 a[220:223], v2, s[4:7], s41 offen offset:3072 sc1
    s_add_u32 s41, s41, 4096
    v_cvt_pk_bf16_f32 v96, v16, v17
    v_lshlrev_b32 v98, 16, v96
    v_and_b32 v99, s54, v96
    v_pk_mul_f32 v[100:101], v[98:99], s[50:51]
    v_max_f32 v98, 0, v98
    v_min_f32 v100, 0, v100
    v_min_f32 v101, 0, v101
    v_exp_f32 v100, v100
    v_exp_f32 v101, v101
    v_max_f32 v99, 0, v99
    v_pk_add_f32 v[98:99], v[98:99], v[100:101]
    v_cvt_pk_bf16_f32 v96, v98, v99
    v_lshlrev_b32 v98, 16, v96
    v_and_b32 v99, s54, v96
    v_pk_add_f32 v[98:99], v[98:99], s[52:53]
    v_cvt_pk_bf16_f32 v32, v98, v99
    v_cvt_pk_bf16_f32 v96, v18, v19
    v_lshlrev_b32 v98, 16, v96
    v_and_b32 v99, s54, v96
    v_pk_mul_f32 v[100:101], v[98:99], s[50:51]
    v_max_f32 v98, 0, v98
    v_min_f32 v100, 0, v100
    v_min_f32 v101, 0, v101
    v_exp_f32 v100, v100
    v_exp_f32 v101, v101
    v_max_f32 v99, 0, v99
    v_pk_add_f32 v[98:99], v[98:99], v[100:101]
    v_cvt_pk_bf16_f32 v96, v98, v99
    v_lshlrev_b32 v98, 16, v96
    v_and_b32 v99, s54, v96
    v_pk_add_f32 v[98:99], v[98:99], s[52:53]
    v_cvt_pk_bf16_f32 v33, v98, v99
    v_cvt_pk_bf16_f32 v96, v20, v21
    v_lshlrev_b32 v98, 16, v96
    v_and_b32 v99, s54, v96
    v_pk_mul_f32 v[100:101], v[98:99], s[50:51]
    v_max_f32 v98, 0, v98
    v_min_f32 v100, 0, v100
    v_min_f32 v101, 0, v101
    v_exp_f32 v100, v100
    v_exp_f32 v101, v101
    v_max_f32 v99, 0, v99
    v_pk_add_f32 v[98:99], v[98:99], v[100:101]
    v_cvt_pk_bf16_f32 v96, v98, v99
    v_lshlrev_b32 v98, 16, v96
    v_and_b32 v99, s54, v96
    v_pk_add_f32 v[98:99], v[98:99], s[52:53]
    v_cvt_pk_bf16_f32 v34, v98, v99
    v_cvt_pk_bf16_f32 v96, v22, v23
    v_lshlrev_b32 v98, 16, v96
    v_and_b32 v99, s54, v96
    v_pk_mul_f32 v[100:101], v[98:99], s[50:51]
    v_max_f32 v98, 0, v98
    v_min_f32 v100, 0, v100
    v_min_f32 v101, 0, v101
    v_exp_f32 v100, v100
    v_exp_f32 v101, v101
    v_max_f32 v99, 0, v99
    v_pk_add_f32 v[98:99], v[98:99], v[100:101]
    v_cvt_pk_bf16_f32 v96, v98, v99
    v_lshlrev_b32 v98, 16, v96
    v_and_b32 v99, s54, v96
    v_pk_add_f32 v[98:99], v[98:99], s[52:53]
    v_cvt_pk_bf16_f32 v35, v98, v99
    v_cvt_pk_bf16_f32 v96, v24, v25
    v_lshlrev_b32 v98, 16, v96
    v_and_b32 v99, s54, v96
    v_pk_mul_f32 v[100:101], v[98:99], s[50:51]
    v_max_f32 v98, 0, v98
    v_min_f32 v100, 0, v100
    v_min_f32 v101, 0, v101
    v_exp_f32 v100, v100
    v_exp_f32 v101, v101
    v_max_f32 v99, 0, v99
    v_pk_add_f32 v[98:99], v[98:99], v[100:101]
    v_cvt_pk_bf16_f32 v96, v98, v99
    v_lshlrev_b32 v98, 16, v96
    v_and_b32 v99, s54, v96
    v_pk_add_f32 v[98:99], v[98:99], s[52:53]
    v_cvt_pk_bf16_f32 v36, v98, v99
    v_cvt_pk_bf16_f32 v96, v26, v27
    v_lshlrev_b32 v98, 16, v96
    v_and_b32 v99, s54, v96
    v_pk_mul_f32 v[100:101], v[98:99], s[50:51]
    v_max_f32 v98, 0, v98
    v_min_f32 v100, 0, v100
    v_min_f32 v101, 0, v101
    v_exp_f32 v100, v100
    v_exp_f32 v101, v101
    v_max_f32 v99, 0, v99
    v_pk_add_f32 v[98:99], v[98:99], v[100:101]
    v_cvt_pk_bf16_f32 v96, v98, v99
    v_lshlrev_b32 v98, 16, v96
    v_and_b32 v99, s54, v96
    v_pk_add_f32 v[98:99], v[98:99], s[52:53]
    v_cvt_pk_bf16_f32 v37, v98, v99
    v_cvt_pk_bf16_f32 v96, v28, v29
    v_lshlrev_b32 v98, 16, v96
    v_and_b32 v99, s54, v96
    v_pk_mul_f32 v[100:101], v[98:99], s[50:51]
    v_max_f32 v98, 0, v98
    v_min_f32 v100, 0, v100
    v_min_f32 v101, 0, v101
    v_exp_f32 v100, v100
    v_exp_f32 v101, v101
    v_max_f32 v99, 0, v99
    v_pk_add_f32 v[98:99], v[98:99], v[100:101]
    v_cvt_pk_bf16_f32 v96, v98, v99
    v_lshlrev_b32 v98, 16, v96
    v_and_b32 v99, s54, v96
    v_pk_add_f32 v[98:99], v[98:99], s[52:53]
    v_cvt_pk_bf16_f32 v38, v98, v99
    v_cvt_pk_bf16_f32 v96, v30, v31
    v_lshlrev_b32 v98, 16, v96
    v_and_b32 v99, s54, v96
    v_pk_mul_f32 v[100:101], v[98:99], s[50:51]
    v_max_f32 v98, 0, v98
    v_min_f32 v100, 0, v100
    v_min_f32 v101, 0, v101
    v_exp_f32 v100, v100
    v_exp_f32 v101, v101
    v_max_f32 v99, 0, v99
    v_pk_add_f32 v[98:99], v[98:99], v[100:101]
    v_cvt_pk_bf16_f32 v96, v98, v99
    v_lshlrev_b32 v98, 16, v96
    v_and_b32 v99, s54, v96
    v_pk_add_f32 v[98:99], v[98:99], s[52:53]
    v_cvt_pk_bf16_f32 v39, v98, v99
    s_waitcnt vmcnt(55)
    v_mfma_f32_16x16x32_bf16 v[16:19], a[0:3], v[128:131], 0
    v_mfma_f32_16x16x32_bf16 v[20:23], a[56:59], v[128:131], 0
    buffer_load_dwordx4 v[128:131], v2, s[4:7], s41 offen offset:0 sc1
    s_waitcnt vmcnt(55)
    v_mfma_f32_16x16x32_bf16 v[16:19], a[4:7], v[132:135], v[16:19]
    v_mfma_f32_16x16x32_bf16 v[20:23], a[60:63], v[132:135], v[20:23]
    buffer_load_dwordx4 v[132:135], v2, s[4:7], s41 offen offset:1024 sc1
    s_waitcnt vmcnt(55)
    v_mfma_f32_16x16x32_bf16 v[16:19], a[8:11], v[136:139], v[16:19]
    v_mfma_f32_16x16x32_bf16 v[20:23], a[64:67], v[136:139], v[20:23]
    buffer_load_dwordx4 v[136:139], v2, s[4:7], s41 offen offset:2048 sc1
    s_waitcnt vmcnt(55)
    v_mfma_f32_16x16x32_bf16 v[16:19], a[12:15], v[140:143], v[16:19]
    v_mfma_f32_16x16x32_bf16 v[20:23], a[68:71], v[140:143], v[20:23]
    buffer_load_dwordx4 v[140:143], v2, s[4:7], s41 offen offset:3072 sc1
    s_add_u32 s41, s41, 4096
    s_waitcnt vmcnt(55)
    v_mfma_f32_16x16x32_bf16 v[16:19], a[16:19], v[144:147], v[16:19]
    v_mfma_f32_16x16x32_bf16 v[20:23], a[72:75], v[144:147], v[20:23]
    buffer_load_dwordx4 v[144:147], v2, s[4:7], s41 offen offset:0 sc1
    s_waitcnt vmcnt(55)
    v_mfma_f32_16x16x32_bf16 v[16:19], a[20:23], v[148:151], v[16:19]
    v_mfma_f32_16x16x32_bf16 v[20:23], a[76:79], v[148:151], v[20:23]
    buffer_load_dwordx4 v[148:151], v2, s[4:7], s41 offen offset:1024 sc1
    s_waitcnt vmcnt(55)
    v_mfma_f32_16x16x32_bf16 v[16:19], a[24:27], v[152:155], v[16:19]
    v_mfma_f32_16x16x32_bf16 v[20:23], a[80:83], v[152:155], v[20:23]
    buffer_load_dwordx4 v[152:155], v2, s[4:7], s41 offen offset:2048 sc1
    s_waitcnt vmcnt(55)
    v_mfma_f32_16x16x32_bf16 v[16:19], a[28:31], v[156:159], v[16:19]
    v_mfma_f32_16x16x32_bf16 v[20:23], a[84:87], v[156:159], v[20:23]
    buffer_load_dwordx4 v[156:159], v2, s[4:7], s41 offen offset:3072 sc1
    s_add_u32 s41, s41, 4096
    s_waitcnt vmcnt(55)
    v_mfma_f32_16x16x32_bf16 v[16:19], a[32:35], v[160:163], v[16:19]
    v_mfma_f32_16x16x32_bf16 v[20:23], a[88:91], v[160:163], v[20:23]
    buffer_load_dwordx4 v[160:163], v2, s[4:7], s41 offen offset:0 sc1
    s_waitcnt vmcnt(55)
    v_mfma_f32_16x16x32_bf16 v[16:19], a[36:39], v[164:167], v[16:19]
    v_mfma_f32_16x16x32_bf16 v[20:23], a[92:95], v[164:167], v[20:23]
    buffer_load_dwordx4 v[164:167], v2, s[4:7], s41 offen offset:1024 sc1
    s_waitcnt vmcnt(55)
    v_mfma_f32_16x16x32_bf16 v[16:19], a[40:43], v[168:171], v[16:19]
    v_mfma_f32_16x16x32_bf16 v[20:23], a[96:99], v[168:171], v[20:23]
    buffer_load_dwordx4 v[168:171], v2, s[4:7], s41 offen offset:2048 sc1
    s_waitcnt vmcnt(55)
    v_mfma_f32_16x16x32_bf16 v[16:19], a[44:47], v[172:175], v[16:19]
    v_mfma_f32_16x16x32_bf16 v[20:23], a[100:103], v[172:175], v[20:23]
    buffer_load_dwordx4 v[172:175], v2, s[4:7], s41 offen offset:3072 sc1
    s_add_u32 s41, s41, 4096
    s_waitcnt vmcnt(55)
    v_mfma_f32_16x16x32_bf16 v[16:19], a[48:51], v[176:179], v[16:19]
    v_mfma_f32_16x16x32_bf16 v[20:23], a[104:107], v[176:179], v[20:23]
    buffer_load_dwordx4 v[176:179], v2, s[4:7], s41 offen offset:0 sc1
    s_waitcnt vmcnt(55)
    v_mfma_f32_16x16x32_bf16 v[16:19], a[52:55], v[180:183], v[16:19]
    v_mfma_f32_16x16x32_bf16 v[20:23], a[108:111], v[180:183], v[20:23]
    buffer_load_dwordx4 v[180:183], v2, s[4:7], s41 offen offset:1024 sc1
    s_waitcnt vmcnt(55)
    v_mfma_f32_16x16x32_bf16 v[24:27], a[0:3], v[184:187], v[124:127]
    v_mfma_f32_16x16x32_bf16 v[28:31], a[56:59], v[184:187], v[124:127]
    buffer_load_dwordx4 v[184:187], v2, s[4:7], s41 offen offset:2048 sc1
    s_waitcnt vmcnt(55)
    v_mfma_f32_16x16x32_bf16 v[24:27], a[4:7], v[188:191], v[24:27]
    v_mfma_f32_16x16x32_bf16 v[28:31], a[60:63], v[188:191], v[28:31]
    buffer_load_dwordx4 v[188:191], v2, s[4:7], s41 offen offset:3072 sc1
    s_add_u32 s41, s41, 4096
    s_waitcnt vmcnt(55)
    v_mfma_f32_16x16x32_bf16 v[24:27], a[8:11], v[192:195], v[24:27]
    v_mfma_f32_16x16x32_bf16 v[28:31], a[64:67], v[192:195], v[28:31]
    buffer_load_dwordx4 v[192:195], v2, s[4:7], s41 offen offset:0 sc1
    s_waitcnt vmcnt(55)
    v_mfma_f32_16x16x32_bf16 v[24:27], a[12:15], v[196:199], v[24:27]
    v_mfma_f32_16x16x32_bf16 v[28:31], a[68:71], v[196:199], v[28:31]
    buffer_load_dwordx4 v[196:199], v2, s[4:7], s41 offen offset:1024 sc1
    s_waitcnt vmcnt(55)
    v_mfma_f32_16x16x32_bf16 v[24:27], a[16:19], v[200:203], v[24:27]
    v_mfma_f32_16x16x32_bf16 v[28:31], a[72:75], v[200:203], v[28:31]
    buffer_load_dwordx4 v[200:203], v2, s[4:7], s41 offen offset:2048 sc1
    s_waitcnt vmcnt(55)
    v_mfma_f32_16x16x32_bf16 v[24:27], a[20:23], v[204:207], v[24:27]
    v_mfma_f32_16x16x32_bf16 v[28:31], a[76:79], v[204:207], v[28:31]
    buffer_load_dwordx4 v[204:207], v2, s[4:7], s41 offen offset:3072 sc1
    s_add_u32 s41, s41, 4096
    s_waitcnt vmcnt(55)
    v_mfma_f32_16x16x32_bf16 v[24:27], a[24:27], v[208:211], v[24:27]
    v_mfma_f32_16x16x32_bf16 v[28:31], a[80:83], v[208:211], v[28:31]
    buffer_load_dwordx4 v[208:211], v2, s[4:7], s41 offen offset:0 sc1
    s_waitcnt vmcnt(55)
    v_mfma_f32_16x16x32_bf16 v[24:27], a[28:31], v[212:215], v[24:27]
    v_mfma_f32_16x16x32_bf16 v[28:31], a[84:87], v[212:215], v[28:31]
    buffer_load_dwordx4 v[212:215], v2, s[4:7], s41 offen offset:1024 sc1
    s_waitcnt vmcnt(55)
    v_mfma_f32_16x16x32_bf16 v[24:27], a[32:35], v[216:219], v[24:27]
    v_mfma_f32_16x16x32_bf16 v[28:31], a[88:91], v[216:219], v[28:31]
    buffer_load_dwordx4 v[216:219], v2, s[4:7], s41 offen offset:2048 sc1
    s_waitcnt vmcnt(55)
    v_mfma_f32_16x16x32_bf16 v[24:27], a[36:39], v[220:223], v[24:27]
    v_mfma_f32_16x16x32_bf16 v[28:31], a[92:95], v[220:223], v[28:31]
    buffer_load_dwordx4 v[220:223], v2, s[4:7], s41 offen offset:3072 sc1
    s_add_u32 s41, s41, 4096
    s_waitcnt vmcnt(55)
    v_mfma_f32_16x16x32_bf16 v[24:27], a[40:43], v[224:227], v[24:27]
    v_mfma_f32_16x16x32_bf16 v[28:31], a[96:99], v[224:227], v[28:31]
    buffer_load_dwordx4 v[224:227], v2, s[4:7], s41 offen offset:0 sc1
    s_waitcnt vmcnt(55)
    v_mfma_f32_16x16x32_bf16 v[24:27], a[44:47], v[228:231], v[24:27]
    v_mfma_f32_16x16x32_bf16 v[28:31], a[100:103], v[228:231], v[28:31]
    buffer_load_dwordx4 v[228:231], v2, s[4:7], s41 offen offset:1024 sc1
    s_waitcnt vmcnt(55)
    v_mfma_f32_16x16x32_bf16 v[24:27], a[48:51], v[232:235], v[24:27]
    v_mfma_f32_16x16x32_bf16 v[28:31], a[104:107], v[232:235], v[28:31]
    buffer_load_dwordx4 v[232:235], v2, s[4:7], s41 offen offset:2048 sc1
    s_waitcnt vmcnt(55)
    v_mfma_f32_16x16x32_bf16 v[24:27], a[52:55], v[236:239], v[24:27]
    v_mfma_f32_16x16x32_bf16 v[28:31], a[108:111], v[236:239], v[28:31]
    buffer_load_dwordx4 v[236:239], v2, s[4:7], s41 offen offset:3072 sc1
    s_add_u32 s41, s41, 4096
    v_cvt_pk_bf16_f32 v40, v16, v17
    v_cvt_pk_bf16_f32 v41, v18, v19
    v_cvt_pk_bf16_f32 v42, v20, v21
    v_cvt_pk_bf16_f32 v43, v22, v23
    v_cvt_pk_bf16_f32 v44, v24, v25
    v_cvt_pk_bf16_f32 v45, v26, v27
    v_cvt_pk_bf16_f32 v46, v28, v29
    v_cvt_pk_bf16_f32 v47, v30, v31
    v_mfma_f32_16x16x32_bf16 v[48:51], v[32:35], v[40:43], 0
    v_mfma_f32_16x16x32_bf16 v[52:55], v[32:35], v[44:47], 0
    v_mfma_f32_16x16x32_bf16 v[56:59], v[36:39], v[40:43], 0
    v_mfma_f32_16x16x32_bf16 v[60:63], v[36:39], v[44:47], 0
    s_nop 1
    buffer_atomic_add_f32 v48, v6, s[4:7], s42 offen offset:0
    buffer_atomic_add_f32 v49, v6, s[4:7], s42 offen offset:256
    buffer_atomic_add_f32 v50, v6, s[4:7], s42 offen offset:512
    buffer_atomic_add_f32 v51, v6, s[4:7], s42 offen offset:768
    buffer_atomic_add_f32 v52, v6, s[4:7], s42 offen offset:1024
    buffer_atomic_add_f32 v53, v6, s[4:7], s42 offen offset:1280
    buffer_atomic_add_f32 v54, v6, s[4:7], s42 offen offset:1536
    buffer_atomic_add_f32 v55, v6, s[4:7], s42 offen offset:1792
    buffer_atomic_add_f32 v56, v6, s[4:7], s42 offen offset:2048
    buffer_atomic_add_f32 v57, v6, s[4:7], s42 offen offset:2304
    buffer_atomic_add_f32 v58, v6, s[4:7], s42 offen offset:2560
    buffer_atomic_add_f32 v59, v6, s[4:7], s42 offen offset:2816
    buffer_atomic_add_f32 v60, v6, s[4:7], s42 offen offset:3072
    buffer_atomic_add_f32 v61, v6, s[4:7], s42 offen offset:3328
    buffer_atomic_add_f32 v62, v6, s[4:7], s42 offen offset:3584
    buffer_atomic_add_f32 v63, v6, s[4:7], s42 offen offset:3840
    s_add_u32 s42, s42, 4096
    s_waitcnt vmcnt(63)
    v_mfma_f32_16x16x32_bf16 v[16:19], a[112:115], a[0:3], 0
    v_mfma_f32_16x16x32_bf16 v[20:23], a[112:115], a[56:59], 0
    buffer_load_dwordx4 a[112:115], v2, s[4:7], s41 offen offset:0 sc1
    s_waitcnt vmcnt(63)
    v_mfma_f32_16x16x32_bf16 v[16:19], a[116:119], a[4:7], v[16:19]
    v_mfma_f32_16x16x32_bf16 v[20:23], a[116:119], a[60:63], v[20:23]
    buffer_load_dwordx4 a[116:119], v2, s[4:7], s41 offen offset:1024 sc1
    s_waitcnt vmcnt(63)
    v_mfma_f32_16x16x32_bf16 v[16:19], a[120:123], a[8:11], v[16:19]
    v_mfma_f32_16x16x32_bf16 v[20:23], a[120:123], a[64:67], v[20:23]
    buffer_load_dwordx4 a[120:123], v2, s[4:7], s41 offen offset:2048 sc1
    s_waitcnt vmcnt(63)
    v_mfma_f32_16x16x32_bf16 v[16:19], a[124:127], a[12:15], v[16:19]
    v_mfma_f32_16x16x32_bf16 v[20:23], a[124:127], a[68:71], v[20:23]
    buffer_load_dwordx4 a[124:127], v2, s[4:7], s41 offen offset:3072 sc1
    s_add_u32 s41, s41, 4096
    s_waitcnt vmcnt(63)
    v_mfma_f32_16x16x32_bf16 v[16:19], a[128:131], a[16:19], v[16:19]
    v_mfma_f32_16x16x32_bf16 v[20:23], a[128:131], a[72:75], v[20:23]
    buffer_load_dwordx4 a[128:131], v2, s[4:7], s41 offen offset:0 sc1
    s_waitcnt vmcnt(63)
    v_mfma_f32_16x16x32_bf16 v[16:19], a[132:135], a[20:23], v[16:19]
    v_mfma_f32_16x16x32_bf16 v[20:23], a[132:135], a[76:79], v[20:23]
    buffer_load_dwordx4 a[132:135], v2, s[4:7], s41 offen offset:1024 sc1
    s_waitcnt vmcnt(63)
    v_mfma_f32_16x16x32_bf16 v[16:19], a[136:139], a[24:27], v[16:19]
    v_mfma_f32_16x16x32_bf16 v[20:23], a[136:139], a[80:83], v[20:23]
    buffer_load_dwordx4 a[136:139], v2, s[4:7], s41 offen offset:2048 sc1
    s_waitcnt vmcnt(63)
    v_mfma_f32_16x16x32_bf16 v[16:19], a[140:143], a[28:31], v[16:19]
    v_mfma_f32_16x16x32_bf16 v[20:23], a[140:143], a[84:87], v[20:23]
    buffer_load_dwordx4 a[140:143], v2, s[4:7], s41 offen offset:3072 sc1
    s_add_u32 s41, s41, 4096
    s_waitcnt vmcnt(63)
    v_mfma_f32_16x16x32_bf16 v[16:19], a[144:147], a[32:35], v[16:19]
    v_mfma_f32_16x16x32_bf16 v[20:23], a[144:147], a[88:91], v[20:23]
    buffer_load_dwordx4 a[144:147], v2, s[4:7], s41 offen offset:0 sc1
    s_waitcnt vmcnt(63)
    v_mfma_f32_16x16x32_bf16 v[16:19], a[148:151], a[36:39], v[16:19]
    v_mfma_f32_16x16x32_bf16 v[20:23], a[148:151], a[92:95], v[20:23]
    buffer_load_dwordx4 a[148:151], v2, s[4:7], s41 offen offset:1024 sc1
    s_waitcnt vmcnt(63)
    v_mfma_f32_16x16x32_bf16 v[16:19], a[152:155], a[40:43], v[16:19]
    v_mfma_f32_16x16x32_bf16 v[20:23], a[152:155], a[96:99], v[20:23]
    buffer_load_dwordx4 a[152:155], v2, s[4:7], s41 offen offset:2048 sc1
    s_waitcnt vmcnt(63)
    v_mfma_f32_16x16x32_bf16 v[16:19], a[156:159], a[44:47], v[16:19]
    v_mfma_f32_16x16x32_bf16 v[20:23], a[156:159], a[100:103], v[20:23]
    buffer_load_dwordx4 a[156:159], v2, s[4:7], s41 offen offset:3072 sc1
    s_add_u32 s41, s41, 4096
    s_waitcnt vmcnt(63)
    v_mfma_f32_16x16x32_bf16 v[16:19], a[160:163], a[48:51], v[16:19]
    v_mfma_f32_16x16x32_bf16 v[20:23], a[160:163], a[104:107], v[20:23]
    buffer_load_dwordx4 a[160:163], v2, s[4:7], s41 offen offset:0 sc1
    s_waitcnt vmcnt(63)
    v_mfma_f32_16x16x32_bf16 v[16:19], a[164:167], a[52:55], v[16:19]
    v_mfma_f32_16x16x32_bf16 v[20:23], a[164:167], a[108:111], v[20:23]
    buffer_load_dwordx4 a[164:167], v2, s[4:7], s41 offen offset:1024 sc1
    s_waitcnt vmcnt(63)
    v_mfma_f32_16x16x32_bf16 v[24:27], a[168:171], a[0:3], 0
    v_mfma_f32_16x16x32_bf16 v[28:31], a[168:171], a[56:59], 0
    buffer_load_dwordx4 a[168:171], v2, s[4:7], s41 offen offset:2048 sc1
    s_waitcnt vmcnt(63)
    v_mfma_f32_16x16x32_bf16 v[24:27], a[172:175], a[4:7], v[24:27]
    v_mfma_f32_16x16x32_bf16 v[28:31], a[172:175], a[60:63], v[28:31]
    buffer_load_dwordx4 a[172:175], v2, s[4:7], s41 offen offset:3072 sc1
    s_add_u32 s41, s41, 4096
    s_waitcnt vmcnt(63)
    v_mfma_f32_16x16x32_bf16 v[24:27], a[176:179], a[8:11], v[24:27]
    v_mfma_f32_16x16x32_bf16 v[28:31], a[176:179], a[64:67], v[28:31]
    buffer_load_dwordx4 a[176:179], v2, s[4:7], s41 offen offset:0 sc1
    s_waitcnt vmcnt(63)
    v_mfma_f32_16x16x32_bf16 v[24:27], a[180:183], a[12:15], v[24:27]
    v_mfma_f32_16x16x32_bf16 v[28:31], a[180:183], a[68:71], v[28:31]
    buffer_load_dwordx4 a[180:183], v2, s[4:7], s41 offen offset:1024 sc1
    s_waitcnt vmcnt(63)
    v_mfma_f32_16x16x32_bf16 v[24:27], a[184:187], a[16:19], v[24:27]
    v_mfma_f32_16x16x32_bf16 v[28:31], a[184:187], a[72:75], v[28:31]
    buffer_load_dwordx4 a[184:187], v2, s[4:7], s41 offen offset:2048 sc1
    s_waitcnt vmcnt(63)
    v_mfma_f32_16x16x32_bf16 v[24:27], a[188:191], a[20:23], v[24:27]
    v_mfma_f32_16x16x32_bf16 v[28:31], a[188:191], a[76:79], v[28:31]
    buffer_load_dwordx4 a[188:191], v2, s[4:7], s41 offen offset:3072 sc1
    s_add_u32 s41, s41, 4096
    s_waitcnt vmcnt(63)
    v_mfma_f32_16x16x32_bf16 v[24:27], a[192:195], a[24:27], v[24:27]
    v_mfma_f32_16x16x32_bf16 v[28:31], a[192:195], a[80:83], v[28:31]
    buffer_load_dwordx4 a[192:195], v2, s[4:7], s41 offen offset:0 sc1
    s_waitcnt vmcnt(63)
    v_mfma_f32_16x16x32_bf16 v[24:27], a[196:199], a[28:31], v[24:27]
    v_mfma_f32_16x16x32_bf16 v[28:31], a[196:199], a[84:87], v[28:31]
    buffer_load_dwordx4 a[196:199], v2, s[4:7], s41 offen offset:1024 sc1
    s_waitcnt vmcnt(63)
    v_mfma_f32_16x16x32_bf16 v[24:27], a[200:203], a[32:35], v[24:27]
    v_mfma_f32_16x16x32_bf16 v[28:31], a[200:203], a[88:91], v[28:31]
    buffer_load_dwordx4 a[200:203], v2, s[4:7], s41 offen offset:2048 sc1
    s_waitcnt vmcnt(63)
    v_mfma_f32_16x16x32_bf16 v[24:27], a[204:207], a[36:39], v[24:27]
    v_mfma_f32_16x16x32_bf16 v[28:31], a[204:207], a[92:95], v[28:31]
    buffer_load_dwordx4 a[204:207], v2, s[4:7], s41 offen offset:3072 sc1
    s_add_u32 s41, s41, 4096
    s_waitcnt vmcnt(63)
    v_mfma_f32_16x16x32_bf16 v[24:27], a[208:211], a[40:43], v[24:27]
    v_mfma_f32_16x16x32_bf16 v[28:31], a[208:211], a[96:99], v[28:31]
    buffer_load_dwordx4 a[208:211], v2, s[4:7], s41 offen offset:0 sc1
    s_waitcnt vmcnt(63)
    v_mfma_f32_16x16x32_bf16 v[24:27], a[212:215], a[44:47], v[24:27]
    v_mfma_f32_16x16x32_bf16 v[28:31], a[212:215], a[100:103], v[28:31]
    buffer_load_dwordx4 a[212:215], v2, s[4:7], s41 offen offset:1024 sc1
    s_waitcnt vmcnt(63)
    v_mfma_f32_16x16x32_bf16 v[24:27], a[216:219], a[48:51], v[24:27]
    v_mfma_f32_16x16x32_bf16 v[28:31], a[216:219], a[104:107], v[28:31]
    buffer_load_dwordx4 a[216:219], v2, s[4:7], s41 offen offset:2048 sc1
    s_waitcnt vmcnt(63)
    v_mfma_f32_16x16x32_bf16 v[24:27], a[220:223], a[52:55], v[24:27]
    v_mfma_f32_16x16x32_bf16 v[28:31], a[220:223], a[108:111], v[28:31]
    buffer_load_dwordx4 a[220:223], v2, s[4:7], s41 offen offset:3072 sc1
    s_add_u32 s41, s41, 4096
    v_cvt_pk_bf16_f32 v96, v16, v17
    v_lshlrev_b32 v98, 16, v96
    v_and_b32 v99, s54, v96
    v_pk_mul_f32 v[100:101], v[98:99], s[50:51]
    v_max_f32 v98, 0, v98
    v_min_f32 v100, 0, v100
    v_min_f32 v101, 0, v101
    v_exp_f32 v100, v100
    v_exp_f32 v101, v101
    v_max_f32 v99, 0, v99
    v_pk_add_f32 v[98:99], v[98:99], v[100:101]
    v_cvt_pk_bf16_f32 v96, v98, v99
    v_lshlrev_b32 v98, 16, v96
    v_and_b32 v99, s54, v96
    v_pk_add_f32 v[98:99], v[98:99], s[52:53]
    v_cvt_pk_bf16_f32 v80, v98, v99
    v_cvt_pk_bf16_f32 v96, v18, v19
    v_lshlrev_b32 v98, 16, v96
    v_and_b32 v99, s54, v96
    v_pk_mul_f32 v[100:101], v[98:99], s[50:51]
    v_max_f32 v98, 0, v98
    v_min_f32 v100, 0, v100
    v_min_f32 v101, 0, v101
    v_exp_f32 v100, v100
    v_exp_f32 v101, v101
    v_max_f32 v99, 0, v99
    v_pk_add_f32 v[98:99], v[98:99], v[100:101]
    v_cvt_pk_bf16_f32 v96, v98, v99
    v_lshlrev_b32 v98, 16, v96
    v_and_b32 v99, s54, v96
    v_pk_add_f32 v[98:99], v[98:99], s[52:53]
    v_cvt_pk_bf16_f32 v81, v98, v99
    v_cvt_pk_bf16_f32 v96, v20, v21
    v_lshlrev_b32 v98, 16, v96
    v_and_b32 v99, s54, v96
    v_pk_mul_f32 v[100:101], v[98:99], s[50:51]
    v_max_f32 v98, 0, v98
    v_min_f32 v100, 0, v100
    v_min_f32 v101, 0, v101
    v_exp_f32 v100, v100
    v_exp_f32 v101, v101
    v_max_f32 v99, 0, v99
    v_pk_add_f32 v[98:99], v[98:99], v[100:101]
    v_cvt_pk_bf16_f32 v96, v98, v99
    v_lshlrev_b32 v98, 16, v96
    v_and_b32 v99, s54, v96
    v_pk_add_f32 v[98:99], v[98:99], s[52:53]
    v_cvt_pk_bf16_f32 v84, v98, v99
    v_cvt_pk_bf16_f32 v96, v22, v23
    v_lshlrev_b32 v98, 16, v96
    v_and_b32 v99, s54, v96
    v_pk_mul_f32 v[100:101], v[98:99], s[50:51]
    v_max_f32 v98, 0, v98
    v_min_f32 v100, 0, v100
    v_min_f32 v101, 0, v101
    v_exp_f32 v100, v100
    v_exp_f32 v101, v101
    v_max_f32 v99, 0, v99
    v_pk_add_f32 v[98:99], v[98:99], v[100:101]
    v_cvt_pk_bf16_f32 v96, v98, v99
    v_lshlrev_b32 v98, 16, v96
    v_and_b32 v99, s54, v96
    v_pk_add_f32 v[98:99], v[98:99], s[52:53]
    v_cvt_pk_bf16_f32 v85, v98, v99
    v_cvt_pk_bf16_f32 v96, v24, v25
    v_lshlrev_b32 v98, 16, v96
    v_and_b32 v99, s54, v96
    v_pk_mul_f32 v[100:101], v[98:99], s[50:51]
    v_max_f32 v98, 0, v98
    v_min_f32 v100, 0, v100
    v_min_f32 v101, 0, v101
    v_exp_f32 v100, v100
    v_exp_f32 v101, v101
    v_max_f32 v99, 0, v99
    v_pk_add_f32 v[98:99], v[98:99], v[100:101]
    v_cvt_pk_bf16_f32 v96, v98, v99
    v_lshlrev_b32 v98, 16, v96
    v_and_b32 v99, s54, v96
    v_pk_add_f32 v[98:99], v[98:99], s[52:53]
    v_cvt_pk_bf16_f32 v82, v98, v99
    v_cvt_pk_bf16_f32 v96, v26, v27
    v_lshlrev_b32 v98, 16, v96
    v_and_b32 v99, s54, v96
    v_pk_mul_f32 v[100:101], v[98:99], s[50:51]
    v_max_f32 v98, 0, v98
    v_min_f32 v100, 0, v100
    v_min_f32 v101, 0, v101
    v_exp_f32 v100, v100
    v_exp_f32 v101, v101
    v_max_f32 v99, 0, v99
    v_pk_add_f32 v[98:99], v[98:99], v[100:101]
    v_cvt_pk_bf16_f32 v96, v98, v99
    v_lshlrev_b32 v98, 16, v96
    v_and_b32 v99, s54, v96
    v_pk_add_f32 v[98:99], v[98:99], s[52:53]
    v_cvt_pk_bf16_f32 v83, v98, v99
    v_cvt_pk_bf16_f32 v96, v28, v29
    v_lshlrev_b32 v98, 16, v96
    v_and_b32 v99, s54, v96
    v_pk_mul_f32 v[100:101], v[98:99], s[50:51]
    v_max_f32 v98, 0, v98
    v_min_f32 v100, 0, v100
    v_min_f32 v101, 0, v101
    v_exp_f32 v100, v100
    v_exp_f32 v101, v101
    v_max_f32 v99, 0, v99
    v_pk_add_f32 v[98:99], v[98:99], v[100:101]
    v_cvt_pk_bf16_f32 v96, v98, v99
    v_lshlrev_b32 v98, 16, v96
    v_and_b32 v99, s54, v96
    v_pk_add_f32 v[98:99], v[98:99], s[52:53]
    v_cvt_pk_bf16_f32 v86, v98, v99
    v_cvt_pk_bf16_f32 v96, v30, v31
    v_lshlrev_b32 v98, 16, v96
    v_and_b32 v99, s54, v96
    v_pk_mul_f32 v[100:101], v[98:99], s[50:51]
    v_max_f32 v98, 0, v98
    v_min_f32 v100, 0, v100
    v_min_f32 v101, 0, v101
    v_exp_f32 v100, v100
    v_exp_f32 v101, v101
    v_max_f32 v99, 0, v99
    v_pk_add_f32 v[98:99], v[98:99], v[100:101]
    v_cvt_pk_bf16_f32 v96, v98, v99
    v_lshlrev_b32 v98, 16, v96
    v_and_b32 v99, s54, v96
    v_pk_add_f32 v[98:99], v[98:99], s[52:53]
    v_cvt_pk_bf16_f32 v87, v98, v99
    s_waitcnt vmcnt(63)
    v_mfma_f32_16x16x32_bf16 v[16:19], a[0:3], v[128:131], 0
    v_mfma_f32_16x16x32_bf16 v[20:23], a[56:59], v[128:131], 0
    buffer_load_dwordx4 v[128:131], v2, s[4:7], s41 offen offset:0 sc1
    s_waitcnt vmcnt(63)
    v_mfma_f32_16x16x32_bf16 v[16:19], a[4:7], v[132:135], v[16:19]
    v_mfma_f32_16x16x32_bf16 v[20:23], a[60:63], v[132:135], v[20:23]
    buffer_load_dwordx4 v[132:135], v2, s[4:7], s41 offen offset:1024 sc1
    s_waitcnt vmcnt(63)
    v_mfma_f32_16x16x32_bf16 v[16:19], a[8:11], v[136:139], v[16:19]
    v_mfma_f32_16x16x32_bf16 v[20:23], a[64:67], v[136:139], v[20:23]
    buffer_load_dwordx4 v[136:139], v2, s[4:7], s41 offen offset:2048 sc1
    s_waitcnt vmcnt(63)
    v_mfma_f32_16x16x32_bf16 v[16:19], a[12:15], v[140:143], v[16:19]
    v_mfma_f32_16x16x32_bf16 v[20:23], a[68:71], v[140:143], v[20:23]
    buffer_load_dwordx4 v[140:143], v2, s[4:7], s41 offen offset:3072 sc1
    s_add_u32 s41, s41, 4096
    s_waitcnt vmcnt(63)
    v_mfma_f32_16x16x32_bf16 v[16:19], a[16:19], v[144:147], v[16:19]
    v_mfma_f32_16x16x32_bf16 v[20:23], a[72:75], v[144:147], v[20:23]
    buffer_load_dwordx4 v[144:147], v2, s[4:7], s41 offen offset:0 sc1
    s_waitcnt vmcnt(63)
    v_mfma_f32_16x16x32_bf16 v[16:19], a[20:23], v[148:151], v[16:19]
    v_mfma_f32_16x16x32_bf16 v[20:23], a[76:79], v[148:151], v[20:23]
    buffer_load_dwordx4 v[148:151], v2, s[4:7], s41 offen offset:1024 sc1
    s_waitcnt vmcnt(63)
    v_mfma_f32_16x16x32_bf16 v[16:19], a[24:27], v[152:155], v[16:19]
    v_mfma_f32_16x16x32_bf16 v[20:23], a[80:83], v[152:155], v[20:23]
    buffer_load_dwordx4 v[152:155], v2, s[4:7], s41 offen offset:2048 sc1
    s_waitcnt vmcnt(63)
    v_mfma_f32_16x16x32_bf16 v[16:19], a[28:31], v[156:159], v[16:19]
    v_mfma_f32_16x16x32_bf16 v[20:23], a[84:87], v[156:159], v[20:23]
    buffer_load_dwordx4 v[156:159], v2, s[4:7], s41 offen offset:3072 sc1
    s_add_u32 s41, s41, 4096
    s_waitcnt vmcnt(63)
    v_mfma_f32_16x16x32_bf16 v[16:19], a[32:35], v[160:163], v[16:19]
    v_mfma_f32_16x16x32_bf16 v[20:23], a[88:91], v[160:163], v[20:23]
    buffer_load_dwordx4 v[160:163], v2, s[4:7], s41 offen offset:0 sc1
    s_waitcnt vmcnt(63)
    v_mfma_f32_16x16x32_bf16 v[16:19], a[36:39], v[164:167], v[16:19]
    v_mfma_f32_16x16x32_bf16 v[20:23], a[92:95], v[164:167], v[20:23]
    buffer_load_dwordx4 v[164:167], v2, s[4:7], s41 offen offset:1024 sc1
    s_waitcnt vmcnt(63)
    v_mfma_f32_16x16x32_bf16 v[16:19], a[40:43], v[168:171], v[16:19]
    v_mfma_f32_16x16x32_bf16 v[20:23], a[96:99], v[168:171], v[20:23]
    buffer_load_dwordx4 v[168:171], v2, s[4:7], s41 offen offset:2048 sc1
    s_waitcnt vmcnt(63)
    v_mfma_f32_16x16x32_bf16 v[16:19], a[44:47], v[172:175], v[16:19]
    v_mfma_f32_16x16x32_bf16 v[20:23], a[100:103], v[172:175], v[20:23]
    buffer_load_dwordx4 v[172:175], v2, s[4:7], s41 offen offset:3072 sc1
    s_add_u32 s41, s41, 4096
    s_waitcnt vmcnt(63)
    v_mfma_f32_16x16x32_bf16 v[16:19], a[48:51], v[176:179], v[16:19]
    v_mfma_f32_16x16x32_bf16 v[20:23], a[104:107], v[176:179], v[20:23]
    buffer_load_dwordx4 v[176:179], v2, s[4:7], s41 offen offset:0 sc1
    s_waitcnt vmcnt(63)
    v_mfma_f32_16x16x32_bf16 v[16:19], a[52:55], v[180:183], v[16:19]
    v_mfma_f32_16x16x32_bf16 v[20:23], a[108:111], v[180:183], v[20:23]
    buffer_load_dwordx4 v[180:183], v2, s[4:7], s41 offen offset:1024 sc1
    s_waitcnt vmcnt(63)
    v_mfma_f32_16x16x32_bf16 v[24:27], a[0:3], v[184:187], 0
    v_mfma_f32_16x16x32_bf16 v[28:31], a[56:59], v[184:187], 0
    buffer_load_dwordx4 v[184:187], v2, s[4:7], s41 offen offset:2048 sc1
    s_waitcnt vmcnt(63)
    v_mfma_f32_16x16x32_bf16 v[24:27], a[4:7], v[188:191], v[24:27]
    v_mfma_f32_16x16x32_bf16 v[28:31], a[60:63], v[188:191], v[28:31]
    buffer_load_dwordx4 v[188:191], v2, s[4:7], s41 offen offset:3072 sc1
    s_add_u32 s41, s41, 4096
    s_waitcnt vmcnt(63)
    v_mfma_f32_16x16x32_bf16 v[24:27], a[8:11], v[192:195], v[24:27]
    v_mfma_f32_16x16x32_bf16 v[28:31], a[64:67], v[192:195], v[28:31]
    buffer_load_dwordx4 v[192:195], v2, s[4:7], s41 offen offset:0 sc1
    s_waitcnt vmcnt(63)
    v_mfma_f32_16x16x32_bf16 v[24:27], a[12:15], v[196:199], v[24:27]
    v_mfma_f32_16x16x32_bf16 v[28:31], a[68:71], v[196:199], v[28:31]
    buffer_load_dwordx4 v[196:199], v2, s[4:7], s41 offen offset:1024 sc1
    s_waitcnt vmcnt(63)
    v_mfma_f32_16x16x32_bf16 v[24:27], a[16:19], v[200:203], v[24:27]
    v_mfma_f32_16x16x32_bf16 v[28:31], a[72:75], v[200:203], v[28:31]
    buffer_load_dwordx4 v[200:203], v2, s[4:7], s41 offen offset:2048 sc1
    s_waitcnt vmcnt(63)
    v_mfma_f32_16x16x32_bf16 v[24:27], a[20:23], v[204:207], v[24:27]
    v_mfma_f32_16x16x32_bf16 v[28:31], a[76:79], v[204:207], v[28:31]
    buffer_load_dwordx4 v[204:207], v2, s[4:7], s41 offen offset:3072 sc1
    s_add_u32 s41, s41, 4096
    s_waitcnt vmcnt(63)
    v_mfma_f32_16x16x32_bf16 v[24:27], a[24:27], v[208:211], v[24:27]
    v_mfma_f32_16x16x32_bf16 v[28:31], a[80:83], v[208:211], v[28:31]
    buffer_load_dwordx4 v[208:211], v2, s[4:7], s41 offen offset:0 sc1
    s_waitcnt vmcnt(63)
    v_mfma_f32_16x16x32_bf16 v[24:27], a[28:31], v[212:215], v[24:27]
    v_mfma_f32_16x16x32_bf16 v[28:31], a[84:87], v[212:215], v[28:31]
    buffer_load_dwordx4 v[212:215], v2, s[4:7], s41 offen offset:1024 sc1
    s_waitcnt vmcnt(63)
    v_mfma_f32_16x16x32_bf16 v[24:27], a[32:35], v[216:219], v[24:27]
    v_mfma_f32_16x16x32_bf16 v[28:31], a[88:91], v[216:219], v[28:31]
    buffer_load_dwordx4 v[216:219], v2, s[4:7], s41 offen offset:2048 sc1
    s_waitcnt vmcnt(63)
    v_mfma_f32_16x16x32_bf16 v[24:27], a[36:39], v[220:223], v[24:27]
    v_mfma_f32_16x16x32_bf16 v[28:31], a[92:95], v[220:223], v[28:31]
    buffer_load_dwordx4 v[220:223], v2, s[4:7], s41 offen offset:3072 sc1
    s_add_u32 s41, s41, 4096
    s_waitcnt vmcnt(63)
    v_mfma_f32_16x16x32_bf16 v[24:27], a[40:43], v[224:227], v[24:27]
    v_mfma_f32_16x16x32_bf16 v[28:31], a[96:99], v[224:227], v[28:31]
    buffer_load_dwordx4 v[224:227], v2, s[4:7], s41 offen offset:0 sc1
    s_waitcnt vmcnt(63)
    v_mfma_f32_16x16x32_bf16 v[24:27], a[44:47], v[228:231], v[24:27]
    v_mfma_f32_16x16x32_bf16 v[28:31], a[100:103], v[228:231], v[28:31]
    buffer_load_dwordx4 v[228:231], v2, s[4:7], s41 offen offset:1024 sc1
    s_waitcnt vmcnt(63)
    v_mfma_f32_16x16x32_bf16 v[24:27], a[48:51], v[232:235], v[24:27]
    v_mfma_f32_16x16x32_bf16 v[28:31], a[104:107], v[232:235], v[28:31]
    buffer_load_dwordx4 v[232:235], v2, s[4:7], s41 offen offset:2048 sc1
    s_waitcnt vmcnt(63)
    v_mfma_f32_16x16x32_bf16 v[24:27], a[52:55], v[236:239], v[24:27]
    v_mfma_f32_16x16x32_bf16 v[28:31], a[108:111], v[236:239], v[28:31]
    buffer_load_dwordx4 v[236:239], v2, s[4:7], s41 offen offset:3072 sc1
    s_add_u32 s41, s41, 4096
    v_cvt_pk_bf16_f32 v96, v16, v17
    v_lshlrev_b32 v98, 16, v96
    v_and_b32 v99, s54, v96
    v_pk_mul_f32 v[100:101], v[98:99], s[50:51]
    v_max_f32 v98, 0, v98
    v_min_f32 v100, 0, v100
    v_min_f32 v101, 0, v101
    v_exp_f32 v100, v100
    v_exp_f32 v101, v101
    v_max_f32 v99, 0, v99
    v_pk_add_f32 v[98:99], v[98:99], v[100:101]
    v_cvt_pk_bf16_f32 v96, v98, v99
    v_lshlrev_b32 v98, 16, v96
    v_and_b32 v99, s54, v96
    v_pk_add_f32 v[98:99], v[98:99], s[52:53]
    v_cvt_pk_bf16_f32 v32, v98, v99
    v_cvt_pk_bf16_f32 v96, v18, v19
    v_lshlrev_b32 v98, 16, v96
    v_and_b32 v99, s54, v96
    v_pk_mul_f32 v[100:101], v[98:99], s[50:51]
    v_max_f32 v98, 0, v98
    v_min_f32 v100, 0, v100
    v_min_f32 v101, 0, v101
    v_exp_f32 v100, v100
    v_exp_f32 v101, v101
    v_max_f32 v99, 0, v99
    v_pk_add_f32 v[98:99], v[98:99], v[100:101]
    v_cvt_pk_bf16_f32 v96, v98, v99
    v_lshlrev_b32 v98, 16, v96
    v_and_b32 v99, s54, v96
    v_pk_add_f32 v[98:99], v[98:99], s[52:53]
    v_cvt_pk_bf16_f32 v33, v98, v99
    v_cvt_pk_bf16_f32 v96, v20, v21
    v_lshlrev_b32 v98, 16, v96
    v_and_b32 v99, s54, v96
    v_pk_mul_f32 v[100:101], v[98:99], s[50:51]
    v_max_f32 v98, 0, v98
    v_min_f32 v100, 0, v100
    v_min_f32 v101, 0, v101
    v_exp_f32 v100, v100
    v_exp_f32 v101, v101
    v_max_f32 v99, 0, v99
    v_pk_add_f32 v[98:99], v[98:99], v[100:101]
    v_cvt_pk_bf16_f32 v96, v98, v99
    v_lshlrev_b32 v98, 16, v96
    v_and_b32 v99, s54, v96
    v_pk_add_f32 v[98:99], v[98:99], s[52:53]
    v_cvt_pk_bf16_f32 v34, v98, v99
    v_cvt_pk_bf16_f32 v96, v22, v23
    v_lshlrev_b32 v98, 16, v96
    v_and_b32 v99, s54, v96
    v_pk_mul_f32 v[100:101], v[98:99], s[50:51]
    v_max_f32 v98, 0, v98
    v_min_f32 v100, 0, v100
    v_min_f32 v101, 0, v101
    v_exp_f32 v100, v100
    v_exp_f32 v101, v101
    v_max_f32 v99, 0, v99
    v_pk_add_f32 v[98:99], v[98:99], v[100:101]
    v_cvt_pk_bf16_f32 v96, v98, v99
    v_lshlrev_b32 v98, 16, v96
    v_and_b32 v99, s54, v96
    v_pk_add_f32 v[98:99], v[98:99], s[52:53]
    v_cvt_pk_bf16_f32 v35, v98, v99
    v_cvt_pk_bf16_f32 v96, v24, v25
    v_lshlrev_b32 v98, 16, v96
    v_and_b32 v99, s54, v96
    v_pk_mul_f32 v[100:101], v[98:99], s[50:51]
    v_max_f32 v98, 0, v98
    v_min_f32 v100, 0, v100
    v_min_f32 v101, 0, v101
    v_exp_f32 v100, v100
    v_exp_f32 v101, v101
    v_max_f32 v99, 0, v99
    v_pk_add_f32 v[98:99], v[98:99], v[100:101]
    v_cvt_pk_bf16_f32 v96, v98, v99
    v_lshlrev_b32 v98, 16, v96
    v_and_b32 v99, s54, v96
    v_pk_add_f32 v[98:99], v[98:99], s[52:53]
    v_cvt_pk_bf16_f32 v36, v98, v99
    v_cvt_pk_bf16_f32 v96, v26, v27
    v_lshlrev_b32 v98, 16, v96
    v_and_b32 v99, s54, v96
    v_pk_mul_f32 v[100:101], v[98:99], s[50:51]
    v_max_f32 v98, 0, v98
    v_min_f32 v100, 0, v100
    v_min_f32 v101, 0, v101
    v_exp_f32 v100, v100
    v_exp_f32 v101, v101
    v_max_f32 v99, 0, v99
    v_pk_add_f32 v[98:99], v[98:99], v[100:101]
    v_cvt_pk_bf16_f32 v96, v98, v99
    v_lshlrev_b32 v98, 16, v96
    v_and_b32 v99, s54, v96
    v_pk_add_f32 v[98:99], v[98:99], s[52:53]
    v_cvt_pk_bf16_f32 v37, v98, v99
    v_cvt_pk_bf16_f32 v96, v28, v29
    v_lshlrev_b32 v98, 16, v96
    v_and_b32 v99, s54, v96
    v_pk_mul_f32 v[100:101], v[98:99], s[50:51]
    v_max_f32 v98, 0, v98
    v_min_f32 v100, 0, v100
    v_min_f32 v101, 0, v101
    v_exp_f32 v100, v100
    v_exp_f32 v101, v101
    v_max_f32 v99, 0, v99
    v_pk_add_f32 v[98:99], v[98:99], v[100:101]
    v_cvt_pk_bf16_f32 v96, v98, v99
    v_lshlrev_b32 v98, 16, v96
    v_and_b32 v99, s54, v96
    v_pk_add_f32 v[98:99], v[98:99], s[52:53]
    v_cvt_pk_bf16_f32 v38, v98, v99
    v_cvt_pk_bf16_f32 v96, v30, v31
    v_lshlrev_b32 v98, 16, v96
    v_and_b32 v99, s54, v96
    v_pk_mul_f32 v[100:101], v[98:99], s[50:51]
    v_max_f32 v98, 0, v98
    v_min_f32 v100, 0, v100
    v_min_f32 v101, 0, v101
    v_exp_f32 v100, v100
    v_exp_f32 v101, v101
    v_max_f32 v99, 0, v99
    v_pk_add_f32 v[98:99], v[98:99], v[100:101]
    v_cvt_pk_bf16_f32 v96, v98, v99
    v_lshlrev_b32 v98, 16, v96
    v_and_b32 v99, s54, v96
    v_pk_add_f32 v[98:99], v[98:99], s[52:53]
    v_cvt_pk_bf16_f32 v39, v98, v99
    s_waitcnt vmcnt(55)
    v_mfma_f32_16x16x32_bf16 v[16:19], a[0:3], a[112:115], 0
    v_mfma_f32_16x16x32_bf16 v[20:23], a[56:59], a[112:115], 0
    buffer_load_dwordx4 a[112:115], v2, s[4:7], s41 offen offset:0 sc1
    s_waitcnt vmcnt(55)
    v_mfma_f32_16x16x32_bf16 v[16:19], a[4:7], a[116:119], v[16:19]
    v_mfma_f32_16x16x32_bf16 v[20:23], a[60:63], a[116:119], v[20:23]
    buffer_load_dwordx4 a[116:119], v2, s[4:7], s41 offen offset:1024 sc1
    s_waitcnt vmcnt(55)
    v_mfma_f32_16x16x32_bf16 v[16:19], a[8:11], a[120:123], v[16:19]
    v_mfma_f32_16x16x32_bf16 v[20:23], a[64:67], a[120:123], v[20:23]
    buffer_load_dwordx4 a[120:123], v2, s[4:7], s41 offen offset:2048 sc1
    s_waitcnt vmcnt(55)
    v_mfma_f32_16x16x32_bf16 v[16:19], a[12:15], a[124:127], v[16:19]
    v_mfma_f32_16x16x32_bf16 v[20:23], a[68:71], a[124:127], v[20:23]
    buffer_load_dwordx4 a[124:127], v2, s[4:7], s41 offen offset:3072 sc1
    s_add_u32 s41, s41, 4096
    s_waitcnt vmcnt(55)
    v_mfma_f32_16x16x32_bf16 v[16:19], a[16:19], a[128:131], v[16:19]
    v_mfma_f32_16x16x32_bf16 v[20:23], a[72:75], a[128:131], v[20:23]
    buffer_load_dwordx4 a[128:131], v2, s[4:7], s41 offen offset:0 sc1
    s_waitcnt vmcnt(55)
    v_mfma_f32_16x16x32_bf16 v[16:19], a[20:23], a[132:135], v[16:19]
    v_mfma_f32_16x16x32_bf16 v[20:23], a[76:79], a[132:135], v[20:23]
    buffer_load_dwordx4 a[132:135], v2, s[4:7], s41 offen offset:1024 sc1
    s_waitcnt vmcnt(55)
    v_mfma_f32_16x16x32_bf16 v[16:19], a[24:27], a[136:139], v[16:19]
    v_mfma_f32_16x16x32_bf16 v[20:23], a[80:83], a[136:139], v[20:23]
    buffer_load_dwordx4 a[136:139], v2, s[4:7], s41 offen offset:2048 sc1
    s_waitcnt vmcnt(55)
    v_mfma_f32_16x16x32_bf16 v[16:19], a[28:31], a[140:143], v[16:19]
    v_mfma_f32_16x16x32_bf16 v[20:23], a[84:87], a[140:143], v[20:23]
    buffer_load_dwordx4 a[140:143], v2, s[4:7], s41 offen offset:3072 sc1
    s_add_u32 s41, s41, 4096
    s_waitcnt vmcnt(55)
    v_mfma_f32_16x16x32_bf16 v[16:19], a[32:35], a[144:147], v[16:19]
    v_mfma_f32_16x16x32_bf16 v[20:23], a[88:91], a[144:147], v[20:23]
    buffer_load_dwordx4 a[144:147], v2, s[4:7], s41 offen offset:0 sc1
    s_waitcnt vmcnt(55)
    v_mfma_f32_16x16x32_bf16 v[16:19], a[36:39], a[148:151], v[16:19]
    v_mfma_f32_16x16x32_bf16 v[20:23], a[92:95], a[148:151], v[20:23]
    buffer_load_dwordx4 a[148:151], v2, s[4:7], s41 offen offset:1024 sc1
    s_waitcnt vmcnt(55)
    v_mfma_f32_16x16x32_bf16 v[16:19], a[40:43], a[152:155], v[16:19]
    v_mfma_f32_16x16x32_bf16 v[20:23], a[96:99], a[152:155], v[20:23]
    buffer_load_dwordx4 a[152:155], v2, s[4:7], s41 offen offset:2048 sc1
    s_waitcnt vmcnt(55)
    v_mfma_f32_16x16x32_bf16 v[16:19], a[44:47], a[156:159], v[16:19]
    v_mfma_f32_16x16x32_bf16 v[20:23], a[100:103], a[156:159], v[20:23]
    buffer_load_dwordx4 a[156:159], v2, s[4:7], s41 offen offset:3072 sc1
    s_add_u32 s41, s41, 4096
    s_waitcnt vmcnt(55)
    v_mfma_f32_16x16x32_bf16 v[16:19], a[48:51], a[160:163], v[16:19]
    v_mfma_f32_16x16x32_bf16 v[20:23], a[104:107], a[160:163], v[20:23]
    buffer_load_dwordx4 a[160:163], v2, s[4:7], s41 offen offset:0 sc1
    s_waitcnt vmcnt(55)
    v_mfma_f32_16x16x32_bf16 v[16:19], a[52:55], a[164:167], v[16:19]
    v_mfma_f32_16x16x32_bf16 v[20:23], a[108:111], a[164:167], v[20:23]
    buffer_load_dwordx4 a[164:167], v2, s[4:7], s41 offen offset:1024 sc1
    s_waitcnt vmcnt(55)
    v_mfma_f32_16x16x32_bf16 v[24:27], a[0:3], a[168:171], v[124:127]
    v_mfma_f32_16x16x32_bf16 v[28:31], a[56:59], a[168:171], v[124:127]
    buffer_load_dwordx4 a[168:171], v2, s[4:7], s41 offen offset:2048 sc1
    s_waitcnt vmcnt(55)
    v_mfma_f32_16x16x32_bf16 v[24:27], a[4:7], a[172:175], v[24:27]
    v_mfma_f32_16x16x32_bf16 v[28:31], a[60:63], a[172:175], v[28:31]
    buffer_load_dwordx4 a[172:175], v2, s[4:7], s41 offen offset:3072 sc1
    s_add_u32 s41, s41, 4096
    s_waitcnt vmcnt(55)
    v_mfma_f32_16x16x32_bf16 v[24:27], a[8:11], a[176:179], v[24:27]
    v_mfma_f32_16x16x32_bf16 v[28:31], a[64:67], a[176:179], v[28:31]
    buffer_load_dwordx4 a[176:179], v2, s[4:7], s41 offen offset:0 sc1
    s_waitcnt vmcnt(55)
    v_mfma_f32_16x16x32_bf16 v[24:27], a[12:15], a[180:183], v[24:27]
    v_mfma_f32_16x16x32_bf16 v[28:31], a[68:71], a[180:183], v[28:31]
    buffer_load_dwordx4 a[180:183], v2, s[4:7], s41 offen offset:1024 sc1
    s_waitcnt vmcnt(55)
    v_mfma_f32_16x16x32_bf16 v[24:27], a[16:19], a[184:187], v[24:27]
    v_mfma_f32_16x16x32_bf16 v[28:31], a[72:75], a[184:187], v[28:31]
    buffer_load_dwordx4 a[184:187], v2, s[4:7], s41 offen offset:2048 sc1
    s_waitcnt vmcnt(55)
    v_mfma_f32_16x16x32_bf16 v[24:27], a[20:23], a[188:191], v[24:27]
    v_mfma_f32_16x16x32_bf16 v[28:31], a[76:79], a[188:191], v[28:31]
    buffer_load_dwordx4 a[188:191], v2, s[4:7], s41 offen offset:3072 sc1
    s_add_u32 s41, s41, 4096
    s_waitcnt vmcnt(55)
    v_mfma_f32_16x16x32_bf16 v[24:27], a[24:27], a[192:195], v[24:27]
    v_mfma_f32_16x16x32_bf16 v[28:31], a[80:83], a[192:195], v[28:31]
    buffer_load_dwordx4 a[192:195], v2, s[4:7], s41 offen offset:0 sc1
    s_waitcnt vmcnt(55)
    v_mfma_f32_16x16x32_bf16 v[24:27], a[28:31], a[196:199], v[24:27]
    v_mfma_f32_16x16x32_bf16 v[28:31], a[84:87], a[196:199], v[28:31]
    buffer_load_dwordx4 a[196:199], v2, s[4:7], s41 offen offset:1024 sc1
    s_waitcnt vmcnt(55)
    v_mfma_f32_16x16x32_bf16 v[24:27], a[32:35], a[200:203], v[24:27]
    v_mfma_f32_16x16x32_bf16 v[28:31], a[88:91], a[200:203], v[28:31]
    buffer_load_dwordx4 a[200:203], v2, s[4:7], s41 offen offset:2048 sc1
    s_waitcnt vmcnt(55)
    v_mfma_f32_16x16x32_bf16 v[24:27], a[36:39], a[204:207], v[24:27]
    v_mfma_f32_16x16x32_bf16 v[28:31], a[92:95], a[204:207], v[28:31]
    buffer_load_dwordx4 a[204:207], v2, s[4:7], s41 offen offset:3072 sc1
    s_add_u32 s41, s41, 4096
    s_waitcnt vmcnt(55)
    v_mfma_f32_16x16x32_bf16 v[24:27], a[40:43], a[208:211], v[24:27]
    v_mfma_f32_16x16x32_bf16 v[28:31], a[96:99], a[208:211], v[28:31]
    buffer_load_dwordx4 a[208:211], v2, s[4:7], s41 offen offset:0 sc1
    s_waitcnt vmcnt(55)
    v_mfma_f32_16x16x32_bf16 v[24:27], a[44:47], a[212:215], v[24:27]
    v_mfma_f32_16x16x32_bf16 v[28:31], a[100:103], a[212:215], v[28:31]
    buffer_load_dwordx4 a[212:215], v2, s[4:7], s41 offen offset:1024 sc1
    s_waitcnt vmcnt(55)
    v_mfma_f32_16x16x32_bf16 v[24:27], a[48:51], a[216:219], v[24:27]
    v_mfma_f32_16x16x32_bf16 v[28:31], a[104:107], a[216:219], v[28:31]
    buffer_load_dwordx4 a[216:219], v2, s[4:7], s41 offen offset:2048 sc1
    s_waitcnt vmcnt(55)
    v_mfma_f32_16x16x32_bf16 v[24:27], a[52:55], a[220:223], v[24:27]
    v_mfma_f32_16x16x32_bf16 v[28:31], a[108:111], a[220:223], v[28:31]
    buffer_load_dwordx4 a[220:223], v2, s[4:7], s41 offen offset:3072 sc1
    s_add_u32 s41, s41, 4096
    v_cvt_pk_bf16_f32 v40, v16, v17
    v_cvt_pk_bf16_f32 v41, v18, v19
    v_cvt_pk_bf16_f32 v42, v20, v21
    v_cvt_pk_bf16_f32 v43, v22, v23
    v_cvt_pk_bf16_f32 v44, v24, v25
    v_cvt_pk_bf16_f32 v45, v26, v27
    v_cvt_pk_bf16_f32 v46, v28, v29
    v_cvt_pk_bf16_f32 v47, v30, v31
    v_mfma_f32_16x16x32_bf16 v[48:51], v[32:35], v[40:43], 0
    v_mfma_f32_16x16x32_bf16 v[52:55], v[32:35], v[44:47], 0
    v_mfma_f32_16x16x32_bf16 v[56:59], v[36:39], v[40:43], 0
    v_mfma_f32_16x16x32_bf16 v[60:63], v[36:39], v[44:47], 0
    s_nop 1
    buffer_atomic_add_f32 v48, v6, s[4:7], s42 offen offset:0
    buffer_atomic_add_f32 v49, v6, s[4:7], s42 offen offset:256
    buffer_atomic_add_f32 v50, v6, s[4:7], s42 offen offset:512
    buffer_atomic_add_f32 v51, v6, s[4:7], s42 offen offset:768
    buffer_atomic_add_f32 v52, v6, s[4:7], s42 offen offset:1024
    buffer_atomic_add_f32 v53, v6, s[4:7], s42 offen offset:1280
    buffer_atomic_add_f32 v54, v6, s[4:7], s42 offen offset:1536
    buffer_atomic_add_f32 v55, v6, s[4:7], s42 offen offset:1792
    buffer_atomic_add_f32 v56, v6, s[4:7], s42 offen offset:2048
    buffer_atomic_add_f32 v57, v6, s[4:7], s42 offen offset:2304
    buffer_atomic_add_f32 v58, v6, s[4:7], s42 offen offset:2560
    buffer_atomic_add_f32 v59, v6, s[4:7], s42 offen offset:2816
    buffer_atomic_add_f32 v60, v6, s[4:7], s42 offen offset:3072
    buffer_atomic_add_f32 v61, v6, s[4:7], s42 offen offset:3328
    buffer_atomic_add_f32 v62, v6, s[4:7], s42 offen offset:3584
    buffer_atomic_add_f32 v63, v6, s[4:7], s42 offen offset:3840
    s_add_u32 s42, s42, 4096
    s_waitcnt vmcnt(63)
    v_mfma_f32_16x16x32_bf16 v[16:19], v[128:131], a[0:3], 0
    v_mfma_f32_16x16x32_bf16 v[20:23], v[128:131], a[56:59], 0
    buffer_load_dwordx4 v[128:131], v2, s[4:7], s41 offen offset:0 sc1
    s_waitcnt vmcnt(63)
    v_mfma_f32_16x16x32_bf16 v[16:19], v[132:135], a[4:7], v[16:19]
    v_mfma_f32_16x16x32_bf16 v[20:23], v[132:135], a[60:63], v[20:23]
    buffer_load_dwordx4 v[132:135], v2, s[4:7], s41 offen offset:1024 sc1
    s_waitcnt vmcnt(63)
    v_mfma_f32_16x16x32_bf16 v[16:19], v[136:139], a[8:11], v[16:19]
    v_mfma_f32_16x16x32_bf16 v[20:23], v[136:139], a[64:67], v[20:23]
    buffer_load_dwordx4 v[136:139], v2, s[4:7], s41 offen offset:2048 sc1
    s_waitcnt vmcnt(63)
    v_mfma_f32_16x16x32_bf16 v[16:19], v[140:143], a[12:15], v[16:19]
    v_mfma_f32_16x16x32_bf16 v[20:23], v[140:143], a[68:71], v[20:23]
    buffer_load_dwordx4 v[140:143], v2, s[4:7], s41 offen offset:3072 sc1
    s_add_u32 s41, s41, 4096
    s_waitcnt vmcnt(63)
    v_mfma_f32_16x16x32_bf16 v[16:19], v[144:147], a[16:19], v[16:19]
    v_mfma_f32_16x16x32_bf16 v[20:23], v[144:147], a[72:75], v[20:23]
    buffer_load_dwordx4 v[144:147], v2, s[4:7], s41 offen offset:0 sc1
    s_waitcnt vmcnt(63)
    v_mfma_f32_16x16x32_bf16 v[16:19], v[148:151], a[20:23], v[16:19]
    v_mfma_f32_16x16x32_bf16 v[20:23], v[148:151], a[76:79], v[20:23]
    buffer_load_dwordx4 v[148:151], v2, s[4:7], s41 offen offset:1024 sc1
    s_waitcnt vmcnt(63)
    v_mfma_f32_16x16x32_bf16 v[16:19], v[152:155], a[24:27], v[16:19]
    v_mfma_f32_16x16x32_bf16 v[20:23], v[152:155], a[80:83], v[20:23]
    buffer_load_dwordx4 v[152:155], v2, s[4:7], s41 offen offset:2048 sc1
    s_waitcnt vmcnt(63)
    v_mfma_f32_16x16x32_bf16 v[16:19], v[156:159], a[28:31], v[16:19]
    v_mfma_f32_16x16x32_bf16 v[20:23], v[156:159], a[84:87], v[20:23]
    buffer_load_dwordx4 v[156:159], v2, s[4:7], s41 offen offset:3072 sc1
    s_add_u32 s41, s41, 4096
    s_waitcnt vmcnt(63)
    v_mfma_f32_16x16x32_bf16 v[16:19], v[160:163], a[32:35], v[16:19]
    v_mfma_f32_16x16x32_bf16 v[20:23], v[160:163], a[88:91], v[20:23]
    buffer_load_dwordx4 v[160:163], v2, s[4:7], s41 offen offset:0 sc1
    s_waitcnt vmcnt(63)
    v_mfma_f32_16x16x32_bf16 v[16:19], v[164:167], a[36:39], v[16:19]
    v_mfma_f32_16x16x32_bf16 v[20:23], v[164:167], a[92:95], v[20:23]
    buffer_load_dwordx4 v[164:167], v2, s[4:7], s41 offen offset:1024 sc1
    s_waitcnt vmcnt(63)
    v_mfma_f32_16x16x32_bf16 v[16:19], v[168:171], a[40:43], v[16:19]
    v_mfma_f32_16x16x32_bf16 v[20:23], v[168:171], a[96:99], v[20:23]
    buffer_load_dwordx4 v[168:171], v2, s[4:7], s41 offen offset:2048 sc1
    s_waitcnt vmcnt(63)
    v_mfma_f32_16x16x32_bf16 v[16:19], v[172:175], a[44:47], v[16:19]
    v_mfma_f32_16x16x32_bf16 v[20:23], v[172:175], a[100:103], v[20:23]
    buffer_load_dwordx4 v[172:175], v2, s[4:7], s41 offen offset:3072 sc1
    s_add_u32 s41, s41, 4096
    s_waitcnt vmcnt(63)
    v_mfma_f32_16x16x32_bf16 v[16:19], v[176:179], a[48:51], v[16:19]
    v_mfma_f32_16x16x32_bf16 v[20:23], v[176:179], a[104:107], v[20:23]
    buffer_load_dwordx4 v[176:179], v2, s[4:7], s41 offen offset:0 sc1
    s_waitcnt vmcnt(63)
    v_mfma_f32_16x16x32_bf16 v[16:19], v[180:183], a[52:55], v[16:19]
    v_mfma_f32_16x16x32_bf16 v[20:23], v[180:183], a[108:111], v[20:23]
    buffer_load_dwordx4 v[180:183], v2, s[4:7], s41 offen offset:1024 sc1
    s_waitcnt vmcnt(63)
    v_mfma_f32_16x16x32_bf16 v[24:27], v[184:187], a[0:3], 0
    v_mfma_f32_16x16x32_bf16 v[28:31], v[184:187], a[56:59], 0
    buffer_load_dwordx4 v[184:187], v2, s[4:7], s41 offen offset:2048 sc1
    s_waitcnt vmcnt(63)
    v_mfma_f32_16x16x32_bf16 v[24:27], v[188:191], a[4:7], v[24:27]
    v_mfma_f32_16x16x32_bf16 v[28:31], v[188:191], a[60:63], v[28:31]
    buffer_load_dwordx4 v[188:191], v2, s[4:7], s41 offen offset:3072 sc1
    s_add_u32 s41, s41, 4096
    s_waitcnt vmcnt(63)
    v_mfma_f32_16x16x32_bf16 v[24:27], v[192:195], a[8:11], v[24:27]
    v_mfma_f32_16x16x32_bf16 v[28:31], v[192:195], a[64:67], v[28:31]
    buffer_load_dwordx4 v[192:195], v2, s[4:7], s41 offen offset:0 sc1
    s_waitcnt vmcnt(63)
    v_mfma_f32_16x16x32_bf16 v[24:27], v[196:199], a[12:15], v[24:27]
    v_mfma_f32_16x16x32_bf16 v[28:31], v[196:199], a[68:71], v[28:31]
    buffer_load_dwordx4 v[196:199], v2, s[4:7], s41 offen offset:1024 sc1
    s_waitcnt vmcnt(63)
    v_mfma_f32_16x16x32_bf16 v[24:27], v[200:203], a[16:19], v[24:27]
    v_mfma_f32_16x16x32_bf16 v[28:31], v[200:203], a[72:75], v[28:31]
    buffer_load_dwordx4 v[200:203], v2, s[4:7], s41 offen offset:2048 sc1
    s_waitcnt vmcnt(63)
    v_mfma_f32_16x16x32_bf16 v[24:27], v[204:207], a[20:23], v[24:27]
    v_mfma_f32_16x16x32_bf16 v[28:31], v[204:207], a[76:79], v[28:31]
    buffer_load_dwordx4 v[204:207], v2, s[4:7], s41 offen offset:3072 sc1
    s_add_u32 s41, s41, 4096
    s_waitcnt vmcnt(63)
    v_mfma_f32_16x16x32_bf16 v[24:27], v[208:211], a[24:27], v[24:27]
    v_mfma_f32_16x16x32_bf16 v[28:31], v[208:211], a[80:83], v[28:31]
    buffer_load_dwordx4 v[208:211], v2, s[4:7], s41 offen offset:0 sc1
    s_waitcnt vmcnt(63)
    v_mfma_f32_16x16x32_bf16 v[24:27], v[212:215], a[28:31], v[24:27]
    v_mfma_f32_16x16x32_bf16 v[28:31], v[212:215], a[84:87], v[28:31]
    buffer_load_dwordx4 v[212:215], v2, s[4:7], s41 offen offset:1024 sc1
    s_waitcnt vmcnt(63)
    v_mfma_f32_16x16x32_bf16 v[24:27], v[216:219], a[32:35], v[24:27]
    v_mfma_f32_16x16x32_bf16 v[28:31], v[216:219], a[88:91], v[28:31]
    buffer_load_dwordx4 v[216:219], v2, s[4:7], s41 offen offset:2048 sc1
    s_waitcnt vmcnt(63)
    v_mfma_f32_16x16x32_bf16 v[24:27], v[220:223], a[36:39], v[24:27]
    v_mfma_f32_16x16x32_bf16 v[28:31], v[220:223], a[92:95], v[28:31]
    buffer_load_dwordx4 v[220:223], v2, s[4:7], s41 offen offset:3072 sc1
    s_add_u32 s41, s41, 4096
    s_waitcnt vmcnt(63)
    v_mfma_f32_16x16x32_bf16 v[24:27], v[224:227], a[40:43], v[24:27]
    v_mfma_f32_16x16x32_bf16 v[28:31], v[224:227], a[96:99], v[28:31]
    buffer_load_dwordx4 v[224:227], v2, s[4:7], s41 offen offset:0 sc1
    s_waitcnt vmcnt(63)
    v_mfma_f32_16x16x32_bf16 v[24:27], v[228:231], a[44:47], v[24:27]
    v_mfma_f32_16x16x32_bf16 v[28:31], v[228:231], a[100:103], v[28:31]
    buffer_load_dwordx4 v[228:231], v2, s[4:7], s41 offen offset:1024 sc1
    s_waitcnt vmcnt(63)
    v_mfma_f32_16x16x32_bf16 v[24:27], v[232:235], a[48:51], v[24:27]
    v_mfma_f32_16x16x32_bf16 v[28:31], v[232:235], a[104:107], v[28:31]
    buffer_load_dwordx4 v[232:235], v2, s[4:7], s41 offen offset:2048 sc1
    s_waitcnt vmcnt(63)
    v_mfma_f32_16x16x32_bf16 v[24:27], v[236:239], a[52:55], v[24:27]
    v_mfma_f32_16x16x32_bf16 v[28:31], v[236:239], a[108:111], v[28:31]
    buffer_load_dwordx4 v[236:239], v2, s[4:7], s41 offen offset:3072 sc1
    s_add_u32 s41, s41, 4096
    v_cvt_pk_bf16_f32 v96, v16, v17
    v_lshlrev_b32 v98, 16, v96
    v_and_b32 v99, s54, v96
    v_pk_mul_f32 v[100:101], v[98:99], s[50:51]
    v_max_f32 v98, 0, v98
    v_min_f32 v100, 0, v100
    v_min_f32 v101, 0, v101
    v_exp_f32 v100, v100
    v_exp_f32 v101, v101
    v_max_f32 v99, 0, v99
    v_pk_add_f32 v[98:99], v[98:99], v[100:101]
    v_cvt_pk_bf16_f32 v96, v98, v99
    v_lshlrev_b32 v98, 16, v96
    v_and_b32 v99, s54, v96
    v_pk_add_f32 v[98:99], v[98:99], s[52:53]
    v_cvt_pk_bf16_f32 v88, v98, v99
    v_cvt_pk_bf16_f32 v96, v18, v19
    v_lshlrev_b32 v98, 16, v96
    v_and_b32 v99, s54, v96
    v_pk_mul_f32 v[100:101], v[98:99], s[50:51]
    v_max_f32 v98, 0, v98
    v_min_f32 v100, 0, v100
    v_min_f32 v101, 0, v101
    v_exp_f32 v100, v100
    v_exp_f32 v101, v101
    v_max_f32 v99, 0, v99
    v_pk_add_f32 v[98:99], v[98:99], v[100:101]
    v_cvt_pk_bf16_f32 v96, v98, v99
    v_lshlrev_b32 v98, 16, v96
    v_and_b32 v99, s54, v96
    v_pk_add_f32 v[98:99], v[98:99], s[52:53]
    v_cvt_pk_bf16_f32 v89, v98, v99
    v_cvt_pk_bf16_f32 v96, v20, v21
    v_lshlrev_b32 v98, 16, v96
    v_and_b32 v99, s54, v96
    v_pk_mul_f32 v[100:101], v[98:99], s[50:51]
    v_max_f32 v98, 0, v98
    v_min_f32 v100, 0, v100
    v_min_f32 v101, 0, v101
    v_exp_f32 v100, v100
    v_exp_f32 v101, v101
    v_max_f32 v99, 0, v99
    v_pk_add_f32 v[98:99], v[98:99], v[100:101]
    v_cvt_pk_bf16_f32 v96, v98, v99
    v_lshlrev_b32 v98, 16, v96
    v_and_b32 v99, s54, v96
    v_pk_add_f32 v[98:99], v[98:99], s[52:53]
    v_cvt_pk_bf16_f32 v92, v98, v99
    v_cvt_pk_bf16_f32 v96, v22, v23
    v_lshlrev_b32 v98, 16, v96
    v_and_b32 v99, s54, v96
    v_pk_mul_f32 v[100:101], v[98:99], s[50:51]
    v_max_f32 v98, 0, v98
    v_min_f32 v100, 0, v100
    v_min_f32 v101, 0, v101
    v_exp_f32 v100, v100
    v_exp_f32 v101, v101
    v_max_f32 v99, 0, v99
    v_pk_add_f32 v[98:99], v[98:99], v[100:101]
    v_cvt_pk_bf16_f32 v96, v98, v99
    v_lshlrev_b32 v98, 16, v96
    v_and_b32 v99, s54, v96
    v_pk_add_f32 v[98:99], v[98:99], s[52:53]
    v_cvt_pk_bf16_f32 v93, v98, v99
    v_cvt_pk_bf16_f32 v96, v24, v25
    v_lshlrev_b32 v98, 16, v96
    v_and_b32 v99, s54, v96
    v_pk_mul_f32 v[100:101], v[98:99], s[50:51]
    v_max_f32 v98, 0, v98
    v_min_f32 v100, 0, v100
    v_min_f32 v101, 0, v101
    v_exp_f32 v100, v100
    v_exp_f32 v101, v101
    v_max_f32 v99, 0, v99
    v_pk_add_f32 v[98:99], v[98:99], v[100:101]
    v_cvt_pk_bf16_f32 v96, v98, v99
    v_lshlrev_b32 v98, 16, v96
    v_and_b32 v99, s54, v96
    v_pk_add_f32 v[98:99], v[98:99], s[52:53]
    v_cvt_pk_bf16_f32 v90, v98, v99
    v_cvt_pk_bf16_f32 v96, v26, v27
    v_lshlrev_b32 v98, 16, v96
    v_and_b32 v99, s54, v96
    v_pk_mul_f32 v[100:101], v[98:99], s[50:51]
    v_max_f32 v98, 0, v98
    v_min_f32 v100, 0, v100
    v_min_f32 v101, 0, v101
    v_exp_f32 v100, v100
    v_exp_f32 v101, v101
    v_max_f32 v99, 0, v99
    v_pk_add_f32 v[98:99], v[98:99], v[100:101]
    v_cvt_pk_bf16_f32 v96, v98, v99
    v_lshlrev_b32 v98, 16, v96
    v_and_b32 v99, s54, v96
    v_pk_add_f32 v[98:99], v[98:99], s[52:53]
    v_cvt_pk_bf16_f32 v91, v98, v99
    v_cvt_pk_bf16_f32 v96, v28, v29
    v_lshlrev_b32 v98, 16, v96
    v_and_b32 v99, s54, v96
    v_pk_mul_f32 v[100:101], v[98:99], s[50:51]
    v_max_f32 v98, 0, v98
    v_min_f32 v100, 0, v100
    v_min_f32 v101, 0, v101
    v_exp_f32 v100, v100
    v_exp_f32 v101, v101
    v_max_f32 v99, 0, v99
    v_pk_add_f32 v[98:99], v[98:99], v[100:101]
    v_cvt_pk_bf16_f32 v96, v98, v99
    v_lshlrev_b32 v98, 16, v96
    v_and_b32 v99, s54, v96
    v_pk_add_f32 v[98:99], v[98:99], s[52:53]
    v_cvt_pk_bf16_f32 v94, v98, v99
    v_cvt_pk_bf16_f32 v96, v30, v31
    v_lshlrev_b32 v98, 16, v96
    v_and_b32 v99, s54, v96
    v_pk_mul_f32 v[100:101], v[98:99], s[50:51]
    v_max_f32 v98, 0, v98
    v_min_f32 v100, 0, v100
    v_min_f32 v101, 0, v101
    v_exp_f32 v100, v100
    v_exp_f32 v101, v101
    v_max_f32 v99, 0, v99
    v_pk_add_f32 v[98:99], v[98:99], v[100:101]
    v_cvt_pk_bf16_f32 v96, v98, v99
    v_lshlrev_b32 v98, 16, v96
    v_and_b32 v99, s54, v96
    v_pk_add_f32 v[98:99], v[98:99], s[52:53]
    v_cvt_pk_bf16_f32 v95, v98, v99
    s_waitcnt vmcnt(63)
    v_mfma_f32_16x16x32_bf16 v[16:19], a[0:3], a[112:115], 0
    v_mfma_f32_16x16x32_bf16 v[20:23], a[56:59], a[112:115], 0
    s_waitcnt vmcnt(63)
    v_mfma_f32_16x16x32_bf16 v[16:19], a[4:7], a[116:119], v[16:19]
    v_mfma_f32_16x16x32_bf16 v[20:23], a[60:63], a[116:119], v[20:23]
    s_waitcnt vmcnt(63)
    v_mfma_f32_16x16x32_bf16 v[16:19], a[8:11], a[120:123], v[16:19]
    v_mfma_f32_16x16x32_bf16 v[20:23], a[64:67], a[120:123], v[20:23]
    s_waitcnt vmcnt(63)
    v_mfma_f32_16x16x32_bf16 v[16:19], a[12:15], a[124:127], v[16:19]
    v_mfma_f32_16x16x32_bf16 v[20:23], a[68:71], a[124:127], v[20:23]
    s_waitcnt vmcnt(63)
    v_mfma_f32_16x16x32_bf16 v[16:19], a[16:19], a[128:131], v[16:19]
    v_mfma_f32_16x16x32_bf16 v[20:23], a[72:75], a[128:131], v[20:23]
    s_waitcnt vmcnt(63)
    v_mfma_f32_16x16x32_bf16 v[16:19], a[20:23], a[132:135], v[16:19]
    v_mfma_f32_16x16x32_bf16 v[20:23], a[76:79], a[132:135], v[20:23]
    s_waitcnt vmcnt(63)
    v_mfma_f32_16x16x32_bf16 v[16:19], a[24:27], a[136:139], v[16:19]
    v_mfma_f32_16x16x32_bf16 v[20:23], a[80:83], a[136:139], v[20:23]
    s_waitcnt vmcnt(63)
    v_mfma_f32_16x16x32_bf16 v[16:19], a[28:31], a[140:143], v[16:19]
    v_mfma_f32_16x16x32_bf16 v[20:23], a[84:87], a[140:143], v[20:23]
    s_waitcnt vmcnt(63)
    v_mfma_f32_16x16x32_bf16 v[16:19], a[32:35], a[144:147], v[16:19]
    v_mfma_f32_16x16x32_bf16 v[20:23], a[88:91], a[144:147], v[20:23]
    s_waitcnt vmcnt(62)
    v_mfma_f32_16x16x32_bf16 v[16:19], a[36:39], a[148:151], v[16:19]
    v_mfma_f32_16x16x32_bf16 v[20:23], a[92:95], a[148:151], v[20:23]
    s_waitcnt vmcnt(61)
    v_mfma_f32_16x16x32_bf16 v[16:19], a[40:43], a[152:155], v[16:19]
    v_mfma_f32_16x16x32_bf16 v[20:23], a[96:99], a[152:155], v[20:23]
    s_waitcnt vmcnt(60)
    v_mfma_f32_16x16x32_bf16 v[16:19], a[44:47], a[156:159], v[16:19]
    v_mfma_f32_16x16x32_bf16 v[20:23], a[100:103], a[156:159], v[20:23]
    s_waitcnt vmcnt(59)
    v_mfma_f32_16x16x32_bf16 v[16:19], a[48:51], a[160:163], v[16:19]
    v_mfma_f32_16x16x32_bf16 v[20:23], a[104:107], a[160:163], v[20:23]
    s_waitcnt vmcnt(58)
    v_mfma_f32_16x16x32_bf16 v[16:19], a[52:55], a[164:167], v[16:19]
    v_mfma_f32_16x16x32_bf16 v[20:23], a[108:111], a[164:167], v[20:23]
    s_waitcnt vmcnt(57)
    v_mfma_f32_16x16x32_bf16 v[24:27], a[0:3], a[168:171], 0
    v_mfma_f32_16x16x32_bf16 v[28:31], a[56:59], a[168:171], 0
    s_waitcnt vmcnt(56)
    v_mfma_f32_16x16x32_bf16 v[24:27], a[4:7], a[172:175], v[24:27]
    v_mfma_f32_16x16x32_bf16 v[28:31], a[60:63], a[172:175], v[28:31]
    s_waitcnt vmcnt(55)
    v_mfma_f32_16x16x32_bf16 v[24:27], a[8:11], a[176:179], v[24:27]
    v_mfma_f32_16x16x32_bf16 v[28:31], a[64:67], a[176:179], v[28:31]
    s_waitcnt vmcnt(54)
    v_mfma_f32_16x16x32_bf16 v[24:27], a[12:15], a[180:183], v[24:27]
    v_mfma_f32_16x16x32_bf16 v[28:31], a[68:71], a[180:183], v[28:31]
    s_waitcnt vmcnt(53)
    v_mfma_f32_16x16x32_bf16 v[24:27], a[16:19], a[184:187], v[24:27]
    v_mfma_f32_16x16x32_bf16 v[28:31], a[72:75], a[184:187], v[28:31]
    s_waitcnt vmcnt(52)
    v_mfma_f32_16x16x32_bf16 v[24:27], a[20:23], a[188:191], v[24:27]
    v_mfma_f32_16x16x32_bf16 v[28:31], a[76:79], a[188:191], v[28:31]
    s_waitcnt vmcnt(51)
    v_mfma_f32_16x16x32_bf16 v[24:27], a[24:27], a[192:195], v[24:27]
    v_mfma_f32_16x16x32_bf16 v[28:31], a[80:83], a[192:195], v[28:31]
    s_waitcnt vmcnt(50)
    v_mfma_f32_16x16x32_bf16 v[24:27], a[28:31], a[196:199], v[24:27]
    v_mfma_f32_16x16x32_bf16 v[28:31], a[84:87], a[196:199], v[28:31]
    s_waitcnt vmcnt(49)
    v_mfma_f32_16x16x32_bf16 v[24:27], a[32:35], a[200:203], v[24:27]
    v_mfma_f32_16x16x32_bf16 v[28:31], a[88:91], a[200:203], v[28:31]
    s_waitcnt vmcnt(48)
    v_mfma_f32_16x16x32_bf16 v[24:27], a[36:39], a[204:207], v[24:27]
    v_mfma_f32_16x16x32_bf16 v[28:31], a[92:95], a[204:207], v[28:31]
    s_waitcnt vmcnt(47)
    v_mfma_f32_16x16x32_bf16 v[24:27], a[40:43], a[208:211], v[24:27]
    v_mfma_f32_16x16x32_bf16 v[28:31], a[96:99], a[208:211], v[28:31]
    s_waitcnt vmcnt(46)
    v_mfma_f32_16x16x32_bf16 v[24:27], a[44:47], a[212:215], v[24:27]
    v_mfma_f32_16x16x32_bf16 v[28:31], a[100:103], a[212:215], v[28:31]
    s_waitcnt vmcnt(45)
    v_mfma_f32_16x16x32_bf16 v[24:27], a[48:51], a[216:219], v[24:27]
    v_mfma_f32_16x16x32_bf16 v[28:31], a[104:107], a[216:219], v[28:31]
    s_waitcnt vmcnt(44)
    v_mfma_f32_16x16x32_bf16 v[24:27], a[52:55], a[220:223], v[24:27]
    v_mfma_f32_16x16x32_bf16 v[28:31], a[108:111], a[220:223], v[28:31]
    v_cvt_pk_bf16_f32 v96, v16, v17
    v_lshlrev_b32 v98, 16, v96
    v_and_b32 v99, s54, v96
    v_pk_mul_f32 v[100:101], v[98:99], s[50:51]
    v_max_f32 v98, 0, v98
    v_min_f32 v100, 0, v100
    v_min_f32 v101, 0, v101
    v_exp_f32 v100, v100
    v_exp_f32 v101, v101
    v_max_f32 v99, 0, v99
    v_pk_add_f32 v[98:99], v[98:99], v[100:101]
    v_cvt_pk_bf16_f32 v96, v98, v99
    v_lshlrev_b32 v98, 16, v96
    v_and_b32 v99, s54, v96
    v_pk_add_f32 v[98:99], v[98:99], s[52:53]
    v_cvt_pk_bf16_f32 v32, v98, v99
    v_cvt_pk_bf16_f32 v96, v18, v19
    v_lshlrev_b32 v98, 16, v96
    v_and_b32 v99, s54, v96
    v_pk_mul_f32 v[100:101], v[98:99], s[50:51]
    v_max_f32 v98, 0, v98
    v_min_f32 v100, 0, v100
    v_min_f32 v101, 0, v101
    v_exp_f32 v100, v100
    v_exp_f32 v101, v101
    v_max_f32 v99, 0, v99
    v_pk_add_f32 v[98:99], v[98:99], v[100:101]
    v_cvt_pk_bf16_f32 v96, v98, v99
    v_lshlrev_b32 v98, 16, v96
    v_and_b32 v99, s54, v96
    v_pk_add_f32 v[98:99], v[98:99], s[52:53]
    v_cvt_pk_bf16_f32 v33, v98, v99
    v_cvt_pk_bf16_f32 v96, v20, v21
    v_lshlrev_b32 v98, 16, v96
    v_and_b32 v99, s54, v96
    v_pk_mul_f32 v[100:101], v[98:99], s[50:51]
    v_max_f32 v98, 0, v98
    v_min_f32 v100, 0, v100
    v_min_f32 v101, 0, v101
    v_exp_f32 v100, v100
    v_exp_f32 v101, v101
    v_max_f32 v99, 0, v99
    v_pk_add_f32 v[98:99], v[98:99], v[100:101]
    v_cvt_pk_bf16_f32 v96, v98, v99
    v_lshlrev_b32 v98, 16, v96
    v_and_b32 v99, s54, v96
    v_pk_add_f32 v[98:99], v[98:99], s[52:53]
    v_cvt_pk_bf16_f32 v34, v98, v99
    v_cvt_pk_bf16_f32 v96, v22, v23
    v_lshlrev_b32 v98, 16, v96
    v_and_b32 v99, s54, v96
    v_pk_mul_f32 v[100:101], v[98:99], s[50:51]
    v_max_f32 v98, 0, v98
    v_min_f32 v100, 0, v100
    v_min_f32 v101, 0, v101
    v_exp_f32 v100, v100
    v_exp_f32 v101, v101
    v_max_f32 v99, 0, v99
    v_pk_add_f32 v[98:99], v[98:99], v[100:101]
    v_cvt_pk_bf16_f32 v96, v98, v99
    v_lshlrev_b32 v98, 16, v96
    v_and_b32 v99, s54, v96
    v_pk_add_f32 v[98:99], v[98:99], s[52:53]
    v_cvt_pk_bf16_f32 v35, v98, v99
    v_cvt_pk_bf16_f32 v96, v24, v25
    v_lshlrev_b32 v98, 16, v96
    v_and_b32 v99, s54, v96
    v_pk_mul_f32 v[100:101], v[98:99], s[50:51]
    v_max_f32 v98, 0, v98
    v_min_f32 v100, 0, v100
    v_min_f32 v101, 0, v101
    v_exp_f32 v100, v100
    v_exp_f32 v101, v101
    v_max_f32 v99, 0, v99
    v_pk_add_f32 v[98:99], v[98:99], v[100:101]
    v_cvt_pk_bf16_f32 v96, v98, v99
    v_lshlrev_b32 v98, 16, v96
    v_and_b32 v99, s54, v96
    v_pk_add_f32 v[98:99], v[98:99], s[52:53]
    v_cvt_pk_bf16_f32 v36, v98, v99
    v_cvt_pk_bf16_f32 v96, v26, v27
    v_lshlrev_b32 v98, 16, v96
    v_and_b32 v99, s54, v96
    v_pk_mul_f32 v[100:101], v[98:99], s[50:51]
    v_max_f32 v98, 0, v98
    v_min_f32 v100, 0, v100
    v_min_f32 v101, 0, v101
    v_exp_f32 v100, v100
    v_exp_f32 v101, v101
    v_max_f32 v99, 0, v99
    v_pk_add_f32 v[98:99], v[98:99], v[100:101]
    v_cvt_pk_bf16_f32 v96, v98, v99
    v_lshlrev_b32 v98, 16, v96
    v_and_b32 v99, s54, v96
    v_pk_add_f32 v[98:99], v[98:99], s[52:53]
    v_cvt_pk_bf16_f32 v37, v98, v99
    v_cvt_pk_bf16_f32 v96, v28, v29
    v_lshlrev_b32 v98, 16, v96
    v_and_b32 v99, s54, v96
    v_pk_mul_f32 v[100:101], v[98:99], s[50:51]
    v_max_f32 v98, 0, v98
    v_min_f32 v100, 0, v100
    v_min_f32 v101, 0, v101
    v_exp_f32 v100, v100
    v_exp_f32 v101, v101
    v_max_f32 v99, 0, v99
    v_pk_add_f32 v[98:99], v[98:99], v[100:101]
    v_cvt_pk_bf16_f32 v96, v98, v99
    v_lshlrev_b32 v98, 16, v96
    v_and_b32 v99, s54, v96
    v_pk_add_f32 v[98:99], v[98:99], s[52:53]
    v_cvt_pk_bf16_f32 v38, v98, v99
    v_cvt_pk_bf16_f32 v96, v30, v31
    v_lshlrev_b32 v98, 16, v96
    v_and_b32 v99, s54, v96
    v_pk_mul_f32 v[100:101], v[98:99], s[50:51]
    v_max_f32 v98, 0, v98
    v_min_f32 v100, 0, v100
    v_min_f32 v101, 0, v101
    v_exp_f32 v100, v100
    v_exp_f32 v101, v101
    v_max_f32 v99, 0, v99
    v_pk_add_f32 v[98:99], v[98:99], v[100:101]
    v_cvt_pk_bf16_f32 v96, v98, v99
    v_lshlrev_b32 v98, 16, v96
    v_and_b32 v99, s54, v96
    v_pk_add_f32 v[98:99], v[98:99], s[52:53]
    v_cvt_pk_bf16_f32 v39, v98, v99
    s_waitcnt vmcnt(27)
    v_mfma_f32_16x16x32_bf16 v[16:19], a[0:3], v[128:131], 0
    v_mfma_f32_16x16x32_bf16 v[20:23], a[56:59], v[128:131], 0
    s_waitcnt vmcnt(26)
    v_mfma_f32_16x16x32_bf16 v[16:19], a[4:7], v[132:135], v[16:19]
    v_mfma_f32_16x16x32_bf16 v[20:23], a[60:63], v[132:135], v[20:23]
    s_waitcnt vmcnt(25)
    v_mfma_f32_16x16x32_bf16 v[16:19], a[8:11], v[136:139], v[16:19]
    v_mfma_f32_16x16x32_bf16 v[20:23], a[64:67], v[136:139], v[20:23]
    s_waitcnt vmcnt(24)
    v_mfma_f32_16x16x32_bf16 v[16:19], a[12:15], v[140:143], v[16:19]
    v_mfma_f32_16x16x32_bf16 v[20:23], a[68:71], v[140:143], v[20:23]
    s_waitcnt vmcnt(23)
    v_mfma_f32_16x16x32_bf16 v[16:19], a[16:19], v[144:147], v[16:19]
    v_mfma_f32_16x16x32_bf16 v[20:23], a[72:75], v[144:147], v[20:23]
    s_waitcnt vmcnt(22)
    v_mfma_f32_16x16x32_bf16 v[16:19], a[20:23], v[148:151], v[16:19]
    v_mfma_f32_16x16x32_bf16 v[20:23], a[76:79], v[148:151], v[20:23]
    s_waitcnt vmcnt(21)
    v_mfma_f32_16x16x32_bf16 v[16:19], a[24:27], v[152:155], v[16:19]
    v_mfma_f32_16x16x32_bf16 v[20:23], a[80:83], v[152:155], v[20:23]
    s_waitcnt vmcnt(20)
    v_mfma_f32_16x16x32_bf16 v[16:19], a[28:31], v[156:159], v[16:19]
    v_mfma_f32_16x16x32_bf16 v[20:23], a[84:87], v[156:159], v[20:23]
    s_waitcnt vmcnt(19)
    v_mfma_f32_16x16x32_bf16 v[16:19], a[32:35], v[160:163], v[16:19]
    v_mfma_f32_16x16x32_bf16 v[20:23], a[88:91], v[160:163], v[20:23]
    s_waitcnt vmcnt(18)
    v_mfma_f32_16x16x32_bf16 v[16:19], a[36:39], v[164:167], v[16:19]
    v_mfma_f32_16x16x32_bf16 v[20:23], a[92:95], v[164:167], v[20:23]
    s_waitcnt vmcnt(17)
    v_mfma_f32_16x16x32_bf16 v[16:19], a[40:43], v[168:171], v[16:19]
    v_mfma_f32_16x16x32_bf16 v[20:23], a[96:99], v[168:171], v[20:23]
    s_waitcnt vmcnt(16)
    v_mfma_f32_16x16x32_bf16 v[16:19], a[44:47], v[172:175], v[16:19]
    v_mfma_f32_16x16x32_bf16 v[20:23], a[100:103], v[172:175], v[20:23]
    s_waitcnt vmcnt(15)
    v_mfma_f32_16x16x32_bf16 v[16:19], a[48:51], v[176:179], v[16:19]
    v_mfma_f32_16x16x32_bf16 v[20:23], a[104:107], v[176:179], v[20:23]
    s_waitcnt vmcnt(14)
    v_mfma_f32_16x16x32_bf16 v[16:19], a[52:55], v[180:183], v[16:19]
    v_mfma_f32_16x16x32_bf16 v[20:23], a[108:111], v[180:183], v[20:23]
    s_waitcnt vmcnt(13)
    v_mfma_f32_16x16x32_bf16 v[24:27], a[0:3], v[184:187], v[124:127]
    v_mfma_f32_16x16x32_bf16 v[28:31], a[56:59], v[184:187], v[124:127]
    s_waitcnt vmcnt(12)
    v_mfma_f32_16x16x32_bf16 v[24:27], a[4:7], v[188:191], v[24:27]
    v_mfma_f32_16x16x32_bf16 v[28:31], a[60:63], v[188:191], v[28:31]
    s_waitcnt vmcnt(11)
    v_mfma_f32_16x16x32_bf16 v[24:27], a[8:11], v[192:195], v[24:27]
    v_mfma_f32_16x16x32_bf16 v[28:31], a[64:67], v[192:195], v[28:31]
    s_waitcnt vmcnt(10)
    v_mfma_f32_16x16x32_bf16 v[24:27], a[12:15], v[196:199], v[24:27]
    v_mfma_f32_16x16x32_bf16 v[28:31], a[68:71], v[196:199], v[28:31]
    s_waitcnt vmcnt(9)
    v_mfma_f32_16x16x32_bf16 v[24:27], a[16:19], v[200:203], v[24:27]
    v_mfma_f32_16x16x32_bf16 v[28:31], a[72:75], v[200:203], v[28:31]
    s_waitcnt vmcnt(8)
    v_mfma_f32_16x16x32_bf16 v[24:27], a[20:23], v[204:207], v[24:27]
    v_mfma_f32_16x16x32_bf16 v[28:31], a[76:79], v[204:207], v[28:31]
    s_waitcnt vmcnt(7)
    v_mfma_f32_16x16x32_bf16 v[24:27], a[24:27], v[208:211], v[24:27]
    v_mfma_f32_16x16x32_bf16 v[28:31], a[80:83], v[208:211], v[28:31]
    s_waitcnt vmcnt(6)
    v_mfma_f32_16x16x32_bf16 v[24:27], a[28:31], v[212:215], v[24:27]
    v_mfma_f32_16x16x32_bf16 v[28:31], a[84:87], v[212:215], v[28:31]
    s_waitcnt vmcnt(5)
    v_mfma_f32_16x16x32_bf16 v[24:27], a[32:35], v[216:219], v[24:27]
    v_mfma_f32_16x16x32_bf16 v[28:31], a[88:91], v[216:219], v[28:31]
    s_waitcnt vmcnt(4)
    v_mfma_f32_16x16x32_bf16 v[24:27], a[36:39], v[220:223], v[24:27]
    v_mfma_f32_16x16x32_bf16 v[28:31], a[92:95], v[220:223], v[28:31]
    s_waitcnt vmcnt(3)
    v_mfma_f32_16x16x32_bf16 v[24:27], a[40:43], v[224:227], v[24:27]
    v_mfma_f32_16x16x32_bf16 v[28:31], a[96:99], v[224:227], v[28:31]
    s_waitcnt vmcnt(2)
    v_mfma_f32_16x16x32_bf16 v[24:27], a[44:47], v[228:231], v[24:27]
    v_mfma_f32_16x16x32_bf16 v[28:31], a[100:103], v[228:231], v[28:31]
    s_waitcnt vmcnt(1)
    v_mfma_f32_16x16x32_bf16 v[24:27], a[48:51], v[232:235], v[24:27]
    v_mfma_f32_16x16x32_bf16 v[28:31], a[104:107], v[232:235], v[28:31]
    s_waitcnt vmcnt(0)
    v_mfma_f32_16x16x32_bf16 v[24:27], a[52:55], v[236:239], v[24:27]
    v_mfma_f32_16x16x32_bf16 v[28:31], a[108:111], v[236:239], v[28:31]
    v_cvt_pk_bf16_f32 v40, v16, v17
    v_cvt_pk_bf16_f32 v41, v18, v19
    v_cvt_pk_bf16_f32 v42, v20, v21
    v_cvt_pk_bf16_f32 v43, v22, v23
    s_nop 1
    v_cvt_pk_bf16_f32 v44, v24, v25
    v_cvt_pk_bf16_f32 v45, v26, v27
    v_cvt_pk_bf16_f32 v46, v28, v29
    v_cvt_pk_bf16_f32 v47, v30, v31
    v_mfma_f32_16x16x32_bf16 v[48:51], v[32:35], v[40:43], 0
    v_mfma_f32_16x16x32_bf16 v[52:55], v[32:35], v[44:47], 0
    v_mfma_f32_16x16x32_bf16 v[56:59], v[36:39], v[40:43], 0
    v_mfma_f32_16x16x32_bf16 v[60:63], v[36:39], v[44:47], 0
    s_nop 1
    buffer_atomic_add_f32 v48, v6, s[4:7], s42 offen offset:0
    buffer_atomic_add_f32 v49, v6, s[4:7], s42 offen offset:256
    buffer_atomic_add_f32 v50, v6, s[4:7], s42 offen offset:512
    buffer_atomic_add_f32 v51, v6, s[4:7], s42 offen offset:768
    buffer_atomic_add_f32 v52, v6, s[4:7], s42 offen offset:1024
    buffer_atomic_add_f32 v53, v6, s[4:7], s42 offen offset:1280
    buffer_atomic_add_f32 v54, v6, s[4:7], s42 offen offset:1536
    buffer_atomic_add_f32 v55, v6, s[4:7], s42 offen offset:1792
    buffer_atomic_add_f32 v56, v6, s[4:7], s42 offen offset:2048
    buffer_atomic_add_f32 v57, v6, s[4:7], s42 offen offset:2304
    buffer_atomic_add_f32 v58, v6, s[4:7], s42 offen offset:2560
    buffer_atomic_add_f32 v59, v6, s[4:7], s42 offen offset:2816
    buffer_atomic_add_f32 v60, v6, s[4:7], s42 offen offset:3072
    buffer_atomic_add_f32 v61, v6, s[4:7], s42 offen offset:3328
    buffer_atomic_add_f32 v62, v6, s[4:7], s42 offen offset:3584
    buffer_atomic_add_f32 v63, v6, s[4:7], s42 offen offset:3840
    s_add_u32 s42, s42, 4096
    s_mul_i32 s41, s26, 114688
    s_add_u32 s41, s41, 0xd90000
    s_waitcnt vmcnt(0)
    s_barrier
    s_cmp_lg_u32 s26, 0
    s_cbranch_scc1 gated_mix__linear_attn_block__memory_aug_recurrent_mem_tr__prompt_kernel_RL_arr
    s_mov_b64 exec, 1
    v_mov_b32 v96, 1
    buffer_atomic_add v96, off, s[84:87], 0 offset:140 sc0 sc1
    s_waitcnt vmcnt(0)
    v_readfirstlane_b32 s33, v96
    s_nop 0
    s_cmp_lg_u32 s33, 63
    s_cbranch_scc1 gated_mix__linear_attn_block__memory_aug_recurrent_mem_tr__prompt_kernel_RL_arr_x
    buffer_store_dword v96, off, s[84:87], 0 offset:32 sc1
gated_mix__linear_attn_block__memory_aug_recurrent_mem_tr__prompt_kernel_RL_arr_x:
    s_mov_b64 exec, -1
gated_mix__linear_attn_block__memory_aug_recurrent_mem_tr__prompt_kernel_RL_arr:
    buffer_load_dwordx4 a[128:131], v2, s[4:7], s41 offen offset:0 sc1
    buffer_load_dwordx4 a[132:135], v2, s[4:7], s41 offen offset:1024 sc1
    buffer_load_dwordx4 a[136:139], v2, s[4:7], s41 offen offset:2048 sc1
    buffer_load_dwordx4 a[140:143], v2, s[4:7], s41 offen offset:3072 sc1
    s_add_u32 s41, s41, 4096
    buffer_load_dwordx4 a[144:147], v2, s[4:7], s41 offen offset:0 sc1
    buffer_load_dwordx4 a[148:151], v2, s[4:7], s41 offen offset:1024 sc1
    buffer_load_dwordx4 a[152:155], v2, s[4:7], s41 offen offset:2048 sc1
    buffer_load_dwordx4 a[156:159], v2, s[4:7], s41 offen offset:3072 sc1
    s_add_u32 s41, s41, 4096
    buffer_load_dwordx4 a[160:163], v2, s[4:7], s41 offen offset:0 sc1
    buffer_load_dwordx4 a[164:167], v2, s[4:7], s41 offen offset:1024 sc1
    buffer_load_dwordx4 a[168:171], v2, s[4:7], s41 offen offset:2048 sc1
    buffer_load_dwordx4 a[172:175], v2, s[4:7], s41 offen offset:3072 sc1
    s_add_u32 s41, s41, 4096
    buffer_load_dwordx4 a[176:179], v2, s[4:7], s41 offen offset:0 sc1
    buffer_load_dwordx4 a[180:183], v2, s[4:7], s41 offen offset:1024 sc1
    buffer_load_dwordx4 a[184:187], v2, s[4:7], s41 offen offset:2048 sc1
    buffer_load_dwordx4 a[188:191], v2, s[4:7], s41 offen offset:3072 sc1
    s_add_u32 s41, s41, 4096
    buffer_load_dwordx4 a[192:195], v2, s[4:7], s41 offen offset:0 sc1
    buffer_load_dwordx4 a[196:199], v2, s[4:7], s41 offen offset:1024 sc1
    buffer_load_dwordx4 a[200:203], v2, s[4:7], s41 offen offset:2048 sc1
    buffer_load_dwordx4 a[204:207], v2, s[4:7], s41 offen offset:3072 sc1
    s_add_u32 s41, s41, 4096
    buffer_load_dwordx4 a[208:211], v2, s[4:7], s41 offen offset:0 sc1
    buffer_load_dwordx4 a[212:215], v2, s[4:7], s41 offen offset:1024 sc1
    buffer_load_dwordx4 a[216:219], v2, s[4:7], s41 offen offset:2048 sc1
    buffer_load_dwordx4 a[220:223], v2, s[4:7], s41 offen offset:3072 sc1
    s_add_u32 s41, s41, 4096
    buffer_load_dwordx4 a[224:227], v2, s[4:7], s41 offen offset:0 sc1
    buffer_load_dwordx4 a[228:231], v2, s[4:7], s41 offen offset:1024 sc1
    buffer_load_dwordx4 a[232:235], v2, s[4:7], s41 offen offset:2048 sc1
    buffer_load_dwordx4 a[236:239], v2, s[4:7], s41 offen offset:3072 sc1
    s_add_u32 s41, s41, 4096
    buffer_load_dwordx4 a[240:243], v2, s[4:7], s41 offen offset:0 sc1
    buffer_load_dwordx4 a[244:247], v2, s[4:7], s41 offen offset:1024 sc1
    buffer_load_dwordx4 a[248:251], v2, s[4:7], s41 offen offset:2048 sc1
    buffer_load_dwordx4 a[252:255], v2, s[4:7], s41 offen offset:3072 sc1
    s_add_u32 s41, s41, 4096
    buffer_load_dwordx4 v[192:195], v2, s[4:7], s41 offen offset:0 sc1
    buffer_load_dwordx4 v[196:199], v2, s[4:7], s41 offen offset:1024 sc1
    buffer_load_dwordx4 v[200:203], v2, s[4:7], s41 offen offset:2048 sc1
    buffer_load_dwordx4 v[204:207], v2, s[4:7], s41 offen offset:3072 sc1
    s_add_u32 s41, s41, 4096
    buffer_load_dwordx4 v[208:211], v2, s[4:7], s41 offen offset:0 sc1
    buffer_load_dwordx4 v[212:215], v2, s[4:7], s41 offen offset:1024 sc1
    buffer_load_dwordx4 v[216:219], v2, s[4:7], s41 offen offset:2048 sc1
    buffer_load_dwordx4 v[220:223], v2, s[4:7], s41 offen offset:3072 sc1
    s_add_u32 s41, s41, 4096
    buffer_load_dwordx4 v[224:227], v2, s[4:7], s41 offen offset:0 sc1
    buffer_load_dwordx4 v[228:231], v2, s[4:7], s41 offen offset:1024 sc1
    buffer_load_dwordx4 v[232:235], v2, s[4:7], s41 offen offset:2048 sc1
    buffer_load_dwordx4 v[236:239], v2, s[4:7], s41 offen offset:3072 sc1
    s_add_u32 s41, s41, 4096
    buffer_load_dwordx4 v[240:243], v2, s[4:7], s41 offen offset:0 sc1
    buffer_load_dwordx4 v[244:247], v2, s[4:7], s41 offen offset:1024 sc1
    buffer_load_dwordx4 v[248:251], v2, s[4:7], s41 offen offset:2048 sc1
    buffer_load_dwordx4 v[252:255], v2, s[4:7], s41 offen offset:3072 sc1
    s_add_u32 s41, s41, 4096
    s_cmp_lg_u32 s26, 0
    s_cbranch_scc1 gated_mix__linear_attn_block__memory_aug_recurrent_mem_tr__prompt_kernel_RL_w_b
gated_mix__linear_attn_block__memory_aug_recurrent_mem_tr__prompt_kernel_RL_w:
    buffer_load_dword v96, off, s[84:87], 0 offset:32 sc1
    s_waitcnt vmcnt(0)
    v_readfirstlane_b32 s33, v96
    s_nop 0
    s_cmp_lg_u32 s33, 0
    s_cbranch_scc1 gated_mix__linear_attn_block__memory_aug_recurrent_mem_tr__prompt_kernel_RL_w_b
    s_sleep 8
    s_branch gated_mix__linear_attn_block__memory_aug_recurrent_mem_tr__prompt_kernel_RL_w
gated_mix__linear_attn_block__memory_aug_recurrent_mem_tr__prompt_kernel_RL_w_b:
    s_barrier
    s_sub_u32 s42, s42, 16384
    buffer_load_dword v128, v6, s[4:7], s42 offen offset:0 sc1
    buffer_load_dword v129, v6, s[4:7], s42 offen offset:256 sc1
    buffer_load_dword v130, v6, s[4:7], s42 offen offset:512 sc1
    buffer_load_dword v131, v6, s[4:7], s42 offen offset:768 sc1
    buffer_load_dword v132, v6, s[4:7], s42 offen offset:1024 sc1
    buffer_load_dword v133, v6, s[4:7], s42 offen offset:1280 sc1
    buffer_load_dword v134, v6, s[4:7], s42 offen offset:1536 sc1
    buffer_load_dword v135, v6, s[4:7], s42 offen offset:1792 sc1
    buffer_load_dword v136, v6, s[4:7], s42 offen offset:2048 sc1
    buffer_load_dword v137, v6, s[4:7], s42 offen offset:2304 sc1
    buffer_load_dword v138, v6, s[4:7], s42 offen offset:2560 sc1
    buffer_load_dword v139, v6, s[4:7], s42 offen offset:2816 sc1
    buffer_load_dword v140, v6, s[4:7], s42 offen offset:3072 sc1
    buffer_load_dword v141, v6, s[4:7], s42 offen offset:3328 sc1
    buffer_load_dword v142, v6, s[4:7], s42 offen offset:3584 sc1
    buffer_load_dword v143, v6, s[4:7], s42 offen offset:3840 sc1
    s_add_u32 s42, s42, 4096
    buffer_load_dword v144, v6, s[4:7], s42 offen offset:0 sc1
    buffer_load_dword v145, v6, s[4:7], s42 offen offset:256 sc1
    buffer_load_dword v146, v6, s[4:7], s42 offen offset:512 sc1
    buffer_load_dword v147, v6, s[4:7], s42 offen offset:768 sc1
    buffer_load_dword v148, v6, s[4:7], s42 offen offset:1024 sc1
    buffer_load_dword v149, v6, s[4:7], s42 offen offset:1280 sc1
    buffer_load_dword v150, v6, s[4:7], s42 offen offset:1536 sc1
    buffer_load_dword v151, v6, s[4:7], s42 offen offset:1792 sc1
    buffer_load_dword v152, v6, s[4:7], s42 offen offset:2048 sc1
    buffer_load_dword v153, v6, s[4:7], s42 offen offset:2304 sc1
    buffer_load_dword v154, v6, s[4:7], s42 offen offset:2560 sc1
    buffer_load_dword v155, v6, s[4:7], s42 offen offset:2816 sc1
    buffer_load_dword v156, v6, s[4:7], s42 offen offset:3072 sc1
    buffer_load_dword v157, v6, s[4:7], s42 offen offset:3328 sc1
    buffer_load_dword v158, v6, s[4:7], s42 offen offset:3584 sc1
    buffer_load_dword v159, v6, s[4:7], s42 offen offset:3840 sc1
    s_add_u32 s42, s42, 4096
    buffer_load_dword v160, v6, s[4:7], s42 offen offset:0 sc1
    buffer_load_dword v161, v6, s[4:7], s42 offen offset:256 sc1
    buffer_load_dword v162, v6, s[4:7], s42 offen offset:512 sc1
    buffer_load_dword v163, v6, s[4:7], s42 offen offset:768 sc1
    buffer_load_dword v164, v6, s[4:7], s42 offen offset:1024 sc1
    buffer_load_dword v165, v6, s[4:7], s42 offen offset:1280 sc1
    buffer_load_dword v166, v6, s[4:7], s42 offen offset:1536 sc1
    buffer_load_dword v167, v6, s[4:7], s42 offen offset:1792 sc1
    buffer_load_dword v168, v6, s[4:7], s42 offen offset:2048 sc1
    buffer_load_dword v169, v6, s[4:7], s42 offen offset:2304 sc1
    buffer_load_dword v170, v6, s[4:7], s42 offen offset:2560 sc1
    buffer_load_dword v171, v6, s[4:7], s42 offen offset:2816 sc1
    buffer_load_dword v172, v6, s[4:7], s42 offen offset:3072 sc1
    buffer_load_dword v173, v6, s[4:7], s42 offen offset:3328 sc1
    buffer_load_dword v174, v6, s[4:7], s42 offen offset:3584 sc1
    buffer_load_dword v175, v6, s[4:7], s42 offen offset:3840 sc1
    s_add_u32 s42, s42, 4096
    buffer_load_dword v176, v6, s[4:7], s42 offen offset:0 sc1
    buffer_load_dword v177, v6, s[4:7], s42 offen offset:256 sc1
    buffer_load_dword v178, v6, s[4:7], s42 offen offset:512 sc1
    buffer_load_dword v179, v6, s[4:7], s42 offen offset:768 sc1
    buffer_load_dword v180, v6, s[4:7], s42 offen offset:1024 sc1
    buffer_load_dword v181, v6, s[4:7], s42 offen offset:1280 sc1
    buffer_load_dword v182, v6, s[4:7], s42 offen offset:1536 sc1
    buffer_load_dword v183, v6, s[4:7], s42 offen offset:1792 sc1
    buffer_load_dword v184, v6, s[4:7], s42 offen offset:2048 sc1
    buffer_load_dword v185, v6, s[4:7], s42 offen offset:2304 sc1
    buffer_load_dword v186, v6, s[4:7], s42 offen offset:2560 sc1
    buffer_load_dword v187, v6, s[4:7], s42 offen offset:2816 sc1
    buffer_load_dword v188, v6, s[4:7], s42 offen offset:3072 sc1
    buffer_load_dword v189, v6, s[4:7], s42 offen offset:3328 sc1
    buffer_load_dword v190, v6, s[4:7], s42 offen offset:3584 sc1
    buffer_load_dword v191, v6, s[4:7], s42 offen offset:3840 sc1
    s_add_u32 s42, s42, 4096
    s_lshl_b32 s33, s26, 13
    v_add_u32 v10, s33, v2
    s_waitcnt vmcnt(48)
    v_cvt_pk_bf16_f32 v32, v128, v129
    v_cvt_pk_bf16_f32 v33, v130, v131
    v_cvt_pk_bf16_f32 v34, v136, v137
    v_cvt_pk_bf16_f32 v35, v138, v139
    v_and_b32 v34, v7, v34
    v_and_b32 v35, v7, v35
    v_cvt_pk_bf16_f32 v36, v132, v133
    v_cvt_pk_bf16_f32 v37, v134, v135
    v_cvt_pk_bf16_f32 v38, v140, v141
    v_cvt_pk_bf16_f32 v39, v142, v143
    v_and_b32 v38, v7, v38
    v_and_b32 v39, v7, v39
    v_mov_b32_dpp v40, v36 row_newbcast:12 row_mask:0xf bank_mask:0xf
    v_mov_b32_dpp v41, v37 row_newbcast:12 row_mask:0xf bank_mask:0xf
    v_mov_b32_dpp v42, v38 row_newbcast:12 row_mask:0xf bank_mask:0xf
    v_mov_b32_dpp v43, v39 row_newbcast:12 row_mask:0xf bank_mask:0xf
    s_nop 1
    v_mfma_f32_16x16x32_bf16 v[24:27], v[40:43], v[64:67], 0
    v_mfma_f32_16x16x32_bf16 v[16:19], v[32:35], v[64:67], 0
    v_mfma_f32_16x16x32_bf16 v[20:23], v[36:39], v[64:67], 0
    s_nop 3
    v_cvt_pk_bf16_f32 v96, v24, v24
    v_lshlrev_b32 v96, 16, v96
    v_add_f32 v96, s52, v96
    v_cvt_pk_bf16_f32 v96, v96, v96
    v_lshlrev_b32 v96, 16, v96
    v_rcp_f32 v96, v96
    v_cvt_pk_bf16_f32 v100, v16, v17
    v_lshlrev_b32 v98, 16, v100
    v_and_b32 v99, s54, v100
    v_pk_mul_f32 v[98:99], v[98:99], v[96:97] op_sel_hi:[1,0]
    v_cvt_pk_bf16_f32 v44, v98, v99
    v_cvt_pk_bf16_f32 v100, v18, v19
    v_lshlrev_b32 v98, 16, v100
    v_and_b32 v99, s54, v100
    v_pk_mul_f32 v[98:99], v[98:99], v[96:97] op_sel_hi:[1,0]
    v_cvt_pk_bf16_f32 v45, v98, v99
    v_cvt_pk_bf16_f32 v100, v20, v21
    v_lshlrev_b32 v98, 16, v100
    v_and_b32 v99, s54, v100
    v_pk_mul_f32 v[98:99], v[98:99], v[96:97] op_sel_hi:[1,0]
    v_cvt_pk_bf16_f32 v46, v98, v99
    v_cvt_pk_bf16_f32 v100, v22, v23
    v_lshlrev_b32 v98, 16, v100
    v_and_b32 v99, s54, v100
    v_pk_mul_f32 v[98:99], v[98:99], v[96:97] op_sel_hi:[1,0]
    v_cvt_pk_bf16_f32 v47, v98, v99
    ds_write_b128 v10, v[44:47] offset:0
    v_mfma_f32_16x16x32_bf16 v[24:27], v[40:43], v[68:71], 0
    v_mfma_f32_16x16x32_bf16 v[16:19], v[32:35], v[68:71], 0
    v_mfma_f32_16x16x32_bf16 v[20:23], v[36:39], v[68:71], 0
    s_nop 3
    v_cvt_pk_bf16_f32 v96, v24, v24
    v_lshlrev_b32 v96, 16, v96
    v_add_f32 v96, s52, v96
    v_cvt_pk_bf16_f32 v96, v96, v96
    v_lshlrev_b32 v96, 16, v96
    v_rcp_f32 v96, v96
    v_cvt_pk_bf16_f32 v100, v16, v17
    v_lshlrev_b32 v98, 16, v100
    v_and_b32 v99, s54, v100
    v_pk_mul_f32 v[98:99], v[98:99], v[96:97] op_sel_hi:[1,0]
    v_cvt_pk_bf16_f32 v44, v98, v99
    v_cvt_pk_bf16_f32 v100, v18, v19
    v_lshlrev_b32 v98, 16, v100
    v_and_b32 v99, s54, v100
    v_pk_mul_f32 v[98:99], v[98:99], v[96:97] op_sel_hi:[1,0]
    v_cvt_pk_bf16_f32 v45, v98, v99
    v_cvt_pk_bf16_f32 v100, v20, v21
    v_lshlrev_b32 v98, 16, v100
    v_and_b32 v99, s54, v100
    v_pk_mul_f32 v[98:99], v[98:99], v[96:97] op_sel_hi:[1,0]
    v_cvt_pk_bf16_f32 v46, v98, v99
    v_cvt_pk_bf16_f32 v100, v22, v23
    v_lshlrev_b32 v98, 16, v100
    v_and_b32 v99, s54, v100
    v_pk_mul_f32 v[98:99], v[98:99], v[96:97] op_sel_hi:[1,0]
    v_cvt_pk_bf16_f32 v47, v98, v99
    ds_write_b128 v10, v[44:47] offset:1024
    s_waitcnt vmcnt(32)
    v_cvt_pk_bf16_f32 v32, v144, v145
    v_cvt_pk_bf16_f32 v33, v146, v147
    v_cvt_pk_bf16_f32 v34, v152, v153
    v_cvt_pk_bf16_f32 v35, v154, v155
    v_and_b32 v34, v7, v34
    v_and_b32 v35, v7, v35
    v_cvt_pk_bf16_f32 v36, v148, v149
    v_cvt_pk_bf16_f32 v37, v150, v151
    v_cvt_pk_bf16_f32 v38, v156, v157
    v_cvt_pk_bf16_f32 v39, v158, v159
    v_and_b32 v38, v7, v38
    v_and_b32 v39, v7, v39
    v_mov_b32_dpp v40, v36 row_newbcast:12 row_mask:0xf bank_mask:0xf
    v_mov_b32_dpp v41, v37 row_newbcast:12 row_mask:0xf bank_mask:0xf
    v_mov_b32_dpp v42, v38 row_newbcast:12 row_mask:0xf bank_mask:0xf
    v_mov_b32_dpp v43, v39 row_newbcast:12 row_mask:0xf bank_mask:0xf
    s_nop 1
    v_mfma_f32_16x16x32_bf16 v[24:27], v[40:43], v[72:75], 0
    v_mfma_f32_16x16x32_bf16 v[16:19], v[32:35], v[72:75], 0
    v_mfma_f32_16x16x32_bf16 v[20:23], v[36:39], v[72:75], 0
    s_nop 3
    v_cvt_pk_bf16_f32 v96, v24, v24
    v_lshlrev_b32 v96, 16, v96
    v_add_f32 v96, s52, v96
    v_cvt_pk_bf16_f32 v96, v96, v96
    v_lshlrev_b32 v96, 16, v96
    v_rcp_f32 v96, v96
    v_cvt_pk_bf16_f32 v100, v16, v17
    v_lshlrev_b32 v98, 16, v100
    v_and_b32 v99, s54, v100
    v_pk_mul_f32 v[98:99], v[98:99], v[96:97] op_sel_hi:[1,0]
    v_cvt_pk_bf16_f32 v44, v98, v99
    v_cvt_pk_bf16_f32 v100, v18, v19
    v_lshlrev_b32 v98, 16, v100
    v_and_b32 v99, s54, v100
    v_pk_mul_f32 v[98:99], v[98:99], v[96:97] op_sel_hi:[1,0]
    v_cvt_pk_bf16_f32 v45, v98, v99
    v_cvt_pk_bf16_f32 v100, v20, v21
    v_lshlrev_b32 v98, 16, v100
    v_and_b32 v99, s54, v100
    v_pk_mul_f32 v[98:99], v[98:99], v[96:97] op_sel_hi:[1,0]
    v_cvt_pk_bf16_f32 v46, v98, v99
    v_cvt_pk_bf16_f32 v100, v22, v23
    v_lshlrev_b32 v98, 16, v100
    v_and_b32 v99, s54, v100
    v_pk_mul_f32 v[98:99], v[98:99], v[96:97] op_sel_hi:[1,0]
    v_cvt_pk_bf16_f32 v47, v98, v99
    ds_write_b128 v10, v[44:47] offset:2048
    v_mfma_f32_16x16x32_bf16 v[24:27], v[40:43], v[76:79], 0
    v_mfma_f32_16x16x32_bf16 v[16:19], v[32:35], v[76:79], 0
    v_mfma_f32_16x16x32_bf16 v[20:23], v[36:39], v[76:79], 0
    s_nop 3
    v_cvt_pk_bf16_f32 v96, v24, v24
    v_lshlrev_b32 v96, 16, v96
    v_add_f32 v96, s52, v96
    v_cvt_pk_bf16_f32 v96, v96, v96
    v_lshlrev_b32 v96, 16, v96
    v_rcp_f32 v96, v96
    v_cvt_pk_bf16_f32 v100, v16, v17
    v_lshlrev_b32 v98, 16, v100
    v_and_b32 v99, s54, v100
    v_pk_mul_f32 v[98:99], v[98:99], v[96:97] op_sel_hi:[1,0]
    v_cvt_pk_bf16_f32 v44, v98, v99
    v_cvt_pk_bf16_f32 v100, v18, v19
    v_lshlrev_b32 v98, 16, v100
    v_and_b32 v99, s54, v100
    v_pk_mul_f32 v[98:99], v[98:99], v[96:97] op_sel_hi:[1,0]
    v_cvt_pk_bf16_f32 v45, v98, v99
    v_cvt_pk_bf16_f32 v100, v20, v21
    v_lshlrev_b32 v98, 16, v100
    v_and_b32 v99, s54, v100
    v_pk_mul_f32 v[98:99], v[98:99], v[96:97] op_sel_hi:[1,0]
    v_cvt_pk_bf16_f32 v46, v98, v99
    v_cvt_pk_bf16_f32 v100, v22, v23
    v_lshlrev_b32 v98, 16, v100
    v_and_b32 v99, s54, v100
    v_pk_mul_f32 v[98:99], v[98:99], v[96:97] op_sel_hi:[1,0]
    v_cvt_pk_bf16_f32 v47, v98, v99
    ds_write_b128 v10, v[44:47] offset:3072
    s_waitcnt vmcnt(16)
    v_cvt_pk_bf16_f32 v32, v160, v161
    v_cvt_pk_bf16_f32 v33, v162, v163
    v_cvt_pk_bf16_f32 v34, v168, v169
    v_cvt_pk_bf16_f32 v35, v170, v171
    v_and_b32 v34, v7, v34
    v_and_b32 v35, v7, v35
    v_cvt_pk_bf16_f32 v36, v164, v165
    v_cvt_pk_bf16_f32 v37, v166, v167
    v_cvt_pk_bf16_f32 v38, v172, v173
    v_cvt_pk_bf16_f32 v39, v174, v175
    v_and_b32 v38, v7, v38
    v_and_b32 v39, v7, v39
    v_mov_b32_dpp v40, v36 row_newbcast:12 row_mask:0xf bank_mask:0xf
    v_mov_b32_dpp v41, v37 row_newbcast:12 row_mask:0xf bank_mask:0xf
    v_mov_b32_dpp v42, v38 row_newbcast:12 row_mask:0xf bank_mask:0xf
    v_mov_b32_dpp v43, v39 row_newbcast:12 row_mask:0xf bank_mask:0xf
    s_nop 1
    v_mfma_f32_16x16x32_bf16 v[24:27], v[40:43], v[80:83], 0
    v_mfma_f32_16x16x32_bf16 v[16:19], v[32:35], v[80:83], 0
    v_mfma_f32_16x16x32_bf16 v[20:23], v[36:39], v[80:83], 0
    s_nop 3
    v_cvt_pk_bf16_f32 v96, v24, v24
    v_lshlrev_b32 v96, 16, v96
    v_add_f32 v96, s52, v96
    v_cvt_pk_bf16_f32 v96, v96, v96
    v_lshlrev_b32 v96, 16, v96
    v_rcp_f32 v96, v96
    v_cvt_pk_bf16_f32 v100, v16, v17
    v_lshlrev_b32 v98, 16, v100
    v_and_b32 v99, s54, v100
    v_pk_mul_f32 v[98:99], v[98:99], v[96:97] op_sel_hi:[1,0]
    v_cvt_pk_bf16_f32 v44, v98, v99
    v_cvt_pk_bf16_f32 v100, v18, v19
    v_lshlrev_b32 v98, 16, v100
    v_and_b32 v99, s54, v100
    v_pk_mul_f32 v[98:99], v[98:99], v[96:97] op_sel_hi:[1,0]
    v_cvt_pk_bf16_f32 v45, v98, v99
    v_cvt_pk_bf16_f32 v100, v20, v21
    v_lshlrev_b32 v98, 16, v100
    v_and_b32 v99, s54, v100
    v_pk_mul_f32 v[98:99], v[98:99], v[96:97] op_sel_hi:[1,0]
    v_cvt_pk_bf16_f32 v46, v98, v99
    v_cvt_pk_bf16_f32 v100, v22, v23
    v_lshlrev_b32 v98, 16, v100
    v_and_b32 v99, s54, v100
    v_pk_mul_f32 v[98:99], v[98:99], v[96:97] op_sel_hi:[1,0]
    v_cvt_pk_bf16_f32 v47, v98, v99
    ds_write_b128 v10, v[44:47] offset:4096
    v_mfma_f32_16x16x32_bf16 v[24:27], v[40:43], v[84:87], 0
    v_mfma_f32_16x16x32_bf16 v[16:19], v[32:35], v[84:87], 0
    v_mfma_f32_16x16x32_bf16 v[20:23], v[36:39], v[84:87], 0
    s_nop 3
    v_cvt_pk_bf16_f32 v96, v24, v24
    v_lshlrev_b32 v96, 16, v96
    v_add_f32 v96, s52, v96
    v_cvt_pk_bf16_f32 v96, v96, v96
    v_lshlrev_b32 v96, 16, v96
    v_rcp_f32 v96, v96
    v_cvt_pk_bf16_f32 v100, v16, v17
    v_lshlrev_b32 v98, 16, v100
    v_and_b32 v99, s54, v100
    v_pk_mul_f32 v[98:99], v[98:99], v[96:97] op_sel_hi:[1,0]
    v_cvt_pk_bf16_f32 v44, v98, v99
    v_cvt_pk_bf16_f32 v100, v18, v19
    v_lshlrev_b32 v98, 16, v100
    v_and_b32 v99, s54, v100
    v_pk_mul_f32 v[98:99], v[98:99], v[96:97] op_sel_hi:[1,0]
    v_cvt_pk_bf16_f32 v45, v98, v99
    v_cvt_pk_bf16_f32 v100, v20, v21
    v_lshlrev_b32 v98, 16, v100
    v_and_b32 v99, s54, v100
    v_pk_mul_f32 v[98:99], v[98:99], v[96:97] op_sel_hi:[1,0]
    v_cvt_pk_bf16_f32 v46, v98, v99
    v_cvt_pk_bf16_f32 v100, v22, v23
    v_lshlrev_b32 v98, 16, v100
    v_and_b32 v99, s54, v100
    v_pk_mul_f32 v[98:99], v[98:99], v[96:97] op_sel_hi:[1,0]
    v_cvt_pk_bf16_f32 v47, v98, v99
    ds_write_b128 v10, v[44:47] offset:5120
    s_waitcnt vmcnt(0)
    v_cvt_pk_bf16_f32 v32, v176, v177
    v_cvt_pk_bf16_f32 v33, v178, v179
    v_cvt_pk_bf16_f32 v34, v184, v185
    v_cvt_pk_bf16_f32 v35, v186, v187
    v_and_b32 v34, v7, v34
    v_and_b32 v35, v7, v35
    v_cvt_pk_bf16_f32 v36, v180, v181
    v_cvt_pk_bf16_f32 v37, v182, v183
    v_cvt_pk_bf16_f32 v38, v188, v189
    v_cvt_pk_bf16_f32 v39, v190, v191
    v_and_b32 v38, v7, v38
    v_and_b32 v39, v7, v39
    v_mov_b32_dpp v40, v36 row_newbcast:12 row_mask:0xf bank_mask:0xf
    v_mov_b32_dpp v41, v37 row_newbcast:12 row_mask:0xf bank_mask:0xf
    v_mov_b32_dpp v42, v38 row_newbcast:12 row_mask:0xf bank_mask:0xf
    v_mov_b32_dpp v43, v39 row_newbcast:12 row_mask:0xf bank_mask:0xf
    s_nop 1
    v_mfma_f32_16x16x32_bf16 v[24:27], v[40:43], v[88:91], 0
    v_mfma_f32_16x16x32_bf16 v[16:19], v[32:35], v[88:91], 0
    v_mfma_f32_16x16x32_bf16 v[20:23], v[36:39], v[88:91], 0
    s_nop 3
    v_cvt_pk_bf16_f32 v96, v24, v24
    v_lshlrev_b32 v96, 16, v96
    v_add_f32 v96, s52, v96
    v_cvt_pk_bf16_f32 v96, v96, v96
    v_lshlrev_b32 v96, 16, v96
    v_rcp_f32 v96, v96
    v_cvt_pk_bf16_f32 v100, v16, v17
    v_lshlrev_b32 v98, 16, v100
    v_and_b32 v99, s54, v100
    v_pk_mul_f32 v[98:99], v[98:99], v[96:97] op_sel_hi:[1,0]
    v_cvt_pk_bf16_f32 v44, v98, v99
    v_cvt_pk_bf16_f32 v100, v18, v19
    v_lshlrev_b32 v98, 16, v100
    v_and_b32 v99, s54, v100
    v_pk_mul_f32 v[98:99], v[98:99], v[96:97] op_sel_hi:[1,0]
    v_cvt_pk_bf16_f32 v45, v98, v99
    v_cvt_pk_bf16_f32 v100, v20, v21
    v_lshlrev_b32 v98, 16, v100
    v_and_b32 v99, s54, v100
    v_pk_mul_f32 v[98:99], v[98:99], v[96:97] op_sel_hi:[1,0]
    v_cvt_pk_bf16_f32 v46, v98, v99
    v_cvt_pk_bf16_f32 v100, v22, v23
    v_lshlrev_b32 v98, 16, v100
    v_and_b32 v99, s54, v100
    v_pk_mul_f32 v[98:99], v[98:99], v[96:97] op_sel_hi:[1,0]
    v_cvt_pk_bf16_f32 v47, v98, v99
    ds_write_b128 v10, v[44:47] offset:6144
    v_mfma_f32_16x16x32_bf16 v[24:27], v[40:43], v[92:95], 0
    v_mfma_f32_16x16x32_bf16 v[16:19], v[32:35], v[92:95], 0
    v_mfma_f32_16x16x32_bf16 v[20:23], v[36:39], v[92:95], 0
    s_nop 3
    v_cvt_pk_bf16_f32 v96, v24, v24
    v_lshlrev_b32 v96, 16, v96
    v_add_f32 v96, s52, v96
    v_cvt_pk_bf16_f32 v96, v96, v96
    v_lshlrev_b32 v96, 16, v96
    v_rcp_f32 v96, v96
    v_cvt_pk_bf16_f32 v100, v16, v17
    v_lshlrev_b32 v98, 16, v100
    v_and_b32 v99, s54, v100
    v_pk_mul_f32 v[98:99], v[98:99], v[96:97] op_sel_hi:[1,0]
    v_cvt_pk_bf16_f32 v44, v98, v99
    v_cvt_pk_bf16_f32 v100, v18, v19
    v_lshlrev_b32 v98, 16, v100
    v_and_b32 v99, s54, v100
    v_pk_mul_f32 v[98:99], v[98:99], v[96:97] op_sel_hi:[1,0]
    v_cvt_pk_bf16_f32 v45, v98, v99
    v_cvt_pk_bf16_f32 v100, v20, v21
    v_lshlrev_b32 v98, 16, v100
    v_and_b32 v99, s54, v100
    v_pk_mul_f32 v[98:99], v[98:99], v[96:97] op_sel_hi:[1,0]
    v_cvt_pk_bf16_f32 v46, v98, v99
    v_cvt_pk_bf16_f32 v100, v22, v23
    v_lshlrev_b32 v98, 16, v100
    v_and_b32 v99, s54, v100
    v_pk_mul_f32 v[98:99], v[98:99], v[96:97] op_sel_hi:[1,0]
    v_cvt_pk_bf16_f32 v47, v98, v99
    ds_write_b128 v10, v[44:47] offset:7168
    s_waitcnt lgkmcnt(0)
    s_barrier
    ds_read_b128 a[0:3], v2 offset:0
    ds_read_b128 a[4:7], v2 offset:1024
    ds_read_b128 a[8:11], v2 offset:2048
    ds_read_b128 a[12:15], v2 offset:3072
    ds_read_b128 a[16:19], v2 offset:4096
    ds_read_b128 a[20:23], v2 offset:5120
    ds_read_b128 a[24:27], v2 offset:6144
    ds_read_b128 a[28:31], v2 offset:7168
    s_waitcnt lgkmcnt(0)
    ds_read_b128 a[32:35], v2 offset:8192
    ds_read_b128 a[36:39], v2 offset:9216
    ds_read_b128 a[40:43], v2 offset:10240
    ds_read_b128 a[44:47], v2 offset:11264
    ds_read_b128 a[48:51], v2 offset:12288
    ds_read_b128 a[52:55], v2 offset:13312
    ds_read_b128 a[56:59], v2 offset:14336
    ds_read_b128 a[60:63], v2 offset:15360
    s_waitcnt lgkmcnt(0)
    ds_read_b128 a[64:67], v2 offset:16384
    ds_read_b128 a[68:71], v2 offset:17408
    ds_read_b128 a[72:75], v2 offset:18432
    ds_read_b128 a[76:79], v2 offset:19456
    ds_read_b128 a[80:83], v2 offset:20480
    ds_read_b128 a[84:87], v2 offset:21504
    ds_read_b128 a[88:91], v2 offset:22528
    ds_read_b128 a[92:95], v2 offset:23552
    s_waitcnt lgkmcnt(0)
    ds_read_b128 a[96:99], v2 offset:24576
    ds_read_b128 a[100:103], v2 offset:25600
    ds_read_b128 a[104:107], v2 offset:26624
    ds_read_b128 a[108:111], v2 offset:27648
    ds_read_b128 a[112:115], v2 offset:28672
    ds_read_b128 a[116:119], v2 offset:29696
    ds_read_b128 a[120:123], v2 offset:30720
    ds_read_b128 a[124:127], v2 offset:31744
    s_waitcnt lgkmcnt(0)
    s_mul_i32 s44, s26, 7
    s_mul_i32 s45, s27, 28672
    s_add_u32 s45, s45, 0x1180000
    s_waitcnt vmcnt(63)
    v_mfma_f32_16x16x32_bf16 v[16:19], a[128:131], a[0:3], 0
    v_mfma_f32_16x16x32_bf16 v[20:23], a[128:131], a[4:7], 0
    s_waitcnt vmcnt(63)
    v_mfma_f32_16x16x32_bf16 v[16:19], a[132:135], a[8:11], v[16:19]
    v_mfma_f32_16x16x32_bf16 v[20:23], a[132:135], a[12:15], v[20:23]
    s_waitcnt vmcnt(63)
    v_mfma_f32_16x16x32_bf16 v[16:19], a[136:139], a[16:19], v[16:19]
    v_mfma_f32_16x16x32_bf16 v[20:23], a[136:139], a[20:23], v[20:23]
    s_waitcnt vmcnt(63)
    v_mfma_f32_16x16x32_bf16 v[16:19], a[140:143], a[24:27], v[16:19]
    v_mfma_f32_16x16x32_bf16 v[20:23], a[140:143], a[28:31], v[20:23]
    s_waitcnt vmcnt(63)
    v_mfma_f32_16x16x32_bf16 v[16:19], a[144:147], a[32:35], v[16:19]
    v_mfma_f32_16x16x32_bf16 v[20:23], a[144:147], a[36:39], v[20:23]
    s_waitcnt vmcnt(63)
    v_mfma_f32_16x16x32_bf16 v[16:19], a[148:151], a[40:43], v[16:19]
    v_mfma_f32_16x16x32_bf16 v[20:23], a[148:151], a[44:47], v[20:23]
    s_waitcnt vmcnt(63)
    v_mfma_f32_16x16x32_bf16 v[16:19], a[152:155], a[48:51], v[16:19]
    v_mfma_f32_16x16x32_bf16 v[20:23], a[152:155], a[52:55], v[20:23]
    s_waitcnt vmcnt(63)
    v_mfma_f32_16x16x32_bf16 v[16:19], a[156:159], a[56:59], v[16:19]
    v_mfma_f32_16x16x32_bf16 v[20:23], a[156:159], a[60:63], v[20:23]
    s_waitcnt vmcnt(63)
    v_mfma_f32_16x16x32_bf16 v[16:19], a[160:163], a[64:67], v[16:19]
    v_mfma_f32_16x16x32_bf16 v[20:23], a[160:163], a[68:71], v[20:23]
    s_waitcnt vmcnt(63)
    v_mfma_f32_16x16x32_bf16 v[16:19], a[164:167], a[72:75], v[16:19]
    v_mfma_f32_16x16x32_bf16 v[20:23], a[164:167], a[76:79], v[20:23]
    s_waitcnt vmcnt(63)
    v_mfma_f32_16x16x32_bf16 v[16:19], a[168:171], a[80:83], v[16:19]
    v_mfma_f32_16x16x32_bf16 v[20:23], a[168:171], a[84:87], v[20:23]
    s_waitcnt vmcnt(63)
    v_mfma_f32_16x16x32_bf16 v[16:19], a[172:175], a[88:91], v[16:19]
    v_mfma_f32_16x16x32_bf16 v[20:23], a[172:175], a[92:95], v[20:23]
    s_waitcnt vmcnt(63)
    v_mfma_f32_16x16x32_bf16 v[16:19], a[176:179], a[96:99], v[16:19]
    v_mfma_f32_16x16x32_bf16 v[20:23], a[176:179], a[100:103], v[20:23]
    s_waitcnt vmcnt(63)
    v_mfma_f32_16x16x32_bf16 v[16:19], a[180:183], a[104:107], v[16:19]
    v_mfma_f32_16x16x32_bf16 v[20:23], a[180:183], a[108:111], v[20:23]
    s_waitcnt vmcnt(63)
    v_mfma_f32_16x16x32_bf16 v[16:19], a[184:187], a[112:115], v[16:19]
    v_mfma_f32_16x16x32_bf16 v[20:23], a[184:187], a[116:119], v[20:23]
    s_waitcnt vmcnt(63)
    v_mfma_f32_16x16x32_bf16 v[16:19], a[188:191], a[120:123], v[16:19]
    v_mfma_f32_16x16x32_bf16 v[20:23], a[188:191], a[124:127], v[20:23]
    buffer_load_dwordx4 a[128:131], v2, s[4:7], s41 offen offset:0 sc1
    buffer_load_dwordx4 a[132:135], v2, s[4:7], s41 offen offset:1024 sc1
    buffer_load_dwordx4 a[136:139], v2, s[4:7], s41 offen offset:2048 sc1
    buffer_load_dwordx4 a[140:143], v2, s[4:7], s41 offen offset:3072 sc1
    s_add_u32 s41, s41, 4096
    buffer_load_dwordx4 a[144:147], v2, s[4:7], s41 offen offset:0 sc1
    buffer_load_dwordx4 a[148:151], v2, s[4:7], s41 offen offset:1024 sc1
    buffer_load_dwordx4 a[152:155], v2, s[4:7], s41 offen offset:2048 sc1
    buffer_load_dwordx4 a[156:159], v2, s[4:7], s41 offen offset:3072 sc1
    s_add_u32 s41, s41, 4096
    buffer_load_dwordx4 a[160:163], v2, s[4:7], s41 offen offset:0 sc1
    buffer_load_dwordx4 a[164:167], v2, s[4:7], s41 offen offset:1024 sc1
    buffer_load_dwordx4 a[168:171], v2, s[4:7], s41 offen offset:2048 sc1
    buffer_load_dwordx4 a[172:175], v2, s[4:7], s41 offen offset:3072 sc1
    s_add_u32 s41, s41, 4096
    buffer_load_dwordx4 a[176:179], v2, s[4:7], s41 offen offset:0 sc1
    buffer_load_dwordx4 a[180:183], v2, s[4:7], s41 offen offset:1024 sc1
    buffer_load_dwordx4 a[184:187], v2, s[4:7], s41 offen offset:2048 sc1
    buffer_load_dwordx4 a[188:191], v2, s[4:7], s41 offen offset:3072 sc1
    s_add_u32 s41, s41, 4096
    s_add_u32 s33, s44, 0
    s_lshr_b32 s46, s33, 1
    s_lshl_b32 s46, s46, 10
    s_and_b32 s33, s33, 1
    s_lshl_b32 s33, s33, 3
    s_add_u32 s46, s46, s33
    s_add_u32 s46, s46, s45
    s_add_u32 s47, s46, 14336
    v_cvt_pk_bf16_f32 v100, v16, v17
    v_lshlrev_b32 v98, 16, v100
    v_and_b32 v99, s54, v100
    v_mul_f32 v98, v98, v120
    v_mul_f32 v99, v99, v120
    v_cvt_pk_bf16_f32 v32, v98, v99
    v_cvt_pk_bf16_f32 v100, v18, v19
    v_lshlrev_b32 v98, 16, v100
    v_and_b32 v99, s54, v100
    v_mul_f32 v98, v98, v120
    v_mul_f32 v99, v99, v120
    v_cvt_pk_bf16_f32 v33, v98, v99
    buffer_store_dwordx2 v[32:33], v2, s[4:7], s46 offen sc1
    v_cvt_pk_bf16_f32 v100, v20, v21
    v_lshlrev_b32 v98, 16, v100
    v_and_b32 v99, s54, v100
    v_mul_f32 v98, v98, v121
    v_mul_f32 v99, v99, v121
    v_cvt_pk_bf16_f32 v34, v98, v99
    v_cvt_pk_bf16_f32 v100, v22, v23
    v_lshlrev_b32 v98, 16, v100
    v_and_b32 v99, s54, v100
    v_mul_f32 v98, v98, v121
    v_mul_f32 v99, v99, v121
    v_cvt_pk_bf16_f32 v35, v98, v99
    buffer_store_dwordx2 v[34:35], v2, s[4:7], s47 offen sc1
    s_waitcnt vmcnt(63)
    v_mfma_f32_16x16x32_bf16 v[16:19], a[192:195], a[0:3], 0
    v_mfma_f32_16x16x32_bf16 v[20:23], a[192:195], a[4:7], 0
    s_waitcnt vmcnt(63)
    v_mfma_f32_16x16x32_bf16 v[16:19], a[196:199], a[8:11], v[16:19]
    v_mfma_f32_16x16x32_bf16 v[20:23], a[196:199], a[12:15], v[20:23]
    s_waitcnt vmcnt(63)
    v_mfma_f32_16x16x32_bf16 v[16:19], a[200:203], a[16:19], v[16:19]
    v_mfma_f32_16x16x32_bf16 v[20:23], a[200:203], a[20:23], v[20:23]
    s_waitcnt vmcnt(63)
    v_mfma_f32_16x16x32_bf16 v[16:19], a[204:207], a[24:27], v[16:19]
    v_mfma_f32_16x16x32_bf16 v[20:23], a[204:207], a[28:31], v[20:23]
    s_waitcnt vmcnt(63)
    v_mfma_f32_16x16x32_bf16 v[16:19], a[208:211], a[32:35], v[16:19]
    v_mfma_f32_16x16x32_bf16 v[20:23], a[208:211], a[36:39], v[20:23]
    s_waitcnt vmcnt(63)
    v_mfma_f32_16x16x32_bf16 v[16:19], a[212:215], a[40:43], v[16:19]
    v_mfma_f32_16x16x32_bf16 v[20:23], a[212:215], a[44:47], v[20:23]
    s_waitcnt vmcnt(63)
    v_mfma_f32_16x16x32_bf16 v[16:19], a[216:219], a[48:51], v[16:19]
    v_mfma_f32_16x16x32_bf16 v[20:23], a[216:219], a[52:55], v[20:23]
    s_waitcnt vmcnt(63)
    v_mfma_f32_16x16x32_bf16 v[16:19], a[220:223], a[56:59], v[16:19]
    v_mfma_f32_16x16x32_bf16 v[20:23], a[220:223], a[60:63], v[20:23]
    s_waitcnt vmcnt(63)
    v_mfma_f32_16x16x32_bf16 v[16:19], a[224:227], a[64:67], v[16:19]
    v_mfma_f32_16x16x32_bf16 v[20:23], a[224:227], a[68:71], v[20:23]
    s_waitcnt vmcnt(63)
    v_mfma_f32_16x16x32_bf16 v[16:19], a[228:231], a[72:75], v[16:19]
    v_mfma_f32_16x16x32_bf16 v[20:23], a[228:231], a[76:79], v[20:23]
    s_waitcnt vmcnt(63)
    v_mfma_f32_16x16x32_bf16 v[16:19], a[232:235], a[80:83], v[16:19]
    v_mfma_f32_16x16x32_bf16 v[20:23], a[232:235], a[84:87], v[20:23]
    s_waitcnt vmcnt(63)
    v_mfma_f32_16x16x32_bf16 v[16:19], a[236:239], a[88:91], v[16:19]
    v_mfma_f32_16x16x32_bf16 v[20:23], a[236:239], a[92:95], v[20:23]
    s_waitcnt vmcnt(63)
    v_mfma_f32_16x16x32_bf16 v[16:19], a[240:243], a[96:99], v[16:19]
    v_mfma_f32_16x16x32_bf16 v[20:23], a[240:243], a[100:103], v[20:23]
    s_waitcnt vmcnt(63)
    v_mfma_f32_16x16x32_bf16 v[16:19], a[244:247], a[104:107], v[16:19]
    v_mfma_f32_16x16x32_bf16 v[20:23], a[244:247], a[108:111], v[20:23]
    s_waitcnt vmcnt(63)
    v_mfma_f32_16x16x32_bf16 v[16:19], a[248:251], a[112:115], v[16:19]
    v_mfma_f32_16x16x32_bf16 v[20:23], a[248:251], a[116:119], v[20:23]
    s_waitcnt vmcnt(63)
    v_mfma_f32_16x16x32_bf16 v[16:19], a[252:255], a[120:123], v[16:19]
    v_mfma_f32_16x16x32_bf16 v[20:23], a[252:255], a[124:127], v[20:23]
    buffer_load_dwordx4 a[192:195], v2, s[4:7], s41 offen offset:0 sc1
    buffer_load_dwordx4 a[196:199], v2, s[4:7], s41 offen offset:1024 sc1
    buffer_load_dwordx4 a[200:203], v2, s[4:7], s41 offen offset:2048 sc1
    buffer_load_dwordx4 a[204:207], v2, s[4:7], s41 offen offset:3072 sc1
    s_add_u32 s41, s41, 4096
    buffer_load_dwordx4 a[208:211], v2, s[4:7], s41 offen offset:0 sc1
    buffer_load_dwordx4 a[212:215], v2, s[4:7], s41 offen offset:1024 sc1
    buffer_load_dwordx4 a[216:219], v2, s[4:7], s41 offen offset:2048 sc1
    buffer_load_dwordx4 a[220:223], v2, s[4:7], s41 offen offset:3072 sc1
    s_add_u32 s41, s41, 4096
    buffer_load_dwordx4 a[224:227], v2, s[4:7], s41 offen offset:0 sc1
    buffer_load_dwordx4 a[228:231], v2, s[4:7], s41 offen offset:1024 sc1
    buffer_load_dwordx4 a[232:235], v2, s[4:7], s41 offen offset:2048 sc1
    buffer_load_dwordx4 a[236:239], v2, s[4:7], s41 offen offset:3072 sc1
    s_add_u32 s41, s41, 4096
    buffer_load_dwordx4 a[240:243], v2, s[4:7], s41 offen offset:0 sc1
    buffer_load_dwordx4 a[244:247], v2, s[4:7], s41 offen offset:1024 sc1
    buffer_load_dwordx4 a[248:251], v2, s[4:7], s41 offen offset:2048 sc1
    buffer_load_dwordx4 a[252:255], v2, s[4:7], s41 offen offset:3072 sc1
    s_add_u32 s41, s41, 4096
    s_add_u32 s33, s44, 1
    s_lshr_b32 s46, s33, 1
    s_lshl_b32 s46, s46, 10
    s_and_b32 s33, s33, 1
    s_lshl_b32 s33, s33, 3
    s_add_u32 s46, s46, s33
    s_add_u32 s46, s46, s45
    s_add_u32 s47, s46, 14336
    v_cvt_pk_bf16_f32 v100, v16, v17
    v_lshlrev_b32 v98, 16, v100
    v_and_b32 v99, s54, v100
    v_mul_f32 v98, v98, v120
    v_mul_f32 v99, v99, v120
    v_cvt_pk_bf16_f32 v36, v98, v99
    v_cvt_pk_bf16_f32 v100, v18, v19
    v_lshlrev_b32 v98, 16, v100
    v_and_b32 v99, s54, v100
    v_mul_f32 v98, v98, v120
    v_mul_f32 v99, v99, v120
    v_cvt_pk_bf16_f32 v37, v98, v99
    buffer_store_dwordx2 v[36:37], v2, s[4:7], s46 offen sc1
    v_cvt_pk_bf16_f32 v100, v20, v21
    v_lshlrev_b32 v98, 16, v100
    v_and_b32 v99, s54, v100
    v_mul_f32 v98, v98, v121
    v_mul_f32 v99, v99, v121
    v_cvt_pk_bf16_f32 v38, v98, v99
    v_cvt_pk_bf16_f32 v100, v22, v23
    v_lshlrev_b32 v98, 16, v100
    v_and_b32 v99, s54, v100
    v_mul_f32 v98, v98, v121
    v_mul_f32 v99, v99, v121
    v_cvt_pk_bf16_f32 v39, v98, v99
    buffer_store_dwordx2 v[38:39], v2, s[4:7], s47 offen sc1
    s_waitcnt vmcnt(63)
    v_mfma_f32_16x16x32_bf16 v[16:19], v[192:195], a[0:3], 0
    v_mfma_f32_16x16x32_bf16 v[20:23], v[192:195], a[4:7], 0
    s_waitcnt vmcnt(63)
    v_mfma_f32_16x16x32_bf16 v[16:19], v[196:199], a[8:11], v[16:19]
    v_mfma_f32_16x16x32_bf16 v[20:23], v[196:199], a[12:15], v[20:23]
    s_waitcnt vmcnt(63)
    v_mfma_f32_16x16x32_bf16 v[16:19], v[200:203], a[16:19], v[16:19]
    v_mfma_f32_16x16x32_bf16 v[20:23], v[200:203], a[20:23], v[20:23]
    s_waitcnt vmcnt(63)
    v_mfma_f32_16x16x32_bf16 v[16:19], v[204:207], a[24:27], v[16:19]
    v_mfma_f32_16x16x32_bf16 v[20:23], v[204:207], a[28:31], v[20:23]
    s_waitcnt vmcnt(63)
    v_mfma_f32_16x16x32_bf16 v[16:19], v[208:211], a[32:35], v[16:19]
    v_mfma_f32_16x16x32_bf16 v[20:23], v[208:211], a[36:39], v[20:23]
    s_waitcnt vmcnt(63)
    v_mfma_f32_16x16x32_bf16 v[16:19], v[212:215], a[40:43], v[16:19]
    v_mfma_f32_16x16x32_bf16 v[20:23], v[212:215], a[44:47], v[20:23]
    s_waitcnt vmcnt(63)
    v_mfma_f32_16x16x32_bf16 v[16:19], v[216:219], a[48:51], v[16:19]
    v_mfma_f32_16x16x32_bf16 v[20:23], v[216:219], a[52:55], v[20:23]
    s_waitcnt vmcnt(63)
    v_mfma_f32_16x16x32_bf16 v[16:19], v[220:223], a[56:59], v[16:19]
    v_mfma_f32_16x16x32_bf16 v[20:23], v[220:223], a[60:63], v[20:23]
    s_waitcnt vmcnt(63)
    v_mfma_f32_16x16x32_bf16 v[16:19], v[224:227], a[64:67], v[16:19]
    v_mfma_f32_16x16x32_bf16 v[20:23], v[224:227], a[68:71], v[20:23]
    s_waitcnt vmcnt(63)
    v_mfma_f32_16x16x32_bf16 v[16:19], v[228:231], a[72:75], v[16:19]
    v_mfma_f32_16x16x32_bf16 v[20:23], v[228:231], a[76:79], v[20:23]
    s_waitcnt vmcnt(63)
    v_mfma_f32_16x16x32_bf16 v[16:19], v[232:235], a[80:83], v[16:19]
    v_mfma_f32_16x16x32_bf16 v[20:23], v[232:235], a[84:87], v[20:23]
    s_waitcnt vmcnt(63)
    v_mfma_f32_16x16x32_bf16 v[16:19], v[236:239], a[88:91], v[16:19]
    v_mfma_f32_16x16x32_bf16 v[20:23], v[236:239], a[92:95], v[20:23]
    s_waitcnt vmcnt(63)
    v_mfma_f32_16x16x32_bf16 v[16:19], v[240:243], a[96:99], v[16:19]
    v_mfma_f32_16x16x32_bf16 v[20:23], v[240:243], a[100:103], v[20:23]
    s_waitcnt vmcnt(63)
    v_mfma_f32_16x16x32_bf16 v[16:19], v[244:247], a[104:107], v[16:19]
    v_mfma_f32_16x16x32_bf16 v[20:23], v[244:247], a[108:111], v[20:23]
    s_waitcnt vmcnt(63)
    v_mfma_f32_16x16x32_bf16 v[16:19], v[248:251], a[112:115], v[16:19]
    v_mfma_f32_16x16x32_bf16 v[20:23], v[248:251], a[116:119], v[20:23]
    s_waitcnt vmcnt(63)
    v_mfma_f32_16x16x32_bf16 v[16:19], v[252:255], a[120:123], v[16:19]
    v_mfma_f32_16x16x32_bf16 v[20:23], v[252:255], a[124:127], v[20:23]
    buffer_load_dwordx4 v[192:195], v2, s[4:7], s41 offen offset:0 sc1
    buffer_load_dwordx4 v[196:199], v2, s[4:7], s41 offen offset:1024 sc1
    buffer_load_dwordx4 v[200:203], v2, s[4:7], s41 offen offset:2048 sc1
    buffer_load_dwordx4 v[204:207], v2, s[4:7], s41 offen offset:3072 sc1
    s_add_u32 s41, s41, 4096
    buffer_load_dwordx4 v[208:211], v2, s[4:7], s41 offen offset:0 sc1
    buffer_load_dwordx4 v[212:215], v2, s[4:7], s41 offen offset:1024 sc1
    buffer_load_dwordx4 v[216:219], v2, s[4:7], s41 offen offset:2048 sc1
    buffer_load_dwordx4 v[220:223], v2, s[4:7], s41 offen offset:3072 sc1
    s_add_u32 s41, s41, 4096
    buffer_load_dwordx4 v[224:227], v2, s[4:7], s41 offen offset:0 sc1
    buffer_load_dwordx4 v[228:231], v2, s[4:7], s41 offen offset:1024 sc1
    buffer_load_dwordx4 v[232:235], v2, s[4:7], s41 offen offset:2048 sc1
    buffer_load_dwordx4 v[236:239], v2, s[4:7], s41 offen offset:3072 sc1
    s_add_u32 s41, s41, 4096
    buffer_load_dwordx4 v[240:243], v2, s[4:7], s41 offen offset:0 sc1
    buffer_load_dwordx4 v[244:247], v2, s[4:7], s41 offen offset:1024 sc1
    buffer_load_dwordx4 v[248:251], v2, s[4:7], s41 offen offset:2048 sc1
    buffer_load_dwordx4 v[252:255], v2, s[4:7], s41 offen offset:3072 sc1
    s_add_u32 s41, s41, 4096
    s_add_u32 s33, s44, 2
    s_lshr_b32 s46, s33, 1
    s_lshl_b32 s46, s46, 10
    s_and_b32 s33, s33, 1
    s_lshl_b32 s33, s33, 3
    s_add_u32 s46, s46, s33
    s_add_u32 s46, s46, s45
    s_add_u32 s47, s46, 14336
    v_cvt_pk_bf16_f32 v100, v16, v17
    v_lshlrev_b32 v98, 16, v100
    v_and_b32 v99, s54, v100
    v_mul_f32 v98, v98, v120
    v_mul_f32 v99, v99, v120
    v_cvt_pk_bf16_f32 v32, v98, v99
    v_cvt_pk_bf16_f32 v100, v18, v19
    v_lshlrev_b32 v98, 16, v100
    v_and_b32 v99, s54, v100
    v_mul_f32 v98, v98, v120
    v_mul_f32 v99, v99, v120
    v_cvt_pk_bf16_f32 v33, v98, v99
    buffer_store_dwordx2 v[32:33], v2, s[4:7], s46 offen sc1
    v_cvt_pk_bf16_f32 v100, v20, v21
    v_lshlrev_b32 v98, 16, v100
    v_and_b32 v99, s54, v100
    v_mul_f32 v98, v98, v121
    v_mul_f32 v99, v99, v121
    v_cvt_pk_bf16_f32 v34, v98, v99
    v_cvt_pk_bf16_f32 v100, v22, v23
    v_lshlrev_b32 v98, 16, v100
    v_and_b32 v99, s54, v100
    v_mul_f32 v98, v98, v121
    v_mul_f32 v99, v99, v121
    v_cvt_pk_bf16_f32 v35, v98, v99
    buffer_store_dwordx2 v[34:35], v2, s[4:7], s47 offen sc1
    s_waitcnt vmcnt(53)
    v_mfma_f32_16x16x32_bf16 v[16:19], a[128:131], a[0:3], 0
    v_mfma_f32_16x16x32_bf16 v[20:23], a[128:131], a[4:7], 0
    s_waitcnt vmcnt(52)
    v_mfma_f32_16x16x32_bf16 v[16:19], a[132:135], a[8:11], v[16:19]
    v_mfma_f32_16x16x32_bf16 v[20:23], a[132:135], a[12:15], v[20:23]
    s_waitcnt vmcnt(51)
    v_mfma_f32_16x16x32_bf16 v[16:19], a[136:139], a[16:19], v[16:19]
    v_mfma_f32_16x16x32_bf16 v[20:23], a[136:139], a[20:23], v[20:23]
    s_waitcnt vmcnt(50)
    v_mfma_f32_16x16x32_bf16 v[16:19], a[140:143], a[24:27], v[16:19]
    v_mfma_f32_16x16x32_bf16 v[20:23], a[140:143], a[28:31], v[20:23]
    s_waitcnt vmcnt(49)
    v_mfma_f32_16x16x32_bf16 v[16:19], a[144:147], a[32:35], v[16:19]
    v_mfma_f32_16x16x32_bf16 v[20:23], a[144:147], a[36:39], v[20:23]
    s_waitcnt vmcnt(48)
    v_mfma_f32_16x16x32_bf16 v[16:19], a[148:151], a[40:43], v[16:19]
    v_mfma_f32_16x16x32_bf16 v[20:23], a[148:151], a[44:47], v[20:23]
    s_waitcnt vmcnt(47)
    v_mfma_f32_16x16x32_bf16 v[16:19], a[152:155], a[48:51], v[16:19]
    v_mfma_f32_16x16x32_bf16 v[20:23], a[152:155], a[52:55], v[20:23]
    s_waitcnt vmcnt(46)
    v_mfma_f32_16x16x32_bf16 v[16:19], a[156:159], a[56:59], v[16:19]
    v_mfma_f32_16x16x32_bf16 v[20:23], a[156:159], a[60:63], v[20:23]
    s_waitcnt vmcnt(45)
    v_mfma_f32_16x16x32_bf16 v[16:19], a[160:163], a[64:67], v[16:19]
    v_mfma_f32_16x16x32_bf16 v[20:23], a[160:163], a[68:71], v[20:23]
    s_waitcnt vmcnt(44)
    v_mfma_f32_16x16x32_bf16 v[16:19], a[164:167], a[72:75], v[16:19]
    v_mfma_f32_16x16x32_bf16 v[20:23], a[164:167], a[76:79], v[20:23]
    s_waitcnt vmcnt(43)
    v_mfma_f32_16x16x32_bf16 v[16:19], a[168:171], a[80:83], v[16:19]
    v_mfma_f32_16x16x32_bf16 v[20:23], a[168:171], a[84:87], v[20:23]
    s_waitcnt vmcnt(42)
    v_mfma_f32_16x16x32_bf16 v[16:19], a[172:175], a[88:91], v[16:19]
    v_mfma_f32_16x16x32_bf16 v[20:23], a[172:175], a[92:95], v[20:23]
    s_waitcnt vmcnt(41)
    v_mfma_f32_16x16x32_bf16 v[16:19], a[176:179], a[96:99], v[16:19]
    v_mfma_f32_16x16x32_bf16 v[20:23], a[176:179], a[100:103], v[20:23]
    s_waitcnt vmcnt(40)
    v_mfma_f32_16x16x32_bf16 v[16:19], a[180:183], a[104:107], v[16:19]
    v_mfma_f32_16x16x32_bf16 v[20:23], a[180:183], a[108:111], v[20:23]
    s_waitcnt vmcnt(39)
    v_mfma_f32_16x16x32_bf16 v[16:19], a[184:187], a[112:115], v[16:19]
    v_mfma_f32_16x16x32_bf16 v[20:23], a[184:187], a[116:119], v[20:23]
    s_waitcnt vmcnt(38)
    v_mfma_f32_16x16x32_bf16 v[16:19], a[188:191], a[120:123], v[16:19]
    v_mfma_f32_16x16x32_bf16 v[20:23], a[188:191], a[124:127], v[20:23]
    buffer_load_dwordx4 a[128:131], v2, s[4:7], s41 offen offset:0 sc1
    buffer_load_dwordx4 a[132:135], v2, s[4:7], s41 offen offset:1024 sc1
    buffer_load_dwordx4 a[136:139], v2, s[4:7], s41 offen offset:2048 sc1
    buffer_load_dwordx4 a[140:143], v2, s[4:7], s41 offen offset:3072 sc1
    s_add_u32 s41, s41, 4096
    buffer_load_dwordx4 a[144:147], v2, s[4:7], s41 offen offset:0 sc1
    buffer_load_dwordx4 a[148:151], v2, s[4:7], s41 offen offset:1024 sc1
    buffer_load_dwordx4 a[152:155], v2, s[4:7], s41 offen offset:2048 sc1
    buffer_load_dwordx4 a[156:159], v2, s[4:7], s41 offen offset:3072 sc1
    s_add_u32 s41, s41, 4096
    buffer_load_dwordx4 a[160:163], v2, s[4:7], s41 offen offset:0 sc1
    buffer_load_dwordx4 a[164:167], v2, s[4:7], s41 offen offset:1024 sc1
    buffer_load_dwordx4 a[168:171], v2, s[4:7], s41 offen offset:2048 sc1
    buffer_load_dwordx4 a[172:175], v2, s[4:7], s41 offen offset:3072 sc1
    s_add_u32 s41, s41, 4096
    buffer_load_dwordx4 a[176:179], v2, s[4:7], s41 offen offset:0 sc1
    buffer_load_dwordx4 a[180:183], v2, s[4:7], s41 offen offset:1024 sc1
    buffer_load_dwordx4 a[184:187], v2, s[4:7], s41 offen offset:2048 sc1
    buffer_load_dwordx4 a[188:191], v2, s[4:7], s41 offen offset:3072 sc1
    s_add_u32 s41, s41, 4096
    s_add_u32 s33, s44, 3
    s_lshr_b32 s46, s33, 1
    s_lshl_b32 s46, s46, 10
    s_and_b32 s33, s33, 1
    s_lshl_b32 s33, s33, 3
    s_add_u32 s46, s46, s33
    s_add_u32 s46, s46, s45
    s_add_u32 s47, s46, 14336
    v_cvt_pk_bf16_f32 v100, v16, v17
    v_lshlrev_b32 v98, 16, v100
    v_and_b32 v99, s54, v100
    v_mul_f32 v98, v98, v120
    v_mul_f32 v99, v99, v120
    v_cvt_pk_bf16_f32 v36, v98, v99
    v_cvt_pk_bf16_f32 v100, v18, v19
    v_lshlrev_b32 v98, 16, v100
    v_and_b32 v99, s54, v100
    v_mul_f32 v98, v98, v120
    v_mul_f32 v99, v99, v120
    v_cvt_pk_bf16_f32 v37, v98, v99
    buffer_store_dwordx2 v[36:37], v2, s[4:7], s46 offen sc1
    v_cvt_pk_bf16_f32 v100, v20, v21
    v_lshlrev_b32 v98, 16, v100
    v_and_b32 v99, s54, v100
    v_mul_f32 v98, v98, v121
    v_mul_f32 v99, v99, v121
    v_cvt_pk_bf16_f32 v38, v98, v99
    v_cvt_pk_bf16_f32 v100, v22, v23
    v_lshlrev_b32 v98, 16, v100
    v_and_b32 v99, s54, v100
    v_mul_f32 v98, v98, v121
    v_mul_f32 v99, v99, v121
    v_cvt_pk_bf16_f32 v39, v98, v99
    buffer_store_dwordx2 v[38:39], v2, s[4:7], s47 offen sc1
    s_waitcnt vmcnt(53)
    v_mfma_f32_16x16x32_bf16 v[16:19], a[192:195], a[0:3], 0
    v_mfma_f32_16x16x32_bf16 v[20:23], a[192:195], a[4:7], 0
    s_waitcnt vmcnt(52)
    v_mfma_f32_16x16x32_bf16 v[16:19], a[196:199], a[8:11], v[16:19]
    v_mfma_f32_16x16x32_bf16 v[20:23], a[196:199], a[12:15], v[20:23]
    s_waitcnt vmcnt(51)
    v_mfma_f32_16x16x32_bf16 v[16:19], a[200:203], a[16:19], v[16:19]
    v_mfma_f32_16x16x32_bf16 v[20:23], a[200:203], a[20:23], v[20:23]
    s_waitcnt vmcnt(50)
    v_mfma_f32_16x16x32_bf16 v[16:19], a[204:207], a[24:27], v[16:19]
    v_mfma_f32_16x16x32_bf16 v[20:23], a[204:207], a[28:31], v[20:23]
    s_waitcnt vmcnt(49)
    v_mfma_f32_16x16x32_bf16 v[16:19], a[208:211], a[32:35], v[16:19]
    v_mfma_f32_16x16x32_bf16 v[20:23], a[208:211], a[36:39], v[20:23]
    s_waitcnt vmcnt(48)
    v_mfma_f32_16x16x32_bf16 v[16:19], a[212:215], a[40:43], v[16:19]
    v_mfma_f32_16x16x32_bf16 v[20:23], a[212:215], a[44:47], v[20:23]
    s_waitcnt vmcnt(47)
    v_mfma_f32_16x16x32_bf16 v[16:19], a[216:219], a[48:51], v[16:19]
    v_mfma_f32_16x16x32_bf16 v[20:23], a[216:219], a[52:55], v[20:23]
    s_waitcnt vmcnt(46)
    v_mfma_f32_16x16x32_bf16 v[16:19], a[220:223], a[56:59], v[16:19]
    v_mfma_f32_16x16x32_bf16 v[20:23], a[220:223], a[60:63], v[20:23]
    s_waitcnt vmcnt(45)
    v_mfma_f32_16x16x32_bf16 v[16:19], a[224:227], a[64:67], v[16:19]
    v_mfma_f32_16x16x32_bf16 v[20:23], a[224:227], a[68:71], v[20:23]
    s_waitcnt vmcnt(44)
    v_mfma_f32_16x16x32_bf16 v[16:19], a[228:231], a[72:75], v[16:19]
    v_mfma_f32_16x16x32_bf16 v[20:23], a[228:231], a[76:79], v[20:23]
    s_waitcnt vmcnt(43)
    v_mfma_f32_16x16x32_bf16 v[16:19], a[232:235], a[80:83], v[16:19]
    v_mfma_f32_16x16x32_bf16 v[20:23], a[232:235], a[84:87], v[20:23]
    s_waitcnt vmcnt(42)
    v_mfma_f32_16x16x32_bf16 v[16:19], a[236:239], a[88:91], v[16:19]
    v_mfma_f32_16x16x32_bf16 v[20:23], a[236:239], a[92:95], v[20:23]
    s_waitcnt vmcnt(41)
    v_mfma_f32_16x16x32_bf16 v[16:19], a[240:243], a[96:99], v[16:19]
    v_mfma_f32_16x16x32_bf16 v[20:23], a[240:243], a[100:103], v[20:23]
    s_waitcnt vmcnt(40)
    v_mfma_f32_16x16x32_bf16 v[16:19], a[244:247], a[104:107], v[16:19]
    v_mfma_f32_16x16x32_bf16 v[20:23], a[244:247], a[108:111], v[20:23]
    s_waitcnt vmcnt(39)
    v_mfma_f32_16x16x32_bf16 v[16:19], a[248:251], a[112:115], v[16:19]
    v_mfma_f32_16x16x32_bf16 v[20:23], a[248:251], a[116:119], v[20:23]
    s_waitcnt vmcnt(38)
    v_mfma_f32_16x16x32_bf16 v[16:19], a[252:255], a[120:123], v[16:19]
    v_mfma_f32_16x16x32_bf16 v[20:23], a[252:255], a[124:127], v[20:23]
    s_add_u32 s33, s44, 4
    s_lshr_b32 s46, s33, 1
    s_lshl_b32 s46, s46, 10
    s_and_b32 s33, s33, 1
    s_lshl_b32 s33, s33, 3
    s_add_u32 s46, s46, s33
    s_add_u32 s46, s46, s45
    s_add_u32 s47, s46, 14336
    v_cvt_pk_bf16_f32 v100, v16, v17
    v_lshlrev_b32 v98, 16, v100
    v_and_b32 v99, s54, v100
    v_mul_f32 v98, v98, v120
    v_mul_f32 v99, v99, v120
    v_cvt_pk_bf16_f32 v32, v98, v99
    v_cvt_pk_bf16_f32 v100, v18, v19
    v_lshlrev_b32 v98, 16, v100
    v_and_b32 v99, s54, v100
    v_mul_f32 v98, v98, v120
    v_mul_f32 v99, v99, v120
    v_cvt_pk_bf16_f32 v33, v98, v99
    buffer_store_dwordx2 v[32:33], v2, s[4:7], s46 offen sc1
    v_cvt_pk_bf16_f32 v100, v20, v21
    v_lshlrev_b32 v98, 16, v100
    v_and_b32 v99, s54, v100
    v_mul_f32 v98, v98, v121
    v_mul_f32 v99, v99, v121
    v_cvt_pk_bf16_f32 v34, v98, v99
    v_cvt_pk_bf16_f32 v100, v22, v23
    v_lshlrev_b32 v98, 16, v100
    v_and_b32 v99, s54, v100
    v_mul_f32 v98, v98, v121
    v_mul_f32 v99, v99, v121
    v_cvt_pk_bf16_f32 v35, v98, v99
    buffer_store_dwordx2 v[34:35], v2, s[4:7], s47 offen sc1
    s_waitcnt vmcnt(37)
    v_mfma_f32_16x16x32_bf16 v[16:19], v[192:195], a[0:3], 0
    v_mfma_f32_16x16x32_bf16 v[20:23], v[192:195], a[4:7], 0
    s_waitcnt vmcnt(36)
    v_mfma_f32_16x16x32_bf16 v[16:19], v[196:199], a[8:11], v[16:19]
    v_mfma_f32_16x16x32_bf16 v[20:23], v[196:199], a[12:15], v[20:23]
    s_waitcnt vmcnt(35)
    v_mfma_f32_16x16x32_bf16 v[16:19], v[200:203], a[16:19], v[16:19]
    v_mfma_f32_16x16x32_bf16 v[20:23], v[200:203], a[20:23], v[20:23]
    s_waitcnt vmcnt(34)
    v_mfma_f32_16x16x32_bf16 v[16:19], v[204:207], a[24:27], v[16:19]
    v_mfma_f32_16x16x32_bf16 v[20:23], v[204:207], a[28:31], v[20:23]
    s_waitcnt vmcnt(33)
    v_mfma_f32_16x16x32_bf16 v[16:19], v[208:211], a[32:35], v[16:19]
    v_mfma_f32_16x16x32_bf16 v[20:23], v[208:211], a[36:39], v[20:23]
    s_waitcnt vmcnt(32)
    v_mfma_f32_16x16x32_bf16 v[16:19], v[212:215], a[40:43], v[16:19]
    v_mfma_f32_16x16x32_bf16 v[20:23], v[212:215], a[44:47], v[20:23]
    s_waitcnt vmcnt(31)
    v_mfma_f32_16x16x32_bf16 v[16:19], v[216:219], a[48:51], v[16:19]
    v_mfma_f32_16x16x32_bf16 v[20:23], v[216:219], a[52:55], v[20:23]
    s_waitcnt vmcnt(30)
    v_mfma_f32_16x16x32_bf16 v[16:19], v[220:223], a[56:59], v[16:19]
    v_mfma_f32_16x16x32_bf16 v[20:23], v[220:223], a[60:63], v[20:23]
    s_waitcnt vmcnt(29)
    v_mfma_f32_16x16x32_bf16 v[16:19], v[224:227], a[64:67], v[16:19]
    v_mfma_f32_16x16x32_bf16 v[20:23], v[224:227], a[68:71], v[20:23]
    s_waitcnt vmcnt(28)
    v_mfma_f32_16x16x32_bf16 v[16:19], v[228:231], a[72:75], v[16:19]
    v_mfma_f32_16x16x32_bf16 v[20:23], v[228:231], a[76:79], v[20:23]
    s_waitcnt vmcnt(27)
    v_mfma_f32_16x16x32_bf16 v[16:19], v[232:235], a[80:83], v[16:19]
    v_mfma_f32_16x16x32_bf16 v[20:23], v[232:235], a[84:87], v[20:23]
    s_waitcnt vmcnt(26)
    v_mfma_f32_16x16x32_bf16 v[16:19], v[236:239], a[88:91], v[16:19]
    v_mfma_f32_16x16x32_bf16 v[20:23], v[236:239], a[92:95], v[20:23]
    s_waitcnt vmcnt(25)
    v_mfma_f32_16x16x32_bf16 v[16:19], v[240:243], a[96:99], v[16:19]
    v_mfma_f32_16x16x32_bf16 v[20:23], v[240:243], a[100:103], v[20:23]
    s_waitcnt vmcnt(24)
    v_mfma_f32_16x16x32_bf16 v[16:19], v[244:247], a[104:107], v[16:19]
    v_mfma_f32_16x16x32_bf16 v[20:23], v[244:247], a[108:111], v[20:23]
    s_waitcnt vmcnt(23)
    v_mfma_f32_16x16x32_bf16 v[16:19], v[248:251], a[112:115], v[16:19]
    v_mfma_f32_16x16x32_bf16 v[20:23], v[248:251], a[116:119], v[20:23]
    s_waitcnt vmcnt(22)
    v_mfma_f32_16x16x32_bf16 v[16:19], v[252:255], a[120:123], v[16:19]
    v_mfma_f32_16x16x32_bf16 v[20:23], v[252:255], a[124:127], v[20:23]
    s_add_u32 s33, s44, 5
    s_lshr_b32 s46, s33, 1
    s_lshl_b32 s46, s46, 10
    s_and_b32 s33, s33, 1
    s_lshl_b32 s33, s33, 3
    s_add_u32 s46, s46, s33
    s_add_u32 s46, s46, s45
    s_add_u32 s47, s46, 14336
    v_cvt_pk_bf16_f32 v100, v16, v17
    v_lshlrev_b32 v98, 16, v100
    v_and_b32 v99, s54, v100
    v_mul_f32 v98, v98, v120
    v_mul_f32 v99, v99, v120
    v_cvt_pk_bf16_f32 v36, v98, v99
    v_cvt_pk_bf16_f32 v100, v18, v19
    v_lshlrev_b32 v98, 16, v100
    v_and_b32 v99, s54, v100
    v_mul_f32 v98, v98, v120
    v_mul_f32 v99, v99, v120
    v_cvt_pk_bf16_f32 v37, v98, v99
    buffer_store_dwordx2 v[36:37], v2, s[4:7], s46 offen sc1
    v_cvt_pk_bf16_f32 v100, v20, v21
    v_lshlrev_b32 v98, 16, v100
    v_and_b32 v99, s54, v100
    v_mul_f32 v98, v98, v121
    v_mul_f32 v99, v99, v121
    v_cvt_pk_bf16_f32 v38, v98, v99
    v_cvt_pk_bf16_f32 v100, v22, v23
    v_lshlrev_b32 v98, 16, v100
    v_and_b32 v99, s54, v100
    v_mul_f32 v98, v98, v121
    v_mul_f32 v99, v99, v121
    v_cvt_pk_bf16_f32 v39, v98, v99
    buffer_store_dwordx2 v[38:39], v2, s[4:7], s47 offen sc1
    s_waitcnt vmcnt(21)
    v_mfma_f32_16x16x32_bf16 v[16:19], a[128:131], a[0:3], 0
    v_mfma_f32_16x16x32_bf16 v[20:23], a[128:131], a[4:7], 0
    s_waitcnt vmcnt(20)
    v_mfma_f32_16x16x32_bf16 v[16:19], a[132:135], a[8:11], v[16:19]
    v_mfma_f32_16x16x32_bf16 v[20:23], a[132:135], a[12:15], v[20:23]
    s_waitcnt vmcnt(19)
    v_mfma_f32_16x16x32_bf16 v[16:19], a[136:139], a[16:19], v[16:19]
    v_mfma_f32_16x16x32_bf16 v[20:23], a[136:139], a[20:23], v[20:23]
    s_waitcnt vmcnt(18)
    v_mfma_f32_16x16x32_bf16 v[16:19], a[140:143], a[24:27], v[16:19]
    v_mfma_f32_16x16x32_bf16 v[20:23], a[140:143], a[28:31], v[20:23]
    s_waitcnt vmcnt(17)
    v_mfma_f32_16x16x32_bf16 v[16:19], a[144:147], a[32:35], v[16:19]
    v_mfma_f32_16x16x32_bf16 v[20:23], a[144:147], a[36:39], v[20:23]
    s_waitcnt vmcnt(16)
    v_mfma_f32_16x16x32_bf16 v[16:19], a[148:151], a[40:43], v[16:19]
    v_mfma_f32_16x16x32_bf16 v[20:23], a[148:151], a[44:47], v[20:23]
    s_waitcnt vmcnt(15)
    v_mfma_f32_16x16x32_bf16 v[16:19], a[152:155], a[48:51], v[16:19]
    v_mfma_f32_16x16x32_bf16 v[20:23], a[152:155], a[52:55], v[20:23]
    s_waitcnt vmcnt(14)
    v_mfma_f32_16x16x32_bf16 v[16:19], a[156:159], a[56:59], v[16:19]
    v_mfma_f32_16x16x32_bf16 v[20:23], a[156:159], a[60:63], v[20:23]
    s_waitcnt vmcnt(13)
    v_mfma_f32_16x16x32_bf16 v[16:19], a[160:163], a[64:67], v[16:19]
    v_mfma_f32_16x16x32_bf16 v[20:23], a[160:163], a[68:71], v[20:23]
    s_waitcnt vmcnt(12)
    v_mfma_f32_16x16x32_bf16 v[16:19], a[164:167], a[72:75], v[16:19]
    v_mfma_f32_16x16x32_bf16 v[20:23], a[164:167], a[76:79], v[20:23]
    s_waitcnt vmcnt(11)
    v_mfma_f32_16x16x32_bf16 v[16:19], a[168:171], a[80:83], v[16:19]
    v_mfma_f32_16x16x32_bf16 v[20:23], a[168:171], a[84:87], v[20:23]
    s_waitcnt vmcnt(10)
    v_mfma_f32_16x16x32_bf16 v[16:19], a[172:175], a[88:91], v[16:19]
    v_mfma_f32_16x16x32_bf16 v[20:23], a[172:175], a[92:95], v[20:23]
    s_waitcnt vmcnt(9)
    v_mfma_f32_16x16x32_bf16 v[16:19], a[176:179], a[96:99], v[16:19]
    v_mfma_f32_16x16x32_bf16 v[20:23], a[176:179], a[100:103], v[20:23]
    s_waitcnt vmcnt(8)
    v_mfma_f32_16x16x32_bf16 v[16:19], a[180:183], a[104:107], v[16:19]
    v_mfma_f32_16x16x32_bf16 v[20:23], a[180:183], a[108:111], v[20:23]
    s_waitcnt vmcnt(7)
    v_mfma_f32_16x16x32_bf16 v[16:19], a[184:187], a[112:115], v[16:19]
    v_mfma_f32_16x16x32_bf16 v[20:23], a[184:187], a[116:119], v[20:23]
    s_waitcnt vmcnt(6)
    v_mfma_f32_16x16x32_bf16 v[16:19], a[188:191], a[120:123], v[16:19]
    v_mfma_f32_16x16x32_bf16 v[20:23], a[188:191], a[124:127], v[20:23]
    s_add_u32 s33, s44, 6
    s_lshr_b32 s46, s33, 1
    s_lshl_b32 s46, s46, 10
    s_and_b32 s33, s33, 1
    s_lshl_b32 s33, s33, 3
    s_add_u32 s46, s46, s33
    s_add_u32 s46, s46, s45
    s_add_u32 s47, s46, 14336
    v_cvt_pk_bf16_f32 v100, v16, v17
    v_lshlrev_b32 v98, 16, v100
    v_and_b32 v99, s54, v100
    v_mul_f32 v98, v98, v120
    v_mul_f32 v99, v99, v120
    v_cvt_pk_bf16_f32 v32, v98, v99
    v_cvt_pk_bf16_f32 v100, v18, v19
    v_lshlrev_b32 v98, 16, v100
    v_and_b32 v99, s54, v100
    v_mul_f32 v98, v98, v120
    v_mul_f32 v99, v99, v120
    v_cvt_pk_bf16_f32 v33, v98, v99
    buffer_store_dwordx2 v[32:33], v2, s[4:7], s46 offen sc1
    v_cvt_pk_bf16_f32 v100, v20, v21
    v_lshlrev_b32 v98, 16, v100
    v_and_b32 v99, s54, v100
    v_mul_f32 v98, v98, v121
    v_mul_f32 v99, v99, v121
    v_cvt_pk_bf16_f32 v34, v98, v99
    v_cvt_pk_bf16_f32 v100, v22, v23
    v_lshlrev_b32 v98, 16, v100
    v_and_b32 v99, s54, v100
    v_mul_f32 v98, v98, v121
    v_mul_f32 v99, v99, v121
    v_cvt_pk_bf16_f32 v35, v98, v99
    buffer_store_dwordx2 v[34:35], v2, s[4:7], s47 offen sc1
    s_lshl_b32 s46, s27, 8
    s_add_u32 s46, s46, 0x11600c0
    v_mov_b32 v96, 1
    s_waitcnt vmcnt(0)
    s_barrier
    buffer_store_dword v96, v9, s[4:7], s46 offen sc1
    s_endpgm
gated_mix__linear_attn_block__memory_aug_recurrent_mem_tr__prompt_kernel_R_F:
    s_cmp_eq_u32 s27, 63
    s_cbranch_scc1 gated_mix__linear_attn_block__memory_aug_recurrent_mem_tr__prompt_kernel_M_end
    s_cmp_lg_u32 s26, 0
    s_cbranch_scc1 gated_mix__linear_attn_block__memory_aug_recurrent_mem_tr__prompt_kernel_RF_iw_b
gated_mix__linear_attn_block__memory_aug_recurrent_mem_tr__prompt_kernel_RF_iw:
    buffer_load_dword v5, off, s[84:87], 0 offset:24 sc1
    s_waitcnt vmcnt(0)
    v_readfirstlane_b32 s33, v5
    s_nop 0
    s_cmp_lg_u32 s33, 0
    s_cbranch_scc1 gated_mix__linear_attn_block__memory_aug_recurrent_mem_tr__prompt_kernel_RF_iw_b
    s_sleep 6
    s_branch gated_mix__linear_attn_block__memory_aug_recurrent_mem_tr__prompt_kernel_RF_iw
gated_mix__linear_attn_block__memory_aug_recurrent_mem_tr__prompt_kernel_RF_iw_b:
    s_barrier
    s_load_dwordx2 s[12:13], s[0:1], 88
    s_mov_b32 s14, 0x1c0000
    s_mov_b32 s15, 0x20000
    s_mul_i32 s28, s27, 37
    s_lshr_b32 s28, s28, 8
    s_mul_i32 s29, s28, 7
    s_sub_u32 s29, s27, s29
    s_lshr_b32 s30, s26, 1
    s_lshl_b32 s31, s29, 1
    s_add_u32 s30, s30, s31
    s_and_b32 s32, s26, 1
    v_lshlrev_b32 v5, 2, v1
    v_lshrrev_b32 v10, 2, v1
    v_lshlrev_b32 v10, 10, v10
    v_and_b32 v11, 3, v1
    v_lshl_add_u32 v10, v11, 2, v10
    v_add_u32 v10, 16384, v10
    v_lshlrev_b32 v6, 2, v4
    v_lshrrev_b32 v7, 2, v4
    v_and_b32 v8, 3, v4
    v_lshl_add_u32 v7, v7, 3, v8
    s_lshl_b32 s33, s32, 2
    v_add_u32 v7, s33, v7
    v_mul_u32_u24 v7, 896, v7
    v_lshl_add_u32 v7, v3, 4, v7
    s_lshl_b32 s33, s30, 6
    v_add_u32 v7, s33, v7
    s_mov_b32 s50, 0x0000ffff
    s_mov_b32 s51, 0x00010000
    s_mov_b32 s52, 0xffff0000
    s_mov_b32 s53, 0
    s_lshl_b32 s56, 3, s31
    s_mov_b32 s57, 0
    s_mov_b32 s40, s28
    s_mov_b32 s54, 0xffff0000
    s_waitcnt lgkmcnt(0)
gated_mix__linear_attn_block__memory_aug_recurrent_mem_tr__prompt_kernel_RF_loop:
    s_lshl_b32 s41, s40, 8
    s_add_u32 s41, s41, 0x1160000
    s_mul_i32 s33, s40, 240
    v_subrev_u32 v11, s33, v10
    v_cmp_gt_u32 vcc, 16, v1
    s_nop 1
    v_cndmask_b32 v11, v5, v11, vcc
    s_cmp_lg_u32 s26, 0
    s_cbranch_scc1 gated_mix__linear_attn_block__memory_aug_recurrent_mem_tr__prompt_kernel_RF_w1_b
gated_mix__linear_attn_block__memory_aug_recurrent_mem_tr__prompt_kernel_RF_w1:
    buffer_load_dword v9, v11, s[4:7], s41 offen sc1
    s_waitcnt vmcnt(0)
    v_cmp_eq_u32 vcc, 0, v9
    s_nop 0
    s_and_b64 vcc, vcc, s[50:51]
    s_cbranch_vccz gated_mix__linear_attn_block__memory_aug_recurrent_mem_tr__prompt_kernel_RF_w1_b
    s_sleep 16
    s_cmp_lt_u32 s40, 60
    s_cbranch_scc0 gated_mix__linear_attn_block__memory_aug_recurrent_mem_tr__prompt_kernel_RF_w1
    s_sleep 30
    s_branch gated_mix__linear_attn_block__memory_aug_recurrent_mem_tr__prompt_kernel_RF_w1
gated_mix__linear_attn_block__memory_aug_recurrent_mem_tr__prompt_kernel_RF_w1_b:
    s_barrier
    s_mul_i32 s42, s40, 448
    s_lshl_b32 s33, s30, 1
    s_add_u32 s42, s42, s33
    s_lshl_b32 s42, s42, 10
    s_add_u32 s42, s42, 0x1ce0000
    buffer_load_dwordx4 v[16:19], v2, s[4:7], s42 offen offset:0 sc1
    buffer_load_dwordx4 v[20:23], v2, s[4:7], s42 offen offset:1024 sc1
    s_add_u32 s42, s42, 28672
    buffer_load_dwordx4 v[24:27], v2, s[4:7], s42 offen offset:0 sc1
    buffer_load_dwordx4 v[28:31], v2, s[4:7], s42 offen offset:1024 sc1
    s_add_u32 s42, s42, 28672
    buffer_load_dwordx4 v[32:35], v2, s[4:7], s42 offen offset:0 sc1
    buffer_load_dwordx4 v[36:39], v2, s[4:7], s42 offen offset:1024 sc1
    s_add_u32 s42, s42, 28672
    buffer_load_dwordx4 v[40:43], v2, s[4:7], s42 offen offset:0 sc1
    buffer_load_dwordx4 v[44:47], v2, s[4:7], s42 offen offset:1024 sc1
    s_add_u32 s42, s42, 28672
    buffer_load_dwordx4 v[48:51], v2, s[4:7], s42 offen offset:0 sc1
    buffer_load_dwordx4 v[52:55], v2, s[4:7], s42 offen offset:1024 sc1
    s_add_u32 s42, s42, 28672
    buffer_load_dwordx4 v[56:59], v2, s[4:7], s42 offen offset:0 sc1
    buffer_load_dwordx4 v[60:63], v2, s[4:7], s42 offen offset:1024 sc1
    s_add_u32 s42, s42, 28672
    buffer_load_dwordx4 v[64:67], v2, s[4:7], s42 offen offset:0 sc1
    buffer_load_dwordx4 v[68:71], v2, s[4:7], s42 offen offset:1024 sc1
    s_add_u32 s42, s42, 28672
    buffer_load_dwordx4 v[72:75], v2, s[4:7], s42 offen offset:0 sc1
    buffer_load_dwordx4 v[76:79], v2, s[4:7], s42 offen offset:1024 sc1
    s_add_u32 s42, s42, 28672
    buffer_load_dwordx4 v[80:83], v2, s[4:7], s42 offen offset:0 sc1
    buffer_load_dwordx4 v[84:87], v2, s[4:7], s42 offen offset:1024 sc1
    s_add_u32 s42, s42, 28672
    buffer_load_dwordx4 v[88:91], v2, s[4:7], s42 offen offset:0 sc1
    buffer_load_dwordx4 v[92:95], v2, s[4:7], s42 offen offset:1024 sc1
    s_add_u32 s42, s42, 28672
    buffer_load_dwordx4 v[96:99], v2, s[4:7], s42 offen offset:0 sc1
    buffer_load_dwordx4 v[100:103], v2, s[4:7], s42 offen offset:1024 sc1
    s_add_u32 s42, s42, 28672
    buffer_load_dwordx4 v[104:107], v2, s[4:7], s42 offen offset:0 sc1
    buffer_load_dwordx4 v[108:111], v2, s[4:7], s42 offen offset:1024 sc1
    s_add_u32 s42, s42, 28672
    buffer_load_dwordx4 v[112:115], v2, s[4:7], s42 offen offset:0 sc1
    buffer_load_dwordx4 v[116:119], v2, s[4:7], s42 offen offset:1024 sc1
    s_add_u32 s42, s42, 28672
    buffer_load_dwordx4 v[120:123], v2, s[4:7], s42 offen offset:0 sc1
    buffer_load_dwordx4 v[124:127], v2, s[4:7], s42 offen offset:1024 sc1
    s_add_u32 s42, s42, 28672
    buffer_load_dwordx4 v[128:131], v2, s[4:7], s42 offen offset:0 sc1
    buffer_load_dwordx4 v[132:135], v2, s[4:7], s42 offen offset:1024 sc1
    s_add_u32 s42, s42, 28672
    buffer_load_dwordx4 v[136:139], v2, s[4:7], s42 offen offset:0 sc1
    buffer_load_dwordx4 v[140:143], v2, s[4:7], s42 offen offset:1024 sc1
    s_lshl_b32 s43, s40, 1
    s_add_u32 s43, s43, s32
    s_lshl_b32 s44, s43, 6
    s_add_u32 s44, s44, 0x1340000
    s_mul_i32 s43, s43, 14
    s_add_u32 s43, s43, s30
    s_lshl_b32 s43, s43, 10
    s_add_u32 s43, s43, 0x1180000
    buffer_load_dwordx4 v[176:179], v2, s[4:7], s43 offen sc1
    buffer_load_dword v180, v6, s[4:7], s44 offen sc1
    s_lshr_b32 s48, s40, 2
    s_lshl_b32 s48, s48, 6
    s_cmp_ge_u32 s40, 60
    s_cselect_b32 s48, 1024, s48
    s_cselect_b32 s53, s56, 0xffff
    s_add_u32 s48, s48, 0x1165f80
    s_sub_u32 s48, s48, s41
    v_add_u32 v11, s48, v5
    v_cmp_gt_u32 vcc, 32, v1
    s_nop 1
    v_cndmask_b32 v11, v11, v5, vcc
    s_cmp_lg_u32 s26, 0
    s_cbranch_scc1 gated_mix__linear_attn_block__memory_aug_recurrent_mem_tr__prompt_kernel_RF_w2_b
gated_mix__linear_attn_block__memory_aug_recurrent_mem_tr__prompt_kernel_RF_w2:
    buffer_load_dword v9, v11, s[4:7], s41 offen sc1
    s_waitcnt vmcnt(0)
    v_cmp_eq_u32 vcc, 0, v9
    s_nop 0
    s_and_b64 vcc, vcc, s[52:53]
    s_cbranch_vccz gated_mix__linear_attn_block__memory_aug_recurrent_mem_tr__prompt_kernel_RF_w2_b
    s_sleep 1
    s_cmp_lt_u32 s40, 60
    s_cbranch_scc0 gated_mix__linear_attn_block__memory_aug_recurrent_mem_tr__prompt_kernel_RF_w2
    s_sleep 30
    s_branch gated_mix__linear_attn_block__memory_aug_recurrent_mem_tr__prompt_kernel_RF_w2
gated_mix__linear_attn_block__memory_aug_recurrent_mem_tr__prompt_kernel_RF_w2_b:
    s_barrier
    s_mul_i32 s45, s40, 40960
    s_lshl_b32 s33, s32, 10
    s_add_u32 s45, s45, s33
    s_add_u32 s45, s45, 0x1360000
    s_mul_i32 s46, s40, 112
    s_lshl_b32 s33, s30, 1
    s_add_u32 s46, s46, s33
    s_lshl_b32 s46, s46, 10
    s_add_u32 s46, s46, 0x15e0000
    buffer_load_dwordx4 a[0:3], v2, s[4:7], s45 offen offset:0 sc1
    buffer_load_dwordx4 a[4:7], v2, s[4:7], s45 offen offset:2048 sc1
    s_add_u32 s45, s45, 4096
    buffer_load_dwordx4 a[8:11], v2, s[4:7], s45 offen offset:0 sc1
    buffer_load_dwordx4 a[12:15], v2, s[4:7], s45 offen offset:2048 sc1
    s_add_u32 s45, s45, 4096
    buffer_load_dwordx4 a[16:19], v2, s[4:7], s45 offen offset:0 sc1
    buffer_load_dwordx4 a[20:23], v2, s[4:7], s45 offen offset:2048 sc1
    s_add_u32 s45, s45, 4096
    buffer_load_dwordx4 a[24:27], v2, s[4:7], s45 offen offset:0 sc1
    buffer_load_dwordx4 a[28:31], v2, s[4:7], s45 offen offset:2048 sc1
    s_add_u32 s45, s45, 4096
    buffer_load_dwordx4 a[32:35], v2, s[4:7], s45 offen offset:0 sc1
    buffer_load_dwordx4 a[36:39], v2, s[4:7], s45 offen offset:2048 sc1
    s_add_u32 s45, s45, 4096
    buffer_load_dwordx4 a[40:43], v2, s[4:7], s45 offen offset:0 sc1
    buffer_load_dwordx4 a[44:47], v2, s[4:7], s45 offen offset:2048 sc1
    s_add_u32 s45, s45, 4096
    buffer_load_dwordx4 a[48:51], v2, s[4:7], s45 offen offset:0 sc1
    buffer_load_dwordx4 a[52:55], v2, s[4:7], s45 offen offset:2048 sc1
    s_add_u32 s45, s45, 4096
    buffer_load_dwordx4 a[56:59], v2, s[4:7], s45 offen offset:0 sc1
    buffer_load_dwordx4 a[60:63], v2, s[4:7], s45 offen offset:2048 sc1
    s_add_u32 s45, s45, 4096
    buffer_load_dwordx4 a[64:67], v2, s[4:7], s45 offen offset:0 sc1
    buffer_load_dwordx4 a[68:71], v2, s[4:7], s45 offen offset:2048 sc1
    s_add_u32 s45, s45, 4096
    buffer_load_dwordx4 a[72:75], v2, s[4:7], s45 offen offset:0 sc1
    buffer_load_dwordx4 a[76:79], v2, s[4:7], s45 offen offset:2048 sc1
    s_add_u32 s45, s45, 4096
    buffer_load_dwordx4 v[144:147], v2, s[4:7], s46 offen offset:0 sc1
    buffer_load_dwordx4 v[148:151], v2, s[4:7], s46 offen offset:1024 sc1
    s_add_u32 s46, s46, 28672
    buffer_load_dwordx4 v[152:155], v2, s[4:7], s46 offen offset:0 sc1
    buffer_load_dwordx4 v[156:159], v2, s[4:7], s46 offen offset:1024 sc1
    s_add_u32 s46, s46, 28672
    buffer_load_dwordx4 v[160:163], v2, s[4:7], s46 offen offset:0 sc1
    buffer_load_dwordx4 v[164:167], v2, s[4:7], s46 offen offset:1024 sc1
    s_add_u32 s46, s46, 28672
    buffer_load_dwordx4 v[168:171], v2, s[4:7], s46 offen offset:0 sc1
    buffer_load_dwordx4 v[172:175], v2, s[4:7], s46 offen offset:1024 sc1
    s_waitcnt vmcnt(27)
    v_mfma_f32_16x16x32_bf16 v[184:187], v[16:19], a[0:3], 0
    v_mfma_f32_16x16x32_bf16 v[188:191], v[20:23], a[0:3], 0
    s_waitcnt vmcnt(26)
    v_mfma_f32_16x16x32_bf16 v[184:187], v[24:27], a[4:7], v[184:187]
    v_mfma_f32_16x16x32_bf16 v[188:191], v[28:31], a[4:7], v[188:191]
    s_waitcnt vmcnt(25)
    v_mfma_f32_16x16x32_bf16 v[184:187], v[32:35], a[8:11], v[184:187]
    v_mfma_f32_16x16x32_bf16 v[188:191], v[36:39], a[8:11], v[188:191]
    s_waitcnt vmcnt(24)
    v_mfma_f32_16x16x32_bf16 v[184:187], v[40:43], a[12:15], v[184:187]
    v_mfma_f32_16x16x32_bf16 v[188:191], v[44:47], a[12:15], v[188:191]
    s_waitcnt vmcnt(23)
    v_mfma_f32_16x16x32_bf16 v[184:187], v[48:51], a[16:19], v[184:187]
    v_mfma_f32_16x16x32_bf16 v[188:191], v[52:55], a[16:19], v[188:191]
    s_waitcnt vmcnt(22)
    v_mfma_f32_16x16x32_bf16 v[184:187], v[56:59], a[20:23], v[184:187]
    v_mfma_f32_16x16x32_bf16 v[188:191], v[60:63], a[20:23], v[188:191]
    s_waitcnt vmcnt(21)
    v_mfma_f32_16x16x32_bf16 v[184:187], v[64:67], a[24:27], v[184:187]
    v_mfma_f32_16x16x32_bf16 v[188:191], v[68:71], a[24:27], v[188:191]
    s_waitcnt vmcnt(20)
    v_mfma_f32_16x16x32_bf16 v[184:187], v[72:75], a[28:31], v[184:187]
    v_mfma_f32_16x16x32_bf16 v[188:191], v[76:79], a[28:31], v[188:191]
    s_waitcnt vmcnt(19)
    v_mfma_f32_16x16x32_bf16 v[184:187], v[80:83], a[32:35], v[184:187]
    v_mfma_f32_16x16x32_bf16 v[188:191], v[84:87], a[32:35], v[188:191]
    s_waitcnt vmcnt(18)
    v_mfma_f32_16x16x32_bf16 v[184:187], v[88:91], a[36:39], v[184:187]
    v_mfma_f32_16x16x32_bf16 v[188:191], v[92:95], a[36:39], v[188:191]
    s_waitcnt vmcnt(17)
    v_mfma_f32_16x16x32_bf16 v[184:187], v[96:99], a[40:43], v[184:187]
    v_mfma_f32_16x16x32_bf16 v[188:191], v[100:103], a[40:43], v[188:191]
    s_waitcnt vmcnt(16)
    v_mfma_f32_16x16x32_bf16 v[184:187], v[104:107], a[44:47], v[184:187]
    v_mfma_f32_16x16x32_bf16 v[188:191], v[108:111], a[44:47], v[188:191]
    s_waitcnt vmcnt(15)
    v_mfma_f32_16x16x32_bf16 v[184:187], v[112:115], a[48:51], v[184:187]
    v_mfma_f32_16x16x32_bf16 v[188:191], v[116:119], a[48:51], v[188:191]
    s_waitcnt vmcnt(14)
    v_mfma_f32_16x16x32_bf16 v[184:187], v[120:123], a[52:55], v[184:187]
    v_mfma_f32_16x16x32_bf16 v[188:191], v[124:127], a[52:55], v[188:191]
    s_waitcnt vmcnt(13)
    v_mfma_f32_16x16x32_bf16 v[184:187], v[128:131], a[56:59], v[184:187]
    v_mfma_f32_16x16x32_bf16 v[188:191], v[132:135], a[56:59], v[188:191]
    s_waitcnt vmcnt(12)
    v_mfma_f32_16x16x32_bf16 v[184:187], v[136:139], a[60:63], v[184:187]
    v_mfma_f32_16x16x32_bf16 v[188:191], v[140:143], a[60:63], v[188:191]
    s_waitcnt vmcnt(0)
    v_mfma_f32_16x16x32_bf16 v[184:187], v[144:147], a[64:67], v[184:187]
    v_mfma_f32_16x16x32_bf16 v[188:191], v[148:151], a[64:67], v[188:191]
    v_mfma_f32_16x16x32_bf16 v[184:187], v[152:155], a[68:71], v[184:187]
    v_mfma_f32_16x16x32_bf16 v[188:191], v[156:159], a[68:71], v[188:191]
    v_mfma_f32_16x16x32_bf16 v[184:187], v[160:163], a[72:75], v[184:187]
    v_mfma_f32_16x16x32_bf16 v[188:191], v[164:167], a[72:75], v[188:191]
    v_mfma_f32_16x16x32_bf16 v[184:187], v[168:171], a[76:79], v[184:187]
    v_mfma_f32_16x16x32_bf16 v[188:191], v[172:175], a[76:79], v[188:191]
    s_mul_i32 s47, s40, 28672
    s_nop 4
    v_cvt_pk_bf16_f32 v192, v184, v185
    v_lshlrev_b32 v194, 16, v192
    v_and_b32 v195, s54, v192
    v_mul_f32 v194, v194, v180
    v_mul_f32 v195, v195, v180
    v_cvt_pk_bf16_f32 v192, v194, v195
    v_lshlrev_b32 v194, 16, v192
    v_and_b32 v195, s54, v192
    v_lshlrev_b32 v196, 16, v176
    v_and_b32 v197, s54, v176
    v_add_f32 v194, v194, v196
    v_add_f32 v195, v195, v197
    v_cvt_pk_bf16_f32 v176, v194, v195
    v_cvt_pk_bf16_f32 v192, v186, v187
    v_lshlrev_b32 v194, 16, v192
    v_and_b32 v195, s54, v192
    v_mul_f32 v194, v194, v180
    v_mul_f32 v195, v195, v180
    v_cvt_pk_bf16_f32 v192, v194, v195
    v_lshlrev_b32 v194, 16, v192
    v_and_b32 v195, s54, v192
    v_lshlrev_b32 v196, 16, v177
    v_and_b32 v197, s54, v177
    v_add_f32 v194, v194, v196
    v_add_f32 v195, v195, v197
    v_cvt_pk_bf16_f32 v177, v194, v195
    v_cvt_pk_bf16_f32 v192, v188, v189
    v_lshlrev_b32 v194, 16, v192
    v_and_b32 v195, s54, v192
    v_mul_f32 v194, v194, v180
    v_mul_f32 v195, v195, v180
    v_cvt_pk_bf16_f32 v192, v194, v195
    v_lshlrev_b32 v194, 16, v192
    v_and_b32 v195, s54, v192
    v_lshlrev_b32 v196, 16, v178
    v_and_b32 v197, s54, v178
    v_add_f32 v194, v194, v196
    v_add_f32 v195, v195, v197
    v_cvt_pk_bf16_f32 v178, v194, v195
    v_cvt_pk_bf16_f32 v192, v190, v191
    v_lshlrev_b32 v194, 16, v192
    v_and_b32 v195, s54, v192
    v_mul_f32 v194, v194, v180
    v_mul_f32 v195, v195, v180
    v_cvt_pk_bf16_f32 v192, v194, v195
    v_lshlrev_b32 v194, 16, v192
    v_and_b32 v195, s54, v192
    v_lshlrev_b32 v196, 16, v179
    v_and_b32 v197, s54, v179
    v_add_f32 v194, v194, v196
    v_add_f32 v195, v195, v197
    v_cvt_pk_bf16_f32 v179, v194, v195
    buffer_store_dwordx4 v[176:179], v7, s[12:15], s47 offen
    s_add_u32 s40, s40, 9
    s_cmp_lt_u32 s40, 64
    s_cbranch_scc1 gated_mix__linear_attn_block__memory_aug_recurrent_mem_tr__prompt_kernel_RF_loop
    s_endpgm
.section .rodata,"a"
.p2align 6
.amdhsa_kernel gated_mix__linear_attn_block__memory_aug_recurrent_mem_tr__prompt_kernel
  .amdhsa_next_free_vgpr 512
  .amdhsa_next_free_sgpr 102
  .amdhsa_accum_offset 256
  .amdhsa_group_segment_fixed_size 0
  .amdhsa_kernarg_size 112
  .amdhsa_user_sgpr_count 2
  .amdhsa_user_sgpr_kernarg_segment_ptr 1
  .amdhsa_system_sgpr_workgroup_id_x 1
.end_amdhsa_kernel
.text
```
